```python
import torch

def _softmax(x, axis=-1):
    return torch.softmax(x, dim=axis)
def _gelu(x):
    return torch.nn.functional.gelu(x, approximate="tanh")
def _silu(x):
    return torch.nn.functional.silu(x)
def _sigmoid(x):
    return torch.sigmoid(x)
def _layernorm(x, axis=-1, eps=1e-5):
    m = x.mean(dim=axis, keepdim=True)
    v = x.var(dim=axis, keepdim=True, unbiased=False)
    return (x - m) / torch.sqrt(v + eps)
def _scatter_add(tgt, idx, src, axis=0):
    return tgt.clone().index_add_(axis, idx, src)
def _segment_sum(src, seg, n):
    out = torch.zeros((n,) + src.shape[1:], dtype=src.dtype)
    return out.index_add_(0, seg, src)
def _pad(x, pw):
    flat = tuple(v for pair in reversed(pw) for v in pair)
    return torch.nn.functional.pad(x, flat)

kernel_name = 'parallel_sum__linear_kernel_hedgehog__glu_gated_swiglu__prompt'

def setup_inputs():

    _w = (lambda a: (lambda t: t.to(torch.bfloat16) if t.is_floating_point() else t)(torch.as_tensor(a)))
    def _A_setup():
        B, S, D, H = 1, 2048, 640, 32
        Dh = D // H
        return {
            "x": _w((lambda *s: torch.randn(*s, dtype=torch.bfloat16) * 0.05)(B, S, D)),
            "wqkv": _w((lambda *s: torch.randn(*s, dtype=torch.bfloat16) * 0.2)(D, 3 * D)),
            "w_phi": _w((lambda *s: torch.randn(*s, dtype=torch.bfloat16) * 0.2)(H, Dh, Dh) * (Dh ** -0.5)),
            "wo": _w((lambda *s: torch.randn(*s, dtype=torch.bfloat16) * 0.05)(D, D)),
        }
    _A_in = _A_setup()

    def _B_setup():
        B, S, D, F = 1, 2048, 640, 1536
        return {
            "x": _w((lambda *s: torch.randn(*s, dtype=torch.bfloat16) * 0.05)(B, S, D)),
            "w1": _w((lambda *s: torch.randn(*s, dtype=torch.bfloat16) * 0.4)(D, F) * (2.0 / D) ** 0.5),
            "w3": _w((lambda *s: torch.randn(*s, dtype=torch.bfloat16) * 0.4)(D, F) * (2.0 / D) ** 0.5),
            "w2": _w((lambda *s: torch.randn(*s, dtype=torch.bfloat16) * 0.4)(F, D) * (2.0 / F) ** 0.5),
        }
    _B_in = _B_setup()

    return {
        "A_x": _A_in["x"],
        "A_wqkv": _A_in["wqkv"],
        "A_w_phi": _A_in["w_phi"],
        "A_wo": _A_in["wo"],
        "B_x": _B_in["x"],
        "B_w1": _B_in["w1"],
        "B_w3": _B_in["w3"],
        "B_w2": _B_in["w2"],
    }

def reference(A_x, A_wqkv, A_w_phi, A_wo, B_x, B_w1, B_w3, B_w2):
    def _A_ref(x, wqkv, w_phi, wo):
        B, S, D = x.shape
        H = 32; Dh = D // H
        qkv = (lambda x, *d: x.permute(*d))((x @ wqkv).reshape(B, S, 3, H, Dh), 2, 0, 3, 1, 4)
        q, k, v = qkv[0], qkv[1], qkv[2]
        pq = torch.einsum("bhsd,hdf->bhsf", q, w_phi)
        pk = torch.einsum("bhsd,hdf->bhsf", k, w_phi)
        phi_q = torch.concatenate([_softmax(pq, axis=-1), _softmax(-pq, axis=-1)], axis=-1)
        phi_k = torch.concatenate([_softmax(pk, axis=-1), _softmax(-pk, axis=-1)], axis=-1)
        kv = torch.einsum("bhsf,bhsd->bhfd", phi_k, v)
        z  = torch.einsum("bhsf->bhf", phi_k)
        num = torch.einsum("bhqf,bhfd->bhqd", phi_q, kv)
        den = torch.einsum("bhqf,bhf->bhq", phi_q, z)[..., None] + 1e-6
        o = num / den
        return (lambda x, *d: x.permute(*d))(o, 0, 2, 1, 3).reshape(B, S, D) @ wo

    def _B_ref(x, w1, w3, w2):
        gate = torch.einsum("bsd,df->bsf", x, w1)
        up = torch.einsum("bsd,df->bsf", x, w3)
        h = _silu(gate) * up
        out = torch.einsum("bsf,fd->bsd", h, w2)
        return out

    x = A_x
    xn = _layernorm(x, axis=-1)
    return x + _A_ref(xn, A_wqkv, A_w_phi, A_wo) + _B_ref(xn, B_w1, B_w3, B_w2)
```

```asm
; @launch grid=(256,1,1) block=(256,1,1) lds=163840
.amdgcn_target "amdgcn-amd-amdhsa--gfx950"
.text
.globl parallel_sum__linear_kernel_hedgehog__glu_gated_swiglu__prompt_kernel
.p2align 8
.type parallel_sum__linear_kernel_hedgehog__glu_gated_swiglu__prompt_kernel,@function
parallel_sum__linear_kernel_hedgehog__glu_gated_swiglu__prompt_kernel:
s_cmp_ge_u32 s2, 256
s_cbranch_scc1 Lend
s_load_dwordx16 s[4:19], s[0:1], 0
s_load_dwordx4 s[20:23], s[0:1], 64
s_load_dwordx2 s[24:25], s[0:1], 80
s_getpc_b64 s[64:65]
Lpc:
s_mov_b32 s66, Lend-Lpc
s_mov_b32 s67, 0x20000
s_lshr_b32 s68, s2, 3
s_lshl_b32 s68, s68, 12
v_lshlrev_b32 v2, 7, v0
v_lshrrev_b32 v3, 5, v0
v_lshl_add_u32 v2, v3, 20, v2
buffer_load_dword v94, v2, s[64:67], s68 offen
v_and_b32 v1, 63, v0
v_lshrrev_b32 v2, 6, v0
s_nop 0
v_readfirstlane_b32 s56, v2
s_and_b32 s64, s2, 7
s_lshr_b32 s65, s2, 3
s_lshr_b32 s66, s64, 2
s_and_b32 s67, s64, 3
s_cmp_lt_u32 s65, 12
s_cbranch_scc0 Lrole_ffn
s_and_b32 s68, s65, 3
s_lshl_b32 s58, s66, 2
s_add_u32 s58, s58, s68
s_lshr_b32 s68, s65, 2
s_lshr_b32 s57, s68, 1
s_lshl_b32 s69, s67, 1
s_add_u32 s69, s69, s68
s_cmp_eq_u32 s68, 2
s_cselect_b32 s59, s67, s69
s_cbranch_scc1 Lq
Lkv:
s_mul_i32 s64, s58, 256
s_mul_i32 s65, s56, 64
s_add_u32 s64, s64, s65
s_mul_i32 s64, s64, 1280
v_lshrrev_b32_e64 v2, 3, v1
v_mul_u32_u24 v2, 1280, v2
v_add_u32 v2, s64, v2
v_lshrrev_b32 v3, 4, v1
v_and_b32 v4, 7, v1
v_xor_b32 v3, v3, v4
v_lshl_add_u32 v4, v3, 4, v2
v_xor_b32_e64 v3, 4, v3
v_lshl_add_u32 v5, v3, 4, v2
v_add_u32_e64 v8, 0, v4
v_add_u32 v9, 9216, v5
v_add_u32 v10, 18432, v4
v_add_u32 v11, 27648, v5
v_add_u32 v12, 40960, v4
v_add_u32 v13, 50176, v5
v_add_u32 v14, 59392, v4
v_add_u32 v15, 68608, v5
s_mul_i32 s62, s56, 8192
s_bfe_u32 s66, s2, 0x10002
s_mul_i32 s67, s66, 4
s_sub_u32 s67, s58, s67
s_mov_b32 s68, 0x76543210
s_mov_b32 s69, 0x76532104
s_cmp_eq_u32 s67, 0
s_cselect_b32 s74, s69, s68
s_mov_b32 s75, 0x98
s_cmp_eq_u32 s66, 0
s_cbranch_scc1 Lupk
s_sub_u32 s74, 0x99999999, s74
s_mov_b32 s75, 0x01
Lupk:
s_and_b32 s68, s74, 15
s_lshl_b32 s60, s68, 7
s_waitcnt lgkmcnt(0)
s_mov_b32 s28, s4
s_mov_b32 s29, s5
s_mov_b32 s30, 2621440
s_mov_b32 s31, 0x20000
s_add_u32 m0, s62, 0
s_nop 0
buffer_load_dwordx4 v8, s[28:31], s60 offen offset:0  lds
buffer_load_dwordx4 v9, s[28:31], s60 offen offset:1024  lds
buffer_load_dwordx4 v10, s[28:31], s60 offen offset:2048  lds
buffer_load_dwordx4 v11, s[28:31], s60 offen offset:3072  lds
s_add_u32 m0, s62, 4096
s_nop 0
buffer_load_dwordx4 v12, s[28:31], s60 offen offset:0  lds
buffer_load_dwordx4 v13, s[28:31], s60 offen offset:1024  lds
buffer_load_dwordx4 v14, s[28:31], s60 offen offset:2048  lds
buffer_load_dwordx4 v15, s[28:31], s60 offen offset:3072  lds
s_mul_i32 s61, s68, 245760
s_lshl_b32 s72, 1, s67
s_cmp_eq_u32 s67, 0
s_cselect_b32 s72, 3, s72
s_lshr_b32 s64, s56, 1
s_mul_i32 s65, s59, 320
s_mul_i32 s66, s64, 160
s_add_u32 s65, s65, s66
s_mul_i32 s66, s59, 160
s_mul_i32 s67, s64, 1280
s_add_u32 s66, s66, s67
s_add_u32 s66, s66, 1280
s_cmp_eq_u32 s57, 1
s_cselect_b32 s65, s65, s66
s_and_b32 s64, s56, 1
s_mul_i32 s64, s64, 320
v_add_u32 v2, s64, v1
v_add_u32 v2, 0, v2
v_mul_u32_u24 v3, 6554, v2
v_lshrrev_b32 v3, 16, v3
v_mul_u32_u24 v4, 10, v3
v_sub_u32 v2, v2, v4
v_lshrrev_b32 v4, 1, v3
v_xor_b32 v4, v4, v3
v_and_b32 v4, 4, v4
v_mul_u32_u24 v4, 3, v4
v_xor_b32 v3, v3, v4
v_mul_u32_u24 v3, 3840, v3
v_lshl_add_u32 v3, v2, 4, v3
v_add_u32 v3, s65, v3
v_subrev_u32 v16, 0, v3
v_add_u32 v2, s64, v1
v_add_u32 v2, 64, v2
v_mul_u32_u24 v3, 6554, v2
v_lshrrev_b32 v3, 16, v3
v_mul_u32_u24 v4, 10, v3
v_sub_u32 v2, v2, v4
v_lshrrev_b32 v4, 1, v3
v_xor_b32 v4, v4, v3
v_and_b32 v4, 4, v4
v_mul_u32_u24 v4, 3, v4
v_xor_b32 v3, v3, v4
v_mul_u32_u24 v3, 3840, v3
v_lshl_add_u32 v3, v2, 4, v3
v_add_u32_e64 v3, s65, v3
v_subrev_u32 v17, 1024, v3
v_add_u32_e64 v2, s64, v1
v_add_u32 v2, 128, v2
v_mul_u32_u24 v3, 6554, v2
v_lshrrev_b32 v3, 16, v3
v_mul_u32_u24 v4, 10, v3
v_sub_u32 v2, v2, v4
v_lshrrev_b32 v4, 1, v3
v_xor_b32 v4, v4, v3
v_and_b32 v4, 4, v4
v_mul_u32_u24 v4, 3, v4
v_xor_b32 v3, v3, v4
v_mul_u32_u24 v3, 3840, v3
v_lshl_add_u32 v3, v2, 4, v3
v_add_u32_e64 v3, s65, v3
v_subrev_u32 v18, 2048, v3
v_add_u32_e64 v2, s64, v1
v_add_u32 v2, 192, v2
v_mul_u32_u24 v3, 6554, v2
v_lshrrev_b32 v3, 16, v3
v_mul_u32_u24 v4, 10, v3
v_sub_u32 v2, v2, v4
v_lshrrev_b32 v4, 1, v3
v_xor_b32 v4, v4, v3
v_and_b32 v4, 4, v4
v_mul_u32_u24 v4, 3, v4
v_xor_b32 v3, v3, v4
v_mul_u32_u24 v3, 3840, v3
v_lshl_add_u32 v3, v2, 4, v3
v_add_u32_e64 v3, s65, v3
v_subrev_u32 v19, 3072, v3
v_add_u32_e64 v2, s64, v1
v_add_u32 v2, 256, v2
v_mul_u32_u24 v3, 6554, v2
v_lshrrev_b32 v3, 16, v3
v_mul_u32_u24 v4, 10, v3
v_sub_u32 v2, v2, v4
v_lshrrev_b32 v4, 1, v3
v_xor_b32 v4, v4, v3
v_and_b32 v4, 4, v4
v_mul_u32_u24 v4, 3, v4
v_xor_b32 v3, v3, v4
v_mul_u32_u24 v3, 3840, v3
v_lshl_add_u32 v3, v2, 4, v3
v_add_u32 v3, s65, v3
v_subrev_u32 v20, 0, v3
s_mul_i32 s63, s56, 5120
s_add_u32 s63, s63, 32768
s_mov_b32 s32, s6
s_mov_b32 s33, s7
s_mov_b32 s34, 2457600
s_mov_b32 s35, 0x20000
s_add_u32 m0, s63, 0
s_nop 0
buffer_load_dwordx4 v16, s[32:35], s61 offen offset:0  lds
buffer_load_dwordx4 v17, s[32:35], s61 offen offset:1024  lds
buffer_load_dwordx4 v18, s[32:35], s61 offen offset:2048  lds
buffer_load_dwordx4 v19, s[32:35], s61 offen offset:3072  lds
s_add_u32 m0, s63, 4096
s_nop 0
buffer_load_dwordx4 v20, s[32:35], s61 offen offset:0  lds
s_mov_b32 s57, s74
v_and_b32 v2, 15, v1
v_lshrrev_b32 v3, 4, v1
v_lshrrev_b32 v4, 1, v2
v_xor_b32 v4, v4, v3
v_lshlrev_b32_e64 v4, 4, v4
v_lshl_add_u32 v4, v2, 7, v4
v_add_u32 v4, s62, v4
v_xor_b32 v5, 64, v4
v_add_u32 v22, 0, v4
v_add_u32 v23, 0, v5
v_add_u32 v24, 53248, v4
v_add_u32 v25, 53248, v5
v_add_u32 v26, 106496, v4
v_add_u32 v27, 106496, v5
v_bfe_u32 v2, v1, 2, 2
v_and_b32 v5, 3, v1
v_and_b32 v4, 1, v3
v_lshl_add_u32 v2, v4, 2, v2
v_lshrrev_b32_e64 v4, 1, v3
v_lshl_add_u32 v2, v4, 4, v2
v_mul_u32_u24 v2, 160, v2
v_mul_u32_u24 v5, 40, v5
v_add_u32 v4, v2, v5
v_add_u32 v28, 32768, v4
v_add_u32 v30, 86016, v4
v_add_u32 v32, 139264, v4
s_lshr_b64 s[74:75], s[74:75], 4
s_and_b32 s13, s74, 15
s_lshl_b32 s60, s13, 7
s_mul_i32 s61, s13, 245760
s_add_u32 m0, s62, 53248
s_nop 0
buffer_load_dwordx4 v8, s[28:31], s60 offen offset:0  lds
buffer_load_dwordx4 v9, s[28:31], s60 offen offset:1024  lds
buffer_load_dwordx4 v10, s[28:31], s60 offen offset:2048  lds
buffer_load_dwordx4 v11, s[28:31], s60 offen offset:3072  lds
s_add_u32 m0, s62, 57344
s_nop 0
buffer_load_dwordx4 v12, s[28:31], s60 offen offset:0  lds
buffer_load_dwordx4 v13, s[28:31], s60 offen offset:1024  lds
buffer_load_dwordx4 v14, s[28:31], s60 offen offset:2048  lds
buffer_load_dwordx4 v15, s[28:31], s60 offen offset:3072  lds
s_add_u32 m0, s63, 53248
s_nop 0
buffer_load_dwordx4 v16, s[32:35], s61 offen offset:0  lds
buffer_load_dwordx4 v17, s[32:35], s61 offen offset:1024  lds
buffer_load_dwordx4 v18, s[32:35], s61 offen offset:2048  lds
buffer_load_dwordx4 v19, s[32:35], s61 offen offset:3072  lds
s_add_u32 m0, s63, 57344
s_nop 0
buffer_load_dwordx4 v20, s[32:35], s61 offen offset:0  lds
s_mov_b32 s40, s24
s_mov_b32 s41, s25
s_mov_b32 s42, 17825792
s_mov_b32 s43, 0x20000
s_mov_b32 s48, s22
s_mov_b32 s49, s23
s_mov_b32 s50, 256
s_mov_b32 s51, 0x20000
v_lshlrev_b32 v6, 4, v1
v_add_u32 v21, 4096, v6
v_add_u32 v0, 8192, v6
v_mov_b32 v7, 0x7f000000
v_cmp_eq_u32 vcc, 0, v1
s_nop 1
v_cndmask_b32 v7, v7, 0, vcc
s_mov_b32 s80, 0x3fb8aa3b
s_mov_b32 s81, 0x3fb8aa3b
s_mov_b32 s82, 0x05040100
s_mov_b32 s83, 0x07060302
s_lshl_b32 s12, s56, 10
s_mov_b32 s78, 0xffff0000
s_and_b32 s64, s2, 7
s_lshr_b32 s65, s2, 3
s_sub_u32 s66, s65, 8
s_and_b32 s67, s66, 3
s_lshl_b32 s68, s64, 2
s_add_u32 s67, s67, s68
s_lshl_b32 s68, s59, 2
s_cmp_lt_u32 s65, 8
s_cselect_b32 s27, s68, s67
s_lshr_b32 s66, s66, 2
s_lshl_b32 s66, s66, 2
s_add_u32 s66, s66, s56
s_mul_i32 s26, s66, 6
s_lshl_b32 s95, s64, 2
s_and_b32 s66, s65, 3
s_add_u32 s95, s95, s66
s_lshr_b32 s96, s65, 2
s_mul_i32 s3, s56, -7168
s_add_u32 s3, s3, 49152
s_mul_i32 s64, s96, 348160
s_mul_i32 s65, s56, 12288
s_add_u32 s64, s64, s65
s_add_u32 s86, s64, 9437184
s_add_u32 s87, s86, 69632
s_add_u32 s88, s87, 69632
s_add_u32 s89, s88, 69632
s_add_u32 s90, s89, 69632
s_mul_i32 s64, s95, 278528
s_add_u32 s64, s64, s65
s_add_u32 s66, s56, 0
s_and_b32 s66, s66, 3
s_mul_i32 s66, s66, 69632
s_add_u32 s91, s64, s66
s_add_u32 s66, s56, 1
s_and_b32 s66, s66, 3
s_mul_i32 s66, s66, 69632
s_add_u32 s92, s64, s66
s_add_u32 s66, s56, 2
s_and_b32 s66, s66, 3
s_mul_i32 s66, s66, 69632
s_add_u32 s93, s64, s66
s_add_u32 s66, s56, 3
s_and_b32 s66, s66, 3
s_mul_i32 s66, s66, 69632
s_add_u32 s94, s64, s66
s_waitcnt vmcnt(13)
s_barrier
ds_read_b128 a[0:3], v22 offset:0
ds_read_b128 a[4:7], v22 offset:2048
ds_read_b128 a[8:11], v22 offset:4096
ds_read_b128 a[12:15], v22 offset:6144
ds_read_b64_tr_b16 a[16:17], v28 offset:0
ds_read_b64_tr_b16 a[18:19], v28 offset:1280
ds_read_b64_tr_b16 a[20:21], v28 offset:8
ds_read_b64_tr_b16 a[22:23], v28 offset:1288
ds_read_b64_tr_b16 a[24:25], v28 offset:16
ds_read_b64_tr_b16 a[26:27], v28 offset:1296
ds_read_b64_tr_b16 a[28:29], v28 offset:24
ds_read_b64_tr_b16 a[30:31], v28 offset:1304
ds_read_b64_tr_b16 a[32:33], v28 offset:32
ds_read_b64_tr_b16 a[34:35], v28 offset:1312
ds_read_b64_tr_b16 a[36:37], v28 offset:10240
ds_read_b64_tr_b16 a[38:39], v28 offset:11520
ds_read_b64_tr_b16 a[40:41], v28 offset:10248
ds_read_b64_tr_b16 a[42:43], v28 offset:11528
ds_read_b64_tr_b16 a[44:45], v28 offset:10256
ds_read_b64_tr_b16 a[46:47], v28 offset:11536
ds_read_b64_tr_b16 a[48:49], v28 offset:10264
ds_read_b64_tr_b16 a[50:51], v28 offset:11544
ds_read_b64_tr_b16 a[52:53], v28 offset:10272
ds_read_b64_tr_b16 a[54:55], v28 offset:11552
s_waitcnt lgkmcnt(0)
v_mfma_f32_16x16x32_bf16 v[96:99], a[16:19], a[0:3], 0
ds_read_b128 a[56:59], v23 offset:0
v_mfma_f32_16x16x32_bf16 v[136:139], a[16:19], a[4:7], 0
ds_read_b128 a[60:63], v23 offset:2048
v_mfma_f32_16x16x32_bf16 v[176:179], a[16:19], a[8:11], 0
v_mfma_f32_16x16x32_bf16 v[216:219], a[16:19], a[12:15], 0
ds_read_b128 a[64:67], v23 offset:4096
s_lshr_b64 s[74:75], s[74:75], 4
s_and_b32 s13, s74, 15
v_mfma_f32_16x16x32_bf16 v[220:223], a[20:23], a[12:15], 0
s_lshl_b32 s60, s13, 7
s_mul_i32 s61, s13, 245760
s_add_u32 m0, s62, 106496
v_mfma_f32_16x16x32_bf16 v[180:183], a[20:23], a[8:11], 0
buffer_load_dwordx4 v8, s[28:31], s60 offen offset:0  lds
ds_read_b128 a[68:71], v23 offset:6144
v_mfma_f32_16x16x32_bf16 v[140:143], a[20:23], a[4:7], 0
ds_read_b64_tr_b16 a[72:73], v28 offset:5120
buffer_load_dwordx4 v9, s[28:31], s60 offen offset:1024  lds
v_mfma_f32_16x16x32_bf16 v[100:103], a[20:23], a[0:3], 0
ds_read_b64_tr_b16 a[74:75], v28 offset:6400
v_mfma_f32_16x16x32_bf16 v[104:107], a[24:27], a[0:3], 0
ds_read_b64_tr_b16 a[76:77], v28 offset:5128
v_mfma_f32_16x16x32_bf16 v[144:147], a[24:27], a[4:7], 0
buffer_load_dwordx4 v10, s[28:31], s60 offen offset:2048  lds
ds_read_b64_tr_b16 a[78:79], v28 offset:6408
v_mfma_f32_16x16x32_bf16 v[184:187], a[24:27], a[8:11], 0
ds_read_b64_tr_b16 a[80:81], v28 offset:5136
v_mfma_f32_16x16x32_bf16 v[224:227], a[24:27], a[12:15], 0
ds_read_b64_tr_b16 a[82:83], v28 offset:6416
v_mfma_f32_16x16x32_bf16 v[228:231], a[28:31], a[12:15], 0
buffer_load_dwordx4 v11, s[28:31], s60 offen offset:3072  lds
v_mfma_f32_16x16x32_bf16 v[188:191], a[28:31], a[8:11], 0
ds_read_b64_tr_b16 a[84:85], v28 offset:5144
v_mfma_f32_16x16x32_bf16 v[148:151], a[28:31], a[4:7], 0
ds_read_b64_tr_b16 a[86:87], v28 offset:6424
v_mfma_f32_16x16x32_bf16 v[108:111], a[28:31], a[0:3], 0
s_add_u32 m0, s62, 110592
v_mfma_f32_16x16x32_bf16 v[112:115], a[32:35], a[0:3], 0
buffer_load_dwordx4 v12, s[28:31], s60 offen offset:0  lds
ds_read_b64_tr_b16 a[88:89], v28 offset:5152
v_mfma_f32_16x16x32_bf16 v[152:155], a[32:35], a[4:7], 0
ds_read_b64_tr_b16 a[90:91], v28 offset:6432
v_mfma_f32_16x16x32_bf16 v[192:195], a[32:35], a[8:11], 0
buffer_load_dwordx4 v13, s[28:31], s60 offen offset:1024  lds
ds_read_b64_tr_b16 a[92:93], v28 offset:15360
v_mfma_f32_16x16x32_bf16 v[232:235], a[32:35], a[12:15], 0
v_mov_b32 v2, 0x3f803f80
v_accvgpr_write_b32 a128, v2
v_accvgpr_write_b32 a129, v2
v_mfma_f32_16x16x32_bf16 v[236:239], a[36:39], a[12:15], 0
v_accvgpr_write_b32 a130, v2
v_accvgpr_write_b32 a131, v2
v_lshrrev_b32_e64 v2, 4, v1
v_mfma_f32_16x16x32_bf16 v[196:199], a[36:39], a[8:11], 0
v_mul_u32_u24 v2, 80, v2
v_and_b32 v3, 15, v1
v_cmp_eq_u32 vcc, 0, v3
v_mfma_f32_16x16x32_bf16 v[156:159], a[36:39], a[4:7], 0
v_mov_b32 v3, 0x7f000000
s_mov_b32 s64, 0
v_cndmask_b32 v94, v3, v2, vcc
v_mfma_f32_16x16x32_bf16 v[116:119], a[36:39], a[0:3], 0
s_mul_i32 s65, s59, 320
s_add_u32 s64, s64, s65
s_add_u32 s73, s64, 16845312
v_mfma_f32_16x16x32_bf16 v[120:123], a[40:43], a[0:3], 0
ds_read_b64_tr_b16 a[94:95], v28 offset:16640
ds_read_b64_tr_b16 a[96:97], v28 offset:15368
v_mfma_f32_16x16x32_bf16 v[160:163], a[40:43], a[4:7], 0
buffer_load_dwordx4 v14, s[28:31], s60 offen offset:2048  lds
ds_read_b64_tr_b16 a[98:99], v28 offset:16648
v_mfma_f32_16x16x32_bf16 v[200:203], a[40:43], a[8:11], 0
ds_read_b64_tr_b16 a[100:101], v28 offset:15376
buffer_load_dwordx4 v15, s[28:31], s60 offen offset:3072  lds
v_mfma_f32_16x16x32_bf16 v[240:243], a[40:43], a[12:15], 0
ds_read_b64_tr_b16 a[102:103], v28 offset:16656
ds_read_b64_tr_b16 a[104:105], v28 offset:15384
s_add_u32 m0, s63, 106496
v_mfma_f32_16x16x32_bf16 v[244:247], a[44:47], a[12:15], 0
buffer_load_dwordx4 v16, s[32:35], s61 offen offset:0  lds
ds_read_b64_tr_b16 a[106:107], v28 offset:16664
v_mfma_f32_16x16x32_bf16 v[204:207], a[44:47], a[8:11], 0
ds_read_b64_tr_b16 a[108:109], v28 offset:15392
ds_read_b64_tr_b16 a[110:111], v28 offset:16672
v_mfma_f32_16x16x32_bf16 v[164:167], a[44:47], a[4:7], 0
buffer_load_dwordx4 v17, s[32:35], s61 offen offset:1024  lds
v_mfma_f32_16x16x32_bf16 v[124:127], a[44:47], a[0:3], 0
v_mfma_f32_16x16x32_bf16 v[128:131], a[48:51], a[0:3], 0
buffer_load_dwordx4 v18, s[32:35], s61 offen offset:2048  lds
v_mfma_f32_16x16x32_bf16 v[168:171], a[48:51], a[4:7], 0
v_mfma_f32_16x16x32_bf16 v[208:211], a[48:51], a[8:11], 0
v_mfma_f32_16x16x32_bf16 v[248:251], a[48:51], a[12:15], 0
buffer_load_dwordx4 v19, s[32:35], s61 offen offset:3072  lds
v_mfma_f32_16x16x32_bf16 v[252:255], a[52:55], a[12:15], 0
v_mfma_f32_16x16x32_bf16 v[212:215], a[52:55], a[8:11], 0
v_mfma_f32_16x16x32_bf16 v[172:175], a[52:55], a[4:7], 0
s_add_u32 m0, s63, 110592
v_mfma_f32_16x16x32_bf16 v[132:135], a[52:55], a[0:3], 0
buffer_load_dwordx4 v20, s[32:35], s61 offen offset:0  lds
s_bitcmp1_b32 s72, 0
s_cbranch_scc1 Lcsk0
Lcrk0:
s_waitcnt lgkmcnt(0)
s_waitcnt vmcnt(13)
s_barrier
v_mfma_f32_16x16x32_bf16 v[96:99], a[72:75], a[56:59], v[96:99]
ds_read_b128 a[0:3], v24 offset:0
v_mfma_f32_16x16x32_bf16 v[136:139], a[72:75], a[60:63], v[136:139]
ds_read_b128 a[4:7], v24 offset:2048
v_mfma_f32_16x16x32_bf16 v[176:179], a[72:75], a[64:67], v[176:179]
v_mfma_f32_16x16x32_bf16 v[216:219], a[72:75], a[68:71], v[216:219]
ds_read_b128 a[8:11], v24 offset:4096
v_mfma_f32_16x16x32_bf16 v[220:223], a[76:79], a[68:71], v[220:223]
ds_read_b128 a[12:15], v24 offset:6144
s_lshr_b64 s[74:75], s[74:75], 4
v_mfma_f32_16x16x32_bf16 v[180:183], a[76:79], a[64:67], v[180:183]
s_and_b32 s13, s74, 15
s_lshl_b32 s60, s13, 7
v_mfma_f32_16x16x32_bf16 v[140:143], a[76:79], a[60:63], v[140:143]
s_mul_i32 s61, s13, 245760
s_add_u32 m0, s62, 0
v_mfma_f32_16x16x32_bf16 v[100:103], a[76:79], a[56:59], v[100:103]
buffer_load_dwordx4 v8, s[28:31], s60 offen offset:0  lds
v_mfma_f32_16x16x32_bf16 v[104:107], a[80:83], a[56:59], v[104:107]
ds_read_b64_tr_b16 a[16:17], v30 offset:0
ds_read_b64_tr_b16 a[18:19], v30 offset:1280
v_mfma_f32_16x16x32_bf16 v[144:147], a[80:83], a[60:63], v[144:147]
ds_read_b64_tr_b16 a[20:21], v30 offset:8
ds_read_b64_tr_b16 a[22:23], v30 offset:1288
v_mfma_f32_16x16x32_bf16 v[184:187], a[80:83], a[64:67], v[184:187]
buffer_load_dwordx4 v9, s[28:31], s60 offen offset:1024  lds
v_mfma_f32_16x16x32_bf16 v[224:227], a[80:83], a[68:71], v[224:227]
ds_read_b64_tr_b16 a[24:25], v30 offset:16
ds_read_b64_tr_b16 a[26:27], v30 offset:1296
v_mfma_f32_16x16x32_bf16 v[228:231], a[84:87], a[68:71], v[228:231]
v_mfma_f32_16x16x32_bf16 v[188:191], a[84:87], a[64:67], v[188:191]
ds_read_b64_tr_b16 a[28:29], v30 offset:24
v_mfma_f32_16x16x32_bf16 v[148:151], a[84:87], a[60:63], v[148:151]
ds_read_b64_tr_b16 a[30:31], v30 offset:1304
v_mfma_f32_16x16x32_bf16 v[108:111], a[84:87], a[56:59], v[108:111]
buffer_load_dwordx4 v10, s[28:31], s60 offen offset:2048  lds
v_mfma_f32_16x16x32_bf16 v[112:115], a[88:91], a[56:59], v[112:115]
ds_read_b64_tr_b16 a[32:33], v30 offset:32
ds_read_b64_tr_b16 a[34:35], v30 offset:1312
v_mfma_f32_16x16x32_bf16 v[152:155], a[88:91], a[60:63], v[152:155]
v_mfma_f32_16x16x32_bf16 v[192:195], a[88:91], a[64:67], v[192:195]
ds_read_b64_tr_b16 a[36:37], v30 offset:10240
v_mfma_f32_16x16x32_bf16 v[232:235], a[88:91], a[68:71], v[232:235]
ds_read_b64_tr_b16 a[38:39], v30 offset:11520
v_mfma_f32_16x16x32_bf16 v[236:239], a[92:95], a[68:71], v[236:239]
ds_read_b64_tr_b16 a[40:41], v30 offset:10248
v_mfma_f32_16x16x32_bf16 v[196:199], a[92:95], a[64:67], v[196:199]
buffer_load_dwordx4 v11, s[28:31], s60 offen offset:3072  lds
v_mfma_f32_16x16x32_bf16 v[156:159], a[92:95], a[60:63], v[156:159]
ds_read_b64_tr_b16 a[42:43], v30 offset:11528
v_mfma_f32_16x16x32_bf16 v[116:119], a[92:95], a[56:59], v[116:119]
ds_read_b64_tr_b16 a[44:45], v30 offset:10256
v_mfma_f32_16x16x32_bf16 v[120:123], a[96:99], a[56:59], v[120:123]
ds_read_b64_tr_b16 a[46:47], v30 offset:11536
v_mfma_f32_16x16x32_bf16 v[160:163], a[96:99], a[60:63], v[160:163]
ds_read_b64_tr_b16 a[48:49], v30 offset:10264
v_mfma_f32_16x16x32_bf16 v[200:203], a[96:99], a[64:67], v[200:203]
s_add_u32 m0, s62, 4096
v_mfma_f32_16x16x32_bf16 v[240:243], a[96:99], a[68:71], v[240:243]
buffer_load_dwordx4 v12, s[28:31], s60 offen offset:0  lds
v_mfma_f32_16x16x32_bf16 v[244:247], a[100:103], a[68:71], v[244:247]
ds_read_b64_tr_b16 a[50:51], v30 offset:11544
ds_read_b64_tr_b16 a[52:53], v30 offset:10272
v_mfma_f32_16x16x32_bf16 v[204:207], a[100:103], a[64:67], v[204:207]
ds_read_b64_tr_b16 a[54:55], v30 offset:11552
v_mfma_f32_16x16x32_bf16 v[164:167], a[100:103], a[60:63], v[164:167]
v_mfma_f32_16x16x32_bf16 v[124:127], a[100:103], a[56:59], v[124:127]
buffer_load_dwordx4 v13, s[28:31], s60 offen offset:1024  lds
v_mfma_f32_16x16x32_bf16 v[128:131], a[104:107], a[56:59], v[128:131]
v_mfma_f32_16x16x32_bf16 v[168:171], a[104:107], a[60:63], v[168:171]
v_mfma_f32_16x16x32_bf16 v[208:211], a[104:107], a[64:67], v[208:211]
v_mfma_f32_16x16x32_bf16 v[248:251], a[104:107], a[68:71], v[248:251]
v_mfma_f32_16x16x32_bf16 v[252:255], a[108:111], a[68:71], v[252:255]
v_mfma_f32_16x16x32_bf16 v[212:215], a[108:111], a[64:67], v[212:215]
buffer_load_dwordx4 v14, s[28:31], s60 offen offset:2048  lds
v_mfma_f32_16x16x32_bf16 v[172:175], a[108:111], a[60:63], v[172:175]
v_mfma_f32_16x16x32_bf16 v[132:135], a[108:111], a[56:59], v[132:135]
s_bitcmp1_b32 s72, 0
s_cbranch_scc1 Lcsk1
Lcrk1:
s_waitcnt lgkmcnt(0)
v_mfma_f32_16x16x32_bf16 v[96:99], a[16:19], a[0:3], v[96:99]
ds_read_b128 a[56:59], v25 offset:0
v_mfma_f32_16x16x32_bf16 v[136:139], a[16:19], a[4:7], v[136:139]
ds_read_b128 a[60:63], v25 offset:2048
v_mfma_f32_16x16x32_bf16 v[176:179], a[16:19], a[8:11], v[176:179]
v_mfma_f32_16x16x32_bf16 v[216:219], a[16:19], a[12:15], v[216:219]
ds_read_b128 a[64:67], v25 offset:4096
v_mfma_f32_16x16x32_bf16 v[220:223], a[20:23], a[12:15], v[220:223]
ds_read_b128 a[68:71], v25 offset:6144
v_mfma_f32_16x16x32_bf16 v[180:183], a[20:23], a[8:11], v[180:183]
buffer_load_dwordx4 v15, s[28:31], s60 offen offset:3072  lds
v_mfma_f32_16x16x32_bf16 v[140:143], a[20:23], a[4:7], v[140:143]
ds_read_b64_tr_b16 a[72:73], v30 offset:5120
ds_read_b64_tr_b16 a[74:75], v30 offset:6400
v_mfma_f32_16x16x32_bf16 v[100:103], a[20:23], a[0:3], v[100:103]
v_mfma_f32_16x16x32_bf16 v[104:107], a[24:27], a[0:3], v[104:107]
ds_read_b64_tr_b16 a[76:77], v30 offset:5128
v_mfma_f32_16x16x32_bf16 v[144:147], a[24:27], a[4:7], v[144:147]
ds_read_b64_tr_b16 a[78:79], v30 offset:6408
v_mfma_f32_16x16x32_bf16 v[184:187], a[24:27], a[8:11], v[184:187]
ds_read_b64_tr_b16 a[80:81], v30 offset:5136
v_mfma_f32_16x16x32_bf16 v[224:227], a[24:27], a[12:15], v[224:227]
s_add_u32 m0, s63, 0
v_mfma_f32_16x16x32_bf16 v[228:231], a[28:31], a[12:15], v[228:231]
buffer_load_dwordx4 v16, s[32:35], s61 offen offset:0  lds
v_mfma_f32_16x16x32_bf16 v[188:191], a[28:31], a[8:11], v[188:191]
ds_read_b64_tr_b16 a[82:83], v30 offset:6416
ds_read_b64_tr_b16 a[84:85], v30 offset:5144
v_mfma_f32_16x16x32_bf16 v[148:151], a[28:31], a[4:7], v[148:151]
ds_read_b64_tr_b16 a[86:87], v30 offset:6424
v_mfma_f32_16x16x32_bf16 v[108:111], a[28:31], a[0:3], v[108:111]
ds_read_b64_tr_b16 a[88:89], v30 offset:5152
v_mfma_f32_16x16x32_bf16 v[112:115], a[32:35], a[0:3], v[112:115]
ds_read_b64_tr_b16 a[90:91], v30 offset:6432
v_mfma_f32_16x16x32_bf16 v[152:155], a[32:35], a[4:7], v[152:155]
buffer_load_dwordx4 v17, s[32:35], s61 offen offset:1024  lds
v_mfma_f32_16x16x32_bf16 v[192:195], a[32:35], a[8:11], v[192:195]
ds_read_b64_tr_b16 a[92:93], v30 offset:15360
v_mfma_f32_16x16x32_bf16 v[232:235], a[32:35], a[12:15], v[232:235]
ds_read_b64_tr_b16 a[94:95], v30 offset:16640
v_mfma_f32_16x16x32_bf16 v[236:239], a[36:39], a[12:15], v[236:239]
ds_read_b64_tr_b16 a[96:97], v30 offset:15368
v_mfma_f32_16x16x32_bf16 v[196:199], a[36:39], a[8:11], v[196:199]
ds_read_b64_tr_b16 a[98:99], v30 offset:16648
v_mfma_f32_16x16x32_bf16 v[156:159], a[36:39], a[4:7], v[156:159]
v_mfma_f32_16x16x32_bf16 v[116:119], a[36:39], a[0:3], v[116:119]
ds_read_b64_tr_b16 a[100:101], v30 offset:15376
v_mfma_f32_16x16x32_bf16 v[120:123], a[40:43], a[0:3], v[120:123]
buffer_load_dwordx4 v18, s[32:35], s61 offen offset:2048  lds
v_mfma_f32_16x16x32_bf16 v[160:163], a[40:43], a[4:7], v[160:163]
ds_read_b64_tr_b16 a[102:103], v30 offset:16656
ds_read_b64_tr_b16 a[104:105], v30 offset:15384
v_mfma_f32_16x16x32_bf16 v[200:203], a[40:43], a[8:11], v[200:203]
ds_read_b64_tr_b16 a[106:107], v30 offset:16664
v_mfma_f32_16x16x32_bf16 v[240:243], a[40:43], a[12:15], v[240:243]
v_mfma_f32_16x16x32_bf16 v[244:247], a[44:47], a[12:15], v[244:247]
ds_read_b64_tr_b16 a[108:109], v30 offset:15392
v_mfma_f32_16x16x32_bf16 v[204:207], a[44:47], a[8:11], v[204:207]
ds_read_b64_tr_b16 a[110:111], v30 offset:16672
v_mfma_f32_16x16x32_bf16 v[164:167], a[44:47], a[4:7], v[164:167]
buffer_load_dwordx4 v19, s[32:35], s61 offen offset:3072  lds
v_mfma_f32_16x16x32_bf16 v[124:127], a[44:47], a[0:3], v[124:127]
v_mfma_f32_16x16x32_bf16 v[128:131], a[48:51], a[0:3], v[128:131]
v_mfma_f32_16x16x32_bf16 v[168:171], a[48:51], a[4:7], v[168:171]
v_mfma_f32_16x16x32_bf16 v[208:211], a[48:51], a[8:11], v[208:211]
v_mfma_f32_16x16x32_bf16 v[248:251], a[48:51], a[12:15], v[248:251]
v_mfma_f32_16x16x32_bf16 v[252:255], a[52:55], a[12:15], v[252:255]
s_add_u32 m0, s63, 4096
v_mfma_f32_16x16x32_bf16 v[212:215], a[52:55], a[8:11], v[212:215]
buffer_load_dwordx4 v20, s[32:35], s61 offen offset:0  lds
v_mfma_f32_16x16x32_bf16 v[172:175], a[52:55], a[4:7], v[172:175]
v_mfma_f32_16x16x32_bf16 v[132:135], a[52:55], a[0:3], v[132:135]
s_bitcmp1_b32 s72, 1
s_cbranch_scc1 Lcsk2
Lcrk2:
s_waitcnt lgkmcnt(0)
s_waitcnt vmcnt(13)
s_barrier
v_mfma_f32_16x16x32_bf16 v[96:99], a[72:75], a[56:59], v[96:99]
ds_read_b128 a[0:3], v26 offset:0
v_mfma_f32_16x16x32_bf16 v[136:139], a[72:75], a[60:63], v[136:139]
ds_read_b128 a[4:7], v26 offset:2048
v_mfma_f32_16x16x32_bf16 v[176:179], a[72:75], a[64:67], v[176:179]
v_mfma_f32_16x16x32_bf16 v[216:219], a[72:75], a[68:71], v[216:219]
ds_read_b128 a[8:11], v26 offset:4096
v_mfma_f32_16x16x32_bf16 v[220:223], a[76:79], a[68:71], v[220:223]
ds_read_b128 a[12:15], v26 offset:6144
s_lshr_b64 s[74:75], s[74:75], 4
v_mfma_f32_16x16x32_bf16 v[180:183], a[76:79], a[64:67], v[180:183]
s_and_b32 s13, s74, 15
s_lshl_b32 s60, s13, 7
v_mfma_f32_16x16x32_bf16 v[140:143], a[76:79], a[60:63], v[140:143]
s_mul_i32 s61, s13, 245760
s_add_u32 m0, s62, 53248
v_mfma_f32_16x16x32_bf16 v[100:103], a[76:79], a[56:59], v[100:103]
buffer_load_dwordx4 v8, s[28:31], s60 offen offset:0  lds
v_mfma_f32_16x16x32_bf16 v[104:107], a[80:83], a[56:59], v[104:107]
ds_read_b64_tr_b16 a[16:17], v32 offset:0
ds_read_b64_tr_b16 a[18:19], v32 offset:1280
v_mfma_f32_16x16x32_bf16 v[144:147], a[80:83], a[60:63], v[144:147]
ds_read_b64_tr_b16 a[20:21], v32 offset:8
ds_read_b64_tr_b16 a[22:23], v32 offset:1288
v_mfma_f32_16x16x32_bf16 v[184:187], a[80:83], a[64:67], v[184:187]
v_and_b32_e64 v90, 3, v1
v_lshlrev_b32 v90, 2, v90
v_mfma_f32_16x16x32_bf16 v[224:227], a[80:83], a[68:71], v[224:227]
buffer_load_dwordx4 v9, s[28:31], s60 offen offset:1024  lds
v_mfma_f32_16x16x32_bf16 v[228:231], a[84:87], a[68:71], v[228:231]
ds_read_b64_tr_b16 a[24:25], v32 offset:16
ds_read_b64_tr_b16 a[26:27], v32 offset:1296
v_mfma_f32_16x16x32_bf16 v[188:191], a[84:87], a[64:67], v[188:191]
ds_read_b64_tr_b16 a[28:29], v32 offset:24
v_mfma_f32_16x16x32_bf16 v[148:151], a[84:87], a[60:63], v[148:151]
ds_read_b64_tr_b16 a[30:31], v32 offset:1304
v_mfma_f32_16x16x32_bf16 v[108:111], a[84:87], a[56:59], v[108:111]
buffer_load_dwordx4 v10, s[28:31], s60 offen offset:2048  lds
v_mfma_f32_16x16x32_bf16 v[112:115], a[88:91], a[56:59], v[112:115]
ds_read_b64_tr_b16 a[32:33], v32 offset:32
ds_read_b64_tr_b16 a[34:35], v32 offset:1312
v_mfma_f32_16x16x32_bf16 v[152:155], a[88:91], a[60:63], v[152:155]
v_mfma_f32_16x16x32_bf16 v[192:195], a[88:91], a[64:67], v[192:195]
ds_read_b64_tr_b16 a[36:37], v32 offset:10240
v_mfma_f32_16x16x32_bf16 v[232:235], a[88:91], a[68:71], v[232:235]
ds_read_b64_tr_b16 a[38:39], v32 offset:11520
v_mfma_f32_16x16x32_bf16 v[236:239], a[92:95], a[68:71], v[236:239]
ds_read_b64_tr_b16 a[40:41], v32 offset:10248
v_mfma_f32_16x16x32_bf16 v[196:199], a[92:95], a[64:67], v[196:199]
buffer_load_dwordx4 v11, s[28:31], s60 offen offset:3072  lds
v_mfma_f32_16x16x32_bf16 v[156:159], a[92:95], a[60:63], v[156:159]
ds_read_b64_tr_b16 a[42:43], v32 offset:11528
v_mfma_f32_16x16x32_bf16 v[116:119], a[92:95], a[56:59], v[116:119]
ds_read_b64_tr_b16 a[44:45], v32 offset:10256
v_mfma_f32_16x16x32_bf16 v[120:123], a[96:99], a[56:59], v[120:123]
ds_read_b64_tr_b16 a[46:47], v32 offset:11536
v_mfma_f32_16x16x32_bf16 v[160:163], a[96:99], a[60:63], v[160:163]
ds_read_b64_tr_b16 a[48:49], v32 offset:10264
v_mfma_f32_16x16x32_bf16 v[200:203], a[96:99], a[64:67], v[200:203]
s_add_u32 m0, s62, 57344
v_mfma_f32_16x16x32_bf16 v[240:243], a[96:99], a[68:71], v[240:243]
buffer_load_dwordx4 v12, s[28:31], s60 offen offset:0  lds
v_mfma_f32_16x16x32_bf16 v[244:247], a[100:103], a[68:71], v[244:247]
ds_read_b64_tr_b16 a[50:51], v32 offset:11544
v_mfma_f32_16x16x32_bf16 v[204:207], a[100:103], a[64:67], v[204:207]
buffer_load_dword v91, v90, s[48:51], 0 offen sc1
v_mfma_f32_16x16x32_bf16 v[164:167], a[100:103], a[60:63], v[164:167]
ds_read_b64_tr_b16 a[52:53], v32 offset:10272
ds_read_b64_tr_b16 a[54:55], v32 offset:11552
v_mfma_f32_16x16x32_bf16 v[124:127], a[100:103], a[56:59], v[124:127]
buffer_load_dwordx4 v13, s[28:31], s60 offen offset:1024  lds
v_mfma_f32_16x16x32_bf16 v[128:131], a[104:107], a[56:59], v[128:131]
v_mfma_f32_16x16x32_bf16 v[168:171], a[104:107], a[60:63], v[168:171]
v_mfma_f32_16x16x32_bf16 v[208:211], a[104:107], a[64:67], v[208:211]
v_mfma_f32_16x16x32_bf16 v[248:251], a[104:107], a[68:71], v[248:251]
v_mfma_f32_16x16x32_bf16 v[252:255], a[108:111], a[68:71], v[252:255]
v_mfma_f32_16x16x32_bf16 v[212:215], a[108:111], a[64:67], v[212:215]
buffer_load_dwordx4 v14, s[28:31], s60 offen offset:2048  lds
v_mfma_f32_16x16x32_bf16 v[172:175], a[108:111], a[60:63], v[172:175]
v_mfma_f32_16x16x32_bf16 v[132:135], a[108:111], a[56:59], v[132:135]
s_bitcmp1_b32 s72, 1
s_cbranch_scc1 Lcsk3
Lcrk3:
s_waitcnt lgkmcnt(0)
v_mfma_f32_16x16x32_bf16 v[96:99], a[16:19], a[0:3], v[96:99]
ds_read_b128 a[56:59], v27 offset:0
v_mfma_f32_16x16x32_bf16 v[136:139], a[16:19], a[4:7], v[136:139]
ds_read_b128 a[60:63], v27 offset:2048
v_mfma_f32_16x16x32_bf16 v[176:179], a[16:19], a[8:11], v[176:179]
v_mfma_f32_16x16x32_bf16 v[216:219], a[16:19], a[12:15], v[216:219]
ds_read_b128 a[64:67], v27 offset:4096
v_mfma_f32_16x16x32_bf16 v[220:223], a[20:23], a[12:15], v[220:223]
ds_read_b128 a[68:71], v27 offset:6144
v_mfma_f32_16x16x32_bf16 v[180:183], a[20:23], a[8:11], v[180:183]
buffer_load_dwordx4 v15, s[28:31], s60 offen offset:3072  lds
v_mfma_f32_16x16x32_bf16 v[140:143], a[20:23], a[4:7], v[140:143]
ds_read_b64_tr_b16 a[72:73], v32 offset:5120
ds_read_b64_tr_b16 a[74:75], v32 offset:6400
v_mfma_f32_16x16x32_bf16 v[100:103], a[20:23], a[0:3], v[100:103]
v_mfma_f32_16x16x32_bf16 v[104:107], a[24:27], a[0:3], v[104:107]
ds_read_b64_tr_b16 a[76:77], v32 offset:5128
v_mfma_f32_16x16x32_bf16 v[144:147], a[24:27], a[4:7], v[144:147]
ds_read_b64_tr_b16 a[78:79], v32 offset:6408
v_mfma_f32_16x16x32_bf16 v[184:187], a[24:27], a[8:11], v[184:187]
ds_read_b64_tr_b16 a[80:81], v32 offset:5136
v_mfma_f32_16x16x32_bf16 v[224:227], a[24:27], a[12:15], v[224:227]
s_add_u32 m0, s63, 53248
v_mfma_f32_16x16x32_bf16 v[228:231], a[28:31], a[12:15], v[228:231]
buffer_load_dwordx4 v16, s[32:35], s61 offen offset:0  lds
v_mfma_f32_16x16x32_bf16 v[188:191], a[28:31], a[8:11], v[188:191]
ds_read_b64_tr_b16 a[82:83], v32 offset:6416
ds_read_b64_tr_b16 a[84:85], v32 offset:5144
v_mfma_f32_16x16x32_bf16 v[148:151], a[28:31], a[4:7], v[148:151]
ds_read_b64_tr_b16 a[86:87], v32 offset:6424
v_mfma_f32_16x16x32_bf16 v[108:111], a[28:31], a[0:3], v[108:111]
ds_read_b64_tr_b16 a[88:89], v32 offset:5152
v_mfma_f32_16x16x32_bf16 v[112:115], a[32:35], a[0:3], v[112:115]
ds_read_b64_tr_b16 a[90:91], v32 offset:6432
v_mfma_f32_16x16x32_bf16 v[152:155], a[32:35], a[4:7], v[152:155]
buffer_load_dwordx4 v17, s[32:35], s61 offen offset:1024  lds
v_mfma_f32_16x16x32_bf16 v[192:195], a[32:35], a[8:11], v[192:195]
ds_read_b64_tr_b16 a[92:93], v32 offset:15360
v_mfma_f32_16x16x32_bf16 v[232:235], a[32:35], a[12:15], v[232:235]
ds_read_b64_tr_b16 a[94:95], v32 offset:16640
v_mfma_f32_16x16x32_bf16 v[236:239], a[36:39], a[12:15], v[236:239]
ds_read_b64_tr_b16 a[96:97], v32 offset:15368
v_mfma_f32_16x16x32_bf16 v[196:199], a[36:39], a[8:11], v[196:199]
ds_read_b64_tr_b16 a[98:99], v32 offset:16648
v_mfma_f32_16x16x32_bf16 v[156:159], a[36:39], a[4:7], v[156:159]
v_mfma_f32_16x16x32_bf16 v[116:119], a[36:39], a[0:3], v[116:119]
ds_read_b64_tr_b16 a[100:101], v32 offset:15376
v_mfma_f32_16x16x32_bf16 v[120:123], a[40:43], a[0:3], v[120:123]
buffer_load_dwordx4 v18, s[32:35], s61 offen offset:2048  lds
v_mfma_f32_16x16x32_bf16 v[160:163], a[40:43], a[4:7], v[160:163]
ds_read_b64_tr_b16 a[102:103], v32 offset:16656
ds_read_b64_tr_b16 a[104:105], v32 offset:15384
v_mfma_f32_16x16x32_bf16 v[200:203], a[40:43], a[8:11], v[200:203]
ds_read_b64_tr_b16 a[106:107], v32 offset:16664
v_mfma_f32_16x16x32_bf16 v[240:243], a[40:43], a[12:15], v[240:243]
v_mfma_f32_16x16x32_bf16 v[244:247], a[44:47], a[12:15], v[244:247]
ds_read_b64_tr_b16 a[108:109], v32 offset:15392
v_mfma_f32_16x16x32_bf16 v[204:207], a[44:47], a[8:11], v[204:207]
ds_read_b64_tr_b16 a[110:111], v32 offset:16672
v_mfma_f32_16x16x32_bf16 v[164:167], a[44:47], a[4:7], v[164:167]
buffer_load_dwordx4 v19, s[32:35], s61 offen offset:3072  lds
v_mfma_f32_16x16x32_bf16 v[124:127], a[44:47], a[0:3], v[124:127]
v_mfma_f32_16x16x32_bf16 v[128:131], a[48:51], a[0:3], v[128:131]
v_mfma_f32_16x16x32_bf16 v[168:171], a[48:51], a[4:7], v[168:171]
v_mfma_f32_16x16x32_bf16 v[208:211], a[48:51], a[8:11], v[208:211]
v_mfma_f32_16x16x32_bf16 v[248:251], a[48:51], a[12:15], v[248:251]
v_mfma_f32_16x16x32_bf16 v[252:255], a[52:55], a[12:15], v[252:255]
s_add_u32 m0, s63, 57344
v_mfma_f32_16x16x32_bf16 v[212:215], a[52:55], a[8:11], v[212:215]
buffer_load_dwordx4 v20, s[32:35], s61 offen offset:0  lds
v_mfma_f32_16x16x32_bf16 v[172:175], a[52:55], a[4:7], v[172:175]
v_mfma_f32_16x16x32_bf16 v[132:135], a[52:55], a[0:3], v[132:135]
s_bitcmp1_b32 s72, 2
s_cbranch_scc1 Lcsk4
Lcrk4:
s_waitcnt lgkmcnt(0)
s_waitcnt vmcnt(14)
s_barrier
v_mfma_f32_16x16x32_bf16 v[96:99], a[72:75], a[56:59], v[96:99]
ds_read_b128 a[0:3], v22 offset:0
v_mfma_f32_16x16x32_bf16 v[136:139], a[72:75], a[60:63], v[136:139]
ds_read_b128 a[4:7], v22 offset:2048
v_mfma_f32_16x16x32_bf16 v[176:179], a[72:75], a[64:67], v[176:179]
v_mfma_f32_16x16x32_bf16 v[216:219], a[72:75], a[68:71], v[216:219]
ds_read_b128 a[8:11], v22 offset:4096
v_mfma_f32_16x16x32_bf16 v[220:223], a[76:79], a[68:71], v[220:223]
ds_read_b128 a[12:15], v22 offset:6144
s_lshr_b64 s[74:75], s[74:75], 4
v_mfma_f32_16x16x32_bf16 v[180:183], a[76:79], a[64:67], v[180:183]
s_and_b32 s13, s74, 15
s_lshl_b32 s60, s13, 7
v_mfma_f32_16x16x32_bf16 v[140:143], a[76:79], a[60:63], v[140:143]
s_mul_i32 s61, s13, 245760
s_add_u32 m0, s62, 106496
v_mfma_f32_16x16x32_bf16 v[100:103], a[76:79], a[56:59], v[100:103]
buffer_load_dwordx4 v8, s[28:31], s60 offen offset:0  lds
v_mfma_f32_16x16x32_bf16 v[104:107], a[80:83], a[56:59], v[104:107]
ds_read_b64_tr_b16 a[16:17], v28 offset:0
ds_read_b64_tr_b16 a[18:19], v28 offset:1280
v_mfma_f32_16x16x32_bf16 v[144:147], a[80:83], a[60:63], v[144:147]
ds_read_b64_tr_b16 a[20:21], v28 offset:8
ds_read_b64_tr_b16 a[22:23], v28 offset:1288
v_mfma_f32_16x16x32_bf16 v[184:187], a[80:83], a[64:67], v[184:187]
s_mov_b32 s44, s8
s_mov_b32 s45, s9
v_mfma_f32_16x16x32_bf16 v[224:227], a[80:83], a[68:71], v[224:227]
s_mov_b32 s46, 25600
s_mov_b32 s47, 0x20000
v_mfma_f32_16x16x32_bf16 v[228:231], a[84:87], a[68:71], v[228:231]
buffer_load_dwordx4 v9, s[28:31], s60 offen offset:1024  lds
v_mfma_f32_16x16x32_bf16 v[188:191], a[84:87], a[64:67], v[188:191]
ds_read_b64_tr_b16 a[24:25], v28 offset:16
ds_read_b64_tr_b16 a[26:27], v28 offset:1296
v_mfma_f32_16x16x32_bf16 v[148:151], a[84:87], a[60:63], v[148:151]
ds_read_b64_tr_b16 a[28:29], v28 offset:24
ds_read_b64_tr_b16 a[30:31], v28 offset:1304
v_mfma_f32_16x16x32_bf16 v[108:111], a[84:87], a[56:59], v[108:111]
buffer_load_dwordx4 v10, s[28:31], s60 offen offset:2048  lds
v_mfma_f32_16x16x32_bf16 v[112:115], a[88:91], a[56:59], v[112:115]
ds_read_b64_tr_b16 a[32:33], v28 offset:32
ds_read_b64_tr_b16 a[34:35], v28 offset:1312
v_mfma_f32_16x16x32_bf16 v[152:155], a[88:91], a[60:63], v[152:155]
v_mfma_f32_16x16x32_bf16 v[192:195], a[88:91], a[64:67], v[192:195]
ds_read_b64_tr_b16 a[36:37], v28 offset:10240
v_mfma_f32_16x16x32_bf16 v[232:235], a[88:91], a[68:71], v[232:235]
ds_read_b64_tr_b16 a[38:39], v28 offset:11520
v_mfma_f32_16x16x32_bf16 v[236:239], a[92:95], a[68:71], v[236:239]
ds_read_b64_tr_b16 a[40:41], v28 offset:10248
v_mfma_f32_16x16x32_bf16 v[196:199], a[92:95], a[64:67], v[196:199]
buffer_load_dwordx4 v11, s[28:31], s60 offen offset:3072  lds
v_mfma_f32_16x16x32_bf16 v[156:159], a[92:95], a[60:63], v[156:159]
ds_read_b64_tr_b16 a[42:43], v28 offset:11528
v_mfma_f32_16x16x32_bf16 v[116:119], a[92:95], a[56:59], v[116:119]
ds_read_b64_tr_b16 a[44:45], v28 offset:10256
v_mfma_f32_16x16x32_bf16 v[120:123], a[96:99], a[56:59], v[120:123]
ds_read_b64_tr_b16 a[46:47], v28 offset:11536
v_mfma_f32_16x16x32_bf16 v[160:163], a[96:99], a[60:63], v[160:163]
ds_read_b64_tr_b16 a[48:49], v28 offset:10264
v_mfma_f32_16x16x32_bf16 v[200:203], a[96:99], a[64:67], v[200:203]
s_add_u32 m0, s62, 110592
v_mfma_f32_16x16x32_bf16 v[240:243], a[96:99], a[68:71], v[240:243]
buffer_load_dwordx4 v12, s[28:31], s60 offen offset:0  lds
v_mfma_f32_16x16x32_bf16 v[244:247], a[100:103], a[68:71], v[244:247]
ds_read_b64_tr_b16 a[50:51], v28 offset:11544
v_mfma_f32_16x16x32_bf16 v[204:207], a[100:103], a[64:67], v[204:207]
s_lshl_b32 s64, s59, 2
s_add_u32 s64, s64, s56
s_mul_i32 s64, s64, 800
s_mul_i32 s65, s56, 800
s_mov_b32 s66, m0
s_add_u32 m0, s65, 159744
v_mov_b32 v34, 0
v_mov_b32 v35, 0
v_mov_b32 v36, 0
v_mov_b32 v37, 0
v_add_u32 v2, 162944, v6
s_mov_b32 exec_hi, 0x3ffff
buffer_load_dwordx4 v6, s[44:47], s64 offen lds
ds_write_b128 v2, v[34:37]
s_mov_b32 exec_hi, -1
s_mov_b32 m0, s66
v_mfma_f32_16x16x32_bf16 v[164:167], a[100:103], a[60:63], v[164:167]
ds_read_b64_tr_b16 a[52:53], v28 offset:10272
ds_read_b64_tr_b16 a[54:55], v28 offset:11552
v_mfma_f32_16x16x32_bf16 v[124:127], a[100:103], a[56:59], v[124:127]
buffer_load_dwordx4 v13, s[28:31], s60 offen offset:1024  lds
v_mfma_f32_16x16x32_bf16 v[128:131], a[104:107], a[56:59], v[128:131]
v_mfma_f32_16x16x32_bf16 v[168:171], a[104:107], a[60:63], v[168:171]
v_mfma_f32_16x16x32_bf16 v[208:211], a[104:107], a[64:67], v[208:211]
v_mfma_f32_16x16x32_bf16 v[248:251], a[104:107], a[68:71], v[248:251]
v_mfma_f32_16x16x32_bf16 v[252:255], a[108:111], a[68:71], v[252:255]
v_mfma_f32_16x16x32_bf16 v[212:215], a[108:111], a[64:67], v[212:215]
buffer_load_dwordx4 v14, s[28:31], s60 offen offset:2048  lds
v_mfma_f32_16x16x32_bf16 v[172:175], a[108:111], a[60:63], v[172:175]
v_mfma_f32_16x16x32_bf16 v[132:135], a[108:111], a[56:59], v[132:135]
s_bitcmp1_b32 s72, 2
s_cbranch_scc1 Lcsk5
Lcrk5:
s_waitcnt lgkmcnt(0)
v_mfma_f32_16x16x32_bf16 v[96:99], a[16:19], a[0:3], v[96:99]
ds_read_b128 a[56:59], v23 offset:0
v_mfma_f32_16x16x32_bf16 v[136:139], a[16:19], a[4:7], v[136:139]
ds_read_b128 a[60:63], v23 offset:2048
v_mfma_f32_16x16x32_bf16 v[176:179], a[16:19], a[8:11], v[176:179]
v_mfma_f32_16x16x32_bf16 v[216:219], a[16:19], a[12:15], v[216:219]
ds_read_b128 a[64:67], v23 offset:4096
v_mfma_f32_16x16x32_bf16 v[220:223], a[20:23], a[12:15], v[220:223]
ds_read_b128 a[68:71], v23 offset:6144
v_mfma_f32_16x16x32_bf16 v[180:183], a[20:23], a[8:11], v[180:183]
buffer_load_dwordx4 v15, s[28:31], s60 offen offset:3072  lds
v_mfma_f32_16x16x32_bf16 v[140:143], a[20:23], a[4:7], v[140:143]
ds_read_b64_tr_b16 a[72:73], v28 offset:5120
ds_read_b64_tr_b16 a[74:75], v28 offset:6400
v_mfma_f32_16x16x32_bf16 v[100:103], a[20:23], a[0:3], v[100:103]
v_mfma_f32_16x16x32_bf16 v[104:107], a[24:27], a[0:3], v[104:107]
ds_read_b64_tr_b16 a[76:77], v28 offset:5128
v_mfma_f32_16x16x32_bf16 v[144:147], a[24:27], a[4:7], v[144:147]
ds_read_b64_tr_b16 a[78:79], v28 offset:6408
v_mfma_f32_16x16x32_bf16 v[184:187], a[24:27], a[8:11], v[184:187]
ds_read_b64_tr_b16 a[80:81], v28 offset:5136
v_mfma_f32_16x16x32_bf16 v[224:227], a[24:27], a[12:15], v[224:227]
s_add_u32 m0, s63, 106496
v_mfma_f32_16x16x32_bf16 v[228:231], a[28:31], a[12:15], v[228:231]
buffer_load_dwordx4 v16, s[32:35], s61 offen offset:0  lds
v_mfma_f32_16x16x32_bf16 v[188:191], a[28:31], a[8:11], v[188:191]
ds_read_b64_tr_b16 a[82:83], v28 offset:6416
ds_read_b64_tr_b16 a[84:85], v28 offset:5144
v_mfma_f32_16x16x32_bf16 v[148:151], a[28:31], a[4:7], v[148:151]
ds_read_b64_tr_b16 a[86:87], v28 offset:6424
v_mfma_f32_16x16x32_bf16 v[108:111], a[28:31], a[0:3], v[108:111]
ds_read_b64_tr_b16 a[88:89], v28 offset:5152
v_mfma_f32_16x16x32_bf16 v[112:115], a[32:35], a[0:3], v[112:115]
ds_read_b64_tr_b16 a[90:91], v28 offset:6432
v_mfma_f32_16x16x32_bf16 v[152:155], a[32:35], a[4:7], v[152:155]
buffer_load_dwordx4 v17, s[32:35], s61 offen offset:1024  lds
v_mfma_f32_16x16x32_bf16 v[192:195], a[32:35], a[8:11], v[192:195]
ds_read_b64_tr_b16 a[92:93], v28 offset:15360
v_mfma_f32_16x16x32_bf16 v[232:235], a[32:35], a[12:15], v[232:235]
ds_read_b64_tr_b16 a[94:95], v28 offset:16640
v_mfma_f32_16x16x32_bf16 v[236:239], a[36:39], a[12:15], v[236:239]
ds_read_b64_tr_b16 a[96:97], v28 offset:15368
v_mfma_f32_16x16x32_bf16 v[196:199], a[36:39], a[8:11], v[196:199]
ds_read_b64_tr_b16 a[98:99], v28 offset:16648
v_mfma_f32_16x16x32_bf16 v[156:159], a[36:39], a[4:7], v[156:159]
v_mfma_f32_16x16x32_bf16 v[116:119], a[36:39], a[0:3], v[116:119]
ds_read_b64_tr_b16 a[100:101], v28 offset:15376
v_mfma_f32_16x16x32_bf16 v[120:123], a[40:43], a[0:3], v[120:123]
buffer_load_dwordx4 v18, s[32:35], s61 offen offset:2048  lds
v_mfma_f32_16x16x32_bf16 v[160:163], a[40:43], a[4:7], v[160:163]
ds_read_b64_tr_b16 a[102:103], v28 offset:16656
ds_read_b64_tr_b16 a[104:105], v28 offset:15384
v_mfma_f32_16x16x32_bf16 v[200:203], a[40:43], a[8:11], v[200:203]
ds_read_b64_tr_b16 a[106:107], v28 offset:16664
v_mfma_f32_16x16x32_bf16 v[240:243], a[40:43], a[12:15], v[240:243]
v_mfma_f32_16x16x32_bf16 v[244:247], a[44:47], a[12:15], v[244:247]
ds_read_b64_tr_b16 a[108:109], v28 offset:15392
v_mfma_f32_16x16x32_bf16 v[204:207], a[44:47], a[8:11], v[204:207]
ds_read_b64_tr_b16 a[110:111], v28 offset:16672
v_mfma_f32_16x16x32_bf16 v[164:167], a[44:47], a[4:7], v[164:167]
buffer_load_dwordx4 v19, s[32:35], s61 offen offset:3072  lds
v_mfma_f32_16x16x32_bf16 v[124:127], a[44:47], a[0:3], v[124:127]
v_mfma_f32_16x16x32_bf16 v[128:131], a[48:51], a[0:3], v[128:131]
v_mfma_f32_16x16x32_bf16 v[168:171], a[48:51], a[4:7], v[168:171]
v_mfma_f32_16x16x32_bf16 v[208:211], a[48:51], a[8:11], v[208:211]
v_mfma_f32_16x16x32_bf16 v[248:251], a[48:51], a[12:15], v[248:251]
v_mfma_f32_16x16x32_bf16 v[252:255], a[52:55], a[12:15], v[252:255]
s_add_u32 m0, s63, 110592
v_mfma_f32_16x16x32_bf16 v[212:215], a[52:55], a[8:11], v[212:215]
buffer_load_dwordx4 v20, s[32:35], s61 offen offset:0  lds
v_mfma_f32_16x16x32_bf16 v[172:175], a[52:55], a[4:7], v[172:175]
v_mfma_f32_16x16x32_bf16 v[132:135], a[52:55], a[0:3], v[132:135]
s_bitcmp1_b32 s72, 3
s_cbranch_scc1 Lcsk6
Lcrk6:
s_waitcnt lgkmcnt(0)
s_waitcnt vmcnt(14)
s_barrier
v_cmp_eq_u32_e64 vcc, 0, v91
s_cbranch_vccz Lok1
s_mov_b32 s85, 40000
Lsp1:
buffer_load_dword v91, v90, s[48:51], 0 offen sc1
s_waitcnt vmcnt(0)
v_cmp_eq_u32 vcc, 0, v91
s_cbranch_vccz Lok1
s_sub_u32 s85, s85, 1
s_cmp_lg_u32 s85, 0
s_cbranch_scc1 Lsp1
Lok1:
v_mfma_f32_16x16x32_bf16 v[96:99], a[72:75], a[56:59], v[96:99]
ds_read_b128 a[0:3], v24 offset:0
v_mfma_f32_16x16x32_bf16 v[136:139], a[72:75], a[60:63], v[136:139]
ds_read_b128 a[4:7], v24 offset:2048
v_mfma_f32_16x16x32_bf16 v[176:179], a[72:75], a[64:67], v[176:179]
v_mfma_f32_16x16x32_bf16 v[216:219], a[72:75], a[68:71], v[216:219]
ds_read_b128 a[8:11], v24 offset:4096
v_mfma_f32_16x16x32_bf16 v[220:223], a[76:79], a[68:71], v[220:223]
ds_read_b128 a[12:15], v24 offset:6144
s_lshr_b64 s[74:75], s[74:75], 4
v_mfma_f32_16x16x32_bf16 v[180:183], a[76:79], a[64:67], v[180:183]
s_and_b32 s13, s74, 15
s_lshl_b32 s60, s13, 7
v_mfma_f32_16x16x32_bf16 v[140:143], a[76:79], a[60:63], v[140:143]
s_mul_i32 s61, s13, 245760
s_add_u32 m0, s62, 0
v_mfma_f32_16x16x32_bf16 v[100:103], a[76:79], a[56:59], v[100:103]
buffer_load_dwordx4 v8, s[28:31], s60 offen offset:0  lds
v_mfma_f32_16x16x32_bf16 v[104:107], a[80:83], a[56:59], v[104:107]
ds_read_b64_tr_b16 a[16:17], v30 offset:0
ds_read_b64_tr_b16 a[18:19], v30 offset:1280
v_mfma_f32_16x16x32_bf16 v[144:147], a[80:83], a[60:63], v[144:147]
ds_read_b64_tr_b16 a[20:21], v30 offset:8
ds_read_b64_tr_b16 a[22:23], v30 offset:1288
v_mfma_f32_16x16x32_bf16 v[184:187], a[80:83], a[64:67], v[184:187]
buffer_load_dwordx4 v9, s[28:31], s60 offen offset:1024  lds
v_mfma_f32_16x16x32_bf16 v[224:227], a[80:83], a[68:71], v[224:227]
ds_read_b64_tr_b16 a[24:25], v30 offset:16
ds_read_b64_tr_b16 a[26:27], v30 offset:1296
v_mfma_f32_16x16x32_bf16 v[228:231], a[84:87], a[68:71], v[228:231]
v_mfma_f32_16x16x32_bf16 v[188:191], a[84:87], a[64:67], v[188:191]
ds_read_b64_tr_b16 a[28:29], v30 offset:24
v_mfma_f32_16x16x32_bf16 v[148:151], a[84:87], a[60:63], v[148:151]
ds_read_b64_tr_b16 a[30:31], v30 offset:1304
v_mfma_f32_16x16x32_bf16 v[108:111], a[84:87], a[56:59], v[108:111]
buffer_load_dwordx4 v10, s[28:31], s60 offen offset:2048  lds
v_mfma_f32_16x16x32_bf16 v[112:115], a[88:91], a[56:59], v[112:115]
ds_read_b64_tr_b16 a[32:33], v30 offset:32
ds_read_b64_tr_b16 a[34:35], v30 offset:1312
v_mfma_f32_16x16x32_bf16 v[152:155], a[88:91], a[60:63], v[152:155]
v_mfma_f32_16x16x32_bf16 v[192:195], a[88:91], a[64:67], v[192:195]
ds_read_b64_tr_b16 a[36:37], v30 offset:10240
v_mfma_f32_16x16x32_bf16 v[232:235], a[88:91], a[68:71], v[232:235]
ds_read_b64_tr_b16 a[38:39], v30 offset:11520
v_mfma_f32_16x16x32_bf16 v[236:239], a[92:95], a[68:71], v[236:239]
ds_read_b64_tr_b16 a[40:41], v30 offset:10248
v_mfma_f32_16x16x32_bf16 v[196:199], a[92:95], a[64:67], v[196:199]
buffer_load_dwordx4 v11, s[28:31], s60 offen offset:3072  lds
v_mfma_f32_16x16x32_bf16 v[156:159], a[92:95], a[60:63], v[156:159]
ds_read_b64_tr_b16 a[42:43], v30 offset:11528
v_mfma_f32_16x16x32_bf16 v[116:119], a[92:95], a[56:59], v[116:119]
ds_read_b64_tr_b16 a[44:45], v30 offset:10256
v_mfma_f32_16x16x32_bf16 v[120:123], a[96:99], a[56:59], v[120:123]
ds_read_b64_tr_b16 a[46:47], v30 offset:11536
v_mfma_f32_16x16x32_bf16 v[160:163], a[96:99], a[60:63], v[160:163]
ds_read_b64_tr_b16 a[48:49], v30 offset:10264
v_mfma_f32_16x16x32_bf16 v[200:203], a[96:99], a[64:67], v[200:203]
s_add_u32 m0, s62, 4096
v_mfma_f32_16x16x32_bf16 v[240:243], a[96:99], a[68:71], v[240:243]
buffer_load_dwordx4 v12, s[28:31], s60 offen offset:0  lds
v_mfma_f32_16x16x32_bf16 v[244:247], a[100:103], a[68:71], v[244:247]
ds_read_b64_tr_b16 a[50:51], v30 offset:11544
ds_read_b64_tr_b16 a[52:53], v30 offset:10272
v_mfma_f32_16x16x32_bf16 v[204:207], a[100:103], a[64:67], v[204:207]
ds_read_b64_tr_b16 a[54:55], v30 offset:11552
v_mfma_f32_16x16x32_bf16 v[164:167], a[100:103], a[60:63], v[164:167]
v_mfma_f32_16x16x32_bf16 v[124:127], a[100:103], a[56:59], v[124:127]
buffer_load_dwordx4 v13, s[28:31], s60 offen offset:1024  lds
v_mfma_f32_16x16x32_bf16 v[128:131], a[104:107], a[56:59], v[128:131]
v_mfma_f32_16x16x32_bf16 v[168:171], a[104:107], a[60:63], v[168:171]
v_mfma_f32_16x16x32_bf16 v[208:211], a[104:107], a[64:67], v[208:211]
v_mfma_f32_16x16x32_bf16 v[248:251], a[104:107], a[68:71], v[248:251]
v_mfma_f32_16x16x32_bf16 v[252:255], a[108:111], a[68:71], v[252:255]
v_mfma_f32_16x16x32_bf16 v[212:215], a[108:111], a[64:67], v[212:215]
buffer_load_dwordx4 v14, s[28:31], s60 offen offset:2048  lds
v_mfma_f32_16x16x32_bf16 v[172:175], a[108:111], a[60:63], v[172:175]
v_mfma_f32_16x16x32_bf16 v[132:135], a[108:111], a[56:59], v[132:135]
s_bitcmp1_b32 s72, 3
s_cbranch_scc1 Lcsk7
Lcrk7:
s_waitcnt lgkmcnt(0)
v_mfma_f32_16x16x32_bf16 v[96:99], a[16:19], a[0:3], v[96:99]
ds_read_b128 a[56:59], v25 offset:0
v_mfma_f32_16x16x32_bf16 v[136:139], a[16:19], a[4:7], v[136:139]
ds_read_b128 a[60:63], v25 offset:2048
v_mfma_f32_16x16x32_bf16 v[176:179], a[16:19], a[8:11], v[176:179]
v_mfma_f32_16x16x32_bf16 v[216:219], a[16:19], a[12:15], v[216:219]
ds_read_b128 a[64:67], v25 offset:4096
v_mfma_f32_16x16x32_bf16 v[220:223], a[20:23], a[12:15], v[220:223]
ds_read_b128 a[68:71], v25 offset:6144
v_mfma_f32_16x16x32_bf16 v[180:183], a[20:23], a[8:11], v[180:183]
buffer_load_dwordx4 v15, s[28:31], s60 offen offset:3072  lds
v_mfma_f32_16x16x32_bf16 v[140:143], a[20:23], a[4:7], v[140:143]
ds_read_b64_tr_b16 a[72:73], v30 offset:5120
ds_read_b64_tr_b16 a[74:75], v30 offset:6400
v_mfma_f32_16x16x32_bf16 v[100:103], a[20:23], a[0:3], v[100:103]
v_mfma_f32_16x16x32_bf16 v[104:107], a[24:27], a[0:3], v[104:107]
ds_read_b64_tr_b16 a[76:77], v30 offset:5128
v_mfma_f32_16x16x32_bf16 v[144:147], a[24:27], a[4:7], v[144:147]
ds_read_b64_tr_b16 a[78:79], v30 offset:6408
v_mfma_f32_16x16x32_bf16 v[184:187], a[24:27], a[8:11], v[184:187]
ds_read_b64_tr_b16 a[80:81], v30 offset:5136
v_mfma_f32_16x16x32_bf16 v[224:227], a[24:27], a[12:15], v[224:227]
s_add_u32 m0, s63, 0
v_mfma_f32_16x16x32_bf16 v[228:231], a[28:31], a[12:15], v[228:231]
buffer_load_dwordx4 v16, s[32:35], s61 offen offset:0  lds
v_mfma_f32_16x16x32_bf16 v[188:191], a[28:31], a[8:11], v[188:191]
ds_read_b64_tr_b16 a[82:83], v30 offset:6416
ds_read_b64_tr_b16 a[84:85], v30 offset:5144
v_mfma_f32_16x16x32_bf16 v[148:151], a[28:31], a[4:7], v[148:151]
ds_read_b64_tr_b16 a[86:87], v30 offset:6424
v_mfma_f32_16x16x32_bf16 v[108:111], a[28:31], a[0:3], v[108:111]
ds_read_b64_tr_b16 a[88:89], v30 offset:5152
v_mfma_f32_16x16x32_bf16 v[112:115], a[32:35], a[0:3], v[112:115]
ds_read_b64_tr_b16 a[90:91], v30 offset:6432
v_mfma_f32_16x16x32_bf16 v[152:155], a[32:35], a[4:7], v[152:155]
buffer_load_dwordx4 v17, s[32:35], s61 offen offset:1024  lds
v_mfma_f32_16x16x32_bf16 v[192:195], a[32:35], a[8:11], v[192:195]
ds_read_b64_tr_b16 a[92:93], v30 offset:15360
v_mfma_f32_16x16x32_bf16 v[232:235], a[32:35], a[12:15], v[232:235]
ds_read_b64_tr_b16 a[94:95], v30 offset:16640
v_mfma_f32_16x16x32_bf16 v[236:239], a[36:39], a[12:15], v[236:239]
ds_read_b64_tr_b16 a[96:97], v30 offset:15368
v_mfma_f32_16x16x32_bf16 v[196:199], a[36:39], a[8:11], v[196:199]
ds_read_b64_tr_b16 a[98:99], v30 offset:16648
v_mfma_f32_16x16x32_bf16 v[156:159], a[36:39], a[4:7], v[156:159]
v_mfma_f32_16x16x32_bf16 v[116:119], a[36:39], a[0:3], v[116:119]
ds_read_b64_tr_b16 a[100:101], v30 offset:15376
v_mfma_f32_16x16x32_bf16 v[120:123], a[40:43], a[0:3], v[120:123]
buffer_load_dwordx4 v18, s[32:35], s61 offen offset:2048  lds
v_mfma_f32_16x16x32_bf16 v[160:163], a[40:43], a[4:7], v[160:163]
ds_read_b64_tr_b16 a[102:103], v30 offset:16656
ds_read_b64_tr_b16 a[104:105], v30 offset:15384
v_mfma_f32_16x16x32_bf16 v[200:203], a[40:43], a[8:11], v[200:203]
ds_read_b64_tr_b16 a[106:107], v30 offset:16664
v_mfma_f32_16x16x32_bf16 v[240:243], a[40:43], a[12:15], v[240:243]
v_mfma_f32_16x16x32_bf16 v[244:247], a[44:47], a[12:15], v[244:247]
ds_read_b64_tr_b16 a[108:109], v30 offset:15392
v_mfma_f32_16x16x32_bf16 v[204:207], a[44:47], a[8:11], v[204:207]
ds_read_b64_tr_b16 a[110:111], v30 offset:16672
v_mfma_f32_16x16x32_bf16 v[164:167], a[44:47], a[4:7], v[164:167]
buffer_load_dwordx4 v19, s[32:35], s61 offen offset:3072  lds
v_mfma_f32_16x16x32_bf16 v[124:127], a[44:47], a[0:3], v[124:127]
v_mfma_f32_16x16x32_bf16 v[128:131], a[48:51], a[0:3], v[128:131]
v_mfma_f32_16x16x32_bf16 v[168:171], a[48:51], a[4:7], v[168:171]
v_mfma_f32_16x16x32_bf16 v[208:211], a[48:51], a[8:11], v[208:211]
v_mfma_f32_16x16x32_bf16 v[248:251], a[48:51], a[12:15], v[248:251]
v_mfma_f32_16x16x32_bf16 v[252:255], a[52:55], a[12:15], v[252:255]
s_add_u32 m0, s63, 4096
v_mfma_f32_16x16x32_bf16 v[212:215], a[52:55], a[8:11], v[212:215]
buffer_load_dwordx4 v20, s[32:35], s61 offen offset:0  lds
v_mfma_f32_16x16x32_bf16 v[172:175], a[52:55], a[4:7], v[172:175]
v_mfma_f32_16x16x32_bf16 v[132:135], a[52:55], a[0:3], v[132:135]
s_waitcnt lgkmcnt(0)
s_waitcnt vmcnt(13)
s_barrier
v_mfma_f32_16x16x32_bf16 v[96:99], a[72:75], a[56:59], v[96:99]
ds_read_b128 a[0:3], v26 offset:0
v_mfma_f32_16x16x32_bf16 v[136:139], a[72:75], a[60:63], v[136:139]
v_lshrrev_b32 v2, 4, v1
v_and_b32_e64 v3, 3, v1
v_mfma_f32_16x16x32_bf16 v[176:179], a[72:75], a[64:67], v[176:179]
v_cmp_eq_u32_e64 vcc, v2, v3
v_mul_u32_u24 v2, 800, v2
v_mfma_f32_16x16x32_bf16 v[216:219], a[72:75], a[68:71], v[216:219]
v_mov_b32 v3, 3200
v_bfe_u32 v4, v1, 2, 2
v_mfma_f32_16x16x32_bf16 v[220:223], a[76:79], a[68:71], v[220:223]
v_cndmask_b32_e64 v2, v3, v2, vcc
v_mul_u32_u24 v4, 40, v4
v_mfma_f32_16x16x32_bf16 v[180:183], a[76:79], a[64:67], v[180:183]
s_mov_b32 s64, 159744
v_add3_u32 v34, v2, v4, s64
v_mfma_f32_16x16x32_bf16 v[140:143], a[76:79], a[60:63], v[140:143]
ds_read_b128 a[4:7], v26 offset:2048
ds_read_b128 a[8:11], v26 offset:4096
v_mfma_f32_16x16x32_bf16 v[100:103], a[76:79], a[56:59], v[100:103]
ds_read_b128 a[12:15], v26 offset:6144
s_lshr_b64 s[74:75], s[74:75], 4
v_mfma_f32_16x16x32_bf16 v[104:107], a[80:83], a[56:59], v[104:107]
s_and_b32 s13, s74, 15
s_lshl_b32 s60, s13, 7
v_mfma_f32_16x16x32_bf16 v[144:147], a[80:83], a[60:63], v[144:147]
s_mul_i32 s61, s13, 245760
s_add_u32 m0, s62, 53248
v_mfma_f32_16x16x32_bf16 v[184:187], a[80:83], a[64:67], v[184:187]
buffer_load_dwordx4 v8, s[28:31], s60 offen offset:0  lds
v_mfma_f32_16x16x32_bf16 v[224:227], a[80:83], a[68:71], v[224:227]
ds_read_b64_tr_b16 a[196:197], v34 offset:0
ds_read_b64_tr_b16 a[16:17], v32 offset:0
v_mfma_f32_16x16x32_bf16 v[228:231], a[84:87], a[68:71], v[228:231]
ds_read_b64_tr_b16 a[18:19], v32 offset:1280
ds_read_b64_tr_b16 a[198:199], v34 offset:160
v_mfma_f32_16x16x32_bf16 v[188:191], a[84:87], a[64:67], v[188:191]
ds_read_b64_tr_b16 a[20:21], v32 offset:8
ds_read_b64_tr_b16 a[22:23], v32 offset:1288
v_mfma_f32_16x16x32_bf16 v[148:151], a[84:87], a[60:63], v[148:151]
buffer_load_dwordx4 v9, s[28:31], s60 offen offset:1024  lds
v_mfma_f32_16x16x32_bf16 v[108:111], a[84:87], a[56:59], v[108:111]
ds_read_b64_tr_b16 a[24:25], v32 offset:16
ds_read_b64_tr_b16 a[200:201], v34 offset:320
v_mfma_f32_16x16x32_bf16 v[112:115], a[88:91], a[56:59], v[112:115]
ds_read_b64_tr_b16 a[26:27], v32 offset:1296
ds_read_b64_tr_b16 a[28:29], v32 offset:24
v_mfma_f32_16x16x32_bf16 v[152:155], a[88:91], a[60:63], v[152:155]
ds_read_b64_tr_b16 a[202:203], v34 offset:480
ds_read_b64_tr_b16 a[30:31], v32 offset:1304
v_mfma_f32_16x16x32_bf16 v[192:195], a[88:91], a[64:67], v[192:195]
buffer_load_dwordx4 v10, s[28:31], s60 offen offset:2048  lds
v_mfma_f32_16x16x32_bf16 v[232:235], a[88:91], a[68:71], v[232:235]
ds_read_b64_tr_b16 a[32:33], v32 offset:32
ds_read_b64_tr_b16 a[34:35], v32 offset:1312
v_mfma_f32_16x16x32_bf16 v[236:239], a[92:95], a[68:71], v[236:239]
ds_read_b64_tr_b16 a[204:205], v34 offset:640
ds_read_b64_tr_b16 a[36:37], v32 offset:10240
v_mfma_f32_16x16x32_bf16 v[196:199], a[92:95], a[64:67], v[196:199]
ds_read_b64_tr_b16 a[38:39], v32 offset:11520
v_accvgpr_write_b32 a206, 0
v_mfma_f32_16x16x32_bf16 v[156:159], a[92:95], a[60:63], v[156:159]
ds_read_b64_tr_b16 a[40:41], v32 offset:10248
v_mfma_f32_16x16x32_bf16 v[116:119], a[92:95], a[56:59], v[116:119]
buffer_load_dwordx4 v11, s[28:31], s60 offen offset:3072  lds
v_mfma_f32_16x16x32_bf16 v[120:123], a[96:99], a[56:59], v[120:123]
ds_read_b64_tr_b16 a[42:43], v32 offset:11528
ds_read_b64_tr_b16 a[44:45], v32 offset:10256
v_mfma_f32_16x16x32_bf16 v[160:163], a[96:99], a[60:63], v[160:163]
v_accvgpr_write_b32 a207, 0
ds_read_b64_tr_b16 a[46:47], v32 offset:11536
v_mfma_f32_16x16x32_bf16 v[200:203], a[96:99], a[64:67], v[200:203]
ds_read_b64_tr_b16 a[48:49], v32 offset:10264
ds_read_b64_tr_b16 a[208:209], v34 offset:8
v_mfma_f32_16x16x32_bf16 v[240:243], a[96:99], a[68:71], v[240:243]
s_add_u32 m0, s62, 57344
v_mfma_f32_16x16x32_bf16 v[244:247], a[100:103], a[68:71], v[244:247]
buffer_load_dwordx4 v12, s[28:31], s60 offen offset:0  lds
v_mfma_f32_16x16x32_bf16 v[204:207], a[100:103], a[64:67], v[204:207]
ds_read_b64_tr_b16 a[50:51], v32 offset:11544
ds_read_b64_tr_b16 a[52:53], v32 offset:10272
v_mfma_f32_16x16x32_bf16 v[164:167], a[100:103], a[60:63], v[164:167]
ds_read_b64_tr_b16 a[210:211], v34 offset:168
ds_read_b64_tr_b16 a[54:55], v32 offset:11552
v_mfma_f32_16x16x32_bf16 v[124:127], a[100:103], a[56:59], v[124:127]
buffer_load_dwordx4 v13, s[28:31], s60 offen offset:1024  lds
v_mfma_f32_16x16x32_bf16 v[128:131], a[104:107], a[56:59], v[128:131]
ds_read_b64_tr_b16 a[212:213], v34 offset:328
v_mfma_f32_16x16x32_bf16 v[168:171], a[104:107], a[60:63], v[168:171]
v_mfma_f32_16x16x32_bf16 v[208:211], a[104:107], a[64:67], v[208:211]
v_mfma_f32_16x16x32_bf16 v[248:251], a[104:107], a[68:71], v[248:251]
ds_read_b64_tr_b16 a[214:215], v34 offset:488
v_mfma_f32_16x16x32_bf16 v[252:255], a[108:111], a[68:71], v[252:255]
v_mfma_f32_16x16x32_bf16 v[212:215], a[108:111], a[64:67], v[212:215]
buffer_load_dwordx4 v14, s[28:31], s60 offen offset:2048  lds
v_mfma_f32_16x16x32_bf16 v[172:175], a[108:111], a[60:63], v[172:175]
v_mfma_f32_16x16x32_bf16 v[132:135], a[108:111], a[56:59], v[132:135]
s_waitcnt lgkmcnt(0)
v_mfma_f32_16x16x32_bf16 v[96:99], a[16:19], a[0:3], v[96:99]
ds_read_b128 a[56:59], v27 offset:0
v_mfma_f32_16x16x32_bf16 v[136:139], a[16:19], a[4:7], v[136:139]
ds_read_b128 a[60:63], v27 offset:2048
v_mfma_f32_16x16x32_bf16 v[176:179], a[16:19], a[8:11], v[176:179]
v_mfma_f32_16x16x32_bf16 v[216:219], a[16:19], a[12:15], v[216:219]
ds_read_b128 a[64:67], v27 offset:4096
v_mfma_f32_16x16x32_bf16 v[220:223], a[20:23], a[12:15], v[220:223]
ds_read_b128 a[68:71], v27 offset:6144
v_mfma_f32_16x16x32_bf16 v[180:183], a[20:23], a[8:11], v[180:183]
buffer_load_dwordx4 v15, s[28:31], s60 offen offset:3072  lds
ds_read_b64_tr_b16 a[72:73], v32 offset:5120
v_mfma_f32_16x16x32_bf16 v[140:143], a[20:23], a[4:7], v[140:143]
ds_read_b64_tr_b16 a[74:75], v32 offset:6400
v_mfma_f32_16x16x32_bf16 v[100:103], a[20:23], a[0:3], v[100:103]
v_mfma_f32_16x16x32_bf16 v[104:107], a[24:27], a[0:3], v[104:107]
ds_read_b64_tr_b16 a[76:77], v32 offset:5128
v_mfma_f32_16x16x32_bf16 v[144:147], a[24:27], a[4:7], v[144:147]
ds_read_b64_tr_b16 a[78:79], v32 offset:6408
v_mfma_f32_16x16x32_bf16 v[184:187], a[24:27], a[8:11], v[184:187]
ds_read_b64_tr_b16 a[80:81], v32 offset:5136
v_mfma_f32_16x16x32_bf16 v[224:227], a[24:27], a[12:15], v[224:227]
s_add_u32 m0, s63, 53248
v_mfma_f32_16x16x32_bf16 v[228:231], a[28:31], a[12:15], v[228:231]
buffer_load_dwordx4 v16, s[32:35], s61 offen offset:0  lds
ds_read_b64_tr_b16 a[82:83], v32 offset:6416
v_mfma_f32_16x16x32_bf16 v[188:191], a[28:31], a[8:11], v[188:191]
ds_read_b64_tr_b16 a[84:85], v32 offset:5144
v_mfma_f32_16x16x32_bf16 v[148:151], a[28:31], a[4:7], v[148:151]
ds_read_b64_tr_b16 a[86:87], v32 offset:6424
v_mfma_f32_16x16x32_bf16 v[108:111], a[28:31], a[0:3], v[108:111]
ds_read_b64_tr_b16 a[88:89], v32 offset:5152
v_mfma_f32_16x16x32_bf16 v[112:115], a[32:35], a[0:3], v[112:115]
ds_read_b64_tr_b16 a[90:91], v32 offset:6432
v_mfma_f32_16x16x32_bf16 v[152:155], a[32:35], a[4:7], v[152:155]
buffer_load_dwordx4 v17, s[32:35], s61 offen offset:1024  lds
v_mfma_f32_16x16x32_bf16 v[192:195], a[32:35], a[8:11], v[192:195]
ds_read_b64_tr_b16 a[92:93], v32 offset:15360
v_mov_b32_e64 v4, s57
s_and_b32 s65, s72, 15
v_mfma_f32_16x16x32_bf16 v[232:235], a[32:35], a[12:15], v[232:235]
v_mov_b32 v5, s65
s_add_u32 s64, s59, 0
s_mul_i32 s64, s64, 1280
v_mfma_f32_16x16x32_bf16 v[236:239], a[36:39], a[12:15], v[236:239]
s_add_u32 s64, s64, 17088512
v_lshlrev_b32 v2, 2, v1
v_lshrrev_b32 v3, v2, v4
v_mfma_f32_16x16x32_bf16 v[196:199], a[36:39], a[8:11], v[196:199]
v_and_b32_e64 v3, 15, v3
v_lshl_add_u32 v3, v3, 7, s64
v_lshrrev_b32_e64 v5, v1, v5
v_mfma_f32_16x16x32_bf16 v[156:159], a[36:39], a[4:7], v[156:159]
v_and_b32 v5, 1, v5
v_cmp_eq_u32 vcc, 1, v5
v_mov_b32 v5, 0x7f000000
v_mfma_f32_16x16x32_bf16 v[116:119], a[36:39], a[0:3], v[116:119]
v_min_u32 v2, 4, v1
v_cndmask_b32 v87, v5, v3, vcc
v_cmp_gt_u32 vcc, 4, v1
v_mfma_f32_16x16x32_bf16 v[120:123], a[40:43], a[0:3], v[120:123]
s_nop 0
v_mov_b32 v5, 0x7f000000
v_cndmask_b32_e64 v87, v5, v87, vcc
v_mfma_f32_16x16x32_bf16 v[160:163], a[40:43], a[4:7], v[160:163]
v_and_b32 v2, 15, v1
v_min_u32 v3, 9, v2
v_lshl_add_u32 v3, v3, 7, s64
v_mfma_f32_16x16x32_bf16 v[200:203], a[40:43], a[8:11], v[200:203]
s_mul_i32 s65, s58, 16
v_min_u32 v2, 15, v2
v_add_u32_e64 v2, s65, v2
v_mfma_f32_16x16x32_bf16 v[240:243], a[40:43], a[12:15], v[240:243]
v_min_u32 v2, 127, v2
v_lshlrev_b32_e64 v2, 7, v2
v_add_u32 v2, 17072128, v2
v_mfma_f32_16x16x32_bf16 v[244:247], a[44:47], a[12:15], v[244:247]
v_and_b32_e64 v5, 16, v1
v_cmp_eq_u32 vcc, 0, v5
s_nop 1
v_mfma_f32_16x16x32_bf16 v[204:207], a[44:47], a[8:11], v[204:207]
v_cndmask_b32_e64 v89, v3, v2, vcc
s_mul_i32 s65, s96, 5
s_lshr_b32 s65, s65, 2
v_mfma_f32_16x16x32_bf16 v[164:167], a[44:47], a[4:7], v[164:167]
s_mul_i32 s65, s65, 2176
s_add_u32 s65, s65, 17379328
v_min_u32_e64 v2, 33, v1
v_mfma_f32_16x16x32_bf16 v[124:127], a[44:47], a[0:3], v[124:127]
v_lshl_add_u32 v88, v2, 7, s65
s_lshr_b32 s65, s27, 2
s_mul_i32 s65, s65, 27
v_mfma_f32_16x16x32_bf16 v[128:131], a[48:51], a[0:3], v[128:131]
s_lshr_b32 s65, s65, 1
v_min_u32 v2, 14, v1
v_add_u32_e64 v2, s65, v2
v_mfma_f32_16x16x32_bf16 v[168:171], a[48:51], a[4:7], v[168:171]
v_min_u32 v2, 107, v2
s_mov_b32 s65, 17379328
v_lshl_add_u32 v85, v2, 7, s65
v_mfma_f32_16x16x32_bf16 v[208:211], a[48:51], a[8:11], v[208:211]
ds_read_b64_tr_b16 a[94:95], v32 offset:16640
ds_read_b64_tr_b16 a[96:97], v32 offset:15368
ds_read_b64_tr_b16 a[98:99], v32 offset:16648
v_mfma_f32_16x16x32_bf16 v[248:251], a[48:51], a[12:15], v[248:251]
ds_read_b64_tr_b16 a[100:101], v32 offset:15376
buffer_load_dwordx4 v18, s[32:35], s61 offen offset:2048  lds
v_mfma_f32_16x16x32_bf16 v[252:255], a[52:55], a[12:15], v[252:255]
ds_read_b64_tr_b16 a[102:103], v32 offset:16656
ds_read_b64_tr_b16 a[104:105], v32 offset:15384
ds_read_b64_tr_b16 a[106:107], v32 offset:16664
v_mfma_f32_16x16x32_bf16 v[212:215], a[52:55], a[8:11], v[212:215]
ds_read_b64_tr_b16 a[108:109], v32 offset:15392
ds_read_b64_tr_b16 a[110:111], v32 offset:16672
v_mfma_f32_16x16x32_bf16 v[172:175], a[52:55], a[4:7], v[172:175]
buffer_load_dwordx4 v19, s[32:35], s61 offen offset:3072  lds
s_add_u32 m0, s63, 57344
v_mfma_f32_16x16x32_bf16 v[132:135], a[52:55], a[0:3], v[132:135]
buffer_load_dwordx4 v20, s[32:35], s61 offen offset:0  lds
s_waitcnt lgkmcnt(0)
s_waitcnt vmcnt(13)
s_barrier
s_cmp_eq_u32 s56, 0
s_cbranch_scc0 Lw0_1
buffer_store_dword v21, v87, s[40:43], 0 offen sc1
Lw0_1:
v_mfma_f32_16x16x32_bf16 v[96:99], a[72:75], a[56:59], v[96:99]
ds_read_b128 a[0:3], v22 offset:0
v_mfma_f32_16x16x32_bf16 v[136:139], a[72:75], a[60:63], v[136:139]
ds_read_b64_tr_b16 a[216:217], v34 offset:648
ds_read_b128 a[4:7], v22 offset:2048
v_mfma_f32_16x16x32_bf16 v[176:179], a[72:75], a[64:67], v[176:179]
v_mfma_f32_16x16x32_bf16 v[216:219], a[72:75], a[68:71], v[216:219]
ds_read_b128 a[8:11], v22 offset:4096
v_mfma_f32_16x16x32_bf16 v[220:223], a[76:79], a[68:71], v[220:223]
ds_read_b128 a[12:15], v22 offset:6144
s_lshr_b64 s[74:75], s[74:75], 4
v_mfma_f32_16x16x32_bf16 v[180:183], a[76:79], a[64:67], v[180:183]
s_and_b32 s13, s74, 15
s_lshl_b32 s60, s13, 7
v_mfma_f32_16x16x32_bf16 v[140:143], a[76:79], a[60:63], v[140:143]
s_mul_i32 s61, s13, 245760
s_add_u32 m0, s62, 106496
v_mfma_f32_16x16x32_bf16 v[100:103], a[76:79], a[56:59], v[100:103]
buffer_load_dwordx4 v8, s[28:31], s60 offen offset:0  lds
v_mfma_f32_16x16x32_bf16 v[104:107], a[80:83], a[56:59], v[104:107]
v_accvgpr_write_b32 a218, 0
ds_read_b64_tr_b16 a[16:17], v28 offset:0
v_mfma_f32_16x16x32_bf16 v[144:147], a[80:83], a[60:63], v[144:147]
ds_read_b64_tr_b16 a[18:19], v28 offset:1280
v_accvgpr_write_b32 a219, 0
v_mfma_f32_16x16x32_bf16 v[184:187], a[80:83], a[64:67], v[184:187]
ds_read_b64_tr_b16 a[20:21], v28 offset:8
ds_read_b64_tr_b16 a[22:23], v28 offset:1288
v_mfma_f32_16x16x32_bf16 v[224:227], a[80:83], a[68:71], v[224:227]
buffer_load_dwordx4 v9, s[28:31], s60 offen offset:1024  lds
v_mfma_f32_16x16x32_bf16 v[228:231], a[84:87], a[68:71], v[228:231]
ds_read_b64_tr_b16 a[24:25], v28 offset:16
ds_read_b64_tr_b16 a[220:221], v34 offset:16
v_mfma_f32_16x16x32_bf16 v[188:191], a[84:87], a[64:67], v[188:191]
ds_read_b64_tr_b16 a[26:27], v28 offset:1296
ds_read_b64_tr_b16 a[28:29], v28 offset:24
v_mfma_f32_16x16x32_bf16 v[148:151], a[84:87], a[60:63], v[148:151]
ds_read_b64_tr_b16 a[222:223], v34 offset:176
ds_read_b64_tr_b16 a[30:31], v28 offset:1304
v_mfma_f32_16x16x32_bf16 v[108:111], a[84:87], a[56:59], v[108:111]
buffer_load_dwordx4 v10, s[28:31], s60 offen offset:2048  lds
v_mfma_f32_16x16x32_bf16 v[112:115], a[88:91], a[56:59], v[112:115]
ds_read_b64_tr_b16 a[32:33], v28 offset:32
ds_read_b64_tr_b16 a[34:35], v28 offset:1312
v_mfma_f32_16x16x32_bf16 v[152:155], a[88:91], a[60:63], v[152:155]
ds_read_b64_tr_b16 a[224:225], v34 offset:336
v_mfma_f32_16x16x32_bf16 v[192:195], a[88:91], a[64:67], v[192:195]
ds_read_b64_tr_b16 a[36:37], v28 offset:10240
v_mfma_f32_16x16x32_bf16 v[232:235], a[88:91], a[68:71], v[232:235]
ds_read_b64_tr_b16 a[38:39], v28 offset:11520
v_mfma_f32_16x16x32_bf16 v[236:239], a[92:95], a[68:71], v[236:239]
ds_read_b64_tr_b16 a[226:227], v34 offset:496
ds_read_b64_tr_b16 a[40:41], v28 offset:10248
v_mfma_f32_16x16x32_bf16 v[196:199], a[92:95], a[64:67], v[196:199]
buffer_load_dwordx4 v11, s[28:31], s60 offen offset:3072  lds
v_mfma_f32_16x16x32_bf16 v[156:159], a[92:95], a[60:63], v[156:159]
ds_read_b64_tr_b16 a[42:43], v28 offset:11528
v_mfma_f32_16x16x32_bf16 v[116:119], a[92:95], a[56:59], v[116:119]
ds_read_b64_tr_b16 a[44:45], v28 offset:10256
ds_read_b64_tr_b16 a[228:229], v34 offset:656
v_mfma_f32_16x16x32_bf16 v[120:123], a[96:99], a[56:59], v[120:123]
ds_read_b64_tr_b16 a[46:47], v28 offset:11536
v_mfma_f32_16x16x32_bf16 v[160:163], a[96:99], a[60:63], v[160:163]
ds_read_b64_tr_b16 a[48:49], v28 offset:10264
v_mfma_f32_16x16x32_bf16 v[200:203], a[96:99], a[64:67], v[200:203]
v_accvgpr_write_b32 a230, 0
s_add_u32 m0, s62, 110592
v_mfma_f32_16x16x32_bf16 v[240:243], a[96:99], a[68:71], v[240:243]
buffer_load_dwordx4 v12, s[28:31], s60 offen offset:0  lds
v_mfma_f32_16x16x32_bf16 v[244:247], a[100:103], a[68:71], v[244:247]
ds_read_b64_tr_b16 a[50:51], v28 offset:11544
ds_read_b64_tr_b16 a[52:53], v28 offset:10272
v_mfma_f32_16x16x32_bf16 v[204:207], a[100:103], a[64:67], v[204:207]
v_accvgpr_write_b32 a231, 0
ds_read_b64_tr_b16 a[54:55], v28 offset:11552
v_mfma_f32_16x16x32_bf16 v[164:167], a[100:103], a[60:63], v[164:167]
v_mfma_f32_16x16x32_bf16 v[124:127], a[100:103], a[56:59], v[124:127]
buffer_load_dwordx4 v13, s[28:31], s60 offen offset:1024  lds
v_mfma_f32_16x16x32_bf16 v[128:131], a[104:107], a[56:59], v[128:131]
ds_read_b64_tr_b16 a[232:233], v34 offset:24
v_mfma_f32_16x16x32_bf16 v[168:171], a[104:107], a[60:63], v[168:171]
v_mfma_f32_16x16x32_bf16 v[208:211], a[104:107], a[64:67], v[208:211]
v_mfma_f32_16x16x32_bf16 v[248:251], a[104:107], a[68:71], v[248:251]
ds_read_b64_tr_b16 a[234:235], v34 offset:184
v_mfma_f32_16x16x32_bf16 v[252:255], a[108:111], a[68:71], v[252:255]
v_mfma_f32_16x16x32_bf16 v[212:215], a[108:111], a[64:67], v[212:215]
buffer_load_dwordx4 v14, s[28:31], s60 offen offset:2048  lds
v_mfma_f32_16x16x32_bf16 v[172:175], a[108:111], a[60:63], v[172:175]
v_mfma_f32_16x16x32_bf16 v[132:135], a[108:111], a[56:59], v[132:135]
s_waitcnt lgkmcnt(0)
v_mfma_f32_16x16x32_bf16 v[96:99], a[16:19], a[0:3], v[96:99]
ds_read_b128 a[56:59], v23 offset:0
v_mfma_f32_16x16x32_bf16 v[136:139], a[16:19], a[4:7], v[136:139]
ds_read_b128 a[60:63], v23 offset:2048
v_mfma_f32_16x16x32_bf16 v[176:179], a[16:19], a[8:11], v[176:179]
v_mfma_f32_16x16x32_bf16 v[216:219], a[16:19], a[12:15], v[216:219]
ds_read_b128 a[64:67], v23 offset:4096
v_mfma_f32_16x16x32_bf16 v[220:223], a[20:23], a[12:15], v[220:223]
ds_read_b128 a[68:71], v23 offset:6144
v_mfma_f32_16x16x32_bf16 v[180:183], a[20:23], a[8:11], v[180:183]
buffer_load_dwordx4 v15, s[28:31], s60 offen offset:3072  lds
v_mfma_f32_16x16x32_bf16 v[140:143], a[20:23], a[4:7], v[140:143]
ds_read_b64_tr_b16 a[72:73], v28 offset:5120
ds_read_b64_tr_b16 a[74:75], v28 offset:6400
v_mfma_f32_16x16x32_bf16 v[100:103], a[20:23], a[0:3], v[100:103]
v_mfma_f32_16x16x32_bf16 v[104:107], a[24:27], a[0:3], v[104:107]
ds_read_b64_tr_b16 a[76:77], v28 offset:5128
v_mfma_f32_16x16x32_bf16 v[144:147], a[24:27], a[4:7], v[144:147]
ds_read_b64_tr_b16 a[78:79], v28 offset:6408
v_mfma_f32_16x16x32_bf16 v[184:187], a[24:27], a[8:11], v[184:187]
ds_read_b64_tr_b16 a[80:81], v28 offset:5136
v_mfma_f32_16x16x32_bf16 v[224:227], a[24:27], a[12:15], v[224:227]
s_add_u32 m0, s63, 106496
v_mfma_f32_16x16x32_bf16 v[228:231], a[28:31], a[12:15], v[228:231]
buffer_load_dwordx4 v16, s[32:35], s61 offen offset:0  lds
v_mfma_f32_16x16x32_bf16 v[188:191], a[28:31], a[8:11], v[188:191]
ds_read_b64_tr_b16 a[82:83], v28 offset:6416
ds_read_b64_tr_b16 a[84:85], v28 offset:5144
v_mfma_f32_16x16x32_bf16 v[148:151], a[28:31], a[4:7], v[148:151]
ds_read_b64_tr_b16 a[86:87], v28 offset:6424
v_mfma_f32_16x16x32_bf16 v[108:111], a[28:31], a[0:3], v[108:111]
ds_read_b64_tr_b16 a[88:89], v28 offset:5152
v_mfma_f32_16x16x32_bf16 v[112:115], a[32:35], a[0:3], v[112:115]
ds_read_b64_tr_b16 a[90:91], v28 offset:6432
v_mfma_f32_16x16x32_bf16 v[152:155], a[32:35], a[4:7], v[152:155]
buffer_load_dwordx4 v17, s[32:35], s61 offen offset:1024  lds
v_mfma_f32_16x16x32_bf16 v[192:195], a[32:35], a[8:11], v[192:195]
ds_read_b64_tr_b16 a[92:93], v28 offset:15360
s_lshr_b32 s64, s27, 3
v_mfma_f32_16x16x32_bf16 v[232:235], a[32:35], a[12:15], v[232:235]
s_lshl_b32 s64, s64, 12
s_add_u32 s97, s64, 17199104
v_mfma_f32_16x16x32_bf16 v[236:239], a[36:39], a[12:15], v[236:239]
s_mul_i32 s64, s95, 52429
s_lshr_b32 s64, s64, 17
v_mfma_f32_16x16x32_bf16 v[196:199], a[36:39], a[8:11], v[196:199]
s_lshl_b32 s65, s95, 6
s_add_u32 s65, s65, 63
v_mfma_f32_16x16x32_bf16 v[156:159], a[36:39], a[4:7], v[156:159]
s_mul_i32 s65, s65, 52429
s_lshr_b32 s65, s65, 23
v_mfma_f32_16x16x32_bf16 v[116:119], a[36:39], a[0:3], v[116:119]
s_sub_u32 s65, s65, s64
s_mul_i32 s77, s65, 384
v_mfma_f32_16x16x32_bf16 v[120:123], a[40:43], a[0:3], v[120:123]
s_mul_i32 s64, s64, 48
s_mul_i32 s66, s56, 12
v_mfma_f32_16x16x32_bf16 v[160:163], a[40:43], a[4:7], v[160:163]
s_add_u32 s64, s64, s66
s_lshl_b32 s64, s64, 7
v_mfma_f32_16x16x32_bf16 v[200:203], a[40:43], a[8:11], v[200:203]
s_add_u32 s98, s64, 17119232
s_mul_i32 s64, s27, 81920
v_mfma_f32_16x16x32_bf16 v[240:243], a[40:43], a[12:15], v[240:243]
s_add_u32 s99, s64, 12582912
s_min_u32 s76, s26, 127
v_mfma_f32_16x16x32_bf16 v[244:247], a[44:47], a[12:15], v[244:247]
s_lshl_b32 s76, s76, 4
ds_read_b64_tr_b16 a[94:95], v28 offset:16640
v_mfma_f32_16x16x32_bf16 v[204:207], a[44:47], a[8:11], v[204:207]
ds_read_b64_tr_b16 a[96:97], v28 offset:15368
ds_read_b64_tr_b16 a[98:99], v28 offset:16648
v_mfma_f32_16x16x32_bf16 v[164:167], a[44:47], a[4:7], v[164:167]
ds_read_b64_tr_b16 a[100:101], v28 offset:15376
v_mfma_f32_16x16x32_bf16 v[124:127], a[44:47], a[0:3], v[124:127]
buffer_load_dwordx4 v18, s[32:35], s61 offen offset:2048  lds
v_mfma_f32_16x16x32_bf16 v[128:131], a[48:51], a[0:3], v[128:131]
ds_read_b64_tr_b16 a[102:103], v28 offset:16656
ds_read_b64_tr_b16 a[104:105], v28 offset:15384
v_mfma_f32_16x16x32_bf16 v[168:171], a[48:51], a[4:7], v[168:171]
ds_read_b64_tr_b16 a[106:107], v28 offset:16664
ds_read_b64_tr_b16 a[108:109], v28 offset:15392
v_mfma_f32_16x16x32_bf16 v[208:211], a[48:51], a[8:11], v[208:211]
ds_read_b64_tr_b16 a[110:111], v28 offset:16672
v_mfma_f32_16x16x32_bf16 v[248:251], a[48:51], a[12:15], v[248:251]
buffer_load_dwordx4 v19, s[32:35], s61 offen offset:3072  lds
v_mfma_f32_16x16x32_bf16 v[252:255], a[52:55], a[12:15], v[252:255]
s_add_u32 m0, s63, 110592
v_mfma_f32_16x16x32_bf16 v[212:215], a[52:55], a[8:11], v[212:215]
buffer_load_dwordx4 v20, s[32:35], s61 offen offset:0  lds
v_mfma_f32_16x16x32_bf16 v[172:175], a[52:55], a[4:7], v[172:175]
v_mfma_f32_16x16x32_bf16 v[132:135], a[52:55], a[0:3], v[132:135]
s_waitcnt lgkmcnt(0)
s_waitcnt vmcnt(13)
s_barrier
v_mfma_f32_16x16x32_bf16 v[96:99], a[72:75], a[56:59], v[96:99]
ds_read_b128 a[0:3], v24 offset:0
v_mfma_f32_16x16x32_bf16 v[136:139], a[72:75], a[60:63], v[136:139]
ds_read_b64_tr_b16 a[236:237], v34 offset:344
ds_read_b128 a[4:7], v24 offset:2048
v_mfma_f32_16x16x32_bf16 v[176:179], a[72:75], a[64:67], v[176:179]
v_mfma_f32_16x16x32_bf16 v[216:219], a[72:75], a[68:71], v[216:219]
ds_read_b128 a[8:11], v24 offset:4096
v_mfma_f32_16x16x32_bf16 v[220:223], a[76:79], a[68:71], v[220:223]
ds_read_b128 a[12:15], v24 offset:6144
s_lshr_b64 s[74:75], s[74:75], 4
v_mfma_f32_16x16x32_bf16 v[180:183], a[76:79], a[64:67], v[180:183]
s_and_b32 s13, s74, 15
s_lshl_b32 s60, s13, 7
v_mfma_f32_16x16x32_bf16 v[140:143], a[76:79], a[60:63], v[140:143]
s_mul_i32 s61, s13, 245760
s_add_u32 m0, s62, 0
v_mfma_f32_16x16x32_bf16 v[100:103], a[76:79], a[56:59], v[100:103]
buffer_load_dwordx4 v8, s[28:31], s60 offen offset:0  lds
v_mfma_f32_16x16x32_bf16 v[104:107], a[80:83], a[56:59], v[104:107]
ds_read_b64_tr_b16 a[238:239], v34 offset:504
ds_read_b64_tr_b16 a[16:17], v30 offset:0
v_mfma_f32_16x16x32_bf16 v[144:147], a[80:83], a[60:63], v[144:147]
ds_read_b64_tr_b16 a[18:19], v30 offset:1280
ds_read_b64_tr_b16 a[240:241], v34 offset:664
v_mfma_f32_16x16x32_bf16 v[184:187], a[80:83], a[64:67], v[184:187]
ds_read_b64_tr_b16 a[20:21], v30 offset:8
ds_read_b64_tr_b16 a[22:23], v30 offset:1288
v_mfma_f32_16x16x32_bf16 v[224:227], a[80:83], a[68:71], v[224:227]
buffer_load_dwordx4 v9, s[28:31], s60 offen offset:1024  lds
v_mfma_f32_16x16x32_bf16 v[228:231], a[84:87], a[68:71], v[228:231]
ds_read_b64_tr_b16 a[24:25], v30 offset:16
v_accvgpr_write_b32 a242, 0
v_mfma_f32_16x16x32_bf16 v[188:191], a[84:87], a[64:67], v[188:191]
ds_read_b64_tr_b16 a[26:27], v30 offset:1296
ds_read_b64_tr_b16 a[28:29], v30 offset:24
v_mfma_f32_16x16x32_bf16 v[148:151], a[84:87], a[60:63], v[148:151]
v_accvgpr_write_b32 a243, 0
ds_read_b64_tr_b16 a[30:31], v30 offset:1304
v_mfma_f32_16x16x32_bf16 v[108:111], a[84:87], a[56:59], v[108:111]
buffer_load_dwordx4 v10, s[28:31], s60 offen offset:2048  lds
v_mfma_f32_16x16x32_bf16 v[112:115], a[88:91], a[56:59], v[112:115]
ds_read_b64_tr_b16 a[32:33], v30 offset:32
ds_read_b64_tr_b16 a[34:35], v30 offset:1312
v_mfma_f32_16x16x32_bf16 v[152:155], a[88:91], a[60:63], v[152:155]
ds_read_b64_tr_b16 a[244:245], v34 offset:32
v_mfma_f32_16x16x32_bf16 v[192:195], a[88:91], a[64:67], v[192:195]
ds_read_b64_tr_b16 a[36:37], v30 offset:10240
v_mfma_f32_16x16x32_bf16 v[232:235], a[88:91], a[68:71], v[232:235]
ds_read_b64_tr_b16 a[38:39], v30 offset:11520
v_mfma_f32_16x16x32_bf16 v[236:239], a[92:95], a[68:71], v[236:239]
ds_read_b64_tr_b16 a[246:247], v34 offset:192
ds_read_b64_tr_b16 a[40:41], v30 offset:10248
v_mfma_f32_16x16x32_bf16 v[196:199], a[92:95], a[64:67], v[196:199]
buffer_load_dwordx4 v11, s[28:31], s60 offen offset:3072  lds
v_mfma_f32_16x16x32_bf16 v[156:159], a[92:95], a[60:63], v[156:159]
ds_read_b64_tr_b16 a[42:43], v30 offset:11528
v_mfma_f32_16x16x32_bf16 v[116:119], a[92:95], a[56:59], v[116:119]
ds_read_b64_tr_b16 a[44:45], v30 offset:10256
ds_read_b64_tr_b16 a[248:249], v34 offset:352
v_mfma_f32_16x16x32_bf16 v[120:123], a[96:99], a[56:59], v[120:123]
ds_read_b64_tr_b16 a[46:47], v30 offset:11536
v_mfma_f32_16x16x32_bf16 v[160:163], a[96:99], a[60:63], v[160:163]
ds_read_b64_tr_b16 a[48:49], v30 offset:10264
v_mfma_f32_16x16x32_bf16 v[200:203], a[96:99], a[64:67], v[200:203]
ds_read_b64_tr_b16 a[250:251], v34 offset:512
s_add_u32 m0, s62, 4096
v_mfma_f32_16x16x32_bf16 v[240:243], a[96:99], a[68:71], v[240:243]
buffer_load_dwordx4 v12, s[28:31], s60 offen offset:0  lds
v_mfma_f32_16x16x32_bf16 v[244:247], a[100:103], a[68:71], v[244:247]
ds_read_b64_tr_b16 a[50:51], v30 offset:11544
ds_read_b64_tr_b16 a[52:53], v30 offset:10272
v_mfma_f32_16x16x32_bf16 v[204:207], a[100:103], a[64:67], v[204:207]
ds_read_b64_tr_b16 a[252:253], v34 offset:672
ds_read_b64_tr_b16 a[54:55], v30 offset:11552
v_mfma_f32_16x16x32_bf16 v[164:167], a[100:103], a[60:63], v[164:167]
v_mfma_f32_16x16x32_bf16 v[124:127], a[100:103], a[56:59], v[124:127]
buffer_load_dwordx4 v13, s[28:31], s60 offen offset:1024  lds
v_mfma_f32_16x16x32_bf16 v[128:131], a[104:107], a[56:59], v[128:131]
v_accvgpr_write_b32 a254, 0
v_mfma_f32_16x16x32_bf16 v[168:171], a[104:107], a[60:63], v[168:171]
v_mfma_f32_16x16x32_bf16 v[208:211], a[104:107], a[64:67], v[208:211]
v_mfma_f32_16x16x32_bf16 v[248:251], a[104:107], a[68:71], v[248:251]
v_accvgpr_write_b32 a255, 0
v_mfma_f32_16x16x32_bf16 v[252:255], a[108:111], a[68:71], v[252:255]
v_mfma_f32_16x16x32_bf16 v[212:215], a[108:111], a[64:67], v[212:215]
buffer_load_dwordx4 v14, s[28:31], s60 offen offset:2048  lds
v_mfma_f32_16x16x32_bf16 v[172:175], a[108:111], a[60:63], v[172:175]
v_mfma_f32_16x16x32_bf16 v[132:135], a[108:111], a[56:59], v[132:135]
s_waitcnt lgkmcnt(0)
v_mfma_f32_16x16x32_bf16 v[96:99], a[16:19], a[0:3], v[96:99]
ds_read_b128 a[56:59], v25 offset:0
v_mfma_f32_16x16x32_bf16 v[136:139], a[16:19], a[4:7], v[136:139]
ds_read_b128 a[60:63], v25 offset:2048
v_mfma_f32_16x16x32_bf16 v[176:179], a[16:19], a[8:11], v[176:179]
v_mfma_f32_16x16x32_bf16 v[216:219], a[16:19], a[12:15], v[216:219]
ds_read_b128 a[64:67], v25 offset:4096
v_mfma_f32_16x16x32_bf16 v[220:223], a[20:23], a[12:15], v[220:223]
ds_read_b128 a[68:71], v25 offset:6144
v_mfma_f32_16x16x32_bf16 v[180:183], a[20:23], a[8:11], v[180:183]
buffer_load_dwordx4 v15, s[28:31], s60 offen offset:3072  lds
v_mfma_f32_16x16x32_bf16 v[140:143], a[20:23], a[4:7], v[140:143]
ds_read_b64_tr_b16 a[72:73], v30 offset:5120
ds_read_b64_tr_b16 a[74:75], v30 offset:6400
v_mfma_f32_16x16x32_bf16 v[100:103], a[20:23], a[0:3], v[100:103]
v_mfma_f32_16x16x32_bf16 v[104:107], a[24:27], a[0:3], v[104:107]
ds_read_b64_tr_b16 a[76:77], v30 offset:5128
v_mfma_f32_16x16x32_bf16 v[144:147], a[24:27], a[4:7], v[144:147]
ds_read_b64_tr_b16 a[78:79], v30 offset:6408
v_mfma_f32_16x16x32_bf16 v[184:187], a[24:27], a[8:11], v[184:187]
ds_read_b64_tr_b16 a[80:81], v30 offset:5136
v_mfma_f32_16x16x32_bf16 v[224:227], a[24:27], a[12:15], v[224:227]
s_add_u32 m0, s63, 0
v_mfma_f32_16x16x32_bf16 v[228:231], a[28:31], a[12:15], v[228:231]
buffer_load_dwordx4 v16, s[32:35], s61 offen offset:0  lds
v_mfma_f32_16x16x32_bf16 v[188:191], a[28:31], a[8:11], v[188:191]
ds_read_b64_tr_b16 a[82:83], v30 offset:6416
ds_read_b64_tr_b16 a[84:85], v30 offset:5144
v_mfma_f32_16x16x32_bf16 v[148:151], a[28:31], a[4:7], v[148:151]
ds_read_b64_tr_b16 a[86:87], v30 offset:6424
v_mfma_f32_16x16x32_bf16 v[108:111], a[28:31], a[0:3], v[108:111]
ds_read_b64_tr_b16 a[88:89], v30 offset:5152
v_mfma_f32_16x16x32_bf16 v[112:115], a[32:35], a[0:3], v[112:115]
ds_read_b64_tr_b16 a[90:91], v30 offset:6432
v_mfma_f32_16x16x32_bf16 v[152:155], a[32:35], a[4:7], v[152:155]
buffer_load_dwordx4 v17, s[32:35], s61 offen offset:1024  lds
v_mfma_f32_16x16x32_bf16 v[192:195], a[32:35], a[8:11], v[192:195]
ds_read_b64_tr_b16 a[92:93], v30 offset:15360
v_mfma_f32_16x16x32_bf16 v[232:235], a[32:35], a[12:15], v[232:235]
ds_read_b64_tr_b16 a[94:95], v30 offset:16640
v_mfma_f32_16x16x32_bf16 v[236:239], a[36:39], a[12:15], v[236:239]
ds_read_b64_tr_b16 a[96:97], v30 offset:15368
v_mfma_f32_16x16x32_bf16 v[196:199], a[36:39], a[8:11], v[196:199]
ds_read_b64_tr_b16 a[98:99], v30 offset:16648
v_mfma_f32_16x16x32_bf16 v[156:159], a[36:39], a[4:7], v[156:159]
v_mfma_f32_16x16x32_bf16 v[116:119], a[36:39], a[0:3], v[116:119]
ds_read_b64_tr_b16 a[100:101], v30 offset:15376
v_mfma_f32_16x16x32_bf16 v[120:123], a[40:43], a[0:3], v[120:123]
buffer_load_dwordx4 v18, s[32:35], s61 offen offset:2048  lds
v_mfma_f32_16x16x32_bf16 v[160:163], a[40:43], a[4:7], v[160:163]
ds_read_b64_tr_b16 a[102:103], v30 offset:16656
ds_read_b64_tr_b16 a[104:105], v30 offset:15384
v_mfma_f32_16x16x32_bf16 v[200:203], a[40:43], a[8:11], v[200:203]
ds_read_b64_tr_b16 a[106:107], v30 offset:16664
v_mfma_f32_16x16x32_bf16 v[240:243], a[40:43], a[12:15], v[240:243]
v_mfma_f32_16x16x32_bf16 v[244:247], a[44:47], a[12:15], v[244:247]
ds_read_b64_tr_b16 a[108:109], v30 offset:15392
v_mfma_f32_16x16x32_bf16 v[204:207], a[44:47], a[8:11], v[204:207]
ds_read_b64_tr_b16 a[110:111], v30 offset:16672
v_mfma_f32_16x16x32_bf16 v[164:167], a[44:47], a[4:7], v[164:167]
buffer_load_dwordx4 v19, s[32:35], s61 offen offset:3072  lds
v_mfma_f32_16x16x32_bf16 v[124:127], a[44:47], a[0:3], v[124:127]
v_mfma_f32_16x16x32_bf16 v[128:131], a[48:51], a[0:3], v[128:131]
v_mfma_f32_16x16x32_bf16 v[168:171], a[48:51], a[4:7], v[168:171]
v_mfma_f32_16x16x32_bf16 v[208:211], a[48:51], a[8:11], v[208:211]
v_mfma_f32_16x16x32_bf16 v[248:251], a[48:51], a[12:15], v[248:251]
v_mfma_f32_16x16x32_bf16 v[252:255], a[52:55], a[12:15], v[252:255]
s_add_u32 m0, s63, 4096
v_mfma_f32_16x16x32_bf16 v[212:215], a[52:55], a[8:11], v[212:215]
buffer_load_dwordx4 v20, s[32:35], s61 offen offset:0  lds
v_mfma_f32_16x16x32_bf16 v[172:175], a[52:55], a[4:7], v[172:175]
v_mfma_f32_16x16x32_bf16 v[132:135], a[52:55], a[0:3], v[132:135]
s_waitcnt lgkmcnt(0)
s_waitcnt vmcnt(13)
s_barrier
s_cmp_eq_u32 s56, 0
s_cbranch_scc0 Lw0_2
buffer_load_dword v83, v88, s[40:43], 0 offen sc1
buffer_load_dword v84, v85, s[40:43], 0 offen sc1
Lw0_2:
s_cmp_eq_u32 s56, 0
s_cbranch_scc0 Lw0_3
buffer_load_dword v86, v89, s[40:43], 0 offen sc1
Lw0_3:
v_mfma_f32_16x16x32_bf16 v[96:99], a[72:75], a[56:59], v[96:99]
ds_read_b128 a[0:3], v26 offset:0
v_mfma_f32_16x16x32_bf16 v[136:139], a[72:75], a[60:63], v[136:139]
ds_read_b128 a[4:7], v26 offset:2048
v_mfma_f32_16x16x32_bf16 v[176:179], a[72:75], a[64:67], v[176:179]
v_mfma_f32_16x16x32_bf16 v[216:219], a[72:75], a[68:71], v[216:219]
ds_read_b128 a[8:11], v26 offset:4096
v_mfma_f32_16x16x32_bf16 v[220:223], a[76:79], a[68:71], v[220:223]
ds_read_b128 a[12:15], v26 offset:6144
v_mfma_f32_16x16x32_bf16 v[180:183], a[76:79], a[64:67], v[180:183]
ds_read_b64_tr_b16 a[16:17], v32 offset:0
v_mfma_f32_16x16x32_bf16 v[140:143], a[76:79], a[60:63], v[140:143]
ds_read_b64_tr_b16 a[18:19], v32 offset:1280
v_mfma_f32_16x16x32_bf16 v[100:103], a[76:79], a[56:59], v[100:103]
v_mfma_f32_16x16x32_bf16 v[104:107], a[80:83], a[56:59], v[104:107]
ds_read_b64_tr_b16 a[20:21], v32 offset:8
v_mfma_f32_16x16x32_bf16 v[144:147], a[80:83], a[60:63], v[144:147]
ds_read_b64_tr_b16 a[22:23], v32 offset:1288
v_mfma_f32_16x16x32_bf16 v[184:187], a[80:83], a[64:67], v[184:187]
ds_read_b64_tr_b16 a[24:25], v32 offset:16
v_mfma_f32_16x16x32_bf16 v[224:227], a[80:83], a[68:71], v[224:227]
ds_read_b64_tr_b16 a[26:27], v32 offset:1296
v_mfma_f32_16x16x32_bf16 v[228:231], a[84:87], a[68:71], v[228:231]
v_mfma_f32_16x16x32_bf16 v[188:191], a[84:87], a[64:67], v[188:191]
ds_read_b64_tr_b16 a[28:29], v32 offset:24
v_mfma_f32_16x16x32_bf16 v[148:151], a[84:87], a[60:63], v[148:151]
ds_read_b64_tr_b16 a[30:31], v32 offset:1304
v_mfma_f32_16x16x32_bf16 v[108:111], a[84:87], a[56:59], v[108:111]
ds_read_b64_tr_b16 a[32:33], v32 offset:32
v_mfma_f32_16x16x32_bf16 v[112:115], a[88:91], a[56:59], v[112:115]
ds_read_b64_tr_b16 a[34:35], v32 offset:1312
v_mfma_f32_16x16x32_bf16 v[152:155], a[88:91], a[60:63], v[152:155]
v_mfma_f32_16x16x32_bf16 v[192:195], a[88:91], a[64:67], v[192:195]
ds_read_b64_tr_b16 a[36:37], v32 offset:10240
v_mfma_f32_16x16x32_bf16 v[232:235], a[88:91], a[68:71], v[232:235]
ds_read_b64_tr_b16 a[38:39], v32 offset:11520
v_mfma_f32_16x16x32_bf16 v[236:239], a[92:95], a[68:71], v[236:239]
ds_read_b64_tr_b16 a[40:41], v32 offset:10248
v_mfma_f32_16x16x32_bf16 v[196:199], a[92:95], a[64:67], v[196:199]
ds_read_b64_tr_b16 a[42:43], v32 offset:11528
v_mfma_f32_16x16x32_bf16 v[156:159], a[92:95], a[60:63], v[156:159]
v_mfma_f32_16x16x32_bf16 v[116:119], a[92:95], a[56:59], v[116:119]
ds_read_b64_tr_b16 a[44:45], v32 offset:10256
v_mfma_f32_16x16x32_bf16 v[120:123], a[96:99], a[56:59], v[120:123]
ds_read_b64_tr_b16 a[46:47], v32 offset:11536
v_mfma_f32_16x16x32_bf16 v[160:163], a[96:99], a[60:63], v[160:163]
ds_read_b64_tr_b16 a[48:49], v32 offset:10264
v_mfma_f32_16x16x32_bf16 v[200:203], a[96:99], a[64:67], v[200:203]
ds_read_b64_tr_b16 a[50:51], v32 offset:11544
v_mfma_f32_16x16x32_bf16 v[240:243], a[96:99], a[68:71], v[240:243]
v_mfma_f32_16x16x32_bf16 v[244:247], a[100:103], a[68:71], v[244:247]
ds_read_b64_tr_b16 a[52:53], v32 offset:10272
v_mfma_f32_16x16x32_bf16 v[204:207], a[100:103], a[64:67], v[204:207]
ds_read_b64_tr_b16 a[54:55], v32 offset:11552
v_mfma_f32_16x16x32_bf16 v[164:167], a[100:103], a[60:63], v[164:167]
v_mfma_f32_16x16x32_bf16 v[124:127], a[100:103], a[56:59], v[124:127]
v_mfma_f32_16x16x32_bf16 v[128:131], a[104:107], a[56:59], v[128:131]
v_mfma_f32_16x16x32_bf16 v[168:171], a[104:107], a[60:63], v[168:171]
v_mfma_f32_16x16x32_bf16 v[208:211], a[104:107], a[64:67], v[208:211]
v_mfma_f32_16x16x32_bf16 v[248:251], a[104:107], a[68:71], v[248:251]
v_mfma_f32_16x16x32_bf16 v[252:255], a[108:111], a[68:71], v[252:255]
v_mfma_f32_16x16x32_bf16 v[212:215], a[108:111], a[64:67], v[212:215]
v_mfma_f32_16x16x32_bf16 v[172:175], a[108:111], a[60:63], v[172:175]
v_mfma_f32_16x16x32_bf16 v[132:135], a[108:111], a[56:59], v[132:135]
s_waitcnt lgkmcnt(0)
v_mfma_f32_16x16x32_bf16 v[96:99], a[16:19], a[0:3], v[96:99]
ds_read_b128 a[56:59], v27 offset:0
v_mfma_f32_16x16x32_bf16 v[136:139], a[16:19], a[4:7], v[136:139]
ds_read_b128 a[60:63], v27 offset:2048
v_mfma_f32_16x16x32_bf16 v[176:179], a[16:19], a[8:11], v[176:179]
v_mfma_f32_16x16x32_bf16 v[216:219], a[16:19], a[12:15], v[216:219]
ds_read_b128 a[64:67], v27 offset:4096
v_mfma_f32_16x16x32_bf16 v[220:223], a[20:23], a[12:15], v[220:223]
ds_read_b128 a[68:71], v27 offset:6144
v_mfma_f32_16x16x32_bf16 v[180:183], a[20:23], a[8:11], v[180:183]
ds_read_b64_tr_b16 a[72:73], v32 offset:5120
v_mfma_f32_16x16x32_bf16 v[140:143], a[20:23], a[4:7], v[140:143]
ds_read_b64_tr_b16 a[74:75], v32 offset:6400
v_mfma_f32_16x16x32_bf16 v[100:103], a[20:23], a[0:3], v[100:103]
v_mfma_f32_16x16x32_bf16 v[104:107], a[24:27], a[0:3], v[104:107]
ds_read_b64_tr_b16 a[76:77], v32 offset:5128
v_mfma_f32_16x16x32_bf16 v[144:147], a[24:27], a[4:7], v[144:147]
ds_read_b64_tr_b16 a[78:79], v32 offset:6408
v_mfma_f32_16x16x32_bf16 v[184:187], a[24:27], a[8:11], v[184:187]
ds_read_b64_tr_b16 a[80:81], v32 offset:5136
v_mfma_f32_16x16x32_bf16 v[224:227], a[24:27], a[12:15], v[224:227]
ds_read_b64_tr_b16 a[82:83], v32 offset:6416
v_mfma_f32_16x16x32_bf16 v[228:231], a[28:31], a[12:15], v[228:231]
v_mfma_f32_16x16x32_bf16 v[188:191], a[28:31], a[8:11], v[188:191]
ds_read_b64_tr_b16 a[84:85], v32 offset:5144
v_mfma_f32_16x16x32_bf16 v[148:151], a[28:31], a[4:7], v[148:151]
ds_read_b64_tr_b16 a[86:87], v32 offset:6424
v_mfma_f32_16x16x32_bf16 v[108:111], a[28:31], a[0:3], v[108:111]
ds_read_b64_tr_b16 a[88:89], v32 offset:5152
v_mfma_f32_16x16x32_bf16 v[112:115], a[32:35], a[0:3], v[112:115]
ds_read_b64_tr_b16 a[90:91], v32 offset:6432
v_mfma_f32_16x16x32_bf16 v[152:155], a[32:35], a[4:7], v[152:155]
v_mfma_f32_16x16x32_bf16 v[192:195], a[32:35], a[8:11], v[192:195]
ds_read_b64_tr_b16 a[92:93], v32 offset:15360
v_mfma_f32_16x16x32_bf16 v[232:235], a[32:35], a[12:15], v[232:235]
ds_read_b64_tr_b16 a[94:95], v32 offset:16640
v_mfma_f32_16x16x32_bf16 v[236:239], a[36:39], a[12:15], v[236:239]
ds_read_b64_tr_b16 a[96:97], v32 offset:15368
v_mfma_f32_16x16x32_bf16 v[196:199], a[36:39], a[8:11], v[196:199]
ds_read_b64_tr_b16 a[98:99], v32 offset:16648
v_mfma_f32_16x16x32_bf16 v[156:159], a[36:39], a[4:7], v[156:159]
v_mfma_f32_16x16x32_bf16 v[116:119], a[36:39], a[0:3], v[116:119]
ds_read_b64_tr_b16 a[100:101], v32 offset:15376
v_mfma_f32_16x16x32_bf16 v[120:123], a[40:43], a[0:3], v[120:123]
ds_read_b64_tr_b16 a[102:103], v32 offset:16656
v_mfma_f32_16x16x32_bf16 v[160:163], a[40:43], a[4:7], v[160:163]
ds_read_b64_tr_b16 a[104:105], v32 offset:15384
v_mfma_f32_16x16x32_bf16 v[200:203], a[40:43], a[8:11], v[200:203]
ds_read_b64_tr_b16 a[106:107], v32 offset:16664
v_mfma_f32_16x16x32_bf16 v[240:243], a[40:43], a[12:15], v[240:243]
v_mfma_f32_16x16x32_bf16 v[244:247], a[44:47], a[12:15], v[244:247]
ds_read_b64_tr_b16 a[108:109], v32 offset:15392
v_mfma_f32_16x16x32_bf16 v[204:207], a[44:47], a[8:11], v[204:207]
ds_read_b64_tr_b16 a[110:111], v32 offset:16672
v_mfma_f32_16x16x32_bf16 v[164:167], a[44:47], a[4:7], v[164:167]
v_mfma_f32_16x16x32_bf16 v[124:127], a[44:47], a[0:3], v[124:127]
v_mfma_f32_16x16x32_bf16 v[128:131], a[48:51], a[0:3], v[128:131]
v_mfma_f32_16x16x32_bf16 v[168:171], a[48:51], a[4:7], v[168:171]
v_mfma_f32_16x16x32_bf16 v[208:211], a[48:51], a[8:11], v[208:211]
v_mfma_f32_16x16x32_bf16 v[248:251], a[48:51], a[12:15], v[248:251]
v_mfma_f32_16x16x32_bf16 v[252:255], a[52:55], a[12:15], v[252:255]
v_mfma_f32_16x16x32_bf16 v[212:215], a[52:55], a[8:11], v[212:215]
v_mfma_f32_16x16x32_bf16 v[172:175], a[52:55], a[4:7], v[172:175]
v_mfma_f32_16x16x32_bf16 v[132:135], a[52:55], a[0:3], v[132:135]
s_waitcnt lgkmcnt(0)
s_waitcnt vmcnt(0)
s_cmp_eq_u32 s56, 0
s_cbranch_scc0 Lw0_4
s_waitcnt vmcnt(0)
v_min_u32 v83, v83, v84
v_cmp_eq_u32 vcc, 0, v83
s_cbranch_vccz Lok2
s_mov_b32 s85, 40000
Lsp2:
buffer_load_dword v83, v88, s[40:43], 0 offen sc1
buffer_load_dword v84, v85, s[40:43], 0 offen sc1
s_waitcnt vmcnt(0)
v_min_u32 v83, v83, v84
v_cmp_eq_u32 vcc, 0, v83
s_cbranch_vccz Lok2
s_sub_u32 s85, s85, 1
s_cmp_lg_u32 s85, 0
s_cbranch_scc1 Lsp2
Lok2:
Lw0_4:
s_cmp_eq_u32 s56, 0
s_cbranch_scc0 Lw0_5
s_waitcnt vmcnt(0)
v_cmp_eq_u32 vcc, 0, v86
s_cbranch_vccz Lok3
s_mov_b32 s85, 40000
Lsp3:
buffer_load_dword v86, v89, s[40:43], 0 offen sc1
s_waitcnt vmcnt(0)
v_cmp_eq_u32_e64 vcc, 0, v86
s_cbranch_vccz Lok3
s_sub_u32 s85, s85, 1
s_cmp_lg_u32 s85, 0
s_cbranch_scc1 Lsp3
Lok3:
Lw0_5:
s_barrier
v_mfma_f32_16x16x32_bf16 v[96:99], a[72:75], a[56:59], v[96:99]
ds_read_b128 a[0:3], v22 offset:0
v_mfma_f32_16x16x32_bf16 v[136:139], a[72:75], a[60:63], v[136:139]
v_min_u32 v2, 39, v1
v_cmp_lt_u32 vcc, 19, v2
v_mfma_f32_16x16x32_bf16 v[176:179], a[72:75], a[64:67], v[176:179]
v_lshlrev_b32_e64 v91, 4, v2
s_mul_i32 s65, s59, 320
v_mfma_f32_16x16x32_bf16 v[216:219], a[72:75], a[68:71], v[216:219]
v_add_u32 v3, 2240, v91
s_add_u32 s65, s65, 16845312
v_mfma_f32_16x16x32_bf16 v[220:223], a[76:79], a[68:71], v[220:223]
v_cndmask_b32 v5, v91, v3, vcc
ds_read_b128 a[4:7], v22 offset:2048
v_mfma_f32_16x16x32_bf16 v[180:183], a[76:79], a[64:67], v[180:183]
ds_read_b128 a[8:11], v22 offset:4096
s_mul_i32 s66, s56, 19968
v_mfma_f32_16x16x32_bf16 v[140:143], a[76:79], a[60:63], v[140:143]
s_add_u32 s65, s65, s66
s_cmp_lt_u32 s56, 2
v_mfma_f32_16x16x32_bf16 v[100:103], a[76:79], a[56:59], v[100:103]
s_cselect_b32 s66, 159744, s42
s_add_u32 s66, s66, s65
v_mfma_f32_16x16x32_bf16 v[104:107], a[80:83], a[56:59], v[104:107]
s_add_u32 s67, s65, 79872
ds_read_b128 a[12:15], v22 offset:6144
v_mfma_f32_16x16x32_bf16 v[144:147], a[80:83], a[60:63], v[144:147]
buffer_load_dwordx4 v[42:45], v5, s[40:43], s65 offen sc1
v_mfma_f32_16x16x32_bf16 v[184:187], a[80:83], a[64:67], v[184:187]
ds_read_b64_tr_b16 a[16:17], v28 offset:0
ds_read_b64_tr_b16 a[18:19], v28 offset:1280
v_mfma_f32_16x16x32_bf16 v[224:227], a[80:83], a[68:71], v[224:227]
buffer_load_dwordx4 v[46:49], v5, s[40:43], s67 offen sc1
v_mfma_f32_16x16x32_bf16 v[228:231], a[84:87], a[68:71], v[228:231]
ds_read_b64_tr_b16 a[20:21], v28 offset:8
ds_read_b64_tr_b16 a[22:23], v28 offset:1288
v_mfma_f32_16x16x32_bf16 v[188:191], a[84:87], a[64:67], v[188:191]
buffer_load_dwordx4 v[50:53], v5, s[40:43], s66 offen sc1
v_mfma_f32_16x16x32_bf16 v[148:151], a[84:87], a[60:63], v[148:151]
ds_read_b64_tr_b16 a[24:25], v28 offset:16
ds_read_b64_tr_b16 a[26:27], v28 offset:1296
v_mfma_f32_16x16x32_bf16 v[108:111], a[84:87], a[56:59], v[108:111]
v_and_b32 v20, 15, v1
v_lshlrev_b32 v20, 4, v20
v_mfma_f32_16x16x32_bf16 v[112:115], a[88:91], a[56:59], v[112:115]
s_lshl_b32 s65, s58, 12
s_add_u32 s65, s65, s12
v_mfma_f32_16x16x32_bf16 v[152:155], a[88:91], a[60:63], v[152:155]
s_add_u32 s65, s65, 16777216
ds_read_b64_tr_b16 a[28:29], v28 offset:24
v_mfma_f32_16x16x32_bf16 v[192:195], a[88:91], a[64:67], v[192:195]
buffer_load_dwordx2 v[34:35], v20, s[40:43], s65 offen offset:0 sc1
v_mfma_f32_16x16x32_bf16 v[232:235], a[88:91], a[68:71], v[232:235]
ds_read_b64_tr_b16 a[30:31], v28 offset:1304
ds_read_b64_tr_b16 a[32:33], v28 offset:32
v_mfma_f32_16x16x32_bf16 v[236:239], a[92:95], a[68:71], v[236:239]
buffer_load_dwordx2 v[36:37], v20, s[40:43], s65 offen offset:256 sc1
v_mfma_f32_16x16x32_bf16 v[196:199], a[92:95], a[64:67], v[196:199]
ds_read_b64_tr_b16 a[34:35], v28 offset:1312
ds_read_b64_tr_b16 a[36:37], v28 offset:10240
v_mfma_f32_16x16x32_bf16 v[156:159], a[92:95], a[60:63], v[156:159]
buffer_load_dwordx2 v[38:39], v20, s[40:43], s65 offen offset:512 sc1
v_mfma_f32_16x16x32_bf16 v[116:119], a[92:95], a[56:59], v[116:119]
ds_read_b64_tr_b16 a[38:39], v28 offset:11520
ds_read_b64_tr_b16 a[40:41], v28 offset:10248
v_mfma_f32_16x16x32_bf16 v[120:123], a[96:99], a[56:59], v[120:123]
buffer_load_dwordx2 v[40:41], v20, s[40:43], s65 offen offset:768 sc1
v_mfma_f32_16x16x32_bf16 v[160:163], a[96:99], a[60:63], v[160:163]
ds_read_b64_tr_b16 a[42:43], v28 offset:11528
v_mfma_f32_16x16x32_bf16 v[200:203], a[96:99], a[64:67], v[200:203]
buffer_load_dwordx4 a[112:115], v6, s[40:43], s86 offen offset:0 sc1
v_mfma_f32_16x16x32_bf16 v[240:243], a[96:99], a[68:71], v[240:243]
ds_read_b64_tr_b16 a[44:45], v28 offset:10256
ds_read_b64_tr_b16 a[46:47], v28 offset:11536
v_mfma_f32_16x16x32_bf16 v[244:247], a[100:103], a[68:71], v[244:247]
buffer_load_dwordx4 a[116:119], v6, s[40:43], s87 offen offset:0 sc1
v_mfma_f32_16x16x32_bf16 v[204:207], a[100:103], a[64:67], v[204:207]
ds_read_b64_tr_b16 a[48:49], v28 offset:10264
ds_read_b64_tr_b16 a[50:51], v28 offset:11544
v_mfma_f32_16x16x32_bf16 v[164:167], a[100:103], a[60:63], v[164:167]
buffer_load_dwordx4 a[120:123], v6, s[40:43], s88 offen offset:0 sc1
v_mfma_f32_16x16x32_bf16 v[124:127], a[100:103], a[56:59], v[124:127]
ds_read_b64_tr_b16 a[52:53], v28 offset:10272
ds_read_b64_tr_b16 a[54:55], v28 offset:11552
v_mfma_f32_16x16x32_bf16 v[128:131], a[104:107], a[56:59], v[128:131]
buffer_load_dwordx4 a[124:127], v6, s[40:43], s89 offen offset:0 sc1
v_mfma_f32_16x16x32_bf16 v[168:171], a[104:107], a[60:63], v[168:171]
buffer_load_dwordx4 a[128:131], v6, s[40:43], s90 offen offset:0 sc1
v_mfma_f32_16x16x32_bf16 v[208:211], a[104:107], a[64:67], v[208:211]
buffer_load_dwordx4 a[132:135], v6, s[40:43], s86 offen offset:1024 sc1
v_mfma_f32_16x16x32_bf16 v[248:251], a[104:107], a[68:71], v[248:251]
buffer_load_dwordx4 a[136:139], v6, s[40:43], s87 offen offset:1024 sc1
v_mfma_f32_16x16x32_bf16 v[252:255], a[108:111], a[68:71], v[252:255]
v_mfma_f32_16x16x32_bf16 v[212:215], a[108:111], a[64:67], v[212:215]
v_mfma_f32_16x16x32_bf16 v[172:175], a[108:111], a[60:63], v[172:175]
v_mfma_f32_16x16x32_bf16 v[132:135], a[108:111], a[56:59], v[132:135]
s_waitcnt lgkmcnt(0)
v_mfma_f32_16x16x32_bf16 v[96:99], a[16:19], a[0:3], v[96:99]
ds_read_b128 a[56:59], v23 offset:0
v_mfma_f32_16x16x32_bf16 v[136:139], a[16:19], a[4:7], v[136:139]
s_waitcnt vmcnt(11)
ds_read_b128 a[60:63], v23 offset:2048
v_mfma_f32_16x16x32_bf16 v[176:179], a[16:19], a[8:11], v[176:179]
v_mfma_f32_16x16x32_bf16 v[216:219], a[16:19], a[12:15], v[216:219]
v_add_f32_e64 v82, v42, v46
ds_read_b128 a[64:67], v23 offset:4096
v_mfma_f32_16x16x32_bf16 v[220:223], a[20:23], a[12:15], v[220:223]
ds_read_b128 a[68:71], v23 offset:6144
v_mfma_f32_16x16x32_bf16 v[180:183], a[20:23], a[8:11], v[180:183]
v_add_f32_e64 v83, v43, v47
ds_read_b64_tr_b16 a[72:73], v28 offset:5120
v_mfma_f32_16x16x32_bf16 v[140:143], a[20:23], a[4:7], v[140:143]
ds_read_b64_tr_b16 a[74:75], v28 offset:6400
v_add_f32_e64 v84, v44, v48
v_mfma_f32_16x16x32_bf16 v[100:103], a[20:23], a[0:3], v[100:103]
v_mfma_f32_16x16x32_bf16 v[104:107], a[24:27], a[0:3], v[104:107]
ds_read_b64_tr_b16 a[76:77], v28 offset:5128
v_add_f32_e64 v85, v45, v49
v_mfma_f32_16x16x32_bf16 v[144:147], a[24:27], a[4:7], v[144:147]
ds_read_b64_tr_b16 a[78:79], v28 offset:6408
v_mfma_f32_16x16x32_bf16 v[184:187], a[24:27], a[8:11], v[184:187]
ds_read_b64_tr_b16 a[80:81], v28 offset:5136
v_add_f32_e64 v82, v82, v50
v_mfma_f32_16x16x32_bf16 v[224:227], a[24:27], a[12:15], v[224:227]
ds_read_b64_tr_b16 a[82:83], v28 offset:6416
v_mfma_f32_16x16x32_bf16 v[228:231], a[28:31], a[12:15], v[228:231]
v_add_f32_e64 v83, v83, v51
v_mfma_f32_16x16x32_bf16 v[188:191], a[28:31], a[8:11], v[188:191]
ds_read_b64_tr_b16 a[84:85], v28 offset:5144
v_mfma_f32_16x16x32_bf16 v[148:151], a[28:31], a[4:7], v[148:151]
ds_read_b64_tr_b16 a[86:87], v28 offset:6424
v_add_f32_e64 v84, v84, v52
v_mfma_f32_16x16x32_bf16 v[108:111], a[28:31], a[0:3], v[108:111]
ds_read_b64_tr_b16 a[88:89], v28 offset:5152
v_mfma_f32_16x16x32_bf16 v[112:115], a[32:35], a[0:3], v[112:115]
v_add_f32_e64 v85, v85, v53
ds_read_b64_tr_b16 a[90:91], v28 offset:6432
v_mfma_f32_16x16x32_bf16 v[152:155], a[32:35], a[4:7], v[152:155]
v_mfma_f32_16x16x32_bf16 v[192:195], a[32:35], a[8:11], v[192:195]
ds_read_b64_tr_b16 a[92:93], v28 offset:15360
s_mul_i32 s65, s56, 640
v_mfma_f32_16x16x32_bf16 v[232:235], a[32:35], a[12:15], v[232:235]
s_add_u32 s65, s65, 159744
v_add_u32_e64 v2, s65, v91
v_mfma_f32_16x16x32_bf16 v[236:239], a[36:39], a[12:15], v[236:239]
v_add_u32 v91, 159744, v91
ds_write_b128 v2, v[82:85]
v_mfma_f32_16x16x32_bf16 v[196:199], a[36:39], a[8:11], v[196:199]
v_lshrrev_b32_e64 v3, 4, v1
v_mul_u32_u24 v3, 80, v3
v_mfma_f32_16x16x32_bf16 v[156:159], a[36:39], a[4:7], v[156:159]
v_add_u32 v94, 162304, v3
ds_read_b64_tr_b16 a[94:95], v28 offset:16640
v_mfma_f32_16x16x32_bf16 v[116:119], a[36:39], a[0:3], v[116:119]
buffer_load_dwordx4 a[140:143], v6, s[40:43], s88 offen offset:1024 sc1
v_mfma_f32_16x16x32_bf16 v[120:123], a[40:43], a[0:3], v[120:123]
ds_read_b64_tr_b16 a[96:97], v28 offset:15368
ds_read_b64_tr_b16 a[98:99], v28 offset:16648
v_mfma_f32_16x16x32_bf16 v[160:163], a[40:43], a[4:7], v[160:163]
buffer_load_dwordx4 a[144:147], v6, s[40:43], s89 offen offset:1024 sc1
v_mfma_f32_16x16x32_bf16 v[200:203], a[40:43], a[8:11], v[200:203]
ds_read_b64_tr_b16 a[100:101], v28 offset:15376
ds_read_b64_tr_b16 a[102:103], v28 offset:16656
v_mfma_f32_16x16x32_bf16 v[240:243], a[40:43], a[12:15], v[240:243]
buffer_load_dwordx4 a[148:151], v6, s[40:43], s90 offen offset:1024 sc1
v_mfma_f32_16x16x32_bf16 v[244:247], a[44:47], a[12:15], v[244:247]
ds_read_b64_tr_b16 a[104:105], v28 offset:15384
v_mfma_f32_16x16x32_bf16 v[204:207], a[44:47], a[8:11], v[204:207]
buffer_load_dwordx4 a[152:155], v6, s[40:43], s86 offen offset:2048 sc1
v_mfma_f32_16x16x32_bf16 v[164:167], a[44:47], a[4:7], v[164:167]
ds_read_b64_tr_b16 a[106:107], v28 offset:16664
ds_read_b64_tr_b16 a[108:109], v28 offset:15392
v_mfma_f32_16x16x32_bf16 v[124:127], a[44:47], a[0:3], v[124:127]
buffer_load_dwordx4 a[156:159], v6, s[40:43], s87 offen offset:2048 sc1
v_mfma_f32_16x16x32_bf16 v[128:131], a[48:51], a[0:3], v[128:131]
ds_read_b64_tr_b16 a[110:111], v28 offset:16672
v_mfma_f32_16x16x32_bf16 v[168:171], a[48:51], a[4:7], v[168:171]
buffer_load_dwordx4 a[160:163], v6, s[40:43], s88 offen offset:2048 sc1
v_mfma_f32_16x16x32_bf16 v[208:211], a[48:51], a[8:11], v[208:211]
buffer_load_dwordx4 a[164:167], v6, s[40:43], s89 offen offset:2048 sc1
v_mfma_f32_16x16x32_bf16 v[248:251], a[48:51], a[12:15], v[248:251]
buffer_load_dwordx4 a[168:171], v6, s[40:43], s90 offen offset:2048 sc1
v_mfma_f32_16x16x32_bf16 v[252:255], a[52:55], a[12:15], v[252:255]
buffer_load_dwordx4 a[172:175], v6, s[40:43], s86 offen offset:3072 sc1
v_mfma_f32_16x16x32_bf16 v[212:215], a[52:55], a[8:11], v[212:215]
v_mfma_f32_16x16x32_bf16 v[172:175], a[52:55], a[4:7], v[172:175]
v_mfma_f32_16x16x32_bf16 v[132:135], a[52:55], a[0:3], v[132:135]
s_waitcnt lgkmcnt(0)
s_barrier
ds_read_b128 v[42:45], v91 offset:0
ds_read_b128 v[46:49], v91 offset:640
ds_read_b128 v[50:53], v91 offset:1280
ds_read_b128 v[54:57], v91 offset:1920
v_mfma_f32_16x16x32_bf16 v[96:99], a[72:75], a[56:59], v[96:99]
v_mfma_f32_16x16x32_bf16 v[136:139], a[72:75], a[60:63], v[136:139]
v_mfma_f32_16x16x32_bf16 v[176:179], a[72:75], a[64:67], v[176:179]
buffer_load_dwordx4 a[176:179], v6, s[40:43], s87 offen offset:3072 sc1
v_mfma_f32_16x16x32_bf16 v[216:219], a[72:75], a[68:71], v[216:219]
v_mfma_f32_16x16x32_bf16 v[220:223], a[76:79], a[68:71], v[220:223]
v_mfma_f32_16x16x32_bf16 v[180:183], a[76:79], a[64:67], v[180:183]
s_waitcnt lgkmcnt(0)
v_add_f32 v82, v42, v46
v_mfma_f32_16x16x32_bf16 v[140:143], a[76:79], a[60:63], v[140:143]
v_add_f32 v83, v43, v47
v_add_f32 v84, v44, v48
v_mfma_f32_16x16x32_bf16 v[100:103], a[76:79], a[56:59], v[100:103]
v_add_f32 v85, v45, v49
v_add_f32 v82, v82, v50
v_mfma_f32_16x16x32_bf16 v[104:107], a[80:83], a[56:59], v[104:107]
v_add_f32 v83, v83, v51
v_add_f32 v84, v84, v52
v_mfma_f32_16x16x32_bf16 v[144:147], a[80:83], a[60:63], v[144:147]
v_add_f32 v85, v85, v53
v_add_f32 v82, v82, v54
v_mfma_f32_16x16x32_bf16 v[184:187], a[80:83], a[64:67], v[184:187]
v_add_f32 v83, v83, v55
v_add_f32 v84, v84, v56
v_mfma_f32_16x16x32_bf16 v[224:227], a[80:83], a[68:71], v[224:227]
v_add_f32 v85, v85, v57
ds_write_b128 v91, v[82:85] offset:2560
v_mfma_f32_16x16x32_bf16 v[228:231], a[84:87], a[68:71], v[228:231]
buffer_load_dwordx4 a[180:183], v6, s[40:43], s88 offen offset:3072 sc1
v_mfma_f32_16x16x32_bf16 v[188:191], a[84:87], a[64:67], v[188:191]
buffer_load_dwordx4 a[184:187], v6, s[40:43], s89 offen offset:3072 sc1
v_mfma_f32_16x16x32_bf16 v[148:151], a[84:87], a[60:63], v[148:151]
buffer_load_dwordx4 a[188:191], v6, s[40:43], s90 offen offset:3072 sc1
v_mfma_f32_16x16x32_bf16 v[108:111], a[84:87], a[56:59], v[108:111]
v_mfma_f32_16x16x32_bf16 v[112:115], a[88:91], a[56:59], v[112:115]
v_mfma_f32_16x16x32_bf16 v[152:155], a[88:91], a[60:63], v[152:155]
v_mfma_f32_16x16x32_bf16 v[192:195], a[88:91], a[64:67], v[192:195]
buffer_load_dwordx4 a[192:195], v21, s[40:43], s86 offen offset:0 sc1
v_mfma_f32_16x16x32_bf16 v[232:235], a[88:91], a[68:71], v[232:235]
v_mfma_f32_16x16x32_bf16 v[236:239], a[92:95], a[68:71], v[236:239]
v_mfma_f32_16x16x32_bf16 v[196:199], a[92:95], a[64:67], v[196:199]
s_waitcnt lgkmcnt(0)
ds_read_b128 v[42:45], v94 offset:0
v_mfma_f32_16x16x32_bf16 v[156:159], a[92:95], a[60:63], v[156:159]
ds_read_b128 v[46:49], v94 offset:16
ds_read_b128 v[50:53], v94 offset:32
v_mfma_f32_16x16x32_bf16 v[116:119], a[92:95], a[56:59], v[116:119]
ds_read_b128 v[54:57], v94 offset:48
ds_read_b128 v[58:61], v94 offset:64
v_mfma_f32_16x16x32_bf16 v[120:123], a[96:99], a[56:59], v[120:123]
ds_read_b128 v[62:65], v94 offset:320
ds_read_b128 v[66:69], v94 offset:336
v_mfma_f32_16x16x32_bf16 v[160:163], a[96:99], a[60:63], v[160:163]
ds_read_b128 v[70:73], v94 offset:352
ds_read_b128 v[74:77], v94 offset:368
v_mfma_f32_16x16x32_bf16 v[200:203], a[96:99], a[64:67], v[200:203]
ds_read_b128 v[78:81], v94 offset:384
s_add_u32 s64, s88, s3
v_mfma_f32_16x16x32_bf16 v[240:243], a[96:99], a[68:71], v[240:243]
s_add_u32 m0, s12, 69632
v_mfma_f32_16x16x32_bf16 v[244:247], a[100:103], a[68:71], v[244:247]
buffer_load_dwordx4 v6, s[40:43], s64 offen offset:0 sc1 lds
v_mfma_f32_16x16x32_bf16 v[204:207], a[100:103], a[64:67], v[204:207]
s_add_u32 s64, s89, s3
s_add_u32 m0, s12, 73728
v_mfma_f32_16x16x32_bf16 v[164:167], a[100:103], a[60:63], v[164:167]
buffer_load_dwordx4 v6, s[40:43], s64 offen offset:0 sc1 lds
v_mfma_f32_16x16x32_bf16 v[124:127], a[100:103], a[56:59], v[124:127]
s_add_u32 s64, s90, s3
s_add_u32 m0, s12, 77824
v_mfma_f32_16x16x32_bf16 v[128:131], a[104:107], a[56:59], v[128:131]
buffer_load_dwordx4 v6, s[40:43], s64 offen offset:0 sc1 lds
v_mfma_f32_16x16x32_bf16 v[168:171], a[104:107], a[60:63], v[168:171]
v_mfma_f32_16x16x32_bf16 v[208:211], a[104:107], a[64:67], v[208:211]
s_add_u32 s64, s86, s3
s_add_u32 m0, s12, 80896
v_mfma_f32_16x16x32_bf16 v[248:251], a[104:107], a[68:71], v[248:251]
buffer_load_dwordx4 v6, s[40:43], s64 offen offset:1024 sc1 lds
v_mfma_f32_16x16x32_bf16 v[252:255], a[108:111], a[68:71], v[252:255]
v_mfma_f32_16x16x32_bf16 v[212:215], a[108:111], a[64:67], v[212:215]
v_mfma_f32_16x16x32_bf16 v[172:175], a[108:111], a[60:63], v[172:175]
v_mfma_f32_16x16x32_bf16 v[132:135], a[108:111], a[56:59], v[132:135]
s_waitcnt vmcnt(25)
s_waitcnt lgkmcnt(0)
v_mov_b32 v32, 0
v_mov_b32 v33, 0
v_mov_b32 v93, 0
v_and_b32 v2, 15, v1
v_mul_u32_u24 v2, 528, v2
v_lshrrev_b32_e64 v3, 4, v1
v_lshl_add_u32 v2, v3, 7, v2
s_mul_i32 s65, s56, 16896
v_add_u32_e64 v20, s65, v2
v_pk_fma_f32 v[96:97], v[42:43], v[34:35], v[96:97] op_sel:[0,1,0] op_sel_hi:[1,1,1]
v_pk_fma_f32 v[98:99], v[44:45], v[34:35], v[98:99] op_sel:[0,1,0] op_sel_hi:[1,1,1]
v_pk_fma_f32 v[100:101], v[46:47], v[34:35], v[100:101] op_sel:[0,1,0] op_sel_hi:[1,1,1]
v_pk_fma_f32 v[102:103], v[48:49], v[34:35], v[102:103] op_sel:[0,1,0] op_sel_hi:[1,1,1]
v_pk_fma_f32 v[104:105], v[50:51], v[34:35], v[104:105] op_sel:[0,1,0] op_sel_hi:[1,1,1]
v_pk_fma_f32 v[106:107], v[52:53], v[34:35], v[106:107] op_sel:[0,1,0] op_sel_hi:[1,1,1]
v_pk_fma_f32 v[108:109], v[54:55], v[34:35], v[108:109] op_sel:[0,1,0] op_sel_hi:[1,1,1]
v_pk_fma_f32 v[110:111], v[56:57], v[34:35], v[110:111] op_sel:[0,1,0] op_sel_hi:[1,1,1]
v_pk_fma_f32 v[112:113], v[58:59], v[34:35], v[112:113] op_sel:[0,1,0] op_sel_hi:[1,1,1]
v_pk_fma_f32 v[114:115], v[60:61], v[34:35], v[114:115] op_sel:[0,1,0] op_sel_hi:[1,1,1]
v_cvt_pk_bf16_f32 v22, v96, v97
v_cvt_pk_bf16_f32 v23, v98, v99
v_cvt_pk_bf16_f32 v24, v100, v101
v_cvt_pk_bf16_f32 v25, v102, v103
v_cvt_pk_bf16_f32 v26, v104, v105
v_cvt_pk_bf16_f32 v27, v106, v107
v_cvt_pk_bf16_f32 v28, v108, v109
v_cvt_pk_bf16_f32 v29, v110, v111
v_cvt_pk_bf16_f32 v30, v112, v113
v_cvt_pk_bf16_f32 v31, v114, v115
v_mfma_f32_16x16x32_bf16 v[96:99], a[196:199], v[22:25], 0
v_bfe_u32 v2, v1, 2, 2
v_mfma_f32_16x16x32_bf16 v[100:103], a[208:211], v[22:25], 0
v_and_b32_e64 v4, 1, v3
v_mfma_f32_16x16x32_bf16 v[104:107], a[220:223], v[22:25], 0
v_lshl_add_u32 v2, v4, 2, v2
v_mfma_f32_16x16x32_bf16 v[108:111], a[232:235], v[22:25], 0
v_lshrrev_b32_e64 v4, 1, v3
v_mfma_f32_16x16x32_bf16 v[112:115], a[244:247], v[22:25], 0
v_lshl_add_u32 v2, v2, 1, v4
v_mfma_f32_16x16x32_bf16 v[96:99], a[200:203], v[26:29], v[96:99]
v_mul_u32_u24 v2, 528, v2
v_mfma_f32_16x16x32_bf16 v[100:103], a[212:215], v[26:29], v[100:103]
v_and_b32_e64 v4, 3, v1
v_mfma_f32_16x16x32_bf16 v[104:107], a[224:227], v[26:29], v[104:107]
v_mfma_f32_16x16x32_bf16 v[108:111], a[236:239], v[26:29], v[108:111]
v_lshl_add_u32 v2, v4, 3, v2
v_mfma_f32_16x16x32_bf16 v[112:115], a[248:251], v[26:29], v[112:115]
s_lshl_b32 s65, s56, 7
v_mfma_f32_16x16x32_bf16 v[96:99], a[204:207], v[30:33], v[96:99]
v_add_u32 v94, s65, v2
v_mfma_f32_16x16x32_bf16 v[100:103], a[216:219], v[30:33], v[100:103]
buffer_load_dwordx4 a[0:3], v21, s[40:43], s87 offen offset:0 sc1
v_mfma_f32_16x16x32_bf16 v[104:107], a[228:231], v[30:33], v[104:107]
buffer_load_dwordx4 a[4:7], v21, s[40:43], s88 offen offset:0 sc1
v_mfma_f32_16x16x32_bf16 v[108:111], a[240:243], v[30:33], v[108:111]
buffer_load_dwordx4 a[8:11], v21, s[40:43], s89 offen offset:0 sc1
v_mfma_f32_16x16x32_bf16 v[112:115], a[252:255], v[30:33], v[112:115]
buffer_load_dwordx4 a[12:15], v21, s[40:43], s90 offen offset:0 sc1
v_rcp_f32_e64 v5, v34
v_mul_f32 v4, 0x3fb8aa3b, v34
v_cvt_pk_bf16_f32 v92, v5, v5
v_pk_fma_f32 v[116:117], v[62:63], v[34:35], v[116:117] op_sel:[0,1,0] op_sel_hi:[1,1,1]
v_pk_fma_f32 v[118:119], v[64:65], v[34:35], v[118:119] op_sel:[0,1,0] op_sel_hi:[1,1,1]
v_pk_fma_f32 v[120:121], v[66:67], v[34:35], v[120:121] op_sel:[0,1,0] op_sel_hi:[1,1,1]
v_pk_fma_f32 v[122:123], v[68:69], v[34:35], v[122:123] op_sel:[0,1,0] op_sel_hi:[1,1,1]
v_pk_fma_f32 v[124:125], v[70:71], v[34:35], v[124:125] op_sel:[0,1,0] op_sel_hi:[1,1,1]
v_pk_fma_f32 v[126:127], v[72:73], v[34:35], v[126:127] op_sel:[0,1,0] op_sel_hi:[1,1,1]
v_pk_fma_f32 v[128:129], v[74:75], v[34:35], v[128:129] op_sel:[0,1,0] op_sel_hi:[1,1,1]
v_pk_fma_f32 v[130:131], v[76:77], v[34:35], v[130:131] op_sel:[0,1,0] op_sel_hi:[1,1,1]
v_pk_fma_f32 v[132:133], v[78:79], v[34:35], v[132:133] op_sel:[0,1,0] op_sel_hi:[1,1,1]
v_pk_fma_f32 v[134:135], v[80:81], v[34:35], v[134:135] op_sel:[0,1,0] op_sel_hi:[1,1,1]
v_cvt_pk_bf16_f32 v82, v116, v117
v_cvt_pk_bf16_f32 v83, v118, v119
v_cvt_pk_bf16_f32 v84, v120, v121
v_cvt_pk_bf16_f32 v85, v122, v123
v_cvt_pk_bf16_f32 v86, v124, v125
v_cvt_pk_bf16_f32 v87, v126, v127
v_cvt_pk_bf16_f32 v88, v128, v129
v_cvt_pk_bf16_f32 v89, v130, v131
v_cvt_pk_bf16_f32 v90, v132, v133
v_cvt_pk_bf16_f32 v91, v134, v135
v_max3_f32 v2, v96, v97, v98
v_min3_f32 v3, v96, v97, v98
v_max3_f32 v2, v2, v99, v100
v_min3_f32 v3, v3, v99, v100
v_max3_f32 v2, v2, v101, v102
v_min3_f32 v3, v3, v101, v102
v_max3_f32 v2, v2, v103, v104
buffer_load_dwordx4 a[16:19], v21, s[40:43], s86 offen offset:1024 sc1
v_min3_f32 v3, v3, v103, v104
v_max3_f32 v2, v2, v105, v106
v_min3_f32 v3, v3, v105, v106
v_max3_f32 v2, v2, v107, v108
v_min3_f32 v3, v3, v107, v108
ds_write_b128 v20, v[82:85] offset:80
v_max3_f32 v2, v2, v109, v110
v_min3_f32 v3, v3, v109, v110
v_max3_f32 v2, v2, v111, v112
v_min3_f32 v3, v3, v111, v112
v_max3_f32 v2, v2, v113, v114
buffer_load_dwordx4 a[20:23], v21, s[40:43], s87 offen offset:1024 sc1
v_min3_f32 v3, v3, v113, v114
v_max_f32 v2, v2, v115
v_min_f32 v3, v3, v115
v_pk_mul_f32 v[2:3], v[2:3], v[4:5] op_sel_hi:[1,0] neg_lo:[0,1]
v_pk_fma_f32 v[116:117], v[96:97], v[4:5], v[2:3] op_sel:[0,0,1] op_sel_hi:[1,0,1] neg_lo:[0,1,0] neg_hi:[0,1,0]
v_pk_fma_f32 v[118:119], v[98:99], v[4:5], v[2:3] op_sel:[0,0,1] op_sel_hi:[1,0,1] neg_lo:[0,1,0] neg_hi:[0,1,0]
v_pk_fma_f32 v[120:121], v[100:101], v[4:5], v[2:3] op_sel:[0,0,1] op_sel_hi:[1,0,1] neg_lo:[0,1,0] neg_hi:[0,1,0]
v_pk_fma_f32 v[122:123], v[102:103], v[4:5], v[2:3] op_sel:[0,0,1] op_sel_hi:[1,0,1] neg_lo:[0,1,0] neg_hi:[0,1,0]
v_pk_fma_f32 v[124:125], v[104:105], v[4:5], v[2:3] op_sel:[0,0,1] op_sel_hi:[1,0,1] neg_lo:[0,1,0] neg_hi:[0,1,0]
v_pk_fma_f32 v[126:127], v[106:107], v[4:5], v[2:3] op_sel:[0,0,1] op_sel_hi:[1,0,1] neg_lo:[0,1,0] neg_hi:[0,1,0]
buffer_load_dwordx4 a[24:27], v21, s[40:43], s88 offen offset:1024 sc1
v_pk_fma_f32 v[128:129], v[108:109], v[4:5], v[2:3] op_sel:[0,0,1] op_sel_hi:[1,0,1] neg_lo:[0,1,0] neg_hi:[0,1,0]
ds_write_b128 v20, v[86:89] offset:96
v_pk_fma_f32 v[130:131], v[110:111], v[4:5], v[2:3] op_sel:[0,0,1] op_sel_hi:[1,0,1] neg_lo:[0,1,0] neg_hi:[0,1,0]
v_pk_fma_f32 v[132:133], v[112:113], v[4:5], v[2:3] op_sel:[0,0,1] op_sel_hi:[1,0,1] neg_lo:[0,1,0] neg_hi:[0,1,0]
v_pk_fma_f32 v[134:135], v[114:115], v[4:5], v[2:3] op_sel:[0,0,1] op_sel_hi:[1,0,1] neg_lo:[0,1,0] neg_hi:[0,1,0]
v_pk_fma_f32 v[96:97], v[96:97], v[4:5], v[2:3] op_sel_hi:[1,0,0]
v_pk_fma_f32 v[98:99], v[98:99], v[4:5], v[2:3] op_sel_hi:[1,0,0]
v_pk_fma_f32 v[100:101], v[100:101], v[4:5], v[2:3] op_sel_hi:[1,0,0]
v_pk_fma_f32 v[102:103], v[102:103], v[4:5], v[2:3] op_sel_hi:[1,0,0]
v_pk_fma_f32 v[104:105], v[104:105], v[4:5], v[2:3] op_sel_hi:[1,0,0]
v_pk_fma_f32 v[106:107], v[106:107], v[4:5], v[2:3] op_sel_hi:[1,0,0]
buffer_load_dwordx4 a[28:31], v21, s[40:43], s89 offen offset:1024 sc1
v_pk_fma_f32 v[108:109], v[108:109], v[4:5], v[2:3] op_sel_hi:[1,0,0]
v_pk_fma_f32 v[110:111], v[110:111], v[4:5], v[2:3] op_sel_hi:[1,0,0]
v_pk_fma_f32 v[112:113], v[112:113], v[4:5], v[2:3] op_sel_hi:[1,0,0]
v_pk_fma_f32 v[114:115], v[114:115], v[4:5], v[2:3] op_sel_hi:[1,0,0]
v_pk_fma_f32 v[136:137], v[42:43], v[36:37], v[136:137] op_sel:[0,1,0] op_sel_hi:[1,1,1]
v_pk_fma_f32 v[138:139], v[44:45], v[36:37], v[138:139] op_sel:[0,1,0] op_sel_hi:[1,1,1]
ds_write_b128 v20, v[90:93] offset:112
v_pk_fma_f32 v[140:141], v[46:47], v[36:37], v[140:141] op_sel:[0,1,0] op_sel_hi:[1,1,1]
v_pk_fma_f32 v[142:143], v[48:49], v[36:37], v[142:143] op_sel:[0,1,0] op_sel_hi:[1,1,1]
v_pk_fma_f32 v[144:145], v[50:51], v[36:37], v[144:145] op_sel:[0,1,0] op_sel_hi:[1,1,1]
v_pk_fma_f32 v[146:147], v[52:53], v[36:37], v[146:147] op_sel:[0,1,0] op_sel_hi:[1,1,1]
buffer_load_dwordx4 a[32:35], v21, s[40:43], s90 offen offset:1024 sc1
v_pk_fma_f32 v[148:149], v[54:55], v[36:37], v[148:149] op_sel:[0,1,0] op_sel_hi:[1,1,1]
v_pk_fma_f32 v[150:151], v[56:57], v[36:37], v[150:151] op_sel:[0,1,0] op_sel_hi:[1,1,1]
v_pk_fma_f32 v[152:153], v[58:59], v[36:37], v[152:153] op_sel:[0,1,0] op_sel_hi:[1,1,1]
v_pk_fma_f32 v[154:155], v[60:61], v[36:37], v[154:155] op_sel:[0,1,0] op_sel_hi:[1,1,1]
v_cvt_pk_bf16_f32 v22, v136, v137
v_cvt_pk_bf16_f32 v23, v138, v139
v_cvt_pk_bf16_f32 v24, v140, v141
v_cvt_pk_bf16_f32 v25, v142, v143
v_cvt_pk_bf16_f32 v26, v144, v145
v_cvt_pk_bf16_f32 v27, v146, v147
buffer_load_dwordx4 a[36:39], v21, s[40:43], s86 offen offset:2048 sc1
v_cvt_pk_bf16_f32 v28, v148, v149
v_cvt_pk_bf16_f32 v29, v150, v151
v_cvt_pk_bf16_f32 v30, v152, v153
v_cvt_pk_bf16_f32 v31, v154, v155
v_exp_f32_e64 v96, v96
v_mfma_f32_16x16x32_bf16 v[136:139], a[196:199], v[22:25], 0
v_exp_f32 v97, v97
v_exp_f32 v98, v98
v_mfma_f32_16x16x32_bf16 v[140:143], a[208:211], v[22:25], 0
v_exp_f32 v99, v99
v_exp_f32 v100, v100
v_mfma_f32_16x16x32_bf16 v[144:147], a[220:223], v[22:25], 0
v_exp_f32 v101, v101
v_exp_f32 v102, v102
v_mfma_f32_16x16x32_bf16 v[148:151], a[232:235], v[22:25], 0
v_exp_f32 v103, v103
v_exp_f32 v104, v104
v_mfma_f32_16x16x32_bf16 v[152:155], a[244:247], v[22:25], 0
v_exp_f32_e64 v105, v105
buffer_load_dwordx4 a[40:43], v21, s[40:43], s87 offen offset:2048 sc1
v_exp_f32_e64 v106, v106
v_mfma_f32_16x16x32_bf16 v[136:139], a[200:203], v[26:29], v[136:139]
v_exp_f32 v107, v107
v_exp_f32 v108, v108
v_mfma_f32_16x16x32_bf16 v[140:143], a[212:215], v[26:29], v[140:143]
v_exp_f32 v109, v109
v_exp_f32 v110, v110
v_mfma_f32_16x16x32_bf16 v[144:147], a[224:227], v[26:29], v[144:147]
v_exp_f32 v111, v111
v_exp_f32 v112, v112
v_mfma_f32_16x16x32_bf16 v[148:151], a[236:239], v[26:29], v[148:151]
v_exp_f32 v113, v113
v_exp_f32 v114, v114
v_mfma_f32_16x16x32_bf16 v[152:155], a[248:251], v[26:29], v[152:155]
v_exp_f32 v115, v115
v_exp_f32 v116, v116
v_mfma_f32_16x16x32_bf16 v[136:139], a[204:207], v[30:33], v[136:139]
v_exp_f32_e64 v117, v117
buffer_load_dwordx4 a[44:47], v21, s[40:43], s88 offen offset:2048 sc1
v_exp_f32_e64 v118, v118
v_mfma_f32_16x16x32_bf16 v[140:143], a[216:219], v[30:33], v[140:143]
v_exp_f32 v119, v119
v_exp_f32 v120, v120
v_mfma_f32_16x16x32_bf16 v[144:147], a[228:231], v[30:33], v[144:147]
v_exp_f32 v121, v121
v_exp_f32 v122, v122
v_mfma_f32_16x16x32_bf16 v[148:151], a[240:243], v[30:33], v[148:151]
v_exp_f32 v123, v123
v_exp_f32 v124, v124
v_mfma_f32_16x16x32_bf16 v[152:155], a[252:255], v[30:33], v[152:155]
v_exp_f32 v125, v125
v_exp_f32 v126, v126
v_exp_f32 v127, v127
v_exp_f32 v128, v128
buffer_load_dwordx4 a[48:51], v21, s[40:43], s89 offen offset:2048 sc1
v_exp_f32 v129, v129
v_exp_f32 v130, v130
v_exp_f32 v131, v131
v_exp_f32 v132, v132
v_exp_f32 v133, v133
v_exp_f32 v134, v134
v_exp_f32_e64 v135, v135
v_pk_add_f32 v[2:3], v[96:97], v[98:99]
v_pk_add_f32 v[4:5], v[116:117], v[118:119]
v_pk_add_f32 v[2:3], v[2:3], v[100:101]
v_pk_add_f32 v[4:5], v[4:5], v[120:121]
v_pk_add_f32 v[2:3], v[2:3], v[102:103]
v_pk_add_f32 v[4:5], v[4:5], v[122:123]
v_pk_add_f32 v[2:3], v[2:3], v[104:105]
v_pk_add_f32 v[4:5], v[4:5], v[124:125]
v_pk_add_f32 v[2:3], v[2:3], v[106:107]
v_pk_add_f32 v[4:5], v[4:5], v[126:127]
v_pk_add_f32 v[2:3], v[2:3], v[108:109]
v_pk_add_f32 v[4:5], v[4:5], v[128:129]
v_pk_add_f32 v[2:3], v[2:3], v[110:111]
v_pk_add_f32 v[4:5], v[4:5], v[130:131]
v_pk_add_f32 v[2:3], v[2:3], v[112:113]
v_pk_add_f32 v[4:5], v[4:5], v[132:133]
v_pk_add_f32 v[2:3], v[2:3], v[114:115]
v_pk_add_f32 v[4:5], v[4:5], v[134:135]
v_add_f32 v2, v2, v3
v_add_f32 v4, v4, v5
v_rcp_f32_e64 v2, v2
v_rcp_f32 v3, v4
s_nop 0
v_pk_mul_f32 v[2:3], v[2:3], v[34:35] op_sel_hi:[1,0]
v_pk_mul_f32 v[96:97], v[96:97], v[2:3] op_sel_hi:[1,0]
v_pk_mul_f32 v[98:99], v[98:99], v[2:3] op_sel_hi:[1,0]
v_pk_mul_f32 v[100:101], v[100:101], v[2:3] op_sel_hi:[1,0]
v_pk_mul_f32 v[116:117], v[116:117], v[2:3] op_sel:[0,1] op_sel_hi:[1,1]
v_pk_mul_f32 v[118:119], v[118:119], v[2:3] op_sel:[0,1] op_sel_hi:[1,1]
v_cvt_pk_bf16_f32 v82, v96, v97
v_cvt_pk_bf16_f32 v83, v98, v99
v_cvt_pk_bf16_f32 v84, v100, v116
v_cvt_pk_bf16_f32 v85, v117, v118
ds_write_b128 v20, v[82:85] offset:0
v_pk_mul_f32 v[120:121], v[120:121], v[2:3] op_sel:[0,1] op_sel_hi:[1,1]
v_pk_mul_f32 v[102:103], v[102:103], v[2:3] op_sel_hi:[1,0]
v_pk_mul_f32 v[104:105], v[104:105], v[2:3] op_sel_hi:[1,0]
v_cvt_pk_bf16_f32 v86, v119, v120
v_cvt_pk_bf16_f32 v87, v101, v102
v_cvt_pk_bf16_f32 v88, v103, v104
v_cvt_pk_bf16_f32 v89, v105, v121
v_pk_mul_f32 v[122:123], v[122:123], v[2:3] op_sel:[0,1] op_sel_hi:[1,1]
v_pk_mul_f32 v[124:125], v[124:125], v[2:3] op_sel:[0,1] op_sel_hi:[1,1]
v_pk_mul_f32 v[106:107], v[106:107], v[2:3] op_sel_hi:[1,0]
v_pk_mul_f32 v[108:109], v[108:109], v[2:3] op_sel_hi:[1,0]
v_cvt_pk_bf16_f32 v16, v122, v123
v_cvt_pk_bf16_f32 v17, v124, v125
v_cvt_pk_bf16_f32 v18, v106, v107
v_cvt_pk_bf16_f32 v19, v108, v109
ds_write_b128 v20, v[86:89] offset:16
v_pk_mul_f32 v[110:111], v[110:111], v[2:3] op_sel_hi:[1,0]
v_pk_mul_f32 v[126:127], v[126:127], v[2:3] op_sel:[0,1] op_sel_hi:[1,1]
v_pk_mul_f32 v[128:129], v[128:129], v[2:3] op_sel:[0,1] op_sel_hi:[1,1]
v_pk_mul_f32 v[130:131], v[130:131], v[2:3] op_sel:[0,1] op_sel_hi:[1,1]
v_pk_mul_f32 v[112:113], v[112:113], v[2:3] op_sel_hi:[1,0]
v_cvt_pk_bf16_f32 v22, v110, v126
v_cvt_pk_bf16_f32 v23, v127, v128
v_cvt_pk_bf16_f32 v24, v129, v130
v_cvt_pk_bf16_f32 v25, v111, v112
v_pk_mul_f32 v[114:115], v[114:115], v[2:3] op_sel_hi:[1,0]
v_pk_mul_f32 v[132:133], v[132:133], v[2:3] op_sel:[0,1] op_sel_hi:[1,1]
v_pk_mul_f32 v[134:135], v[134:135], v[2:3] op_sel:[0,1] op_sel_hi:[1,1]
v_cvt_pk_bf16_f32 v26, v113, v114
v_cvt_pk_bf16_f32 v27, v115, v131
v_cvt_pk_bf16_f32 v28, v132, v133
v_cvt_pk_bf16_f32 v29, v134, v135
ds_write_b128 v20, v[16:19] offset:32
v_rcp_f32_e64 v5, v36
v_mul_f32 v4, 0x3fb8aa3b, v36
v_cvt_pk_bf16_f32 v92, v5, v5
v_pk_fma_f32 v[156:157], v[62:63], v[36:37], v[156:157] op_sel:[0,1,0] op_sel_hi:[1,1,1]
v_pk_fma_f32 v[158:159], v[64:65], v[36:37], v[158:159] op_sel:[0,1,0] op_sel_hi:[1,1,1]
v_pk_fma_f32 v[160:161], v[66:67], v[36:37], v[160:161] op_sel:[0,1,0] op_sel_hi:[1,1,1]
v_pk_fma_f32 v[162:163], v[68:69], v[36:37], v[162:163] op_sel:[0,1,0] op_sel_hi:[1,1,1]
ds_write_b128 v20, v[22:25] offset:48
v_pk_fma_f32 v[164:165], v[70:71], v[36:37], v[164:165] op_sel:[0,1,0] op_sel_hi:[1,1,1]
v_pk_fma_f32 v[166:167], v[72:73], v[36:37], v[166:167] op_sel:[0,1,0] op_sel_hi:[1,1,1]
v_pk_fma_f32 v[168:169], v[74:75], v[36:37], v[168:169] op_sel:[0,1,0] op_sel_hi:[1,1,1]
v_pk_fma_f32 v[170:171], v[76:77], v[36:37], v[170:171] op_sel:[0,1,0] op_sel_hi:[1,1,1]
v_pk_fma_f32 v[172:173], v[78:79], v[36:37], v[172:173] op_sel:[0,1,0] op_sel_hi:[1,1,1]
v_pk_fma_f32 v[174:175], v[80:81], v[36:37], v[174:175] op_sel:[0,1,0] op_sel_hi:[1,1,1]
v_cvt_pk_bf16_f32 v82, v156, v157
v_cvt_pk_bf16_f32 v83, v158, v159
v_cvt_pk_bf16_f32 v84, v160, v161
v_cvt_pk_bf16_f32 v85, v162, v163
ds_write_b128 v20, v[26:29] offset:64
v_cvt_pk_bf16_f32 v86, v164, v165
v_cvt_pk_bf16_f32 v87, v166, v167
v_cvt_pk_bf16_f32 v88, v168, v169
v_cvt_pk_bf16_f32 v89, v170, v171
v_cvt_pk_bf16_f32 v90, v172, v173
v_cvt_pk_bf16_f32 v91, v174, v175
v_max3_f32 v2, v136, v137, v138
v_min3_f32 v3, v136, v137, v138
v_max3_f32 v2, v2, v139, v140
v_min3_f32 v3, v3, v139, v140
v_max3_f32 v2, v2, v141, v142
v_min3_f32 v3, v3, v141, v142
v_max3_f32 v2, v2, v143, v144
buffer_load_dwordx4 a[52:55], v21, s[40:43], s90 offen offset:2048 sc1
v_min3_f32 v3, v3, v143, v144
v_max3_f32 v2, v2, v145, v146
v_min3_f32 v3, v3, v145, v146
v_max3_f32 v2, v2, v147, v148
v_min3_f32 v3, v3, v147, v148
ds_write_b128 v20, v[82:85] offset:8528
v_max3_f32 v2, v2, v149, v150
v_min3_f32 v3, v3, v149, v150
v_max3_f32 v2, v2, v151, v152
v_min3_f32 v3, v3, v151, v152
v_max3_f32 v2, v2, v153, v154
buffer_load_dwordx4 a[56:59], v21, s[40:43], s86 offen offset:3072 sc1
v_min3_f32 v3, v3, v153, v154
v_max_f32 v2, v2, v155
v_min_f32 v3, v3, v155
v_pk_mul_f32 v[2:3], v[2:3], v[4:5] op_sel_hi:[1,0] neg_lo:[0,1]
v_pk_fma_f32 v[156:157], v[136:137], v[4:5], v[2:3] op_sel:[0,0,1] op_sel_hi:[1,0,1] neg_lo:[0,1,0] neg_hi:[0,1,0]
v_pk_fma_f32 v[158:159], v[138:139], v[4:5], v[2:3] op_sel:[0,0,1] op_sel_hi:[1,0,1] neg_lo:[0,1,0] neg_hi:[0,1,0]
v_pk_fma_f32 v[160:161], v[140:141], v[4:5], v[2:3] op_sel:[0,0,1] op_sel_hi:[1,0,1] neg_lo:[0,1,0] neg_hi:[0,1,0]
v_pk_fma_f32 v[162:163], v[142:143], v[4:5], v[2:3] op_sel:[0,0,1] op_sel_hi:[1,0,1] neg_lo:[0,1,0] neg_hi:[0,1,0]
v_pk_fma_f32 v[164:165], v[144:145], v[4:5], v[2:3] op_sel:[0,0,1] op_sel_hi:[1,0,1] neg_lo:[0,1,0] neg_hi:[0,1,0]
v_pk_fma_f32 v[166:167], v[146:147], v[4:5], v[2:3] op_sel:[0,0,1] op_sel_hi:[1,0,1] neg_lo:[0,1,0] neg_hi:[0,1,0]
buffer_load_dwordx4 a[60:63], v21, s[40:43], s87 offen offset:3072 sc1
v_pk_fma_f32 v[168:169], v[148:149], v[4:5], v[2:3] op_sel:[0,0,1] op_sel_hi:[1,0,1] neg_lo:[0,1,0] neg_hi:[0,1,0]
ds_write_b128 v20, v[86:89] offset:8544
v_pk_fma_f32 v[170:171], v[150:151], v[4:5], v[2:3] op_sel:[0,0,1] op_sel_hi:[1,0,1] neg_lo:[0,1,0] neg_hi:[0,1,0]
v_pk_fma_f32 v[172:173], v[152:153], v[4:5], v[2:3] op_sel:[0,0,1] op_sel_hi:[1,0,1] neg_lo:[0,1,0] neg_hi:[0,1,0]
v_pk_fma_f32 v[174:175], v[154:155], v[4:5], v[2:3] op_sel:[0,0,1] op_sel_hi:[1,0,1] neg_lo:[0,1,0] neg_hi:[0,1,0]
v_pk_fma_f32 v[136:137], v[136:137], v[4:5], v[2:3] op_sel_hi:[1,0,0]
v_pk_fma_f32 v[138:139], v[138:139], v[4:5], v[2:3] op_sel_hi:[1,0,0]
v_pk_fma_f32 v[140:141], v[140:141], v[4:5], v[2:3] op_sel_hi:[1,0,0]
v_pk_fma_f32 v[142:143], v[142:143], v[4:5], v[2:3] op_sel_hi:[1,0,0]
v_pk_fma_f32 v[144:145], v[144:145], v[4:5], v[2:3] op_sel_hi:[1,0,0]
v_pk_fma_f32 v[146:147], v[146:147], v[4:5], v[2:3] op_sel_hi:[1,0,0]
buffer_load_dwordx4 a[64:67], v21, s[40:43], s88 offen offset:3072 sc1
v_pk_fma_f32 v[148:149], v[148:149], v[4:5], v[2:3] op_sel_hi:[1,0,0]
v_pk_fma_f32 v[150:151], v[150:151], v[4:5], v[2:3] op_sel_hi:[1,0,0]
v_pk_fma_f32 v[152:153], v[152:153], v[4:5], v[2:3] op_sel_hi:[1,0,0]
v_pk_fma_f32 v[154:155], v[154:155], v[4:5], v[2:3] op_sel_hi:[1,0,0]
v_pk_fma_f32 v[176:177], v[42:43], v[38:39], v[176:177] op_sel:[0,1,0] op_sel_hi:[1,1,1]
v_pk_fma_f32 v[178:179], v[44:45], v[38:39], v[178:179] op_sel:[0,1,0] op_sel_hi:[1,1,1]
ds_write_b128 v20, v[90:93] offset:8560
v_pk_fma_f32 v[180:181], v[46:47], v[38:39], v[180:181] op_sel:[0,1,0] op_sel_hi:[1,1,1]
v_pk_fma_f32 v[182:183], v[48:49], v[38:39], v[182:183] op_sel:[0,1,0] op_sel_hi:[1,1,1]
v_pk_fma_f32 v[184:185], v[50:51], v[38:39], v[184:185] op_sel:[0,1,0] op_sel_hi:[1,1,1]
v_pk_fma_f32 v[186:187], v[52:53], v[38:39], v[186:187] op_sel:[0,1,0] op_sel_hi:[1,1,1]
buffer_load_dwordx4 a[68:71], v21, s[40:43], s89 offen offset:3072 sc1
v_pk_fma_f32 v[188:189], v[54:55], v[38:39], v[188:189] op_sel:[0,1,0] op_sel_hi:[1,1,1]
v_pk_fma_f32 v[190:191], v[56:57], v[38:39], v[190:191] op_sel:[0,1,0] op_sel_hi:[1,1,1]
v_pk_fma_f32 v[192:193], v[58:59], v[38:39], v[192:193] op_sel:[0,1,0] op_sel_hi:[1,1,1]
v_pk_fma_f32 v[194:195], v[60:61], v[38:39], v[194:195] op_sel:[0,1,0] op_sel_hi:[1,1,1]
v_cvt_pk_bf16_f32 v22, v176, v177
v_cvt_pk_bf16_f32 v23, v178, v179
v_cvt_pk_bf16_f32 v24, v180, v181
v_cvt_pk_bf16_f32 v25, v182, v183
v_cvt_pk_bf16_f32 v26, v184, v185
v_cvt_pk_bf16_f32 v27, v186, v187
buffer_load_dwordx4 a[72:75], v21, s[40:43], s90 offen offset:3072 sc1
v_cvt_pk_bf16_f32 v28, v188, v189
v_cvt_pk_bf16_f32 v29, v190, v191
v_cvt_pk_bf16_f32 v30, v192, v193
v_cvt_pk_bf16_f32 v31, v194, v195
v_exp_f32_e64 v136, v136
v_mfma_f32_16x16x32_bf16 v[176:179], a[196:199], v[22:25], 0
v_exp_f32 v137, v137
v_exp_f32 v138, v138
v_mfma_f32_16x16x32_bf16 v[180:183], a[208:211], v[22:25], 0
v_exp_f32 v139, v139
v_exp_f32 v140, v140
v_mfma_f32_16x16x32_bf16 v[184:187], a[220:223], v[22:25], 0
v_exp_f32 v141, v141
v_exp_f32 v142, v142
v_mfma_f32_16x16x32_bf16 v[188:191], a[232:235], v[22:25], 0
v_exp_f32 v143, v143
v_exp_f32 v144, v144
v_mfma_f32_16x16x32_bf16 v[192:195], a[244:247], v[22:25], 0
v_exp_f32_e64 v145, v145
buffer_load_dwordx4 a[76:79], v0, s[40:43], s86 offen offset:0 sc1
v_exp_f32_e64 v146, v146
v_mfma_f32_16x16x32_bf16 v[176:179], a[200:203], v[26:29], v[176:179]
v_exp_f32 v147, v147
v_exp_f32 v148, v148
v_mfma_f32_16x16x32_bf16 v[180:183], a[212:215], v[26:29], v[180:183]
v_exp_f32 v149, v149
v_exp_f32 v150, v150
v_mfma_f32_16x16x32_bf16 v[184:187], a[224:227], v[26:29], v[184:187]
v_exp_f32 v151, v151
v_exp_f32 v152, v152
v_mfma_f32_16x16x32_bf16 v[188:191], a[236:239], v[26:29], v[188:191]
v_exp_f32 v153, v153
v_exp_f32 v154, v154
v_mfma_f32_16x16x32_bf16 v[192:195], a[248:251], v[26:29], v[192:195]
v_exp_f32 v155, v155
v_exp_f32 v156, v156
v_mfma_f32_16x16x32_bf16 v[176:179], a[204:207], v[30:33], v[176:179]
v_exp_f32_e64 v157, v157
buffer_load_dwordx4 a[80:83], v0, s[40:43], s87 offen offset:0 sc1
v_exp_f32_e64 v158, v158
v_mfma_f32_16x16x32_bf16 v[180:183], a[216:219], v[30:33], v[180:183]
v_exp_f32 v159, v159
v_exp_f32 v160, v160
v_mfma_f32_16x16x32_bf16 v[184:187], a[228:231], v[30:33], v[184:187]
v_exp_f32 v161, v161
v_exp_f32 v162, v162
v_mfma_f32_16x16x32_bf16 v[188:191], a[240:243], v[30:33], v[188:191]
v_exp_f32 v163, v163
v_exp_f32 v164, v164
v_mfma_f32_16x16x32_bf16 v[192:195], a[252:255], v[30:33], v[192:195]
v_exp_f32 v165, v165
v_exp_f32 v166, v166
v_exp_f32 v167, v167
v_exp_f32 v168, v168
buffer_load_dwordx4 a[84:87], v0, s[40:43], s88 offen offset:0 sc1
v_exp_f32 v169, v169
v_exp_f32 v170, v170
v_exp_f32 v171, v171
v_exp_f32 v172, v172
v_exp_f32 v173, v173
v_exp_f32 v174, v174
v_exp_f32_e64 v175, v175
v_pk_add_f32 v[2:3], v[136:137], v[138:139]
v_pk_add_f32 v[4:5], v[156:157], v[158:159]
v_pk_add_f32 v[2:3], v[2:3], v[140:141]
v_pk_add_f32 v[4:5], v[4:5], v[160:161]
v_pk_add_f32 v[2:3], v[2:3], v[142:143]
v_pk_add_f32 v[4:5], v[4:5], v[162:163]
v_pk_add_f32 v[2:3], v[2:3], v[144:145]
v_pk_add_f32 v[4:5], v[4:5], v[164:165]
v_pk_add_f32 v[2:3], v[2:3], v[146:147]
v_pk_add_f32 v[4:5], v[4:5], v[166:167]
v_pk_add_f32 v[2:3], v[2:3], v[148:149]
v_pk_add_f32 v[4:5], v[4:5], v[168:169]
v_pk_add_f32 v[2:3], v[2:3], v[150:151]
v_pk_add_f32 v[4:5], v[4:5], v[170:171]
v_pk_add_f32 v[2:3], v[2:3], v[152:153]
v_pk_add_f32 v[4:5], v[4:5], v[172:173]
v_pk_add_f32 v[2:3], v[2:3], v[154:155]
v_pk_add_f32 v[4:5], v[4:5], v[174:175]
v_add_f32 v2, v2, v3
v_add_f32 v4, v4, v5
v_rcp_f32_e64 v2, v2
v_rcp_f32 v3, v4
s_nop 0
v_pk_mul_f32 v[2:3], v[2:3], v[36:37] op_sel_hi:[1,0]
v_pk_mul_f32 v[136:137], v[136:137], v[2:3] op_sel_hi:[1,0]
v_pk_mul_f32 v[138:139], v[138:139], v[2:3] op_sel_hi:[1,0]
v_pk_mul_f32 v[140:141], v[140:141], v[2:3] op_sel_hi:[1,0]
v_pk_mul_f32 v[156:157], v[156:157], v[2:3] op_sel:[0,1] op_sel_hi:[1,1]
v_pk_mul_f32 v[158:159], v[158:159], v[2:3] op_sel:[0,1] op_sel_hi:[1,1]
v_cvt_pk_bf16_f32 v96, v136, v137
v_cvt_pk_bf16_f32 v97, v138, v139
v_cvt_pk_bf16_f32 v98, v140, v156
v_cvt_pk_bf16_f32 v99, v157, v158
ds_write_b128 v20, v[96:99] offset:8448
v_pk_mul_f32 v[160:161], v[160:161], v[2:3] op_sel:[0,1] op_sel_hi:[1,1]
v_pk_mul_f32 v[142:143], v[142:143], v[2:3] op_sel_hi:[1,0]
v_pk_mul_f32 v[144:145], v[144:145], v[2:3] op_sel_hi:[1,0]
v_cvt_pk_bf16_f32 v100, v159, v160
v_cvt_pk_bf16_f32 v101, v141, v142
v_cvt_pk_bf16_f32 v102, v143, v144
v_cvt_pk_bf16_f32 v103, v145, v161
ds_write_b128 v20, v[100:103] offset:8464
v_pk_mul_f32 v[162:163], v[162:163], v[2:3] op_sel:[0,1] op_sel_hi:[1,1]
v_pk_mul_f32 v[164:165], v[164:165], v[2:3] op_sel:[0,1] op_sel_hi:[1,1]
v_pk_mul_f32 v[146:147], v[146:147], v[2:3] op_sel_hi:[1,0]
v_pk_mul_f32 v[148:149], v[148:149], v[2:3] op_sel_hi:[1,0]
v_cvt_pk_bf16_f32 v104, v162, v163
v_cvt_pk_bf16_f32 v105, v164, v165
v_cvt_pk_bf16_f32 v106, v146, v147
v_cvt_pk_bf16_f32 v107, v148, v149
ds_write_b128 v20, v[104:107] offset:8480
v_pk_mul_f32 v[150:151], v[150:151], v[2:3] op_sel_hi:[1,0]
v_pk_mul_f32 v[166:167], v[166:167], v[2:3] op_sel:[0,1] op_sel_hi:[1,1]
v_pk_mul_f32 v[168:169], v[168:169], v[2:3] op_sel:[0,1] op_sel_hi:[1,1]
v_pk_mul_f32 v[170:171], v[170:171], v[2:3] op_sel:[0,1] op_sel_hi:[1,1]
v_pk_mul_f32 v[152:153], v[152:153], v[2:3] op_sel_hi:[1,0]
v_cvt_pk_bf16_f32 v108, v150, v166
v_cvt_pk_bf16_f32 v109, v167, v168
v_cvt_pk_bf16_f32 v110, v169, v170
v_cvt_pk_bf16_f32 v111, v151, v152
ds_write_b128 v20, v[108:111] offset:8496
v_pk_mul_f32 v[154:155], v[154:155], v[2:3] op_sel_hi:[1,0]
v_pk_mul_f32 v[172:173], v[172:173], v[2:3] op_sel:[0,1] op_sel_hi:[1,1]
v_pk_mul_f32 v[174:175], v[174:175], v[2:3] op_sel:[0,1] op_sel_hi:[1,1]
v_cvt_pk_bf16_f32 v112, v153, v154
v_cvt_pk_bf16_f32 v113, v155, v171
v_cvt_pk_bf16_f32 v114, v172, v173
v_cvt_pk_bf16_f32 v115, v174, v175
ds_write_b128 v20, v[112:115] offset:8512
v_and_b32 v2, 15, v1
v_min_u32 v3, 11, v2
v_and_b32 v4, 16, v1
v_mul_u32_u24 v4, s77, v4
v_lshl_add_u32 v164, v3, 7, v4
s_waitcnt lgkmcnt(0)
s_barrier
v_rcp_f32_e64 v5, v38
ds_read_b64_tr_b16 v[96:97], v94 offset:0
v_mul_f32 v4, 0x3fb8aa3b, v38
ds_read_b64_tr_b16 v[98:99], v94 offset:8448
v_cvt_pk_bf16_f32 v92, v5, v5
ds_read_b64_tr_b16 v[100:101], v94 offset:32
v_pk_fma_f32 v[196:197], v[62:63], v[38:39], v[196:197] op_sel:[0,1,0] op_sel_hi:[1,1,1]
ds_read_b64_tr_b16 v[102:103], v94 offset:8480
v_pk_fma_f32 v[198:199], v[64:65], v[38:39], v[198:199] op_sel:[0,1,0] op_sel_hi:[1,1,1]
ds_read_b64_tr_b16 v[104:105], v94 offset:64
v_pk_fma_f32 v[200:201], v[66:67], v[38:39], v[200:201] op_sel:[0,1,0] op_sel_hi:[1,1,1]
v_pk_fma_f32 v[202:203], v[68:69], v[38:39], v[202:203] op_sel:[0,1,0] op_sel_hi:[1,1,1]
ds_read_b64_tr_b16 v[106:107], v94 offset:8512
v_pk_fma_f32 v[204:205], v[70:71], v[38:39], v[204:205] op_sel:[0,1,0] op_sel_hi:[1,1,1]
ds_read_b64_tr_b16 v[108:109], v94 offset:80
v_pk_fma_f32 v[206:207], v[72:73], v[38:39], v[206:207] op_sel:[0,1,0] op_sel_hi:[1,1,1]
ds_read_b64_tr_b16 v[110:111], v94 offset:8528
v_pk_fma_f32 v[208:209], v[74:75], v[38:39], v[208:209] op_sel:[0,1,0] op_sel_hi:[1,1,1]
ds_read_b64_tr_b16 v[112:113], v94 offset:112
v_pk_fma_f32 v[210:211], v[76:77], v[38:39], v[210:211] op_sel:[0,1,0] op_sel_hi:[1,1,1]
ds_read_b64_tr_b16 v[114:115], v94 offset:8560
v_pk_fma_f32 v[212:213], v[78:79], v[38:39], v[212:213] op_sel:[0,1,0] op_sel_hi:[1,1,1]
ds_read_b64_tr_b16 v[116:117], v94 offset:16896
v_pk_fma_f32 v[214:215], v[80:81], v[38:39], v[214:215] op_sel:[0,1,0] op_sel_hi:[1,1,1]
ds_read_b64_tr_b16 v[118:119], v94 offset:25344
v_cvt_pk_bf16_f32 v82, v196, v197
ds_read_b64_tr_b16 v[120:121], v94 offset:16928
v_cvt_pk_bf16_f32 v83, v198, v199
ds_read_b64_tr_b16 v[122:123], v94 offset:25376
v_cvt_pk_bf16_f32 v84, v200, v201
ds_read_b64_tr_b16 v[124:125], v94 offset:16960
v_cvt_pk_bf16_f32 v85, v202, v203
v_cvt_pk_bf16_f32 v86, v204, v205
ds_read_b64_tr_b16 v[126:127], v94 offset:25408
v_cvt_pk_bf16_f32 v87, v206, v207
ds_read_b64_tr_b16 v[128:129], v94 offset:16976
v_cvt_pk_bf16_f32 v88, v208, v209
ds_read_b64_tr_b16 v[130:131], v94 offset:25424
v_cvt_pk_bf16_f32 v89, v210, v211
ds_read_b64_tr_b16 v[132:133], v94 offset:17008
v_cvt_pk_bf16_f32 v90, v212, v213
ds_read_b64_tr_b16 v[134:135], v94 offset:25456
v_cvt_pk_bf16_f32 v91, v214, v215
v_max3_f32 v2, v176, v177, v178
v_min3_f32 v3, v176, v177, v178
v_max3_f32 v2, v2, v179, v180
v_min3_f32 v3, v3, v179, v180
v_max3_f32 v2, v2, v181, v182
v_min3_f32 v3, v3, v181, v182
v_max3_f32 v2, v2, v183, v184
v_min3_f32 v3, v3, v183, v184
v_max3_f32 v2, v2, v185, v186
v_min3_f32 v3, v3, v185, v186
buffer_load_dwordx4 a[88:91], v0, s[40:43], s89 offen offset:0 sc1
v_max3_f32 v2, v2, v187, v188
v_min3_f32 v3, v3, v187, v188
v_max3_f32 v2, v2, v189, v190
v_min3_f32 v3, v3, v189, v190
v_max3_f32 v2, v2, v191, v192
v_min3_f32 v3, v3, v191, v192
v_max3_f32 v2, v2, v193, v194
v_min3_f32 v3, v3, v193, v194
v_max_f32 v2, v2, v195
v_min_f32 v3, v3, v195
v_pk_mul_f32 v[2:3], v[2:3], v[4:5] op_sel_hi:[1,0] neg_lo:[0,1]
v_pk_fma_f32 v[196:197], v[176:177], v[4:5], v[2:3] op_sel:[0,0,1] op_sel_hi:[1,0,1] neg_lo:[0,1,0] neg_hi:[0,1,0]
v_pk_fma_f32 v[198:199], v[178:179], v[4:5], v[2:3] op_sel:[0,0,1] op_sel_hi:[1,0,1] neg_lo:[0,1,0] neg_hi:[0,1,0]
v_pk_fma_f32 v[200:201], v[180:181], v[4:5], v[2:3] op_sel:[0,0,1] op_sel_hi:[1,0,1] neg_lo:[0,1,0] neg_hi:[0,1,0]
v_pk_fma_f32 v[202:203], v[182:183], v[4:5], v[2:3] op_sel:[0,0,1] op_sel_hi:[1,0,1] neg_lo:[0,1,0] neg_hi:[0,1,0]
buffer_load_dwordx4 a[92:95], v0, s[40:43], s90 offen offset:0 sc1
v_pk_fma_f32 v[204:205], v[184:185], v[4:5], v[2:3] op_sel:[0,0,1] op_sel_hi:[1,0,1] neg_lo:[0,1,0] neg_hi:[0,1,0]
v_pk_fma_f32 v[206:207], v[186:187], v[4:5], v[2:3] op_sel:[0,0,1] op_sel_hi:[1,0,1] neg_lo:[0,1,0] neg_hi:[0,1,0]
v_pk_fma_f32 v[208:209], v[188:189], v[4:5], v[2:3] op_sel:[0,0,1] op_sel_hi:[1,0,1] neg_lo:[0,1,0] neg_hi:[0,1,0]
v_pk_fma_f32 v[210:211], v[190:191], v[4:5], v[2:3] op_sel:[0,0,1] op_sel_hi:[1,0,1] neg_lo:[0,1,0] neg_hi:[0,1,0]
v_pk_fma_f32 v[212:213], v[192:193], v[4:5], v[2:3] op_sel:[0,0,1] op_sel_hi:[1,0,1] neg_lo:[0,1,0] neg_hi:[0,1,0]
v_pk_fma_f32 v[214:215], v[194:195], v[4:5], v[2:3] op_sel:[0,0,1] op_sel_hi:[1,0,1] neg_lo:[0,1,0] neg_hi:[0,1,0]
v_pk_fma_f32 v[176:177], v[176:177], v[4:5], v[2:3] op_sel_hi:[1,0,0]
v_pk_fma_f32 v[178:179], v[178:179], v[4:5], v[2:3] op_sel_hi:[1,0,0]
v_pk_fma_f32 v[180:181], v[180:181], v[4:5], v[2:3] op_sel_hi:[1,0,0]
v_pk_fma_f32 v[182:183], v[182:183], v[4:5], v[2:3] op_sel_hi:[1,0,0]
v_pk_fma_f32 v[184:185], v[184:185], v[4:5], v[2:3] op_sel_hi:[1,0,0]
v_pk_fma_f32 v[186:187], v[186:187], v[4:5], v[2:3] op_sel_hi:[1,0,0]
v_pk_fma_f32 v[188:189], v[188:189], v[4:5], v[2:3] op_sel_hi:[1,0,0]
v_pk_fma_f32 v[190:191], v[190:191], v[4:5], v[2:3] op_sel_hi:[1,0,0]
buffer_load_dwordx4 a[96:99], v0, s[40:43], s86 offen offset:1024 sc1
v_pk_fma_f32 v[192:193], v[192:193], v[4:5], v[2:3] op_sel_hi:[1,0,0]
v_pk_fma_f32 v[194:195], v[194:195], v[4:5], v[2:3] op_sel_hi:[1,0,0]
v_pk_fma_f32 v[216:217], v[42:43], v[40:41], v[216:217] op_sel:[0,1,0] op_sel_hi:[1,1,1]
v_pk_fma_f32 v[218:219], v[44:45], v[40:41], v[218:219] op_sel:[0,1,0] op_sel_hi:[1,1,1]
v_pk_fma_f32 v[220:221], v[46:47], v[40:41], v[220:221] op_sel:[0,1,0] op_sel_hi:[1,1,1]
v_pk_fma_f32 v[222:223], v[48:49], v[40:41], v[222:223] op_sel:[0,1,0] op_sel_hi:[1,1,1]
v_pk_fma_f32 v[224:225], v[50:51], v[40:41], v[224:225] op_sel:[0,1,0] op_sel_hi:[1,1,1]
v_pk_fma_f32 v[226:227], v[52:53], v[40:41], v[226:227] op_sel:[0,1,0] op_sel_hi:[1,1,1]
v_pk_fma_f32 v[228:229], v[54:55], v[40:41], v[228:229] op_sel:[0,1,0] op_sel_hi:[1,1,1]
v_pk_fma_f32 v[230:231], v[56:57], v[40:41], v[230:231] op_sel:[0,1,0] op_sel_hi:[1,1,1]
v_pk_fma_f32 v[232:233], v[58:59], v[40:41], v[232:233] op_sel:[0,1,0] op_sel_hi:[1,1,1]
v_pk_fma_f32 v[234:235], v[60:61], v[40:41], v[234:235] op_sel:[0,1,0] op_sel_hi:[1,1,1]
v_cvt_pk_bf16_f32 v22, v216, v217
v_cvt_pk_bf16_f32 v23, v218, v219
v_cvt_pk_bf16_f32 v24, v220, v221
buffer_load_dwordx4 a[100:103], v0, s[40:43], s87 offen offset:1024 sc1
v_cvt_pk_bf16_f32 v25, v222, v223
v_cvt_pk_bf16_f32 v26, v224, v225
v_cvt_pk_bf16_f32 v27, v226, v227
v_cvt_pk_bf16_f32 v28, v228, v229
v_cvt_pk_bf16_f32 v29, v230, v231
v_cvt_pk_bf16_f32 v30, v232, v233
v_cvt_pk_bf16_f32 v31, v234, v235
s_waitcnt lgkmcnt(0)
v_exp_f32 v176, v176
v_mfma_f32_16x16x32_bf16 v[140:143], v[96:99], v[108:111], 0
v_exp_f32_e64 v177, v177
v_mfma_f32_16x16x32_bf16 v[144:147], v[96:99], v[112:115], 0
v_exp_f32_e64 v178, v178
v_mfma_f32_16x16x32_bf16 v[148:151], v[100:103], v[108:111], 0
v_exp_f32_e64 v179, v179
v_mfma_f32_16x16x32_bf16 v[152:155], v[100:103], v[112:115], 0
v_exp_f32_e64 v180, v180
v_mfma_f32_16x16x32_bf16 v[156:159], v[104:107], v[108:111], 0
v_exp_f32_e64 v181, v181
v_mfma_f32_16x16x32_bf16 v[160:163], v[104:107], v[112:115], 0
v_exp_f32 v182, v182
v_exp_f32 v183, v183
ds_read_b64_tr_b16 v[96:97], v94 offset:33792
v_mfma_f32_16x16x32_bf16 v[140:143], v[116:119], v[128:131], v[140:143]
ds_read_b64_tr_b16 v[98:99], v94 offset:42240
v_exp_f32_e64 v184, v184
ds_read_b64_tr_b16 v[100:101], v94 offset:33824
v_mfma_f32_16x16x32_bf16 v[144:147], v[116:119], v[132:135], v[144:147]
v_exp_f32_e64 v185, v185
ds_read_b64_tr_b16 v[102:103], v94 offset:42272
v_mfma_f32_16x16x32_bf16 v[148:151], v[120:123], v[128:131], v[148:151]
ds_read_b64_tr_b16 v[104:105], v94 offset:33856
v_exp_f32_e64 v186, v186
ds_read_b64_tr_b16 v[106:107], v94 offset:42304
v_mfma_f32_16x16x32_bf16 v[152:155], v[120:123], v[132:135], v[152:155]
ds_read_b64_tr_b16 v[108:109], v94 offset:33872
v_exp_f32_e64 v187, v187
ds_read_b64_tr_b16 v[110:111], v94 offset:42320
v_mfma_f32_16x16x32_bf16 v[156:159], v[124:127], v[128:131], v[156:159]
v_exp_f32_e64 v188, v188
ds_read_b64_tr_b16 v[112:113], v94 offset:33904
v_mfma_f32_16x16x32_bf16 v[160:163], v[124:127], v[132:135], v[160:163]
ds_read_b64_tr_b16 v[114:115], v94 offset:42352
v_exp_f32 v189, v189
v_exp_f32 v190, v190
ds_read_b64_tr_b16 v[116:117], v94 offset:50688
v_mfma_f32_16x16x32_bf16 v[216:219], a[196:199], v[22:25], 0
ds_read_b64_tr_b16 v[118:119], v94 offset:59136
v_exp_f32_e64 v191, v191
ds_read_b64_tr_b16 v[120:121], v94 offset:50720
v_mfma_f32_16x16x32_bf16 v[220:223], a[208:211], v[22:25], 0
ds_read_b64_tr_b16 v[122:123], v94 offset:59168
v_exp_f32_e64 v192, v192
ds_read_b64_tr_b16 v[124:125], v94 offset:50752
v_mfma_f32_16x16x32_bf16 v[224:227], a[220:223], v[22:25], 0
ds_read_b64_tr_b16 v[126:127], v94 offset:59200
v_exp_f32_e64 v193, v193
ds_read_b64_tr_b16 v[128:129], v94 offset:50768
v_mfma_f32_16x16x32_bf16 v[228:231], a[232:235], v[22:25], 0
ds_read_b64_tr_b16 v[130:131], v94 offset:59216
v_exp_f32_e64 v194, v194
ds_read_b64_tr_b16 v[132:133], v94 offset:50800
v_mfma_f32_16x16x32_bf16 v[232:235], a[244:247], v[22:25], 0
ds_read_b64_tr_b16 v[134:135], v94 offset:59248
v_exp_f32 v195, v195
s_waitcnt lgkmcnt(0)
s_barrier
v_exp_f32 v196, v196
v_mfma_f32_16x16x32_bf16 v[140:143], v[96:99], v[108:111], v[140:143]
v_exp_f32_e64 v197, v197
v_mfma_f32_16x16x32_bf16 v[144:147], v[96:99], v[112:115], v[144:147]
v_exp_f32_e64 v198, v198
v_mfma_f32_16x16x32_bf16 v[148:151], v[100:103], v[108:111], v[148:151]
v_exp_f32_e64 v199, v199
v_mfma_f32_16x16x32_bf16 v[152:155], v[100:103], v[112:115], v[152:155]
v_exp_f32_e64 v200, v200
v_mfma_f32_16x16x32_bf16 v[156:159], v[104:107], v[108:111], v[156:159]
ds_write_b128 v20, v[82:85] offset:80
v_exp_f32_e64 v201, v201
v_mfma_f32_16x16x32_bf16 v[160:163], v[104:107], v[112:115], v[160:163]
v_mfma_f32_16x16x32_bf16 v[140:143], v[116:119], v[128:131], v[140:143]
v_exp_f32_e64 v202, v202
v_mfma_f32_16x16x32_bf16 v[144:147], v[116:119], v[132:135], v[144:147]
v_exp_f32_e64 v203, v203
v_mfma_f32_16x16x32_bf16 v[148:151], v[120:123], v[128:131], v[148:151]
v_exp_f32_e64 v204, v204
v_mfma_f32_16x16x32_bf16 v[152:155], v[120:123], v[132:135], v[152:155]
v_exp_f32_e64 v205, v205
v_mfma_f32_16x16x32_bf16 v[156:159], v[124:127], v[128:131], v[156:159]
v_exp_f32_e64 v206, v206
v_mfma_f32_16x16x32_bf16 v[160:163], v[124:127], v[132:135], v[160:163]
ds_write_b128 v20, v[86:89] offset:96
v_exp_f32_e64 v207, v207
v_mfma_f32_16x16x32_bf16 v[216:219], a[200:203], v[26:29], v[216:219]
v_exp_f32_e64 v208, v208
v_mfma_f32_16x16x32_bf16 v[220:223], a[212:215], v[26:29], v[220:223]
v_exp_f32_e64 v209, v209
v_mfma_f32_16x16x32_bf16 v[224:227], a[224:227], v[26:29], v[224:227]
v_exp_f32_e64 v210, v210
v_mfma_f32_16x16x32_bf16 v[228:231], a[236:239], v[26:29], v[228:231]
v_mfma_f32_16x16x32_bf16 v[232:235], a[248:251], v[26:29], v[232:235]
v_exp_f32_e64 v211, v211
v_mfma_f32_16x16x32_bf16 v[216:219], a[204:207], v[30:33], v[216:219]
v_exp_f32_e64 v212, v212
ds_write_b128 v20, v[90:93] offset:112
v_mfma_f32_16x16x32_bf16 v[220:223], a[216:219], v[30:33], v[220:223]
v_exp_f32_e64 v213, v213
v_mfma_f32_16x16x32_bf16 v[224:227], a[228:231], v[30:33], v[224:227]
v_exp_f32_e64 v214, v214
v_mfma_f32_16x16x32_bf16 v[228:231], a[240:243], v[30:33], v[228:231]
v_exp_f32 v215, v215
v_mfma_f32_16x16x32_bf16 v[232:235], a[252:255], v[30:33], v[232:235]
v_pk_add_f32 v[2:3], v[176:177], v[178:179]
v_pk_add_f32 v[4:5], v[196:197], v[198:199]
v_pk_add_f32 v[2:3], v[2:3], v[180:181]
v_pk_add_f32 v[4:5], v[4:5], v[200:201]
v_pk_add_f32 v[2:3], v[2:3], v[182:183]
v_pk_add_f32 v[4:5], v[4:5], v[202:203]
s_add_u32 s64, s87, s3
s_add_u32 m0, s12, 84992
v_pk_add_f32 v[2:3], v[2:3], v[184:185]
buffer_load_dwordx4 v6, s[40:43], s64 offen offset:1024 sc1 lds
v_pk_add_f32 v[4:5], v[4:5], v[204:205]
v_pk_add_f32 v[2:3], v[2:3], v[186:187]
v_pk_add_f32 v[4:5], v[4:5], v[206:207]
v_pk_add_f32 v[2:3], v[2:3], v[188:189]
v_pk_add_f32 v[4:5], v[4:5], v[208:209]
buffer_load_dwordx4 a[104:107], v0, s[40:43], s88 offen offset:1024 sc1
v_pk_add_f32 v[2:3], v[2:3], v[190:191]
v_pk_add_f32 v[4:5], v[4:5], v[210:211]
v_pk_add_f32 v[2:3], v[2:3], v[192:193]
v_pk_add_f32 v[4:5], v[4:5], v[212:213]
v_pk_add_f32 v[2:3], v[2:3], v[194:195]
v_pk_add_f32 v[4:5], v[4:5], v[214:215]
v_add_f32_e64 v2, v2, v3
buffer_load_dwordx4 a[108:111], v0, s[40:43], s89 offen offset:1024 sc1
v_add_f32 v4, v4, v5
v_rcp_f32 v2, v2
v_rcp_f32 v3, v4
s_nop 0
v_pk_mul_f32 v[2:3], v[2:3], v[38:39] op_sel_hi:[1,0]
v_pk_mul_f32 v[176:177], v[176:177], v[2:3] op_sel_hi:[1,0]
v_pk_mul_f32 v[178:179], v[178:179], v[2:3] op_sel_hi:[1,0]
v_pk_mul_f32 v[180:181], v[180:181], v[2:3] op_sel_hi:[1,0]
v_pk_mul_f32 v[196:197], v[196:197], v[2:3] op_sel:[0,1] op_sel_hi:[1,1]
v_pk_mul_f32 v[198:199], v[198:199], v[2:3] op_sel:[0,1] op_sel_hi:[1,1]
v_cvt_pk_bf16_f32 v96, v176, v177
v_cvt_pk_bf16_f32 v97, v178, v179
v_cvt_pk_bf16_f32 v98, v180, v196
v_cvt_pk_bf16_f32 v99, v197, v198
ds_write_b128 v20, v[96:99] offset:0
v_pk_mul_f32 v[200:201], v[200:201], v[2:3] op_sel:[0,1] op_sel_hi:[1,1]
v_pk_mul_f32 v[182:183], v[182:183], v[2:3] op_sel_hi:[1,0]
v_pk_mul_f32 v[184:185], v[184:185], v[2:3] op_sel_hi:[1,0]
v_cvt_pk_bf16_f32 v100, v199, v200
v_cvt_pk_bf16_f32 v101, v181, v182
v_cvt_pk_bf16_f32 v102, v183, v184
v_cvt_pk_bf16_f32 v103, v185, v201
v_pk_mul_f32 v[202:203], v[202:203], v[2:3] op_sel:[0,1] op_sel_hi:[1,1]
v_pk_mul_f32 v[204:205], v[204:205], v[2:3] op_sel:[0,1] op_sel_hi:[1,1]
v_pk_mul_f32 v[186:187], v[186:187], v[2:3] op_sel_hi:[1,0]
v_pk_mul_f32 v[188:189], v[188:189], v[2:3] op_sel_hi:[1,0]
v_cvt_pk_bf16_f32 v104, v202, v203
v_cvt_pk_bf16_f32 v105, v204, v205
v_cvt_pk_bf16_f32 v106, v186, v187
v_cvt_pk_bf16_f32 v107, v188, v189
ds_write_b128 v20, v[100:103] offset:16
v_pk_mul_f32 v[190:191], v[190:191], v[2:3] op_sel_hi:[1,0]
v_pk_mul_f32 v[206:207], v[206:207], v[2:3] op_sel:[0,1] op_sel_hi:[1,1]
v_pk_mul_f32 v[208:209], v[208:209], v[2:3] op_sel:[0,1] op_sel_hi:[1,1]
v_pk_mul_f32 v[210:211], v[210:211], v[2:3] op_sel:[0,1] op_sel_hi:[1,1]
v_pk_mul_f32 v[192:193], v[192:193], v[2:3] op_sel_hi:[1,0]
v_cvt_pk_bf16_f32 v108, v190, v206
v_cvt_pk_bf16_f32 v109, v207, v208
v_cvt_pk_bf16_f32 v110, v209, v210
v_cvt_pk_bf16_f32 v111, v191, v192
v_pk_mul_f32 v[194:195], v[194:195], v[2:3] op_sel_hi:[1,0]
v_pk_mul_f32 v[212:213], v[212:213], v[2:3] op_sel:[0,1] op_sel_hi:[1,1]
v_pk_mul_f32 v[214:215], v[214:215], v[2:3] op_sel:[0,1] op_sel_hi:[1,1]
v_cvt_pk_bf16_f32 v112, v193, v194
v_cvt_pk_bf16_f32 v113, v195, v211
v_cvt_pk_bf16_f32 v114, v212, v213
v_cvt_pk_bf16_f32 v115, v214, v215
ds_write_b128 v20, v[104:107] offset:32
v_rcp_f32_e64 v5, v40
buffer_load_dword v170, v164, s[40:43], s98 offen sc1
v_mul_f32 v4, 0x3fb8aa3b, v40
v_cvt_pk_bf16_f32 v92, v5, v5
v_pk_fma_f32 v[236:237], v[62:63], v[40:41], v[236:237] op_sel:[0,1,0] op_sel_hi:[1,1,1]
v_pk_fma_f32 v[238:239], v[64:65], v[40:41], v[238:239] op_sel:[0,1,0] op_sel_hi:[1,1,1]
v_pk_fma_f32 v[240:241], v[66:67], v[40:41], v[240:241] op_sel:[0,1,0] op_sel_hi:[1,1,1]
v_pk_fma_f32 v[242:243], v[68:69], v[40:41], v[242:243] op_sel:[0,1,0] op_sel_hi:[1,1,1]
ds_write_b128 v20, v[108:111] offset:48
v_pk_fma_f32 v[244:245], v[70:71], v[40:41], v[244:245] op_sel:[0,1,0] op_sel_hi:[1,1,1]
v_pk_fma_f32 v[246:247], v[72:73], v[40:41], v[246:247] op_sel:[0,1,0] op_sel_hi:[1,1,1]
v_pk_fma_f32 v[248:249], v[74:75], v[40:41], v[248:249] op_sel:[0,1,0] op_sel_hi:[1,1,1]
v_pk_fma_f32 v[250:251], v[76:77], v[40:41], v[250:251] op_sel:[0,1,0] op_sel_hi:[1,1,1]
v_pk_fma_f32 v[252:253], v[78:79], v[40:41], v[252:253] op_sel:[0,1,0] op_sel_hi:[1,1,1]
v_pk_fma_f32 v[254:255], v[80:81], v[40:41], v[254:255] op_sel:[0,1,0] op_sel_hi:[1,1,1]
v_cvt_pk_bf16_f32 v82, v236, v237
v_cvt_pk_bf16_f32 v83, v238, v239
v_cvt_pk_bf16_f32 v84, v240, v241
v_cvt_pk_bf16_f32 v85, v242, v243
ds_write_b128 v20, v[112:115] offset:64
v_cvt_pk_bf16_f32 v86, v244, v245
v_cvt_pk_bf16_f32 v87, v246, v247
v_cvt_pk_bf16_f32 v88, v248, v249
v_cvt_pk_bf16_f32 v89, v250, v251
v_cvt_pk_bf16_f32 v90, v252, v253
v_cvt_pk_bf16_f32 v91, v254, v255
v_max3_f32 v2, v216, v217, v218
v_min3_f32 v3, v216, v217, v218
v_max3_f32 v2, v2, v219, v220
v_min3_f32 v3, v3, v219, v220
v_max3_f32 v2, v2, v221, v222
v_min3_f32 v3, v3, v221, v222
buffer_load_dwordx4 a[196:199], v0, s[40:43], s90 offen offset:1024 sc1
v_max3_f32 v2, v2, v223, v224
v_min3_f32 v3, v3, v223, v224
v_max3_f32 v2, v2, v225, v226
v_min3_f32 v3, v3, v225, v226
ds_write_b128 v20, v[82:85] offset:8528
v_max3_f32 v2, v2, v227, v228
v_min3_f32 v3, v3, v227, v228
buffer_load_dwordx4 a[200:203], v0, s[40:43], s86 offen offset:2048 sc1
v_max3_f32 v2, v2, v229, v230
v_min3_f32 v3, v3, v229, v230
v_max3_f32 v2, v2, v231, v232
v_min3_f32 v3, v3, v231, v232
v_max3_f32 v2, v2, v233, v234
v_min3_f32 v3, v3, v233, v234
v_max_f32_e64 v2, v2, v235
buffer_load_dwordx4 a[204:207], v0, s[40:43], s87 offen offset:2048 sc1
v_min_f32_e64 v3, v3, v235
v_pk_mul_f32 v[2:3], v[2:3], v[4:5] op_sel_hi:[1,0] neg_lo:[0,1]
v_pk_fma_f32 v[236:237], v[216:217], v[4:5], v[2:3] op_sel:[0,0,1] op_sel_hi:[1,0,1] neg_lo:[0,1,0] neg_hi:[0,1,0]
ds_write_b128 v20, v[86:89] offset:8544
v_pk_fma_f32 v[238:239], v[218:219], v[4:5], v[2:3] op_sel:[0,0,1] op_sel_hi:[1,0,1] neg_lo:[0,1,0] neg_hi:[0,1,0]
v_pk_fma_f32 v[240:241], v[220:221], v[4:5], v[2:3] op_sel:[0,0,1] op_sel_hi:[1,0,1] neg_lo:[0,1,0] neg_hi:[0,1,0]
v_pk_fma_f32 v[242:243], v[222:223], v[4:5], v[2:3] op_sel:[0,0,1] op_sel_hi:[1,0,1] neg_lo:[0,1,0] neg_hi:[0,1,0]
buffer_load_dwordx4 a[208:211], v0, s[40:43], s88 offen offset:2048 sc1
v_pk_fma_f32 v[244:245], v[224:225], v[4:5], v[2:3] op_sel:[0,0,1] op_sel_hi:[1,0,1] neg_lo:[0,1,0] neg_hi:[0,1,0]
v_pk_fma_f32 v[246:247], v[226:227], v[4:5], v[2:3] op_sel:[0,0,1] op_sel_hi:[1,0,1] neg_lo:[0,1,0] neg_hi:[0,1,0]
v_pk_fma_f32 v[248:249], v[228:229], v[4:5], v[2:3] op_sel:[0,0,1] op_sel_hi:[1,0,1] neg_lo:[0,1,0] neg_hi:[0,1,0]
v_pk_fma_f32 v[250:251], v[230:231], v[4:5], v[2:3] op_sel:[0,0,1] op_sel_hi:[1,0,1] neg_lo:[0,1,0] neg_hi:[0,1,0]
v_pk_fma_f32 v[252:253], v[232:233], v[4:5], v[2:3] op_sel:[0,0,1] op_sel_hi:[1,0,1] neg_lo:[0,1,0] neg_hi:[0,1,0]
v_pk_fma_f32 v[254:255], v[234:235], v[4:5], v[2:3] op_sel:[0,0,1] op_sel_hi:[1,0,1] neg_lo:[0,1,0] neg_hi:[0,1,0]
v_pk_fma_f32 v[216:217], v[216:217], v[4:5], v[2:3] op_sel_hi:[1,0,0]
buffer_load_dwordx4 a[212:215], v0, s[40:43], s89 offen offset:2048 sc1
v_pk_fma_f32 v[218:219], v[218:219], v[4:5], v[2:3] op_sel_hi:[1,0,0]
v_pk_fma_f32 v[220:221], v[220:221], v[4:5], v[2:3] op_sel_hi:[1,0,0]
ds_write_b128 v20, v[90:93] offset:8560
v_pk_fma_f32 v[222:223], v[222:223], v[4:5], v[2:3] op_sel_hi:[1,0,0]
v_pk_fma_f32 v[224:225], v[224:225], v[4:5], v[2:3] op_sel_hi:[1,0,0]
v_pk_fma_f32 v[226:227], v[226:227], v[4:5], v[2:3] op_sel_hi:[1,0,0]
v_pk_fma_f32 v[228:229], v[228:229], v[4:5], v[2:3] op_sel_hi:[1,0,0]
buffer_load_dwordx4 a[216:219], v0, s[40:43], s90 offen offset:2048 sc1
v_pk_fma_f32 v[230:231], v[230:231], v[4:5], v[2:3] op_sel_hi:[1,0,0]
v_pk_fma_f32 v[232:233], v[232:233], v[4:5], v[2:3] op_sel_hi:[1,0,0]
v_pk_fma_f32 v[234:235], v[234:235], v[4:5], v[2:3] op_sel_hi:[1,0,0]
v_exp_f32 v216, v216
v_exp_f32 v217, v217
v_exp_f32 v218, v218
v_exp_f32 v219, v219
v_exp_f32 v220, v220
v_exp_f32 v221, v221
v_exp_f32 v222, v222
v_exp_f32 v223, v223
v_exp_f32_e64 v224, v224
buffer_load_dwordx4 a[220:223], v0, s[40:43], s86 offen offset:3072 sc1
v_exp_f32 v225, v225
v_exp_f32 v226, v226
v_exp_f32 v227, v227
v_exp_f32 v228, v228
v_exp_f32 v229, v229
v_exp_f32 v230, v230
v_exp_f32 v231, v231
v_exp_f32 v232, v232
v_exp_f32 v233, v233
v_exp_f32 v234, v234
v_exp_f32 v235, v235
v_exp_f32 v236, v236
buffer_load_dwordx4 a[224:227], v0, s[40:43], s87 offen offset:3072 sc1
v_exp_f32 v237, v237
v_exp_f32 v238, v238
v_exp_f32 v239, v239
v_exp_f32 v240, v240
v_exp_f32 v241, v241
v_exp_f32 v242, v242
v_exp_f32 v243, v243
v_exp_f32 v244, v244
v_exp_f32 v245, v245
v_exp_f32 v246, v246
v_exp_f32 v247, v247
v_exp_f32 v248, v248
buffer_load_dwordx4 a[228:231], v0, s[40:43], s88 offen offset:3072 sc1
v_exp_f32 v249, v249
v_exp_f32 v250, v250
v_exp_f32 v251, v251
v_exp_f32 v252, v252
v_exp_f32 v253, v253
v_exp_f32 v254, v254
v_exp_f32_e64 v255, v255
v_pk_add_f32 v[2:3], v[216:217], v[218:219]
v_pk_add_f32 v[4:5], v[236:237], v[238:239]
v_pk_add_f32 v[2:3], v[2:3], v[220:221]
v_pk_add_f32 v[4:5], v[4:5], v[240:241]
v_pk_add_f32 v[2:3], v[2:3], v[222:223]
v_pk_add_f32 v[4:5], v[4:5], v[242:243]
v_pk_add_f32 v[2:3], v[2:3], v[224:225]
buffer_load_dwordx4 a[232:235], v0, s[40:43], s89 offen offset:3072 sc1
v_pk_add_f32 v[4:5], v[4:5], v[244:245]
v_pk_add_f32 v[2:3], v[2:3], v[226:227]
v_pk_add_f32 v[4:5], v[4:5], v[246:247]
v_pk_add_f32 v[2:3], v[2:3], v[228:229]
v_pk_add_f32 v[4:5], v[4:5], v[248:249]
v_pk_add_f32 v[2:3], v[2:3], v[230:231]
v_pk_add_f32 v[4:5], v[4:5], v[250:251]
v_pk_add_f32 v[2:3], v[2:3], v[232:233]
v_pk_add_f32 v[4:5], v[4:5], v[252:253]
v_pk_add_f32 v[2:3], v[2:3], v[234:235]
buffer_load_dwordx4 a[236:239], v0, s[40:43], s90 offen offset:3072 sc1
v_pk_add_f32 v[4:5], v[4:5], v[254:255]
v_add_f32 v2, v2, v3
v_add_f32 v4, v4, v5
v_rcp_f32_e64 v2, v2
v_rcp_f32 v3, v4
s_nop 0
v_pk_mul_f32 v[2:3], v[2:3], v[40:41] op_sel_hi:[1,0]
v_pk_mul_f32 v[216:217], v[216:217], v[2:3] op_sel_hi:[1,0]
v_pk_mul_f32 v[218:219], v[218:219], v[2:3] op_sel_hi:[1,0]
v_pk_mul_f32 v[220:221], v[220:221], v[2:3] op_sel_hi:[1,0]
v_pk_mul_f32 v[236:237], v[236:237], v[2:3] op_sel:[0,1] op_sel_hi:[1,1]
v_pk_mul_f32 v[238:239], v[238:239], v[2:3] op_sel:[0,1] op_sel_hi:[1,1]
v_cvt_pk_bf16_f32 v176, v216, v217
v_cvt_pk_bf16_f32 v177, v218, v219
v_cvt_pk_bf16_f32 v178, v220, v236
v_cvt_pk_bf16_f32 v179, v237, v238
ds_write_b128 v20, v[176:179] offset:8448
v_pk_mul_f32 v[240:241], v[240:241], v[2:3] op_sel:[0,1] op_sel_hi:[1,1]
v_pk_mul_f32 v[222:223], v[222:223], v[2:3] op_sel_hi:[1,0]
v_pk_mul_f32 v[224:225], v[224:225], v[2:3] op_sel_hi:[1,0]
v_cvt_pk_bf16_f32 v180, v239, v240
v_cvt_pk_bf16_f32 v181, v221, v222
v_cvt_pk_bf16_f32 v182, v223, v224
v_cvt_pk_bf16_f32 v183, v225, v241
ds_write_b128 v20, v[180:183] offset:8464
v_pk_mul_f32 v[242:243], v[242:243], v[2:3] op_sel:[0,1] op_sel_hi:[1,1]
v_pk_mul_f32 v[244:245], v[244:245], v[2:3] op_sel:[0,1] op_sel_hi:[1,1]
v_pk_mul_f32 v[226:227], v[226:227], v[2:3] op_sel_hi:[1,0]
v_pk_mul_f32 v[228:229], v[228:229], v[2:3] op_sel_hi:[1,0]
v_cvt_pk_bf16_f32 v184, v242, v243
v_cvt_pk_bf16_f32 v185, v244, v245
v_cvt_pk_bf16_f32 v186, v226, v227
v_cvt_pk_bf16_f32 v187, v228, v229
ds_write_b128 v20, v[184:187] offset:8480
v_pk_mul_f32 v[230:231], v[230:231], v[2:3] op_sel_hi:[1,0]
v_pk_mul_f32 v[246:247], v[246:247], v[2:3] op_sel:[0,1] op_sel_hi:[1,1]
v_pk_mul_f32 v[248:249], v[248:249], v[2:3] op_sel:[0,1] op_sel_hi:[1,1]
v_pk_mul_f32 v[250:251], v[250:251], v[2:3] op_sel:[0,1] op_sel_hi:[1,1]
v_pk_mul_f32 v[232:233], v[232:233], v[2:3] op_sel_hi:[1,0]
v_cvt_pk_bf16_f32 v188, v230, v246
v_cvt_pk_bf16_f32 v189, v247, v248
v_cvt_pk_bf16_f32 v190, v249, v250
v_cvt_pk_bf16_f32 v191, v231, v232
ds_write_b128 v20, v[188:191] offset:8496
v_pk_mul_f32 v[234:235], v[234:235], v[2:3] op_sel_hi:[1,0]
v_pk_mul_f32 v[252:253], v[252:253], v[2:3] op_sel:[0,1] op_sel_hi:[1,1]
v_pk_mul_f32 v[254:255], v[254:255], v[2:3] op_sel:[0,1] op_sel_hi:[1,1]
v_cvt_pk_bf16_f32 v192, v233, v234
v_cvt_pk_bf16_f32 v193, v235, v251
v_cvt_pk_bf16_f32 v194, v252, v253
v_cvt_pk_bf16_f32 v195, v254, v255
ds_write_b128 v20, v[192:195] offset:8512
v_lshrrev_b32 v2, 4, v1
v_and_b32 v3, 15, v1
v_mul_u32_u24_e64 v4, 21, v2
v_add_lshl_u32 v82, v4, v3, 4
v_add_u32 v83, 256, v82
v_mov_b32 v5, 0x7f000000
v_cmp_gt_u32 vcc, 5, v3
s_nop 1
v_cndmask_b32 v83, v5, v83, vcc
v_cmp_gt_u32 vcc, 32, v1
s_nop 1
v_cndmask_b32 v84, v5, v82, vcc
v_cndmask_b32 v85, v5, v83, vcc
s_lshl_b32 s65, s59, 2
s_add_u32 s65, s65, s56
s_lshl_b32 s65, s65, 3
s_add_u32 s65, s65, s58
s_mul_i32 s66, s65, 3456
s_add_u32 s66, s66, 15728640
s_lshl_b32 s65, s65, 7
s_add_u32 s69, s65, 17215488
s_waitcnt lgkmcnt(0)
s_barrier
ds_read_b64_tr_b16 v[176:177], v94 offset:0
ds_read_b64_tr_b16 v[178:179], v94 offset:8448
ds_read_b64_tr_b16 v[180:181], v94 offset:32
ds_read_b64_tr_b16 v[182:183], v94 offset:8480
ds_read_b64_tr_b16 v[184:185], v94 offset:64
ds_read_b64_tr_b16 v[186:187], v94 offset:8512
ds_read_b64_tr_b16 v[188:189], v94 offset:80
ds_read_b64_tr_b16 v[190:191], v94 offset:8528
ds_read_b64_tr_b16 v[192:193], v94 offset:112
ds_read_b64_tr_b16 v[194:195], v94 offset:8560
ds_read_b64_tr_b16 v[196:197], v94 offset:16896
ds_read_b64_tr_b16 v[198:199], v94 offset:25344
ds_read_b64_tr_b16 v[200:201], v94 offset:16928
ds_read_b64_tr_b16 v[202:203], v94 offset:25376
ds_read_b64_tr_b16 v[204:205], v94 offset:16960
s_waitcnt lgkmcnt(5)
v_mfma_f32_16x16x32_bf16 v[140:143], v[176:179], v[188:191], v[140:143]
ds_read_b64_tr_b16 v[206:207], v94 offset:25408
ds_read_b64_tr_b16 v[208:209], v94 offset:16976
v_mfma_f32_16x16x32_bf16 v[144:147], v[176:179], v[192:195], v[144:147]
ds_read_b64_tr_b16 v[210:211], v94 offset:25424
ds_read_b64_tr_b16 v[212:213], v94 offset:17008
v_mfma_f32_16x16x32_bf16 v[148:151], v[180:183], v[188:191], v[148:151]
ds_read_b64_tr_b16 v[214:215], v94 offset:25456
ds_read_b64_tr_b16 v[216:217], v94 offset:33792
v_mfma_f32_16x16x32_bf16 v[152:155], v[180:183], v[192:195], v[152:155]
ds_read_b64_tr_b16 v[218:219], v94 offset:42240
ds_read_b64_tr_b16 v[220:221], v94 offset:33824
v_mfma_f32_16x16x32_bf16 v[156:159], v[184:187], v[188:191], v[156:159]
ds_read_b64_tr_b16 v[222:223], v94 offset:42272
ds_read_b64_tr_b16 v[224:225], v94 offset:33856
v_mfma_f32_16x16x32_bf16 v[160:163], v[184:187], v[192:195], v[160:163]
s_waitcnt lgkmcnt(5)
v_mfma_f32_16x16x32_bf16 v[140:143], v[196:199], v[208:211], v[140:143]
ds_read_b64_tr_b16 v[226:227], v94 offset:42304
ds_read_b64_tr_b16 v[228:229], v94 offset:33872
v_mfma_f32_16x16x32_bf16 v[144:147], v[196:199], v[212:215], v[144:147]
ds_read_b64_tr_b16 v[230:231], v94 offset:42320
ds_read_b64_tr_b16 v[232:233], v94 offset:33904
v_mfma_f32_16x16x32_bf16 v[148:151], v[200:203], v[208:211], v[148:151]
ds_read_b64_tr_b16 v[234:235], v94 offset:42352
ds_read_b64_tr_b16 v[236:237], v94 offset:50688
v_mfma_f32_16x16x32_bf16 v[152:155], v[200:203], v[212:215], v[152:155]
ds_read_b64_tr_b16 v[238:239], v94 offset:59136
ds_read_b64_tr_b16 v[240:241], v94 offset:50720
v_mfma_f32_16x16x32_bf16 v[156:159], v[204:207], v[208:211], v[156:159]
ds_read_b64_tr_b16 v[242:243], v94 offset:59168
ds_read_b64_tr_b16 v[244:245], v94 offset:50752
v_mfma_f32_16x16x32_bf16 v[160:163], v[204:207], v[212:215], v[160:163]
s_waitcnt lgkmcnt(5)
v_mfma_f32_16x16x32_bf16 v[140:143], v[216:219], v[228:231], v[140:143]
ds_read_b64_tr_b16 v[246:247], v94 offset:59200
v_mfma_f32_16x16x32_bf16 v[144:147], v[216:219], v[232:235], v[144:147]
ds_read_b64_tr_b16 v[248:249], v94 offset:50768
v_mfma_f32_16x16x32_bf16 v[148:151], v[220:223], v[228:231], v[148:151]
ds_read_b64_tr_b16 v[250:251], v94 offset:59216
v_mfma_f32_16x16x32_bf16 v[152:155], v[220:223], v[232:235], v[152:155]
ds_read_b64_tr_b16 v[252:253], v94 offset:50800
v_mfma_f32_16x16x32_bf16 v[156:159], v[224:227], v[228:231], v[156:159]
ds_read_b64_tr_b16 v[254:255], v94 offset:59248
v_mfma_f32_16x16x32_bf16 v[160:163], v[224:227], v[232:235], v[160:163]
s_waitcnt lgkmcnt(0)
v_mfma_f32_16x16x32_bf16 v[140:143], v[236:239], v[248:251], v[140:143]
v_mfma_f32_16x16x32_bf16 v[144:147], v[236:239], v[252:255], v[144:147]
v_mfma_f32_16x16x32_bf16 v[148:151], v[240:243], v[248:251], v[148:151]
v_mfma_f32_16x16x32_bf16 v[152:155], v[240:243], v[252:255], v[152:155]
v_mfma_f32_16x16x32_bf16 v[156:159], v[244:247], v[248:251], v[156:159]
v_mfma_f32_16x16x32_bf16 v[160:163], v[244:247], v[252:255], v[160:163]
s_nop 2
buffer_store_dwordx4 v[140:143], v82, s[40:43], s66 offen offset:0 sc1
buffer_store_dwordx4 v[144:147], v83, s[40:43], s66 offen offset:0 sc1
buffer_store_dwordx4 v[148:151], v82, s[40:43], s66 offen offset:1344 sc1
buffer_store_dwordx4 v[152:155], v83, s[40:43], s66 offen offset:1344 sc1
buffer_store_dwordx4 v[156:159], v84, s[40:43], s66 offen offset:2688 sc1
buffer_store_dwordx4 v[160:163], v85, s[40:43], s66 offen offset:2688 sc1
s_barrier
s_waitcnt vmcnt(17)
v_cmp_eq_u32_e64 vcc, 0, v170
s_cbranch_vccz Lok4
s_mov_b32 s85, 40000
Lsp4:
buffer_load_dword v170, v164, s[40:43], s98 offen sc1
s_waitcnt vmcnt(0)
v_cmp_eq_u32 vcc, 0, v170
s_cbranch_vccz Lok4
s_sub_u32 s85, s85, 1
s_cmp_lg_u32 s85, 0
s_cbranch_scc1 Lsp4
Lok4:
buffer_load_dwordx4 v[96:99], v6, s[40:43], s91 offen offset:0 sc1
buffer_load_dwordx4 v[100:103], v6, s[40:43], s92 offen offset:0 sc1
buffer_load_dwordx4 v[104:107], v6, s[40:43], s93 offen offset:0 sc1
buffer_load_dwordx4 v[108:111], v6, s[40:43], s94 offen offset:0 sc1
buffer_load_dwordx4 v[112:115], v6, s[40:43], s91 offen offset:1024 sc1
buffer_load_dwordx4 v[116:119], v6, s[40:43], s92 offen offset:1024 sc1
buffer_load_dwordx4 v[120:123], v6, s[40:43], s93 offen offset:1024 sc1
buffer_load_dwordx4 v[124:127], v6, s[40:43], s94 offen offset:1024 sc1
buffer_load_dwordx4 v[128:131], v6, s[40:43], s91 offen offset:2048 sc1
buffer_load_dwordx4 v[132:135], v6, s[40:43], s92 offen offset:2048 sc1
buffer_load_dwordx4 v[136:139], v6, s[40:43], s93 offen offset:2048 sc1
buffer_load_dwordx4 v[140:143], v6, s[40:43], s94 offen offset:2048 sc1
buffer_load_dwordx4 v[144:147], v6, s[40:43], s91 offen offset:3072 sc1
buffer_load_dwordx4 v[148:151], v6, s[40:43], s92 offen offset:3072 sc1
buffer_load_dwordx4 v[152:155], v6, s[40:43], s93 offen offset:3072 sc1
buffer_load_dwordx4 v[156:159], v6, s[40:43], s94 offen offset:3072 sc1
buffer_load_dwordx4 v[160:163], v21, s[40:43], s91 offen offset:0 sc1
buffer_load_dwordx4 v[164:167], v21, s[40:43], s92 offen offset:0 sc1
buffer_load_dwordx4 v[168:171], v21, s[40:43], s93 offen offset:0 sc1
buffer_load_dwordx4 v[172:175], v21, s[40:43], s94 offen offset:0 sc1
s_waitcnt vmcnt(16)
v_mfma_f32_16x16x32_bf16 v[176:179], a[112:115], v[96:99], 0
v_mfma_f32_16x16x32_bf16 v[180:183], a[116:119], v[96:99], 0
v_mfma_f32_16x16x32_bf16 v[184:187], a[120:123], v[96:99], 0
s_add_u32 s64, s88, s3
s_add_u32 m0, s12, 89088
v_mfma_f32_16x16x32_bf16 v[188:191], a[124:127], v[96:99], 0
buffer_load_dwordx4 v6, s[40:43], s64 offen offset:1024 sc1 lds
v_mfma_f32_16x16x32_bf16 v[192:195], a[128:131], v[96:99], 0
buffer_load_dwordx4 v[96:99], v21, s[40:43], s91 offen offset:1024 sc1
v_mfma_f32_16x16x32_bf16 v[212:215], a[128:131], v[100:103], 0
v_mfma_f32_16x16x32_bf16 v[208:211], a[124:127], v[100:103], 0
v_mfma_f32_16x16x32_bf16 v[204:207], a[120:123], v[100:103], 0
s_add_u32 s64, s89, s3
s_add_u32 m0, s12, 93184
v_mfma_f32_16x16x32_bf16 v[200:203], a[116:119], v[100:103], 0
buffer_load_dwordx4 v6, s[40:43], s64 offen offset:1024 sc1 lds
v_mfma_f32_16x16x32_bf16 v[196:199], a[112:115], v[100:103], 0
buffer_load_dwordx4 v[100:103], v21, s[40:43], s92 offen offset:1024 sc1
v_mfma_f32_16x16x32_bf16 v[216:219], a[112:115], v[104:107], 0
v_mfma_f32_16x16x32_bf16 v[220:223], a[116:119], v[104:107], 0
s_add_u32 s64, s90, s3
s_add_u32 m0, s12, 97280
v_mfma_f32_16x16x32_bf16 v[224:227], a[120:123], v[104:107], 0
buffer_load_dwordx4 v6, s[40:43], s64 offen offset:1024 sc1 lds
v_mfma_f32_16x16x32_bf16 v[228:231], a[124:127], v[104:107], 0
v_mfma_f32_16x16x32_bf16 v[232:235], a[128:131], v[104:107], 0
buffer_load_dwordx4 v[104:107], v21, s[40:43], s93 offen offset:1024 sc1
v_mfma_f32_16x16x32_bf16 v[252:255], a[128:131], v[108:111], 0
v_mfma_f32_16x16x32_bf16 v[248:251], a[124:127], v[108:111], 0
s_add_u32 s64, s86, s3
s_add_u32 m0, s12, 100352
v_mfma_f32_16x16x32_bf16 v[244:247], a[120:123], v[108:111], 0
buffer_load_dwordx4 v6, s[40:43], s64 offen offset:2048 sc1 lds
v_mfma_f32_16x16x32_bf16 v[240:243], a[116:119], v[108:111], 0
v_mfma_f32_16x16x32_bf16 v[236:239], a[112:115], v[108:111], 0
buffer_load_dwordx4 v[108:111], v21, s[40:43], s94 offen offset:1024 sc1
s_waitcnt vmcnt(20)
v_mfma_f32_16x16x32_bf16 v[176:179], a[132:135], v[112:115], v[176:179]
v_mfma_f32_16x16x32_bf16 v[180:183], a[136:139], v[112:115], v[180:183]
v_mfma_f32_16x16x32_bf16 v[184:187], a[140:143], v[112:115], v[184:187]
s_add_u32 s64, s87, s3
s_add_u32 m0, s12, 104448
v_mfma_f32_16x16x32_bf16 v[188:191], a[144:147], v[112:115], v[188:191]
buffer_load_dwordx4 v6, s[40:43], s64 offen offset:2048 sc1 lds
v_mfma_f32_16x16x32_bf16 v[192:195], a[148:151], v[112:115], v[192:195]
buffer_load_dwordx4 v[112:115], v21, s[40:43], s91 offen offset:2048 sc1
v_mfma_f32_16x16x32_bf16 v[212:215], a[148:151], v[116:119], v[212:215]
v_mfma_f32_16x16x32_bf16 v[208:211], a[144:147], v[116:119], v[208:211]
v_mfma_f32_16x16x32_bf16 v[204:207], a[140:143], v[116:119], v[204:207]
s_add_u32 s64, s88, s3
s_add_u32 m0, s12, 108544
v_mfma_f32_16x16x32_bf16 v[200:203], a[136:139], v[116:119], v[200:203]
buffer_load_dwordx4 v6, s[40:43], s64 offen offset:2048 sc1 lds
v_mfma_f32_16x16x32_bf16 v[196:199], a[132:135], v[116:119], v[196:199]
buffer_load_dwordx4 v[116:119], v21, s[40:43], s92 offen offset:2048 sc1
v_mfma_f32_16x16x32_bf16 v[216:219], a[132:135], v[120:123], v[216:219]
v_mfma_f32_16x16x32_bf16 v[220:223], a[136:139], v[120:123], v[220:223]
s_add_u32 s64, s89, s3
s_add_u32 m0, s12, 112640
v_mfma_f32_16x16x32_bf16 v[224:227], a[140:143], v[120:123], v[224:227]
buffer_load_dwordx4 v6, s[40:43], s64 offen offset:2048 sc1 lds
v_mfma_f32_16x16x32_bf16 v[228:231], a[144:147], v[120:123], v[228:231]
v_mfma_f32_16x16x32_bf16 v[232:235], a[148:151], v[120:123], v[232:235]
buffer_load_dwordx4 v[120:123], v21, s[40:43], s93 offen offset:2048 sc1
v_mfma_f32_16x16x32_bf16 v[252:255], a[148:151], v[124:127], v[252:255]
v_mfma_f32_16x16x32_bf16 v[248:251], a[144:147], v[124:127], v[248:251]
s_add_u32 s64, s90, s3
s_add_u32 m0, s12, 116736
v_mfma_f32_16x16x32_bf16 v[244:247], a[140:143], v[124:127], v[244:247]
buffer_load_dwordx4 v6, s[40:43], s64 offen offset:2048 sc1 lds
v_mfma_f32_16x16x32_bf16 v[240:243], a[136:139], v[124:127], v[240:243]
v_mfma_f32_16x16x32_bf16 v[236:239], a[132:135], v[124:127], v[236:239]
buffer_load_dwordx4 v[124:127], v21, s[40:43], s94 offen offset:2048 sc1
s_waitcnt vmcnt(24)
v_mfma_f32_16x16x32_bf16 v[176:179], a[152:155], v[128:131], v[176:179]
v_mfma_f32_16x16x32_bf16 v[180:183], a[156:159], v[128:131], v[180:183]
v_mfma_f32_16x16x32_bf16 v[184:187], a[160:163], v[128:131], v[184:187]
s_add_u32 s64, s86, s3
s_add_u32 m0, s12, 119808
v_mfma_f32_16x16x32_bf16 v[188:191], a[164:167], v[128:131], v[188:191]
buffer_load_dwordx4 v6, s[40:43], s64 offen offset:3072 sc1 lds
v_mfma_f32_16x16x32_bf16 v[192:195], a[168:171], v[128:131], v[192:195]
buffer_load_dwordx4 v[128:131], v21, s[40:43], s91 offen offset:3072 sc1
v_mfma_f32_16x16x32_bf16 v[212:215], a[168:171], v[132:135], v[212:215]
v_mfma_f32_16x16x32_bf16 v[208:211], a[164:167], v[132:135], v[208:211]
v_mfma_f32_16x16x32_bf16 v[204:207], a[160:163], v[132:135], v[204:207]
s_add_u32 s64, s87, s3
s_add_u32 m0, s12, 123904
v_mfma_f32_16x16x32_bf16 v[200:203], a[156:159], v[132:135], v[200:203]
buffer_load_dwordx4 v6, s[40:43], s64 offen offset:3072 sc1 lds
v_mfma_f32_16x16x32_bf16 v[196:199], a[152:155], v[132:135], v[196:199]
buffer_load_dwordx4 v[132:135], v21, s[40:43], s92 offen offset:3072 sc1
v_mfma_f32_16x16x32_bf16 v[216:219], a[152:155], v[136:139], v[216:219]
v_mfma_f32_16x16x32_bf16 v[220:223], a[156:159], v[136:139], v[220:223]
s_add_u32 s64, s88, s3
s_add_u32 m0, s12, 128000
v_mfma_f32_16x16x32_bf16 v[224:227], a[160:163], v[136:139], v[224:227]
buffer_load_dwordx4 v6, s[40:43], s64 offen offset:3072 sc1 lds
v_mfma_f32_16x16x32_bf16 v[228:231], a[164:167], v[136:139], v[228:231]
v_mfma_f32_16x16x32_bf16 v[232:235], a[168:171], v[136:139], v[232:235]
buffer_load_dwordx4 v[136:139], v21, s[40:43], s93 offen offset:3072 sc1
v_mfma_f32_16x16x32_bf16 v[252:255], a[168:171], v[140:143], v[252:255]
v_mfma_f32_16x16x32_bf16 v[248:251], a[164:167], v[140:143], v[248:251]
s_add_u32 s64, s89, s3
s_add_u32 m0, s12, 132096
v_mfma_f32_16x16x32_bf16 v[244:247], a[160:163], v[140:143], v[244:247]
buffer_load_dwordx4 v6, s[40:43], s64 offen offset:3072 sc1 lds
v_mfma_f32_16x16x32_bf16 v[240:243], a[156:159], v[140:143], v[240:243]
v_mfma_f32_16x16x32_bf16 v[236:239], a[152:155], v[140:143], v[236:239]
buffer_load_dwordx4 v[140:143], v21, s[40:43], s94 offen offset:3072 sc1
s_waitcnt vmcnt(28)
v_mfma_f32_16x16x32_bf16 v[176:179], a[172:175], v[144:147], v[176:179]
v_mfma_f32_16x16x32_bf16 v[180:183], a[176:179], v[144:147], v[180:183]
v_mfma_f32_16x16x32_bf16 v[184:187], a[180:183], v[144:147], v[184:187]
s_add_u32 s64, s90, s3
s_add_u32 m0, s12, 136192
v_mfma_f32_16x16x32_bf16 v[188:191], a[184:187], v[144:147], v[188:191]
buffer_load_dwordx4 v6, s[40:43], s64 offen offset:3072 sc1 lds
v_mfma_f32_16x16x32_bf16 v[192:195], a[188:191], v[144:147], v[192:195]
buffer_load_dwordx4 v[144:147], v0, s[40:43], s91 offen offset:0 sc1
v_mfma_f32_16x16x32_bf16 v[212:215], a[188:191], v[148:151], v[212:215]
v_mfma_f32_16x16x32_bf16 v[208:211], a[184:187], v[148:151], v[208:211]
v_mfma_f32_16x16x32_bf16 v[204:207], a[180:183], v[148:151], v[204:207]
s_add_u32 s64, s86, s3
s_add_u32 m0, s12, 143360
v_mfma_f32_16x16x32_bf16 v[200:203], a[176:179], v[148:151], v[200:203]
buffer_load_dwordx4 v21, s[40:43], s64 offen offset:0 sc1 lds
v_mfma_f32_16x16x32_bf16 v[196:199], a[172:175], v[148:151], v[196:199]
buffer_load_dwordx4 v[148:151], v0, s[40:43], s92 offen offset:0 sc1
v_mfma_f32_16x16x32_bf16 v[216:219], a[172:175], v[152:155], v[216:219]
v_mfma_f32_16x16x32_bf16 v[220:223], a[176:179], v[152:155], v[220:223]
s_add_u32 s64, s87, s3
s_add_u32 m0, s12, 147456
v_mfma_f32_16x16x32_bf16 v[224:227], a[180:183], v[152:155], v[224:227]
buffer_load_dwordx4 v21, s[40:43], s64 offen offset:0 sc1 lds
v_mfma_f32_16x16x32_bf16 v[228:231], a[184:187], v[152:155], v[228:231]
v_mfma_f32_16x16x32_bf16 v[232:235], a[188:191], v[152:155], v[232:235]
buffer_load_dwordx4 v[152:155], v0, s[40:43], s93 offen offset:0 sc1
v_mfma_f32_16x16x32_bf16 v[252:255], a[188:191], v[156:159], v[252:255]
v_mfma_f32_16x16x32_bf16 v[248:251], a[184:187], v[156:159], v[248:251]
s_add_u32 s64, s88, s3
s_add_u32 m0, s12, 151552
v_mfma_f32_16x16x32_bf16 v[244:247], a[180:183], v[156:159], v[244:247]
buffer_load_dwordx4 v21, s[40:43], s64 offen offset:0 sc1 lds
v_mfma_f32_16x16x32_bf16 v[240:243], a[176:179], v[156:159], v[240:243]
v_mfma_f32_16x16x32_bf16 v[236:239], a[172:175], v[156:159], v[236:239]
buffer_load_dwordx4 v[156:159], v0, s[40:43], s94 offen offset:0 sc1
s_waitcnt vmcnt(32)
v_mfma_f32_16x16x32_bf16 v[176:179], a[192:195], v[160:163], v[176:179]
v_mfma_f32_16x16x32_bf16 v[180:183], a[0:3], v[160:163], v[180:183]
v_mfma_f32_16x16x32_bf16 v[184:187], a[4:7], v[160:163], v[184:187]
s_add_u32 s64, s89, s3
s_add_u32 m0, s12, 155648
v_mfma_f32_16x16x32_bf16 v[188:191], a[8:11], v[160:163], v[188:191]
buffer_load_dwordx4 v21, s[40:43], s64 offen offset:0 sc1 lds
v_mfma_f32_16x16x32_bf16 v[192:195], a[12:15], v[160:163], v[192:195]
buffer_load_dwordx4 v[160:163], v0, s[40:43], s91 offen offset:1024 sc1
v_mfma_f32_16x16x32_bf16 v[212:215], a[12:15], v[164:167], v[212:215]
v_mfma_f32_16x16x32_bf16 v[208:211], a[8:11], v[164:167], v[208:211]
v_mfma_f32_16x16x32_bf16 v[204:207], a[4:7], v[164:167], v[204:207]
s_add_u32 s64, s86, s3
s_add_u32 m0, s12, 61440
v_mfma_f32_16x16x32_bf16 v[200:203], a[0:3], v[164:167], v[200:203]
buffer_load_dwordx4 v6, s[40:43], s64 offen offset:0 sc1 lds
v_mfma_f32_16x16x32_bf16 v[196:199], a[192:195], v[164:167], v[196:199]
buffer_load_dwordx4 v[164:167], v0, s[40:43], s92 offen offset:1024 sc1
v_mfma_f32_16x16x32_bf16 v[216:219], a[192:195], v[168:171], v[216:219]
v_mfma_f32_16x16x32_bf16 v[220:223], a[0:3], v[168:171], v[220:223]
s_add_u32 s64, s87, s3
s_add_u32 m0, s12, 65536
v_mfma_f32_16x16x32_bf16 v[224:227], a[4:7], v[168:171], v[224:227]
buffer_load_dwordx4 v6, s[40:43], s64 offen offset:0 sc1 lds
v_mfma_f32_16x16x32_bf16 v[228:231], a[8:11], v[168:171], v[228:231]
v_mfma_f32_16x16x32_bf16 v[232:235], a[12:15], v[168:171], v[232:235]
buffer_load_dwordx4 v[168:171], v0, s[40:43], s93 offen offset:1024 sc1
v_mfma_f32_16x16x32_bf16 v[252:255], a[12:15], v[172:175], v[252:255]
v_mfma_f32_16x16x32_bf16 v[248:251], a[8:11], v[172:175], v[248:251]
s_add_u32 s64, s90, s3
s_add_u32 m0, s12, 159744
v_mfma_f32_16x16x32_bf16 v[244:247], a[4:7], v[172:175], v[244:247]
buffer_load_dwordx4 v21, s[40:43], s64 offen offset:0 sc1 lds
v_mfma_f32_16x16x32_bf16 v[240:243], a[0:3], v[172:175], v[240:243]
v_mfma_f32_16x16x32_bf16 v[236:239], a[192:195], v[172:175], v[236:239]
buffer_load_dwordx4 v[172:175], v0, s[40:43], s94 offen offset:1024 sc1
s_waitcnt vmcnt(32)
v_mfma_f32_16x16x32_bf16 v[176:179], a[16:19], v[96:99], v[176:179]
v_mfma_f32_16x16x32_bf16 v[180:183], a[20:23], v[96:99], v[180:183]
v_mfma_f32_16x16x32_bf16 v[184:187], a[24:27], v[96:99], v[184:187]
v_mfma_f32_16x16x32_bf16 v[188:191], a[28:31], v[96:99], v[188:191]
v_mfma_f32_16x16x32_bf16 v[192:195], a[32:35], v[96:99], v[192:195]
buffer_load_dwordx4 v[96:99], v0, s[40:43], s91 offen offset:2048 sc1
v_mfma_f32_16x16x32_bf16 v[212:215], a[32:35], v[100:103], v[212:215]
v_mfma_f32_16x16x32_bf16 v[208:211], a[28:31], v[100:103], v[208:211]
v_mfma_f32_16x16x32_bf16 v[204:207], a[24:27], v[100:103], v[204:207]
v_mfma_f32_16x16x32_bf16 v[200:203], a[20:23], v[100:103], v[200:203]
v_mfma_f32_16x16x32_bf16 v[196:199], a[16:19], v[100:103], v[196:199]
buffer_load_dwordx4 v[100:103], v0, s[40:43], s92 offen offset:2048 sc1
v_mfma_f32_16x16x32_bf16 v[216:219], a[16:19], v[104:107], v[216:219]
v_mfma_f32_16x16x32_bf16 v[220:223], a[20:23], v[104:107], v[220:223]
v_mfma_f32_16x16x32_bf16 v[224:227], a[24:27], v[104:107], v[224:227]
v_mfma_f32_16x16x32_bf16 v[228:231], a[28:31], v[104:107], v[228:231]
v_mfma_f32_16x16x32_bf16 v[232:235], a[32:35], v[104:107], v[232:235]
buffer_load_dwordx4 v[104:107], v0, s[40:43], s93 offen offset:2048 sc1
v_mfma_f32_16x16x32_bf16 v[252:255], a[32:35], v[108:111], v[252:255]
v_mfma_f32_16x16x32_bf16 v[248:251], a[28:31], v[108:111], v[248:251]
v_mfma_f32_16x16x32_bf16 v[244:247], a[24:27], v[108:111], v[244:247]
v_mfma_f32_16x16x32_bf16 v[240:243], a[20:23], v[108:111], v[240:243]
v_mfma_f32_16x16x32_bf16 v[236:239], a[16:19], v[108:111], v[236:239]
buffer_load_dwordx4 v[108:111], v0, s[40:43], s94 offen offset:2048 sc1
s_waitcnt vmcnt(28)
v_mfma_f32_16x16x32_bf16 v[176:179], a[36:39], v[112:115], v[176:179]
v_mfma_f32_16x16x32_bf16 v[180:183], a[40:43], v[112:115], v[180:183]
v_mfma_f32_16x16x32_bf16 v[184:187], a[44:47], v[112:115], v[184:187]
v_mfma_f32_16x16x32_bf16 v[188:191], a[48:51], v[112:115], v[188:191]
v_mfma_f32_16x16x32_bf16 v[192:195], a[52:55], v[112:115], v[192:195]
buffer_load_dwordx4 v[112:115], v0, s[40:43], s91 offen offset:3072 sc1
v_mfma_f32_16x16x32_bf16 v[212:215], a[52:55], v[116:119], v[212:215]
v_mfma_f32_16x16x32_bf16 v[208:211], a[48:51], v[116:119], v[208:211]
v_mfma_f32_16x16x32_bf16 v[204:207], a[44:47], v[116:119], v[204:207]
v_mfma_f32_16x16x32_bf16 v[200:203], a[40:43], v[116:119], v[200:203]
v_mfma_f32_16x16x32_bf16 v[196:199], a[36:39], v[116:119], v[196:199]
buffer_load_dwordx4 v[116:119], v0, s[40:43], s92 offen offset:3072 sc1
v_mfma_f32_16x16x32_bf16 v[216:219], a[36:39], v[120:123], v[216:219]
v_mfma_f32_16x16x32_bf16 v[220:223], a[40:43], v[120:123], v[220:223]
v_mfma_f32_16x16x32_bf16 v[224:227], a[44:47], v[120:123], v[224:227]
v_mfma_f32_16x16x32_bf16 v[228:231], a[48:51], v[120:123], v[228:231]
v_mfma_f32_16x16x32_bf16 v[232:235], a[52:55], v[120:123], v[232:235]
buffer_load_dwordx4 v[120:123], v0, s[40:43], s93 offen offset:3072 sc1
v_mfma_f32_16x16x32_bf16 v[252:255], a[52:55], v[124:127], v[252:255]
v_mfma_f32_16x16x32_bf16 v[248:251], a[48:51], v[124:127], v[248:251]
v_mfma_f32_16x16x32_bf16 v[244:247], a[44:47], v[124:127], v[244:247]
v_mfma_f32_16x16x32_bf16 v[240:243], a[40:43], v[124:127], v[240:243]
v_mfma_f32_16x16x32_bf16 v[236:239], a[36:39], v[124:127], v[236:239]
buffer_load_dwordx4 v[124:127], v0, s[40:43], s94 offen offset:3072 sc1
s_waitcnt vmcnt(24)
v_mfma_f32_16x16x32_bf16 v[176:179], a[56:59], v[128:131], v[176:179]
s_add_u32 s64, s56, 1
s_and_b32 s64, s64, 3
s_mul_i32 s64, s64, 15360
v_add_u32_e64 v48, s64, v6
v_mfma_f32_16x16x32_bf16 v[180:183], a[60:63], v[128:131], v[180:183]
s_add_u32 s64, s56, 2
s_and_b32 s64, s64, 3
s_mul_i32 s64, s64, 15360
v_add_u32_e64 v49, s64, v6
v_mfma_f32_16x16x32_bf16 v[184:187], a[64:67], v[128:131], v[184:187]
s_add_u32 s64, s56, 3
s_and_b32 s64, s64, 3
s_mul_i32 s64, s64, 15360
v_add_u32_e64 v50, s64, v6
v_mfma_f32_16x16x32_bf16 v[188:191], a[68:71], v[128:131], v[188:191]
s_mul_i32 s65, s56, 15360
v_add_u32 v51, s65, v6
v_and_b32 v2, 15, v1
v_mul_u32_u24 v2, 336, v2
v_and_b32_e64 v3, 48, v1
v_mfma_f32_16x16x32_bf16 v[192:195], a[72:75], v[128:131], v[192:195]
v_add3_u32 v52, v2, v3, s65
v_add_u32 v20, 61440, v6
v_add_u32 v94, 0x10000, v20
v_mfma_f32_16x16x32_bf16 v[212:215], a[72:75], v[132:135], v[212:215]
v_add_u32_e64 v2, 0, v1
v_mul_u32_u24 v3, 6554, v2
v_lshrrev_b32 v3, 16, v3
v_mul_u32_u24 v18, 10, v3
v_sub_u32_e64 v2, v2, v18
v_mfma_f32_16x16x32_bf16 v[208:211], a[68:71], v[132:135], v[208:211]
v_mul_u32_u24 v18, 1280, v3
v_lshl_add_u32 v53, v2, 4, v18
v_mul_u32_u24 v3, 336, v3
v_lshrrev_b32_e64 v18, 1, v2
v_mfma_f32_16x16x32_bf16 v[204:207], a[64:67], v[132:135], v[204:207]
v_lshl_add_u32 v3, v18, 6, v3
v_and_b32_e64 v2, 1, v2
v_lshl_add_u32 v3, v2, 3, v3
v_add_u32_e64 v68, s65, v3
v_mfma_f32_16x16x32_bf16 v[200:203], a[60:63], v[132:135], v[200:203]
v_add_u32_e64 v2, 64, v1
v_mul_u32_u24 v3, 6554, v2
v_lshrrev_b32 v3, 16, v3
v_mul_u32_u24 v18, 10, v3
v_sub_u32_e64 v2, v2, v18
v_mfma_f32_16x16x32_bf16 v[196:199], a[56:59], v[132:135], v[196:199]
v_mul_u32_u24 v18, 1280, v3
v_lshl_add_u32 v54, v2, 4, v18
v_mul_u32_u24 v3, 336, v3
v_lshrrev_b32_e64 v18, 1, v2
v_mfma_f32_16x16x32_bf16 v[216:219], a[56:59], v[136:139], v[216:219]
v_lshl_add_u32 v3, v18, 6, v3
v_and_b32_e64 v2, 1, v2
v_lshl_add_u32 v3, v2, 3, v3
v_add_u32_e64 v69, s65, v3
v_mfma_f32_16x16x32_bf16 v[220:223], a[60:63], v[136:139], v[220:223]
v_add_u32 v2, 128, v1
v_mul_u32_u24 v3, 6554, v2
v_lshrrev_b32 v3, 16, v3
v_mul_u32_u24 v18, 10, v3
v_sub_u32_e64 v2, v2, v18
v_mfma_f32_16x16x32_bf16 v[224:227], a[64:67], v[136:139], v[224:227]
v_mul_u32_u24 v18, 1280, v3
v_lshl_add_u32 v55, v2, 4, v18
v_mul_u32_u24 v3, 336, v3
v_lshrrev_b32_e64 v18, 1, v2
v_mfma_f32_16x16x32_bf16 v[228:231], a[68:71], v[136:139], v[228:231]
v_lshl_add_u32 v3, v18, 6, v3
v_and_b32_e64 v2, 1, v2
v_lshl_add_u32 v3, v2, 3, v3
v_add_u32_e64 v70, s65, v3
v_mfma_f32_16x16x32_bf16 v[232:235], a[72:75], v[136:139], v[232:235]
v_mfma_f32_16x16x32_bf16 v[252:255], a[72:75], v[140:143], v[252:255]
v_mov_b32 v3, 0x7f000000
v_cmp_gt_u32 vcc, 32, v1
s_lshl_b32 s76, s95, 2
s_add_u32 s76, s76, s56
v_cndmask_b32 v55, v3, v55, vcc
v_mfma_f32_16x16x32_bf16 v[248:251], a[68:71], v[140:143], v[248:251]
s_mul_i32 s76, s76, 20480
s_mul_i32 s77, s96, 160
s_add_u32 s76, s76, s77
v_and_b32 v93, 31, v1
v_lshlrev_b32_e64 v93, 7, v93
v_mfma_f32_16x16x32_bf16 v[244:247], a[64:67], v[140:143], v[244:247]
s_lshl_b32 s64, s95, 2
s_add_u32 s64, s64, s56
s_mul_i32 s64, s64, 171
s_lshr_b32 s64, s64, 10
s_lshl_b32 s64, s64, 12
v_mfma_f32_16x16x32_bf16 v[240:243], a[60:63], v[140:143], v[240:243]
s_add_u32 s79, s64, 17248256
s_mov_b32 s28, s4
s_mov_b32 s29, s5
s_mov_b32 s30, 2621440
s_mov_b32 s31, 0x20000
v_mfma_f32_16x16x32_bf16 v[236:239], a[56:59], v[140:143], v[236:239]
s_mov_b32 s44, s20
s_mov_b32 s45, s21
s_mov_b32 s46, 2621440
s_mov_b32 s47, 0x20000
s_waitcnt vmcnt(16)
v_mfma_f32_16x16x32_bf16 v[176:179], a[76:79], v[144:147], v[176:179]
v_mfma_f32_16x16x32_bf16 v[180:183], a[80:83], v[144:147], v[180:183]
buffer_load_dwordx4 v[56:59], v53, s[28:31], s76 offen
v_mfma_f32_16x16x32_bf16 v[184:187], a[84:87], v[144:147], v[184:187]
v_mfma_f32_16x16x32_bf16 v[188:191], a[88:91], v[144:147], v[188:191]
v_mfma_f32_16x16x32_bf16 v[192:195], a[92:95], v[144:147], v[192:195]
buffer_load_dwordx4 v[60:63], v54, s[28:31], s76 offen
v_mfma_f32_16x16x32_bf16 v[212:215], a[92:95], v[148:151], v[212:215]
v_mfma_f32_16x16x32_bf16 v[208:211], a[88:91], v[148:151], v[208:211]
v_mfma_f32_16x16x32_bf16 v[204:207], a[84:87], v[148:151], v[204:207]
v_mfma_f32_16x16x32_bf16 v[200:203], a[80:83], v[148:151], v[200:203]
buffer_load_dwordx4 v[64:67], v55, s[28:31], s76 offen
v_mfma_f32_16x16x32_bf16 v[196:199], a[76:79], v[148:151], v[196:199]
v_mfma_f32_16x16x32_bf16 v[216:219], a[76:79], v[152:155], v[216:219]
v_mfma_f32_16x16x32_bf16 v[220:223], a[80:83], v[152:155], v[220:223]
v_mfma_f32_16x16x32_bf16 v[224:227], a[84:87], v[152:155], v[224:227]
v_mfma_f32_16x16x32_bf16 v[228:231], a[88:91], v[152:155], v[228:231]
v_mfma_f32_16x16x32_bf16 v[232:235], a[92:95], v[152:155], v[232:235]
v_mfma_f32_16x16x32_bf16 v[252:255], a[92:95], v[156:159], v[252:255]
v_mfma_f32_16x16x32_bf16 v[248:251], a[88:91], v[156:159], v[248:251]
v_mfma_f32_16x16x32_bf16 v[244:247], a[84:87], v[156:159], v[244:247]
v_mfma_f32_16x16x32_bf16 v[240:243], a[80:83], v[156:159], v[240:243]
v_mfma_f32_16x16x32_bf16 v[236:239], a[76:79], v[156:159], v[236:239]
s_waitcnt vmcnt(11)
v_mfma_f32_16x16x32_bf16 v[176:179], a[96:99], v[160:163], v[176:179]
v_mfma_f32_16x16x32_bf16 v[180:183], a[100:103], v[160:163], v[180:183]
v_mfma_f32_16x16x32_bf16 v[184:187], a[104:107], v[160:163], v[184:187]
v_mfma_f32_16x16x32_bf16 v[188:191], a[108:111], v[160:163], v[188:191]
v_mfma_f32_16x16x32_bf16 v[192:195], a[196:199], v[160:163], v[192:195]
v_mfma_f32_16x16x32_bf16 v[212:215], a[196:199], v[164:167], v[212:215]
v_mfma_f32_16x16x32_bf16 v[208:211], a[108:111], v[164:167], v[208:211]
v_mfma_f32_16x16x32_bf16 v[204:207], a[104:107], v[164:167], v[204:207]
v_mfma_f32_16x16x32_bf16 v[200:203], a[100:103], v[164:167], v[200:203]
v_mfma_f32_16x16x32_bf16 v[196:199], a[96:99], v[164:167], v[196:199]
v_mfma_f32_16x16x32_bf16 v[216:219], a[96:99], v[168:171], v[216:219]
v_mfma_f32_16x16x32_bf16 v[220:223], a[100:103], v[168:171], v[220:223]
v_mfma_f32_16x16x32_bf16 v[224:227], a[104:107], v[168:171], v[224:227]
v_mfma_f32_16x16x32_bf16 v[228:231], a[108:111], v[168:171], v[228:231]
v_mfma_f32_16x16x32_bf16 v[232:235], a[196:199], v[168:171], v[232:235]
v_mfma_f32_16x16x32_bf16 v[252:255], a[196:199], v[172:175], v[252:255]
v_mfma_f32_16x16x32_bf16 v[248:251], a[108:111], v[172:175], v[248:251]
v_mfma_f32_16x16x32_bf16 v[244:247], a[104:107], v[172:175], v[244:247]
v_mfma_f32_16x16x32_bf16 v[240:243], a[100:103], v[172:175], v[240:243]
v_mfma_f32_16x16x32_bf16 v[236:239], a[96:99], v[172:175], v[236:239]
s_waitcnt vmcnt(3)
s_barrier
v_mfma_f32_16x16x32_bf16 v[196:199], a[200:203], v[100:103], v[196:199]
v_mfma_f32_16x16x32_bf16 v[200:203], a[204:207], v[100:103], v[200:203]
v_mfma_f32_16x16x32_bf16 v[204:207], a[208:211], v[100:103], v[204:207]
v_mfma_f32_16x16x32_bf16 v[208:211], a[212:215], v[100:103], v[208:211]
v_mfma_f32_16x16x32_bf16 v[212:215], a[216:219], v[100:103], v[212:215]
v_mfma_f32_16x16x32_bf16 v[196:199], a[220:223], v[116:119], v[196:199]
v_mfma_f32_16x16x32_bf16 v[200:203], a[224:227], v[116:119], v[200:203]
v_mfma_f32_16x16x32_bf16 v[204:207], a[228:231], v[116:119], v[204:207]
v_mfma_f32_16x16x32_bf16 v[208:211], a[232:235], v[116:119], v[208:211]
v_mfma_f32_16x16x32_bf16 v[212:215], a[236:239], v[116:119], v[212:215]
buffer_load_dword v84, v93, s[40:43], s79 offen sc1
v_mfma_f32_16x16x32_bf16 v[216:219], a[200:203], v[104:107], v[216:219]
v_mfma_f32_16x16x32_bf16 v[220:223], a[204:207], v[104:107], v[220:223]
v_mfma_f32_16x16x32_bf16 v[224:227], a[208:211], v[104:107], v[224:227]
v_mfma_f32_16x16x32_bf16 v[228:231], a[212:215], v[104:107], v[228:231]
ds_write_b128 v48, v[196:199] offset:0
v_mfma_f32_16x16x32_bf16 v[232:235], a[216:219], v[104:107], v[232:235]
v_mfma_f32_16x16x32_bf16 v[216:219], a[220:223], v[120:123], v[216:219]
ds_write_b128 v48, v[200:203] offset:1024
v_mfma_f32_16x16x32_bf16 v[220:223], a[224:227], v[120:123], v[220:223]
v_mfma_f32_16x16x32_bf16 v[224:227], a[228:231], v[120:123], v[224:227]
ds_write_b128 v48, v[204:207] offset:2048
v_mfma_f32_16x16x32_bf16 v[228:231], a[232:235], v[120:123], v[228:231]
v_mfma_f32_16x16x32_bf16 v[232:235], a[236:239], v[120:123], v[232:235]
v_mfma_f32_16x16x32_bf16 v[236:239], a[200:203], v[108:111], v[236:239]
ds_write_b128 v48, v[208:211] offset:3072
v_mfma_f32_16x16x32_bf16 v[240:243], a[204:207], v[108:111], v[240:243]
v_mfma_f32_16x16x32_bf16 v[244:247], a[208:211], v[108:111], v[244:247]
ds_write_b128 v48, v[212:215] offset:4096
v_mfma_f32_16x16x32_bf16 v[248:251], a[212:215], v[108:111], v[248:251]
ds_write_b128 v49, v[216:219] offset:5120
v_mfma_f32_16x16x32_bf16 v[252:255], a[216:219], v[108:111], v[252:255]
v_mfma_f32_16x16x32_bf16 v[236:239], a[220:223], v[124:127], v[236:239]
ds_write_b128 v49, v[220:223] offset:6144
v_mfma_f32_16x16x32_bf16 v[240:243], a[224:227], v[124:127], v[240:243]
v_mfma_f32_16x16x32_bf16 v[244:247], a[228:231], v[124:127], v[244:247]
ds_write_b128 v49, v[224:227] offset:7168
v_mfma_f32_16x16x32_bf16 v[248:251], a[232:235], v[124:127], v[248:251]
v_mfma_f32_16x16x32_bf16 v[252:255], a[236:239], v[124:127], v[252:255]
v_mfma_f32_16x16x32_bf16 v[176:179], a[200:203], v[96:99], v[176:179]
ds_write_b128 v49, v[228:231] offset:8192
v_mfma_f32_16x16x32_bf16 v[180:183], a[204:207], v[96:99], v[180:183]
v_mfma_f32_16x16x32_bf16 v[184:187], a[208:211], v[96:99], v[184:187]
ds_write_b128 v49, v[232:235] offset:9216
ds_write_b128 v50, v[236:239] offset:10240
v_mfma_f32_16x16x32_bf16 v[188:191], a[212:215], v[96:99], v[188:191]
v_mfma_f32_16x16x32_bf16 v[192:195], a[216:219], v[96:99], v[192:195]
ds_write_b128 v50, v[240:243] offset:11264
v_mfma_f32_16x16x32_bf16 v[176:179], a[220:223], v[112:115], v[176:179]
ds_write_b128 v50, v[244:247] offset:12288
v_mfma_f32_16x16x32_bf16 v[180:183], a[224:227], v[112:115], v[180:183]
v_mfma_f32_16x16x32_bf16 v[184:187], a[228:231], v[112:115], v[184:187]
ds_write_b128 v50, v[248:251] offset:13312
v_mfma_f32_16x16x32_bf16 v[188:191], a[232:235], v[112:115], v[188:191]
v_mfma_f32_16x16x32_bf16 v[192:195], a[236:239], v[112:115], v[192:195]
ds_write_b128 v50, v[252:255] offset:14336
s_branch Ltail
Lcsk0:
s_cmp_eq_u32 s56, 0
s_cbranch_scc0 Lcsk0_0
v_mfma_f32_16x16x32_bf16 a[112:115], a[16:19], a[128:131], 0
v_mfma_f32_16x16x32_bf16 a[116:119], a[32:35], a[128:131], 0
v_mfma_f32_16x16x32_bf16 a[120:123], a[48:51], a[128:131], 0
s_branch Lcrk0
Lcsk0_0:
s_cmp_eq_u32 s56, 1
s_cbranch_scc0 Lcsk0_1
s_nop 0
v_mfma_f32_16x16x32_bf16 a[112:115], a[20:23], a[128:131], 0
v_mfma_f32_16x16x32_bf16 a[116:119], a[36:39], a[128:131], 0
v_mfma_f32_16x16x32_bf16 a[120:123], a[52:55], a[128:131], 0
s_branch Lcrk0
Lcsk0_1:
s_cmp_eq_u32 s56, 2
s_cbranch_scc0 Lcsk0_2
s_nop 0
v_mfma_f32_16x16x32_bf16 a[112:115], a[24:27], a[128:131], 0
v_mfma_f32_16x16x32_bf16 a[116:119], a[40:43], a[128:131], 0
s_branch Lcrk0
Lcsk0_2:
s_nop 3
v_mfma_f32_16x16x32_bf16 a[112:115], a[28:31], a[128:131], 0
v_mfma_f32_16x16x32_bf16 a[116:119], a[44:47], a[128:131], 0
s_branch Lcrk0
Lcsk1:
s_cmp_eq_u32 s56, 0
s_cbranch_scc0 Lcsk1_0
v_mfma_f32_16x16x32_bf16 a[112:115], a[72:75], a[128:131], a[112:115]
v_mfma_f32_16x16x32_bf16 a[116:119], a[88:91], a[128:131], a[116:119]
v_mfma_f32_16x16x32_bf16 a[120:123], a[104:107], a[128:131], a[120:123]
s_bfe_u32 s66, s57, 0x40000
s_mul_i32 s66, s66, 19968
s_add_u32 s66, s66, s73
s_add_u32 s67, s66, 6144
s_nop 4
buffer_store_dwordx4 a[112:115], v94, s[40:43], s66 offen offset:0 sc1
buffer_store_dwordx4 a[116:119], v94, s[40:43], s66 offen offset:64 sc1
buffer_store_dwordx4 a[120:123], v94, s[40:43], s66 offen offset:2608 sc1
s_branch Lcrk1
Lcsk1_0:
s_cmp_eq_u32 s56, 1
s_cbranch_scc0 Lcsk1_1
v_mfma_f32_16x16x32_bf16 a[112:115], a[76:79], a[128:131], a[112:115]
v_mfma_f32_16x16x32_bf16 a[116:119], a[92:95], a[128:131], a[116:119]
v_mfma_f32_16x16x32_bf16 a[120:123], a[108:111], a[128:131], a[120:123]
s_bfe_u32 s66, s57, 0x40000
s_mul_i32 s66, s66, 19968
s_add_u32 s66, s66, s73
s_add_u32 s67, s66, 6144
s_nop 4
buffer_store_dwordx4 a[112:115], v94, s[40:43], s66 offen offset:16 sc1
buffer_store_dwordx4 a[116:119], v94, s[40:43], s66 offen offset:2560 sc1
buffer_store_dwordx4 a[120:123], v94, s[40:43], s66 offen offset:2624 sc1
s_branch Lcrk1
Lcsk1_1:
s_cmp_eq_u32 s56, 2
s_cbranch_scc0 Lcsk1_2
v_mfma_f32_16x16x32_bf16 a[112:115], a[80:83], a[128:131], a[112:115]
v_mfma_f32_16x16x32_bf16 a[116:119], a[96:99], a[128:131], a[116:119]
s_bfe_u32 s66, s57, 0x40000
s_mul_i32 s66, s66, 19968
s_add_u32 s66, s66, s73
s_add_u32 s67, s66, 6144
s_nop 4
buffer_store_dwordx4 a[112:115], v94, s[40:43], s66 offen offset:32 sc1
buffer_store_dwordx4 a[116:119], v94, s[40:43], s66 offen offset:2576 sc1
s_branch Lcrk1
Lcsk1_2:
v_mfma_f32_16x16x32_bf16 a[112:115], a[84:87], a[128:131], a[112:115]
v_mfma_f32_16x16x32_bf16 a[116:119], a[100:103], a[128:131], a[116:119]
s_bfe_u32 s66, s57, 0x40000
s_mul_i32 s66, s66, 19968
s_add_u32 s66, s66, s73
s_add_u32 s67, s66, 6144
s_nop 4
buffer_store_dwordx4 a[112:115], v94, s[40:43], s66 offen offset:48 sc1
buffer_store_dwordx4 a[116:119], v94, s[40:43], s66 offen offset:2592 sc1
s_branch Lcrk1
Lcsk2:
s_cmp_eq_u32 s56, 0
s_cbranch_scc0 Lcsk2_0
v_mfma_f32_16x16x32_bf16 a[112:115], a[16:19], a[128:131], 0
v_mfma_f32_16x16x32_bf16 a[116:119], a[32:35], a[128:131], 0
v_mfma_f32_16x16x32_bf16 a[120:123], a[48:51], a[128:131], 0
s_branch Lcrk2
Lcsk2_0:
s_cmp_eq_u32 s56, 1
s_cbranch_scc0 Lcsk2_1
s_nop 0
v_mfma_f32_16x16x32_bf16 a[112:115], a[20:23], a[128:131], 0
v_mfma_f32_16x16x32_bf16 a[116:119], a[36:39], a[128:131], 0
v_mfma_f32_16x16x32_bf16 a[120:123], a[52:55], a[128:131], 0
s_branch Lcrk2
Lcsk2_1:
s_cmp_eq_u32 s56, 2
s_cbranch_scc0 Lcsk2_2
s_nop 0
v_mfma_f32_16x16x32_bf16 a[112:115], a[24:27], a[128:131], 0
v_mfma_f32_16x16x32_bf16 a[116:119], a[40:43], a[128:131], 0
s_branch Lcrk2
Lcsk2_2:
s_nop 3
v_mfma_f32_16x16x32_bf16 a[112:115], a[28:31], a[128:131], 0
v_mfma_f32_16x16x32_bf16 a[116:119], a[44:47], a[128:131], 0
s_branch Lcrk2
Lcsk3:
s_cmp_eq_u32 s56, 0
s_cbranch_scc0 Lcsk3_0
v_mfma_f32_16x16x32_bf16 a[112:115], a[72:75], a[128:131], a[112:115]
v_mfma_f32_16x16x32_bf16 a[116:119], a[88:91], a[128:131], a[116:119]
v_mfma_f32_16x16x32_bf16 a[120:123], a[104:107], a[128:131], a[120:123]
s_bfe_u32 s66, s57, 0x40004
s_mul_i32 s66, s66, 19968
s_add_u32 s66, s66, s73
s_add_u32 s67, s66, 6144
s_nop 4
buffer_store_dwordx4 a[112:115], v94, s[40:43], s66 offen offset:0 sc1
buffer_store_dwordx4 a[116:119], v94, s[40:43], s66 offen offset:64 sc1
buffer_store_dwordx4 a[120:123], v94, s[40:43], s66 offen offset:2608 sc1
s_branch Lcrk3
Lcsk3_0:
s_cmp_eq_u32 s56, 1
s_cbranch_scc0 Lcsk3_1
v_mfma_f32_16x16x32_bf16 a[112:115], a[76:79], a[128:131], a[112:115]
v_mfma_f32_16x16x32_bf16 a[116:119], a[92:95], a[128:131], a[116:119]
v_mfma_f32_16x16x32_bf16 a[120:123], a[108:111], a[128:131], a[120:123]
s_bfe_u32 s66, s57, 0x40004
s_mul_i32 s66, s66, 19968
s_add_u32 s66, s66, s73
s_add_u32 s67, s66, 6144
s_nop 4
buffer_store_dwordx4 a[112:115], v94, s[40:43], s66 offen offset:16 sc1
buffer_store_dwordx4 a[116:119], v94, s[40:43], s66 offen offset:2560 sc1
buffer_store_dwordx4 a[120:123], v94, s[40:43], s66 offen offset:2624 sc1
s_branch Lcrk3
Lcsk3_1:
s_cmp_eq_u32 s56, 2
s_cbranch_scc0 Lcsk3_2
v_mfma_f32_16x16x32_bf16 a[112:115], a[80:83], a[128:131], a[112:115]
v_mfma_f32_16x16x32_bf16 a[116:119], a[96:99], a[128:131], a[116:119]
s_bfe_u32 s66, s57, 0x40004
s_mul_i32 s66, s66, 19968
s_add_u32 s66, s66, s73
s_add_u32 s67, s66, 6144
s_nop 4
buffer_store_dwordx4 a[112:115], v94, s[40:43], s66 offen offset:32 sc1
buffer_store_dwordx4 a[116:119], v94, s[40:43], s66 offen offset:2576 sc1
s_branch Lcrk3
Lcsk3_2:
v_mfma_f32_16x16x32_bf16 a[112:115], a[84:87], a[128:131], a[112:115]
v_mfma_f32_16x16x32_bf16 a[116:119], a[100:103], a[128:131], a[116:119]
s_bfe_u32 s66, s57, 0x40004
s_mul_i32 s66, s66, 19968
s_add_u32 s66, s66, s73
s_add_u32 s67, s66, 6144
s_nop 4
buffer_store_dwordx4 a[112:115], v94, s[40:43], s66 offen offset:48 sc1
buffer_store_dwordx4 a[116:119], v94, s[40:43], s66 offen offset:2592 sc1
s_branch Lcrk3
Lcsk4:
s_cmp_eq_u32 s56, 0
s_cbranch_scc0 Lcsk4_0
v_mfma_f32_16x16x32_bf16 a[112:115], a[16:19], a[128:131], 0
v_mfma_f32_16x16x32_bf16 a[116:119], a[32:35], a[128:131], 0
v_mfma_f32_16x16x32_bf16 a[120:123], a[48:51], a[128:131], 0
s_branch Lcrk4
Lcsk4_0:
s_cmp_eq_u32 s56, 1
s_cbranch_scc0 Lcsk4_1
s_nop 0
v_mfma_f32_16x16x32_bf16 a[112:115], a[20:23], a[128:131], 0
v_mfma_f32_16x16x32_bf16 a[116:119], a[36:39], a[128:131], 0
v_mfma_f32_16x16x32_bf16 a[120:123], a[52:55], a[128:131], 0
s_branch Lcrk4
Lcsk4_1:
s_cmp_eq_u32 s56, 2
s_cbranch_scc0 Lcsk4_2
s_nop 0
v_mfma_f32_16x16x32_bf16 a[112:115], a[24:27], a[128:131], 0
v_mfma_f32_16x16x32_bf16 a[116:119], a[40:43], a[128:131], 0
s_branch Lcrk4
Lcsk4_2:
s_nop 3
v_mfma_f32_16x16x32_bf16 a[112:115], a[28:31], a[128:131], 0
v_mfma_f32_16x16x32_bf16 a[116:119], a[44:47], a[128:131], 0
s_branch Lcrk4
Lcsk5:
s_cmp_eq_u32 s56, 0
s_cbranch_scc0 Lcsk5_0
v_mfma_f32_16x16x32_bf16 a[112:115], a[72:75], a[128:131], a[112:115]
v_mfma_f32_16x16x32_bf16 a[116:119], a[88:91], a[128:131], a[116:119]
v_mfma_f32_16x16x32_bf16 a[120:123], a[104:107], a[128:131], a[120:123]
s_bfe_u32 s66, s57, 0x40008
s_mul_i32 s66, s66, 19968
s_add_u32 s66, s66, s73
s_add_u32 s67, s66, 6144
s_nop 4
buffer_store_dwordx4 a[112:115], v94, s[40:43], s66 offen offset:0 sc1
buffer_store_dwordx4 a[116:119], v94, s[40:43], s66 offen offset:64 sc1
buffer_store_dwordx4 a[120:123], v94, s[40:43], s66 offen offset:2608 sc1
s_branch Lcrk5
Lcsk5_0:
s_cmp_eq_u32 s56, 1
s_cbranch_scc0 Lcsk5_1
v_mfma_f32_16x16x32_bf16 a[112:115], a[76:79], a[128:131], a[112:115]
v_mfma_f32_16x16x32_bf16 a[116:119], a[92:95], a[128:131], a[116:119]
v_mfma_f32_16x16x32_bf16 a[120:123], a[108:111], a[128:131], a[120:123]
s_bfe_u32 s66, s57, 0x40008
s_mul_i32 s66, s66, 19968
s_add_u32 s66, s66, s73
s_add_u32 s67, s66, 6144
s_nop 4
buffer_store_dwordx4 a[112:115], v94, s[40:43], s66 offen offset:16 sc1
buffer_store_dwordx4 a[116:119], v94, s[40:43], s66 offen offset:2560 sc1
buffer_store_dwordx4 a[120:123], v94, s[40:43], s66 offen offset:2624 sc1
s_branch Lcrk5
Lcsk5_1:
s_cmp_eq_u32 s56, 2
s_cbranch_scc0 Lcsk5_2
v_mfma_f32_16x16x32_bf16 a[112:115], a[80:83], a[128:131], a[112:115]
v_mfma_f32_16x16x32_bf16 a[116:119], a[96:99], a[128:131], a[116:119]
s_bfe_u32 s66, s57, 0x40008
s_mul_i32 s66, s66, 19968
s_add_u32 s66, s66, s73
s_add_u32 s67, s66, 6144
s_nop 4
buffer_store_dwordx4 a[112:115], v94, s[40:43], s66 offen offset:32 sc1
buffer_store_dwordx4 a[116:119], v94, s[40:43], s66 offen offset:2576 sc1
s_branch Lcrk5
Lcsk5_2:
v_mfma_f32_16x16x32_bf16 a[112:115], a[84:87], a[128:131], a[112:115]
v_mfma_f32_16x16x32_bf16 a[116:119], a[100:103], a[128:131], a[116:119]
s_bfe_u32 s66, s57, 0x40008
s_mul_i32 s66, s66, 19968
s_add_u32 s66, s66, s73
s_add_u32 s67, s66, 6144
s_nop 4
buffer_store_dwordx4 a[112:115], v94, s[40:43], s66 offen offset:48 sc1
buffer_store_dwordx4 a[116:119], v94, s[40:43], s66 offen offset:2592 sc1
s_branch Lcrk5
Lcsk6:
s_cmp_eq_u32 s56, 0
s_cbranch_scc0 Lcsk6_0
v_mfma_f32_16x16x32_bf16 a[112:115], a[16:19], a[128:131], 0
v_mfma_f32_16x16x32_bf16 a[116:119], a[32:35], a[128:131], 0
v_mfma_f32_16x16x32_bf16 a[120:123], a[48:51], a[128:131], 0
s_branch Lcrk6
Lcsk6_0:
s_cmp_eq_u32 s56, 1
s_cbranch_scc0 Lcsk6_1
s_nop 0
v_mfma_f32_16x16x32_bf16 a[112:115], a[20:23], a[128:131], 0
v_mfma_f32_16x16x32_bf16 a[116:119], a[36:39], a[128:131], 0
v_mfma_f32_16x16x32_bf16 a[120:123], a[52:55], a[128:131], 0
s_branch Lcrk6
Lcsk6_1:
s_cmp_eq_u32 s56, 2
s_cbranch_scc0 Lcsk6_2
s_nop 0
v_mfma_f32_16x16x32_bf16 a[112:115], a[24:27], a[128:131], 0
v_mfma_f32_16x16x32_bf16 a[116:119], a[40:43], a[128:131], 0
s_branch Lcrk6
Lcsk6_2:
s_nop 3
v_mfma_f32_16x16x32_bf16 a[112:115], a[28:31], a[128:131], 0
v_mfma_f32_16x16x32_bf16 a[116:119], a[44:47], a[128:131], 0
s_branch Lcrk6
Lcsk7:
s_cmp_eq_u32 s56, 0
s_cbranch_scc0 Lcsk7_0
v_mfma_f32_16x16x32_bf16 a[112:115], a[72:75], a[128:131], a[112:115]
v_mfma_f32_16x16x32_bf16 a[116:119], a[88:91], a[128:131], a[116:119]
v_mfma_f32_16x16x32_bf16 a[120:123], a[104:107], a[128:131], a[120:123]
s_bfe_u32 s66, s57, 0x4000c
s_mul_i32 s66, s66, 19968
s_add_u32 s66, s66, s73
s_add_u32 s67, s66, 6144
s_nop 4
buffer_store_dwordx4 a[112:115], v94, s[40:43], s66 offen offset:0 sc1
buffer_store_dwordx4 a[116:119], v94, s[40:43], s66 offen offset:64 sc1
buffer_store_dwordx4 a[120:123], v94, s[40:43], s66 offen offset:2608 sc1
s_branch Lcrk7
Lcsk7_0:
s_cmp_eq_u32 s56, 1
s_cbranch_scc0 Lcsk7_1
v_mfma_f32_16x16x32_bf16 a[112:115], a[76:79], a[128:131], a[112:115]
v_mfma_f32_16x16x32_bf16 a[116:119], a[92:95], a[128:131], a[116:119]
v_mfma_f32_16x16x32_bf16 a[120:123], a[108:111], a[128:131], a[120:123]
s_bfe_u32 s66, s57, 0x4000c
s_mul_i32 s66, s66, 19968
s_add_u32 s66, s66, s73
s_add_u32 s67, s66, 6144
s_nop 4
buffer_store_dwordx4 a[112:115], v94, s[40:43], s66 offen offset:16 sc1
buffer_store_dwordx4 a[116:119], v94, s[40:43], s66 offen offset:2560 sc1
buffer_store_dwordx4 a[120:123], v94, s[40:43], s66 offen offset:2624 sc1
s_branch Lcrk7
Lcsk7_1:
s_cmp_eq_u32 s56, 2
s_cbranch_scc0 Lcsk7_2
v_mfma_f32_16x16x32_bf16 a[112:115], a[80:83], a[128:131], a[112:115]
v_mfma_f32_16x16x32_bf16 a[116:119], a[96:99], a[128:131], a[116:119]
s_bfe_u32 s66, s57, 0x4000c
s_mul_i32 s66, s66, 19968
s_add_u32 s66, s66, s73
s_add_u32 s67, s66, 6144
s_nop 4
buffer_store_dwordx4 a[112:115], v94, s[40:43], s66 offen offset:32 sc1
buffer_store_dwordx4 a[116:119], v94, s[40:43], s66 offen offset:2576 sc1
s_branch Lcrk7
Lcsk7_2:
v_mfma_f32_16x16x32_bf16 a[112:115], a[84:87], a[128:131], a[112:115]
v_mfma_f32_16x16x32_bf16 a[116:119], a[100:103], a[128:131], a[116:119]
s_bfe_u32 s66, s57, 0x4000c
s_mul_i32 s66, s66, 19968
s_add_u32 s66, s66, s73
s_add_u32 s67, s66, 6144
s_nop 4
buffer_store_dwordx4 a[112:115], v94, s[40:43], s66 offen offset:48 sc1
buffer_store_dwordx4 a[116:119], v94, s[40:43], s66 offen offset:2592 sc1
s_branch Lcrk7
Lq:
s_mul_i32 s64, s58, 256
s_mul_i32 s65, s56, 64
s_add_u32 s64, s64, s65
s_mul_i32 s64, s64, 1280
v_lshrrev_b32 v2, 3, v1
v_mul_u32_u24 v2, 1280, v2
v_add_u32 v2, s64, v2
v_lshrrev_b32 v3, 4, v1
v_and_b32 v4, 7, v1
v_xor_b32 v3, v3, v4
v_lshl_add_u32 v4, v3, 4, v2
v_xor_b32_e64 v3, 4, v3
v_lshl_add_u32 v5, v3, 4, v2
v_add_u32_e64 v8, 0, v4
v_add_u32 v9, 9216, v5
v_add_u32 v10, 18432, v4
v_add_u32 v11, 27648, v5
v_add_u32 v12, 40960, v4
v_add_u32 v13, 50176, v5
v_add_u32 v14, 59392, v4
v_add_u32 v15, 68608, v5
s_mul_i32 s62, s56, 8192
s_bfe_u32 s66, s2, 0x10002
s_mul_i32 s67, s66, 4
s_sub_u32 s67, s58, s67
s_mov_b32 s68, 0x76543210
s_mov_b32 s69, 0x76532104
s_cmp_eq_u32 s67, 0
s_cselect_b32 s74, s69, s68
s_mov_b32 s75, 0x98
s_cmp_eq_u32 s66, 0
s_cbranch_scc1 Lupq
s_sub_u32 s74, 0x99999999, s74
s_mov_b32 s75, 0x01
Lupq:
s_and_b32 s68, s74, 15
s_lshl_b32 s60, s68, 7
s_waitcnt lgkmcnt(0)
s_mov_b32 s28, s4
s_mov_b32 s29, s5
s_mov_b32 s30, 2621440
s_mov_b32 s31, 0x20000
s_add_u32 m0, s62, 0
s_nop 0
buffer_load_dwordx4 v8, s[28:31], s60 offen offset:0  lds
buffer_load_dwordx4 v9, s[28:31], s60 offen offset:1024  lds
buffer_load_dwordx4 v10, s[28:31], s60 offen offset:2048  lds
buffer_load_dwordx4 v11, s[28:31], s60 offen offset:3072  lds
s_add_u32 m0, s62, 4096
s_nop 0
buffer_load_dwordx4 v12, s[28:31], s60 offen offset:0  lds
buffer_load_dwordx4 v13, s[28:31], s60 offen offset:1024  lds
buffer_load_dwordx4 v14, s[28:31], s60 offen offset:2048  lds
buffer_load_dwordx4 v15, s[28:31], s60 offen offset:3072  lds
s_mul_i32 s61, s68, 245760
s_lshl_b32 s72, 1, s67
s_cmp_eq_u32 s67, 0
s_cselect_b32 s72, 3, s72
s_lshr_b32 s64, s56, 1
s_mul_i32 s65, s59, 320
s_mul_i32 s66, s64, 160
s_add_u32 s65, s65, s66
s_mul_i32 s66, s59, 160
s_mul_i32 s67, s64, 1280
s_add_u32 s66, s66, s67
s_add_u32 s66, s66, 1280
s_cmp_eq_u32 s57, 1
s_cselect_b32 s65, s65, s66
s_and_b32 s64, s56, 1
s_mul_i32 s64, s64, 320
v_add_u32 v2, s64, v1
v_add_u32 v2, 0, v2
v_mul_u32_u24 v3, 6554, v2
v_lshrrev_b32 v3, 16, v3
v_mul_u32_u24 v4, 10, v3
v_sub_u32 v2, v2, v4
v_lshrrev_b32 v4, 1, v3
v_xor_b32 v4, v4, v3
v_and_b32 v4, 4, v4
v_mul_u32_u24 v4, 3, v4
v_xor_b32 v3, v3, v4
v_mul_u32_u24 v3, 3840, v3
v_lshl_add_u32 v3, v2, 4, v3
v_add_u32 v3, s65, v3
v_subrev_u32 v16, 0, v3
v_add_u32 v2, s64, v1
v_add_u32 v2, 64, v2
v_mul_u32_u24 v3, 6554, v2
v_lshrrev_b32 v3, 16, v3
v_mul_u32_u24 v4, 10, v3
v_sub_u32 v2, v2, v4
v_lshrrev_b32 v4, 1, v3
v_xor_b32 v4, v4, v3
v_and_b32 v4, 4, v4
v_mul_u32_u24 v4, 3, v4
v_xor_b32 v3, v3, v4
v_mul_u32_u24 v3, 3840, v3
v_lshl_add_u32 v3, v2, 4, v3
v_add_u32_e64 v3, s65, v3
v_subrev_u32 v17, 1024, v3
v_add_u32_e64 v2, s64, v1
v_add_u32 v2, 128, v2
v_mul_u32_u24 v3, 6554, v2
v_lshrrev_b32 v3, 16, v3
v_mul_u32_u24 v4, 10, v3
v_sub_u32 v2, v2, v4
v_lshrrev_b32 v4, 1, v3
v_xor_b32 v4, v4, v3
v_and_b32 v4, 4, v4
v_mul_u32_u24 v4, 3, v4
v_xor_b32 v3, v3, v4
v_mul_u32_u24 v3, 3840, v3
v_lshl_add_u32 v3, v2, 4, v3
v_add_u32_e64 v3, s65, v3
v_subrev_u32 v18, 2048, v3
v_add_u32_e64 v2, s64, v1
v_add_u32 v2, 192, v2
v_mul_u32_u24 v3, 6554, v2
v_lshrrev_b32 v3, 16, v3
v_mul_u32_u24 v4, 10, v3
v_sub_u32 v2, v2, v4
v_lshrrev_b32 v4, 1, v3
v_xor_b32 v4, v4, v3
v_and_b32 v4, 4, v4
v_mul_u32_u24 v4, 3, v4
v_xor_b32 v3, v3, v4
v_mul_u32_u24 v3, 3840, v3
v_lshl_add_u32 v3, v2, 4, v3
v_add_u32_e64 v3, s65, v3
v_subrev_u32 v19, 3072, v3
v_add_u32_e64 v2, s64, v1
v_add_u32 v2, 256, v2
v_mul_u32_u24 v3, 6554, v2
v_lshrrev_b32 v3, 16, v3
v_mul_u32_u24 v4, 10, v3
v_sub_u32 v2, v2, v4
v_lshrrev_b32 v4, 1, v3
v_xor_b32 v4, v4, v3
v_and_b32 v4, 4, v4
v_mul_u32_u24 v4, 3, v4
v_xor_b32 v3, v3, v4
v_mul_u32_u24 v3, 3840, v3
v_lshl_add_u32 v3, v2, 4, v3
v_add_u32 v3, s65, v3
v_subrev_u32 v20, 0, v3
s_mul_i32 s63, s56, 5120
s_add_u32 s63, s63, 32768
s_mov_b32 s32, s6
s_mov_b32 s33, s7
s_mov_b32 s34, 2457600
s_mov_b32 s35, 0x20000
s_add_u32 m0, s63, 0
s_nop 0
buffer_load_dwordx4 v16, s[32:35], s61 offen offset:0  lds
buffer_load_dwordx4 v17, s[32:35], s61 offen offset:1024  lds
buffer_load_dwordx4 v18, s[32:35], s61 offen offset:2048  lds
buffer_load_dwordx4 v19, s[32:35], s61 offen offset:3072  lds
s_add_u32 m0, s63, 4096
s_nop 0
buffer_load_dwordx4 v20, s[32:35], s61 offen offset:0  lds
s_mov_b32 s57, s74
v_and_b32 v2, 15, v1
v_lshrrev_b32 v3, 4, v1
v_lshrrev_b32 v4, 1, v2
v_xor_b32 v4, v4, v3
v_lshlrev_b32_e64 v4, 4, v4
v_lshl_add_u32 v4, v2, 7, v4
v_add_u32 v4, s62, v4
v_xor_b32 v5, 64, v4
v_add_u32 v22, 0, v4
v_add_u32 v23, 0, v5
v_add_u32 v24, 53248, v4
v_add_u32 v25, 53248, v5
v_add_u32 v26, 106496, v4
v_add_u32 v27, 106496, v5
v_bfe_u32 v2, v1, 2, 2
v_and_b32 v5, 3, v1
v_and_b32 v4, 1, v3
v_lshl_add_u32 v2, v4, 2, v2
v_lshrrev_b32_e64 v4, 1, v3
v_lshl_add_u32 v2, v4, 4, v2
v_mul_u32_u24 v2, 160, v2
v_mul_u32_u24 v5, 40, v5
v_add_u32 v4, v2, v5
v_add_u32 v28, 32768, v4
v_add_u32 v30, 86016, v4
v_add_u32 v32, 139264, v4
s_lshr_b64 s[74:75], s[74:75], 4
s_and_b32 s13, s74, 15
s_lshl_b32 s60, s13, 7
s_mul_i32 s61, s13, 245760
s_add_u32 m0, s62, 53248
s_nop 0
buffer_load_dwordx4 v8, s[28:31], s60 offen offset:0  lds
buffer_load_dwordx4 v9, s[28:31], s60 offen offset:1024  lds
buffer_load_dwordx4 v10, s[28:31], s60 offen offset:2048  lds
buffer_load_dwordx4 v11, s[28:31], s60 offen offset:3072  lds
s_add_u32 m0, s62, 57344
s_nop 0
buffer_load_dwordx4 v12, s[28:31], s60 offen offset:0  lds
buffer_load_dwordx4 v13, s[28:31], s60 offen offset:1024  lds
buffer_load_dwordx4 v14, s[28:31], s60 offen offset:2048  lds
buffer_load_dwordx4 v15, s[28:31], s60 offen offset:3072  lds
s_add_u32 m0, s63, 53248
s_nop 0
buffer_load_dwordx4 v16, s[32:35], s61 offen offset:0  lds
buffer_load_dwordx4 v17, s[32:35], s61 offen offset:1024  lds
buffer_load_dwordx4 v18, s[32:35], s61 offen offset:2048  lds
buffer_load_dwordx4 v19, s[32:35], s61 offen offset:3072  lds
s_add_u32 m0, s63, 57344
s_nop 0
buffer_load_dwordx4 v20, s[32:35], s61 offen offset:0  lds
s_mov_b32 s40, s24
s_mov_b32 s41, s25
s_mov_b32 s42, 17825792
s_mov_b32 s43, 0x20000
s_mov_b32 s48, s22
s_mov_b32 s49, s23
s_mov_b32 s50, 256
s_mov_b32 s51, 0x20000
v_lshlrev_b32 v6, 4, v1
v_add_u32 v21, 4096, v6
v_add_u32 v0, 8192, v6
v_mov_b32 v7, 0x7f000000
v_cmp_eq_u32 vcc, 0, v1
s_nop 1
v_cndmask_b32 v7, v7, 0, vcc
s_mov_b32 s80, 0x3fb8aa3b
s_mov_b32 s81, 0x3fb8aa3b
s_mov_b32 s82, 0x05040100
s_mov_b32 s83, 0x07060302
s_lshl_b32 s12, s56, 10
s_mov_b32 s78, 0xffff0000
s_and_b32 s64, s2, 7
s_lshr_b32 s65, s2, 3
s_sub_u32 s66, s65, 8
s_and_b32 s67, s66, 3
s_lshl_b32 s68, s64, 2
s_add_u32 s67, s67, s68
s_lshl_b32 s68, s59, 2
s_cmp_lt_u32 s65, 8
s_cselect_b32 s27, s68, s67
s_lshr_b32 s66, s66, 2
s_lshl_b32 s66, s66, 2
s_add_u32 s66, s66, s56
s_mul_i32 s26, s66, 6
s_lshl_b32 s95, s64, 2
s_and_b32 s66, s65, 3
s_add_u32 s95, s95, s66
s_lshr_b32 s96, s65, 2
s_mul_i32 s3, s56, -7168
s_add_u32 s3, s3, 49152
s_mul_i32 s64, s96, 348160
s_mul_i32 s65, s56, 12288
s_add_u32 s64, s64, s65
s_add_u32 s86, s64, 9437184
s_add_u32 s87, s86, 69632
s_add_u32 s88, s87, 69632
s_add_u32 s89, s88, 69632
s_add_u32 s90, s89, 69632
s_mul_i32 s64, s95, 278528
s_add_u32 s64, s64, s65
s_add_u32 s66, s56, 0
s_and_b32 s66, s66, 3
s_mul_i32 s66, s66, 69632
s_add_u32 s91, s64, s66
s_add_u32 s66, s56, 1
s_and_b32 s66, s66, 3
s_mul_i32 s66, s66, 69632
s_add_u32 s92, s64, s66
s_add_u32 s66, s56, 2
s_and_b32 s66, s66, 3
s_mul_i32 s66, s66, 69632
s_add_u32 s93, s64, s66
s_add_u32 s66, s56, 3
s_and_b32 s66, s66, 3
s_mul_i32 s66, s66, 69632
s_add_u32 s94, s64, s66
s_waitcnt vmcnt(13)
s_barrier
ds_read_b128 a[0:3], v22 offset:0
ds_read_b128 a[4:7], v22 offset:2048
ds_read_b128 a[8:11], v22 offset:4096
ds_read_b128 a[12:15], v22 offset:6144
ds_read_b64_tr_b16 a[16:17], v28 offset:0
ds_read_b64_tr_b16 a[18:19], v28 offset:1280
ds_read_b64_tr_b16 a[20:21], v28 offset:8
ds_read_b64_tr_b16 a[22:23], v28 offset:1288
ds_read_b64_tr_b16 a[24:25], v28 offset:16
ds_read_b64_tr_b16 a[26:27], v28 offset:1296
ds_read_b64_tr_b16 a[28:29], v28 offset:24
ds_read_b64_tr_b16 a[30:31], v28 offset:1304
ds_read_b64_tr_b16 a[32:33], v28 offset:32
ds_read_b64_tr_b16 a[34:35], v28 offset:1312
ds_read_b64_tr_b16 a[36:37], v28 offset:10240
ds_read_b64_tr_b16 a[38:39], v28 offset:11520
ds_read_b64_tr_b16 a[40:41], v28 offset:10248
ds_read_b64_tr_b16 a[42:43], v28 offset:11528
ds_read_b64_tr_b16 a[44:45], v28 offset:10256
ds_read_b64_tr_b16 a[46:47], v28 offset:11536
ds_read_b64_tr_b16 a[48:49], v28 offset:10264
ds_read_b64_tr_b16 a[50:51], v28 offset:11544
ds_read_b64_tr_b16 a[52:53], v28 offset:10272
ds_read_b64_tr_b16 a[54:55], v28 offset:11552
s_waitcnt lgkmcnt(0)
v_mfma_f32_16x16x32_bf16 v[96:99], a[16:19], a[0:3], 0
ds_read_b128 a[56:59], v23 offset:0
v_mfma_f32_16x16x32_bf16 v[136:139], a[16:19], a[4:7], 0
ds_read_b128 a[60:63], v23 offset:2048
v_mfma_f32_16x16x32_bf16 v[176:179], a[16:19], a[8:11], 0
v_mfma_f32_16x16x32_bf16 v[216:219], a[16:19], a[12:15], 0
ds_read_b128 a[64:67], v23 offset:4096
s_lshr_b64 s[74:75], s[74:75], 4
s_and_b32 s13, s74, 15
v_mfma_f32_16x16x32_bf16 v[220:223], a[20:23], a[12:15], 0
s_lshl_b32 s60, s13, 7
s_mul_i32 s61, s13, 245760
s_add_u32 m0, s62, 106496
v_mfma_f32_16x16x32_bf16 v[180:183], a[20:23], a[8:11], 0
buffer_load_dwordx4 v8, s[28:31], s60 offen offset:0  lds
ds_read_b128 a[68:71], v23 offset:6144
v_mfma_f32_16x16x32_bf16 v[140:143], a[20:23], a[4:7], 0
ds_read_b64_tr_b16 a[72:73], v28 offset:5120
buffer_load_dwordx4 v9, s[28:31], s60 offen offset:1024  lds
v_mfma_f32_16x16x32_bf16 v[100:103], a[20:23], a[0:3], 0
ds_read_b64_tr_b16 a[74:75], v28 offset:6400
v_mfma_f32_16x16x32_bf16 v[104:107], a[24:27], a[0:3], 0
ds_read_b64_tr_b16 a[76:77], v28 offset:5128
v_mfma_f32_16x16x32_bf16 v[144:147], a[24:27], a[4:7], 0
buffer_load_dwordx4 v10, s[28:31], s60 offen offset:2048  lds
ds_read_b64_tr_b16 a[78:79], v28 offset:6408
v_mfma_f32_16x16x32_bf16 v[184:187], a[24:27], a[8:11], 0
ds_read_b64_tr_b16 a[80:81], v28 offset:5136
v_mfma_f32_16x16x32_bf16 v[224:227], a[24:27], a[12:15], 0
ds_read_b64_tr_b16 a[82:83], v28 offset:6416
v_mfma_f32_16x16x32_bf16 v[228:231], a[28:31], a[12:15], 0
buffer_load_dwordx4 v11, s[28:31], s60 offen offset:3072  lds
v_mfma_f32_16x16x32_bf16 v[188:191], a[28:31], a[8:11], 0
ds_read_b64_tr_b16 a[84:85], v28 offset:5144
v_mfma_f32_16x16x32_bf16 v[148:151], a[28:31], a[4:7], 0
ds_read_b64_tr_b16 a[86:87], v28 offset:6424
v_mfma_f32_16x16x32_bf16 v[108:111], a[28:31], a[0:3], 0
s_add_u32 m0, s62, 110592
v_mfma_f32_16x16x32_bf16 v[112:115], a[32:35], a[0:3], 0
buffer_load_dwordx4 v12, s[28:31], s60 offen offset:0  lds
ds_read_b64_tr_b16 a[88:89], v28 offset:5152
v_mfma_f32_16x16x32_bf16 v[152:155], a[32:35], a[4:7], 0
ds_read_b64_tr_b16 a[90:91], v28 offset:6432
v_mfma_f32_16x16x32_bf16 v[192:195], a[32:35], a[8:11], 0
buffer_load_dwordx4 v13, s[28:31], s60 offen offset:1024  lds
ds_read_b64_tr_b16 a[92:93], v28 offset:15360
v_mfma_f32_16x16x32_bf16 v[232:235], a[32:35], a[12:15], 0
v_mov_b32 v2, 0x3f803f80
v_accvgpr_write_b32 a128, v2
v_accvgpr_write_b32 a129, v2
v_mfma_f32_16x16x32_bf16 v[236:239], a[36:39], a[12:15], 0
v_accvgpr_write_b32 a130, v2
v_accvgpr_write_b32 a131, v2
v_lshrrev_b32_e64 v2, 4, v1
v_mfma_f32_16x16x32_bf16 v[196:199], a[36:39], a[8:11], 0
v_mul_u32_u24 v2, 80, v2
v_and_b32 v3, 15, v1
v_cmp_eq_u32 vcc, 0, v3
v_mfma_f32_16x16x32_bf16 v[156:159], a[36:39], a[4:7], 0
v_mov_b32 v3, 0x7f000000
s_mov_b32 s64, 0
v_cndmask_b32 v94, v3, v2, vcc
v_mfma_f32_16x16x32_bf16 v[116:119], a[36:39], a[0:3], 0
s_mul_i32 s65, s59, 640
s_add_u32 s64, s64, s65
s_add_u32 s73, s64, 16842752
v_mfma_f32_16x16x32_bf16 v[120:123], a[40:43], a[0:3], 0
ds_read_b64_tr_b16 a[94:95], v28 offset:16640
ds_read_b64_tr_b16 a[96:97], v28 offset:15368
v_mfma_f32_16x16x32_bf16 v[160:163], a[40:43], a[4:7], 0
buffer_load_dwordx4 v14, s[28:31], s60 offen offset:2048  lds
ds_read_b64_tr_b16 a[98:99], v28 offset:16648
v_mfma_f32_16x16x32_bf16 v[200:203], a[40:43], a[8:11], 0
ds_read_b64_tr_b16 a[100:101], v28 offset:15376
buffer_load_dwordx4 v15, s[28:31], s60 offen offset:3072  lds
v_mfma_f32_16x16x32_bf16 v[240:243], a[40:43], a[12:15], 0
ds_read_b64_tr_b16 a[102:103], v28 offset:16656
ds_read_b64_tr_b16 a[104:105], v28 offset:15384
s_add_u32 m0, s63, 106496
v_mfma_f32_16x16x32_bf16 v[244:247], a[44:47], a[12:15], 0
buffer_load_dwordx4 v16, s[32:35], s61 offen offset:0  lds
ds_read_b64_tr_b16 a[106:107], v28 offset:16664
v_mfma_f32_16x16x32_bf16 v[204:207], a[44:47], a[8:11], 0
ds_read_b64_tr_b16 a[108:109], v28 offset:15392
ds_read_b64_tr_b16 a[110:111], v28 offset:16672
v_mfma_f32_16x16x32_bf16 v[164:167], a[44:47], a[4:7], 0
buffer_load_dwordx4 v17, s[32:35], s61 offen offset:1024  lds
v_mfma_f32_16x16x32_bf16 v[124:127], a[44:47], a[0:3], 0
v_mfma_f32_16x16x32_bf16 v[128:131], a[48:51], a[0:3], 0
buffer_load_dwordx4 v18, s[32:35], s61 offen offset:2048  lds
v_mfma_f32_16x16x32_bf16 v[168:171], a[48:51], a[4:7], 0
v_mfma_f32_16x16x32_bf16 v[208:211], a[48:51], a[8:11], 0
v_mfma_f32_16x16x32_bf16 v[248:251], a[48:51], a[12:15], 0
buffer_load_dwordx4 v19, s[32:35], s61 offen offset:3072  lds
v_mfma_f32_16x16x32_bf16 v[252:255], a[52:55], a[12:15], 0
v_mfma_f32_16x16x32_bf16 v[212:215], a[52:55], a[8:11], 0
v_mfma_f32_16x16x32_bf16 v[172:175], a[52:55], a[4:7], 0
s_add_u32 m0, s63, 110592
v_mfma_f32_16x16x32_bf16 v[132:135], a[52:55], a[0:3], 0
buffer_load_dwordx4 v20, s[32:35], s61 offen offset:0  lds
s_bitcmp1_b32 s72, 0
s_cbranch_scc1 Lcsq0
Lcrq0:
s_waitcnt lgkmcnt(0)
s_waitcnt vmcnt(13)
s_barrier
v_mfma_f32_16x16x32_bf16 v[96:99], a[72:75], a[56:59], v[96:99]
ds_read_b128 a[0:3], v24 offset:0
v_mfma_f32_16x16x32_bf16 v[136:139], a[72:75], a[60:63], v[136:139]
ds_read_b128 a[4:7], v24 offset:2048
v_mfma_f32_16x16x32_bf16 v[176:179], a[72:75], a[64:67], v[176:179]
v_mfma_f32_16x16x32_bf16 v[216:219], a[72:75], a[68:71], v[216:219]
ds_read_b128 a[8:11], v24 offset:4096
v_mfma_f32_16x16x32_bf16 v[220:223], a[76:79], a[68:71], v[220:223]
ds_read_b128 a[12:15], v24 offset:6144
s_lshr_b64 s[74:75], s[74:75], 4
v_mfma_f32_16x16x32_bf16 v[180:183], a[76:79], a[64:67], v[180:183]
s_and_b32 s13, s74, 15
s_lshl_b32 s60, s13, 7
v_mfma_f32_16x16x32_bf16 v[140:143], a[76:79], a[60:63], v[140:143]
s_mul_i32 s61, s13, 245760
s_add_u32 m0, s62, 0
v_mfma_f32_16x16x32_bf16 v[100:103], a[76:79], a[56:59], v[100:103]
buffer_load_dwordx4 v8, s[28:31], s60 offen offset:0  lds
v_mfma_f32_16x16x32_bf16 v[104:107], a[80:83], a[56:59], v[104:107]
ds_read_b64_tr_b16 a[16:17], v30 offset:0
ds_read_b64_tr_b16 a[18:19], v30 offset:1280
v_mfma_f32_16x16x32_bf16 v[144:147], a[80:83], a[60:63], v[144:147]
ds_read_b64_tr_b16 a[20:21], v30 offset:8
ds_read_b64_tr_b16 a[22:23], v30 offset:1288
v_mfma_f32_16x16x32_bf16 v[184:187], a[80:83], a[64:67], v[184:187]
buffer_load_dwordx4 v9, s[28:31], s60 offen offset:1024  lds
v_mfma_f32_16x16x32_bf16 v[224:227], a[80:83], a[68:71], v[224:227]
ds_read_b64_tr_b16 a[24:25], v30 offset:16
ds_read_b64_tr_b16 a[26:27], v30 offset:1296
v_mfma_f32_16x16x32_bf16 v[228:231], a[84:87], a[68:71], v[228:231]
v_mfma_f32_16x16x32_bf16 v[188:191], a[84:87], a[64:67], v[188:191]
ds_read_b64_tr_b16 a[28:29], v30 offset:24
v_mfma_f32_16x16x32_bf16 v[148:151], a[84:87], a[60:63], v[148:151]
ds_read_b64_tr_b16 a[30:31], v30 offset:1304
v_mfma_f32_16x16x32_bf16 v[108:111], a[84:87], a[56:59], v[108:111]
buffer_load_dwordx4 v10, s[28:31], s60 offen offset:2048  lds
v_mfma_f32_16x16x32_bf16 v[112:115], a[88:91], a[56:59], v[112:115]
ds_read_b64_tr_b16 a[32:33], v30 offset:32
ds_read_b64_tr_b16 a[34:35], v30 offset:1312
v_mfma_f32_16x16x32_bf16 v[152:155], a[88:91], a[60:63], v[152:155]
v_mfma_f32_16x16x32_bf16 v[192:195], a[88:91], a[64:67], v[192:195]
ds_read_b64_tr_b16 a[36:37], v30 offset:10240
v_mfma_f32_16x16x32_bf16 v[232:235], a[88:91], a[68:71], v[232:235]
ds_read_b64_tr_b16 a[38:39], v30 offset:11520
v_mfma_f32_16x16x32_bf16 v[236:239], a[92:95], a[68:71], v[236:239]
ds_read_b64_tr_b16 a[40:41], v30 offset:10248
v_mfma_f32_16x16x32_bf16 v[196:199], a[92:95], a[64:67], v[196:199]
buffer_load_dwordx4 v11, s[28:31], s60 offen offset:3072  lds
v_mfma_f32_16x16x32_bf16 v[156:159], a[92:95], a[60:63], v[156:159]
ds_read_b64_tr_b16 a[42:43], v30 offset:11528
v_mfma_f32_16x16x32_bf16 v[116:119], a[92:95], a[56:59], v[116:119]
ds_read_b64_tr_b16 a[44:45], v30 offset:10256
v_mfma_f32_16x16x32_bf16 v[120:123], a[96:99], a[56:59], v[120:123]
ds_read_b64_tr_b16 a[46:47], v30 offset:11536
v_mfma_f32_16x16x32_bf16 v[160:163], a[96:99], a[60:63], v[160:163]
ds_read_b64_tr_b16 a[48:49], v30 offset:10264
v_mfma_f32_16x16x32_bf16 v[200:203], a[96:99], a[64:67], v[200:203]
s_add_u32 m0, s62, 4096
v_mfma_f32_16x16x32_bf16 v[240:243], a[96:99], a[68:71], v[240:243]
buffer_load_dwordx4 v12, s[28:31], s60 offen offset:0  lds
v_mfma_f32_16x16x32_bf16 v[244:247], a[100:103], a[68:71], v[244:247]
ds_read_b64_tr_b16 a[50:51], v30 offset:11544
ds_read_b64_tr_b16 a[52:53], v30 offset:10272
v_mfma_f32_16x16x32_bf16 v[204:207], a[100:103], a[64:67], v[204:207]
ds_read_b64_tr_b16 a[54:55], v30 offset:11552
v_mfma_f32_16x16x32_bf16 v[164:167], a[100:103], a[60:63], v[164:167]
v_mfma_f32_16x16x32_bf16 v[124:127], a[100:103], a[56:59], v[124:127]
buffer_load_dwordx4 v13, s[28:31], s60 offen offset:1024  lds
v_mfma_f32_16x16x32_bf16 v[128:131], a[104:107], a[56:59], v[128:131]
v_mfma_f32_16x16x32_bf16 v[168:171], a[104:107], a[60:63], v[168:171]
v_mfma_f32_16x16x32_bf16 v[208:211], a[104:107], a[64:67], v[208:211]
v_mfma_f32_16x16x32_bf16 v[248:251], a[104:107], a[68:71], v[248:251]
v_mfma_f32_16x16x32_bf16 v[252:255], a[108:111], a[68:71], v[252:255]
v_mfma_f32_16x16x32_bf16 v[212:215], a[108:111], a[64:67], v[212:215]
buffer_load_dwordx4 v14, s[28:31], s60 offen offset:2048  lds
v_mfma_f32_16x16x32_bf16 v[172:175], a[108:111], a[60:63], v[172:175]
v_mfma_f32_16x16x32_bf16 v[132:135], a[108:111], a[56:59], v[132:135]
s_bitcmp1_b32 s72, 0
s_cbranch_scc1 Lcsq1
Lcrq1:
s_waitcnt lgkmcnt(0)
v_mfma_f32_16x16x32_bf16 v[96:99], a[16:19], a[0:3], v[96:99]
ds_read_b128 a[56:59], v25 offset:0
v_mfma_f32_16x16x32_bf16 v[136:139], a[16:19], a[4:7], v[136:139]
ds_read_b128 a[60:63], v25 offset:2048
v_mfma_f32_16x16x32_bf16 v[176:179], a[16:19], a[8:11], v[176:179]
v_mfma_f32_16x16x32_bf16 v[216:219], a[16:19], a[12:15], v[216:219]
ds_read_b128 a[64:67], v25 offset:4096
v_mfma_f32_16x16x32_bf16 v[220:223], a[20:23], a[12:15], v[220:223]
ds_read_b128 a[68:71], v25 offset:6144
v_mfma_f32_16x16x32_bf16 v[180:183], a[20:23], a[8:11], v[180:183]
buffer_load_dwordx4 v15, s[28:31], s60 offen offset:3072  lds
v_mfma_f32_16x16x32_bf16 v[140:143], a[20:23], a[4:7], v[140:143]
ds_read_b64_tr_b16 a[72:73], v30 offset:5120
ds_read_b64_tr_b16 a[74:75], v30 offset:6400
v_mfma_f32_16x16x32_bf16 v[100:103], a[20:23], a[0:3], v[100:103]
v_mfma_f32_16x16x32_bf16 v[104:107], a[24:27], a[0:3], v[104:107]
ds_read_b64_tr_b16 a[76:77], v30 offset:5128
v_mfma_f32_16x16x32_bf16 v[144:147], a[24:27], a[4:7], v[144:147]
ds_read_b64_tr_b16 a[78:79], v30 offset:6408
v_mfma_f32_16x16x32_bf16 v[184:187], a[24:27], a[8:11], v[184:187]
ds_read_b64_tr_b16 a[80:81], v30 offset:5136
v_mfma_f32_16x16x32_bf16 v[224:227], a[24:27], a[12:15], v[224:227]
s_add_u32 m0, s63, 0
v_mfma_f32_16x16x32_bf16 v[228:231], a[28:31], a[12:15], v[228:231]
buffer_load_dwordx4 v16, s[32:35], s61 offen offset:0  lds
v_mfma_f32_16x16x32_bf16 v[188:191], a[28:31], a[8:11], v[188:191]
ds_read_b64_tr_b16 a[82:83], v30 offset:6416
ds_read_b64_tr_b16 a[84:85], v30 offset:5144
v_mfma_f32_16x16x32_bf16 v[148:151], a[28:31], a[4:7], v[148:151]
ds_read_b64_tr_b16 a[86:87], v30 offset:6424
v_mfma_f32_16x16x32_bf16 v[108:111], a[28:31], a[0:3], v[108:111]
ds_read_b64_tr_b16 a[88:89], v30 offset:5152
v_mfma_f32_16x16x32_bf16 v[112:115], a[32:35], a[0:3], v[112:115]
ds_read_b64_tr_b16 a[90:91], v30 offset:6432
v_mfma_f32_16x16x32_bf16 v[152:155], a[32:35], a[4:7], v[152:155]
buffer_load_dwordx4 v17, s[32:35], s61 offen offset:1024  lds
v_mfma_f32_16x16x32_bf16 v[192:195], a[32:35], a[8:11], v[192:195]
ds_read_b64_tr_b16 a[92:93], v30 offset:15360
v_mfma_f32_16x16x32_bf16 v[232:235], a[32:35], a[12:15], v[232:235]
ds_read_b64_tr_b16 a[94:95], v30 offset:16640
v_mfma_f32_16x16x32_bf16 v[236:239], a[36:39], a[12:15], v[236:239]
ds_read_b64_tr_b16 a[96:97], v30 offset:15368
v_mfma_f32_16x16x32_bf16 v[196:199], a[36:39], a[8:11], v[196:199]
ds_read_b64_tr_b16 a[98:99], v30 offset:16648
v_mfma_f32_16x16x32_bf16 v[156:159], a[36:39], a[4:7], v[156:159]
v_mfma_f32_16x16x32_bf16 v[116:119], a[36:39], a[0:3], v[116:119]
ds_read_b64_tr_b16 a[100:101], v30 offset:15376
v_mfma_f32_16x16x32_bf16 v[120:123], a[40:43], a[0:3], v[120:123]
buffer_load_dwordx4 v18, s[32:35], s61 offen offset:2048  lds
v_mfma_f32_16x16x32_bf16 v[160:163], a[40:43], a[4:7], v[160:163]
ds_read_b64_tr_b16 a[102:103], v30 offset:16656
ds_read_b64_tr_b16 a[104:105], v30 offset:15384
v_mfma_f32_16x16x32_bf16 v[200:203], a[40:43], a[8:11], v[200:203]
ds_read_b64_tr_b16 a[106:107], v30 offset:16664
v_mfma_f32_16x16x32_bf16 v[240:243], a[40:43], a[12:15], v[240:243]
v_mfma_f32_16x16x32_bf16 v[244:247], a[44:47], a[12:15], v[244:247]
ds_read_b64_tr_b16 a[108:109], v30 offset:15392
v_mfma_f32_16x16x32_bf16 v[204:207], a[44:47], a[8:11], v[204:207]
ds_read_b64_tr_b16 a[110:111], v30 offset:16672
v_mfma_f32_16x16x32_bf16 v[164:167], a[44:47], a[4:7], v[164:167]
buffer_load_dwordx4 v19, s[32:35], s61 offen offset:3072  lds
v_mfma_f32_16x16x32_bf16 v[124:127], a[44:47], a[0:3], v[124:127]
v_mfma_f32_16x16x32_bf16 v[128:131], a[48:51], a[0:3], v[128:131]
v_mfma_f32_16x16x32_bf16 v[168:171], a[48:51], a[4:7], v[168:171]
v_mfma_f32_16x16x32_bf16 v[208:211], a[48:51], a[8:11], v[208:211]
v_mfma_f32_16x16x32_bf16 v[248:251], a[48:51], a[12:15], v[248:251]
v_mfma_f32_16x16x32_bf16 v[252:255], a[52:55], a[12:15], v[252:255]
s_add_u32 m0, s63, 4096
v_mfma_f32_16x16x32_bf16 v[212:215], a[52:55], a[8:11], v[212:215]
buffer_load_dwordx4 v20, s[32:35], s61 offen offset:0  lds
v_mfma_f32_16x16x32_bf16 v[172:175], a[52:55], a[4:7], v[172:175]
v_mfma_f32_16x16x32_bf16 v[132:135], a[52:55], a[0:3], v[132:135]
s_bitcmp1_b32 s72, 1
s_cbranch_scc1 Lcsq2
Lcrq2:
s_waitcnt lgkmcnt(0)
s_waitcnt vmcnt(13)
s_barrier
v_mfma_f32_16x16x32_bf16 v[96:99], a[72:75], a[56:59], v[96:99]
ds_read_b128 a[0:3], v26 offset:0
v_mfma_f32_16x16x32_bf16 v[136:139], a[72:75], a[60:63], v[136:139]
ds_read_b128 a[4:7], v26 offset:2048
v_mfma_f32_16x16x32_bf16 v[176:179], a[72:75], a[64:67], v[176:179]
v_mfma_f32_16x16x32_bf16 v[216:219], a[72:75], a[68:71], v[216:219]
ds_read_b128 a[8:11], v26 offset:4096
v_mfma_f32_16x16x32_bf16 v[220:223], a[76:79], a[68:71], v[220:223]
ds_read_b128 a[12:15], v26 offset:6144
s_lshr_b64 s[74:75], s[74:75], 4
v_mfma_f32_16x16x32_bf16 v[180:183], a[76:79], a[64:67], v[180:183]
s_and_b32 s13, s74, 15
s_lshl_b32 s60, s13, 7
v_mfma_f32_16x16x32_bf16 v[140:143], a[76:79], a[60:63], v[140:143]
s_mul_i32 s61, s13, 245760
s_add_u32 m0, s62, 53248
v_mfma_f32_16x16x32_bf16 v[100:103], a[76:79], a[56:59], v[100:103]
buffer_load_dwordx4 v8, s[28:31], s60 offen offset:0  lds
v_mfma_f32_16x16x32_bf16 v[104:107], a[80:83], a[56:59], v[104:107]
ds_read_b64_tr_b16 a[16:17], v32 offset:0
ds_read_b64_tr_b16 a[18:19], v32 offset:1280
v_mfma_f32_16x16x32_bf16 v[144:147], a[80:83], a[60:63], v[144:147]
ds_read_b64_tr_b16 a[20:21], v32 offset:8
ds_read_b64_tr_b16 a[22:23], v32 offset:1288
v_mfma_f32_16x16x32_bf16 v[184:187], a[80:83], a[64:67], v[184:187]
v_and_b32_e64 v90, 3, v1
v_lshlrev_b32 v90, 2, v90
v_mfma_f32_16x16x32_bf16 v[224:227], a[80:83], a[68:71], v[224:227]
buffer_load_dwordx4 v9, s[28:31], s60 offen offset:1024  lds
v_mfma_f32_16x16x32_bf16 v[228:231], a[84:87], a[68:71], v[228:231]
ds_read_b64_tr_b16 a[24:25], v32 offset:16
ds_read_b64_tr_b16 a[26:27], v32 offset:1296
v_mfma_f32_16x16x32_bf16 v[188:191], a[84:87], a[64:67], v[188:191]
ds_read_b64_tr_b16 a[28:29], v32 offset:24
v_mfma_f32_16x16x32_bf16 v[148:151], a[84:87], a[60:63], v[148:151]
ds_read_b64_tr_b16 a[30:31], v32 offset:1304
v_mfma_f32_16x16x32_bf16 v[108:111], a[84:87], a[56:59], v[108:111]
buffer_load_dwordx4 v10, s[28:31], s60 offen offset:2048  lds
v_mfma_f32_16x16x32_bf16 v[112:115], a[88:91], a[56:59], v[112:115]
ds_read_b64_tr_b16 a[32:33], v32 offset:32
ds_read_b64_tr_b16 a[34:35], v32 offset:1312
v_mfma_f32_16x16x32_bf16 v[152:155], a[88:91], a[60:63], v[152:155]
v_mfma_f32_16x16x32_bf16 v[192:195], a[88:91], a[64:67], v[192:195]
ds_read_b64_tr_b16 a[36:37], v32 offset:10240
v_mfma_f32_16x16x32_bf16 v[232:235], a[88:91], a[68:71], v[232:235]
ds_read_b64_tr_b16 a[38:39], v32 offset:11520
v_mfma_f32_16x16x32_bf16 v[236:239], a[92:95], a[68:71], v[236:239]
ds_read_b64_tr_b16 a[40:41], v32 offset:10248
v_mfma_f32_16x16x32_bf16 v[196:199], a[92:95], a[64:67], v[196:199]
buffer_load_dwordx4 v11, s[28:31], s60 offen offset:3072  lds
v_mfma_f32_16x16x32_bf16 v[156:159], a[92:95], a[60:63], v[156:159]
ds_read_b64_tr_b16 a[42:43], v32 offset:11528
v_mfma_f32_16x16x32_bf16 v[116:119], a[92:95], a[56:59], v[116:119]
ds_read_b64_tr_b16 a[44:45], v32 offset:10256
v_mfma_f32_16x16x32_bf16 v[120:123], a[96:99], a[56:59], v[120:123]
ds_read_b64_tr_b16 a[46:47], v32 offset:11536
v_mfma_f32_16x16x32_bf16 v[160:163], a[96:99], a[60:63], v[160:163]
ds_read_b64_tr_b16 a[48:49], v32 offset:10264
v_mfma_f32_16x16x32_bf16 v[200:203], a[96:99], a[64:67], v[200:203]
s_add_u32 m0, s62, 57344
v_mfma_f32_16x16x32_bf16 v[240:243], a[96:99], a[68:71], v[240:243]
buffer_load_dwordx4 v12, s[28:31], s60 offen offset:0  lds
v_mfma_f32_16x16x32_bf16 v[244:247], a[100:103], a[68:71], v[244:247]
ds_read_b64_tr_b16 a[50:51], v32 offset:11544
v_mfma_f32_16x16x32_bf16 v[204:207], a[100:103], a[64:67], v[204:207]
buffer_load_dword v91, v90, s[48:51], 0 offen sc1
v_mfma_f32_16x16x32_bf16 v[164:167], a[100:103], a[60:63], v[164:167]
ds_read_b64_tr_b16 a[52:53], v32 offset:10272
ds_read_b64_tr_b16 a[54:55], v32 offset:11552
v_mfma_f32_16x16x32_bf16 v[124:127], a[100:103], a[56:59], v[124:127]
buffer_load_dwordx4 v13, s[28:31], s60 offen offset:1024  lds
v_mfma_f32_16x16x32_bf16 v[128:131], a[104:107], a[56:59], v[128:131]
v_mfma_f32_16x16x32_bf16 v[168:171], a[104:107], a[60:63], v[168:171]
v_mfma_f32_16x16x32_bf16 v[208:211], a[104:107], a[64:67], v[208:211]
v_mfma_f32_16x16x32_bf16 v[248:251], a[104:107], a[68:71], v[248:251]
v_mfma_f32_16x16x32_bf16 v[252:255], a[108:111], a[68:71], v[252:255]
v_mfma_f32_16x16x32_bf16 v[212:215], a[108:111], a[64:67], v[212:215]
buffer_load_dwordx4 v14, s[28:31], s60 offen offset:2048  lds
v_mfma_f32_16x16x32_bf16 v[172:175], a[108:111], a[60:63], v[172:175]
v_mfma_f32_16x16x32_bf16 v[132:135], a[108:111], a[56:59], v[132:135]
s_bitcmp1_b32 s72, 1
s_cbranch_scc1 Lcsq3
Lcrq3:
s_waitcnt lgkmcnt(0)
v_mfma_f32_16x16x32_bf16 v[96:99], a[16:19], a[0:3], v[96:99]
ds_read_b128 a[56:59], v27 offset:0
v_mfma_f32_16x16x32_bf16 v[136:139], a[16:19], a[4:7], v[136:139]
ds_read_b128 a[60:63], v27 offset:2048
v_mfma_f32_16x16x32_bf16 v[176:179], a[16:19], a[8:11], v[176:179]
v_mfma_f32_16x16x32_bf16 v[216:219], a[16:19], a[12:15], v[216:219]
ds_read_b128 a[64:67], v27 offset:4096
v_mfma_f32_16x16x32_bf16 v[220:223], a[20:23], a[12:15], v[220:223]
ds_read_b128 a[68:71], v27 offset:6144
v_mfma_f32_16x16x32_bf16 v[180:183], a[20:23], a[8:11], v[180:183]
buffer_load_dwordx4 v15, s[28:31], s60 offen offset:3072  lds
v_mfma_f32_16x16x32_bf16 v[140:143], a[20:23], a[4:7], v[140:143]
ds_read_b64_tr_b16 a[72:73], v32 offset:5120
ds_read_b64_tr_b16 a[74:75], v32 offset:6400
v_mfma_f32_16x16x32_bf16 v[100:103], a[20:23], a[0:3], v[100:103]
v_mfma_f32_16x16x32_bf16 v[104:107], a[24:27], a[0:3], v[104:107]
ds_read_b64_tr_b16 a[76:77], v32 offset:5128
v_mfma_f32_16x16x32_bf16 v[144:147], a[24:27], a[4:7], v[144:147]
ds_read_b64_tr_b16 a[78:79], v32 offset:6408
v_mfma_f32_16x16x32_bf16 v[184:187], a[24:27], a[8:11], v[184:187]
ds_read_b64_tr_b16 a[80:81], v32 offset:5136
v_mfma_f32_16x16x32_bf16 v[224:227], a[24:27], a[12:15], v[224:227]
s_add_u32 m0, s63, 53248
v_mfma_f32_16x16x32_bf16 v[228:231], a[28:31], a[12:15], v[228:231]
buffer_load_dwordx4 v16, s[32:35], s61 offen offset:0  lds
v_mfma_f32_16x16x32_bf16 v[188:191], a[28:31], a[8:11], v[188:191]
ds_read_b64_tr_b16 a[82:83], v32 offset:6416
ds_read_b64_tr_b16 a[84:85], v32 offset:5144
v_mfma_f32_16x16x32_bf16 v[148:151], a[28:31], a[4:7], v[148:151]
ds_read_b64_tr_b16 a[86:87], v32 offset:6424
v_mfma_f32_16x16x32_bf16 v[108:111], a[28:31], a[0:3], v[108:111]
ds_read_b64_tr_b16 a[88:89], v32 offset:5152
v_mfma_f32_16x16x32_bf16 v[112:115], a[32:35], a[0:3], v[112:115]
ds_read_b64_tr_b16 a[90:91], v32 offset:6432
v_mfma_f32_16x16x32_bf16 v[152:155], a[32:35], a[4:7], v[152:155]
buffer_load_dwordx4 v17, s[32:35], s61 offen offset:1024  lds
v_mfma_f32_16x16x32_bf16 v[192:195], a[32:35], a[8:11], v[192:195]
ds_read_b64_tr_b16 a[92:93], v32 offset:15360
v_mfma_f32_16x16x32_bf16 v[232:235], a[32:35], a[12:15], v[232:235]
ds_read_b64_tr_b16 a[94:95], v32 offset:16640
v_mfma_f32_16x16x32_bf16 v[236:239], a[36:39], a[12:15], v[236:239]
ds_read_b64_tr_b16 a[96:97], v32 offset:15368
v_mfma_f32_16x16x32_bf16 v[196:199], a[36:39], a[8:11], v[196:199]
ds_read_b64_tr_b16 a[98:99], v32 offset:16648
v_mfma_f32_16x16x32_bf16 v[156:159], a[36:39], a[4:7], v[156:159]
v_mfma_f32_16x16x32_bf16 v[116:119], a[36:39], a[0:3], v[116:119]
ds_read_b64_tr_b16 a[100:101], v32 offset:15376
v_mfma_f32_16x16x32_bf16 v[120:123], a[40:43], a[0:3], v[120:123]
buffer_load_dwordx4 v18, s[32:35], s61 offen offset:2048  lds
v_mfma_f32_16x16x32_bf16 v[160:163], a[40:43], a[4:7], v[160:163]
ds_read_b64_tr_b16 a[102:103], v32 offset:16656
ds_read_b64_tr_b16 a[104:105], v32 offset:15384
v_mfma_f32_16x16x32_bf16 v[200:203], a[40:43], a[8:11], v[200:203]
ds_read_b64_tr_b16 a[106:107], v32 offset:16664
v_mfma_f32_16x16x32_bf16 v[240:243], a[40:43], a[12:15], v[240:243]
v_mfma_f32_16x16x32_bf16 v[244:247], a[44:47], a[12:15], v[244:247]
ds_read_b64_tr_b16 a[108:109], v32 offset:15392
v_mfma_f32_16x16x32_bf16 v[204:207], a[44:47], a[8:11], v[204:207]
ds_read_b64_tr_b16 a[110:111], v32 offset:16672
v_mfma_f32_16x16x32_bf16 v[164:167], a[44:47], a[4:7], v[164:167]
buffer_load_dwordx4 v19, s[32:35], s61 offen offset:3072  lds
v_mfma_f32_16x16x32_bf16 v[124:127], a[44:47], a[0:3], v[124:127]
v_mfma_f32_16x16x32_bf16 v[128:131], a[48:51], a[0:3], v[128:131]
v_mfma_f32_16x16x32_bf16 v[168:171], a[48:51], a[4:7], v[168:171]
v_mfma_f32_16x16x32_bf16 v[208:211], a[48:51], a[8:11], v[208:211]
v_mfma_f32_16x16x32_bf16 v[248:251], a[48:51], a[12:15], v[248:251]
v_mfma_f32_16x16x32_bf16 v[252:255], a[52:55], a[12:15], v[252:255]
s_add_u32 m0, s63, 57344
v_mfma_f32_16x16x32_bf16 v[212:215], a[52:55], a[8:11], v[212:215]
buffer_load_dwordx4 v20, s[32:35], s61 offen offset:0  lds
v_mfma_f32_16x16x32_bf16 v[172:175], a[52:55], a[4:7], v[172:175]
v_mfma_f32_16x16x32_bf16 v[132:135], a[52:55], a[0:3], v[132:135]
s_bitcmp1_b32 s72, 2
s_cbranch_scc1 Lcsq4
Lcrq4:
s_waitcnt lgkmcnt(0)
s_waitcnt vmcnt(14)
s_barrier
v_mfma_f32_16x16x32_bf16 v[96:99], a[72:75], a[56:59], v[96:99]
ds_read_b128 a[0:3], v22 offset:0
v_mfma_f32_16x16x32_bf16 v[136:139], a[72:75], a[60:63], v[136:139]
ds_read_b128 a[4:7], v22 offset:2048
v_mfma_f32_16x16x32_bf16 v[176:179], a[72:75], a[64:67], v[176:179]
v_mfma_f32_16x16x32_bf16 v[216:219], a[72:75], a[68:71], v[216:219]
ds_read_b128 a[8:11], v22 offset:4096
v_mfma_f32_16x16x32_bf16 v[220:223], a[76:79], a[68:71], v[220:223]
ds_read_b128 a[12:15], v22 offset:6144
s_lshr_b64 s[74:75], s[74:75], 4
v_mfma_f32_16x16x32_bf16 v[180:183], a[76:79], a[64:67], v[180:183]
s_and_b32 s13, s74, 15
s_lshl_b32 s60, s13, 7
v_mfma_f32_16x16x32_bf16 v[140:143], a[76:79], a[60:63], v[140:143]
s_mul_i32 s61, s13, 245760
s_add_u32 m0, s62, 106496
v_mfma_f32_16x16x32_bf16 v[100:103], a[76:79], a[56:59], v[100:103]
buffer_load_dwordx4 v8, s[28:31], s60 offen offset:0  lds
v_mfma_f32_16x16x32_bf16 v[104:107], a[80:83], a[56:59], v[104:107]
ds_read_b64_tr_b16 a[16:17], v28 offset:0
ds_read_b64_tr_b16 a[18:19], v28 offset:1280
v_mfma_f32_16x16x32_bf16 v[144:147], a[80:83], a[60:63], v[144:147]
ds_read_b64_tr_b16 a[20:21], v28 offset:8
ds_read_b64_tr_b16 a[22:23], v28 offset:1288
v_mfma_f32_16x16x32_bf16 v[184:187], a[80:83], a[64:67], v[184:187]
buffer_load_dwordx4 v9, s[28:31], s60 offen offset:1024  lds
v_mfma_f32_16x16x32_bf16 v[224:227], a[80:83], a[68:71], v[224:227]
ds_read_b64_tr_b16 a[24:25], v28 offset:16
ds_read_b64_tr_b16 a[26:27], v28 offset:1296
v_mfma_f32_16x16x32_bf16 v[228:231], a[84:87], a[68:71], v[228:231]
v_mfma_f32_16x16x32_bf16 v[188:191], a[84:87], a[64:67], v[188:191]
ds_read_b64_tr_b16 a[28:29], v28 offset:24
v_mfma_f32_16x16x32_bf16 v[148:151], a[84:87], a[60:63], v[148:151]
ds_read_b64_tr_b16 a[30:31], v28 offset:1304
v_mfma_f32_16x16x32_bf16 v[108:111], a[84:87], a[56:59], v[108:111]
buffer_load_dwordx4 v10, s[28:31], s60 offen offset:2048  lds
v_mfma_f32_16x16x32_bf16 v[112:115], a[88:91], a[56:59], v[112:115]
ds_read_b64_tr_b16 a[32:33], v28 offset:32
ds_read_b64_tr_b16 a[34:35], v28 offset:1312
v_mfma_f32_16x16x32_bf16 v[152:155], a[88:91], a[60:63], v[152:155]
v_mfma_f32_16x16x32_bf16 v[192:195], a[88:91], a[64:67], v[192:195]
ds_read_b64_tr_b16 a[36:37], v28 offset:10240
v_mfma_f32_16x16x32_bf16 v[232:235], a[88:91], a[68:71], v[232:235]
ds_read_b64_tr_b16 a[38:39], v28 offset:11520
v_mfma_f32_16x16x32_bf16 v[236:239], a[92:95], a[68:71], v[236:239]
ds_read_b64_tr_b16 a[40:41], v28 offset:10248
v_mfma_f32_16x16x32_bf16 v[196:199], a[92:95], a[64:67], v[196:199]
buffer_load_dwordx4 v11, s[28:31], s60 offen offset:3072  lds
v_mfma_f32_16x16x32_bf16 v[156:159], a[92:95], a[60:63], v[156:159]
ds_read_b64_tr_b16 a[42:43], v28 offset:11528
v_mfma_f32_16x16x32_bf16 v[116:119], a[92:95], a[56:59], v[116:119]
ds_read_b64_tr_b16 a[44:45], v28 offset:10256
v_mfma_f32_16x16x32_bf16 v[120:123], a[96:99], a[56:59], v[120:123]
ds_read_b64_tr_b16 a[46:47], v28 offset:11536
v_mfma_f32_16x16x32_bf16 v[160:163], a[96:99], a[60:63], v[160:163]
ds_read_b64_tr_b16 a[48:49], v28 offset:10264
v_mfma_f32_16x16x32_bf16 v[200:203], a[96:99], a[64:67], v[200:203]
s_add_u32 m0, s62, 110592
v_mfma_f32_16x16x32_bf16 v[240:243], a[96:99], a[68:71], v[240:243]
buffer_load_dwordx4 v12, s[28:31], s60 offen offset:0  lds
v_mfma_f32_16x16x32_bf16 v[244:247], a[100:103], a[68:71], v[244:247]
ds_read_b64_tr_b16 a[50:51], v28 offset:11544
ds_read_b64_tr_b16 a[52:53], v28 offset:10272
v_mfma_f32_16x16x32_bf16 v[204:207], a[100:103], a[64:67], v[204:207]
ds_read_b64_tr_b16 a[54:55], v28 offset:11552
v_mfma_f32_16x16x32_bf16 v[164:167], a[100:103], a[60:63], v[164:167]
v_mfma_f32_16x16x32_bf16 v[124:127], a[100:103], a[56:59], v[124:127]
buffer_load_dwordx4 v13, s[28:31], s60 offen offset:1024  lds
v_mfma_f32_16x16x32_bf16 v[128:131], a[104:107], a[56:59], v[128:131]
v_mfma_f32_16x16x32_bf16 v[168:171], a[104:107], a[60:63], v[168:171]
v_mfma_f32_16x16x32_bf16 v[208:211], a[104:107], a[64:67], v[208:211]
v_mfma_f32_16x16x32_bf16 v[248:251], a[104:107], a[68:71], v[248:251]
v_mfma_f32_16x16x32_bf16 v[252:255], a[108:111], a[68:71], v[252:255]
v_mfma_f32_16x16x32_bf16 v[212:215], a[108:111], a[64:67], v[212:215]
buffer_load_dwordx4 v14, s[28:31], s60 offen offset:2048  lds
v_mfma_f32_16x16x32_bf16 v[172:175], a[108:111], a[60:63], v[172:175]
v_mfma_f32_16x16x32_bf16 v[132:135], a[108:111], a[56:59], v[132:135]
s_bitcmp1_b32 s72, 2
s_cbranch_scc1 Lcsq5
Lcrq5:
s_waitcnt lgkmcnt(0)
v_mfma_f32_16x16x32_bf16 v[96:99], a[16:19], a[0:3], v[96:99]
ds_read_b128 a[56:59], v23 offset:0
v_mfma_f32_16x16x32_bf16 v[136:139], a[16:19], a[4:7], v[136:139]
ds_read_b128 a[60:63], v23 offset:2048
v_mfma_f32_16x16x32_bf16 v[176:179], a[16:19], a[8:11], v[176:179]
v_mfma_f32_16x16x32_bf16 v[216:219], a[16:19], a[12:15], v[216:219]
ds_read_b128 a[64:67], v23 offset:4096
v_mfma_f32_16x16x32_bf16 v[220:223], a[20:23], a[12:15], v[220:223]
ds_read_b128 a[68:71], v23 offset:6144
v_mfma_f32_16x16x32_bf16 v[180:183], a[20:23], a[8:11], v[180:183]
buffer_load_dwordx4 v15, s[28:31], s60 offen offset:3072  lds
v_mfma_f32_16x16x32_bf16 v[140:143], a[20:23], a[4:7], v[140:143]
ds_read_b64_tr_b16 a[72:73], v28 offset:5120
ds_read_b64_tr_b16 a[74:75], v28 offset:6400
v_mfma_f32_16x16x32_bf16 v[100:103], a[20:23], a[0:3], v[100:103]
v_mfma_f32_16x16x32_bf16 v[104:107], a[24:27], a[0:3], v[104:107]
ds_read_b64_tr_b16 a[76:77], v28 offset:5128
v_mfma_f32_16x16x32_bf16 v[144:147], a[24:27], a[4:7], v[144:147]
ds_read_b64_tr_b16 a[78:79], v28 offset:6408
v_mfma_f32_16x16x32_bf16 v[184:187], a[24:27], a[8:11], v[184:187]
ds_read_b64_tr_b16 a[80:81], v28 offset:5136
v_mfma_f32_16x16x32_bf16 v[224:227], a[24:27], a[12:15], v[224:227]
s_add_u32 m0, s63, 106496
v_mfma_f32_16x16x32_bf16 v[228:231], a[28:31], a[12:15], v[228:231]
buffer_load_dwordx4 v16, s[32:35], s61 offen offset:0  lds
v_mfma_f32_16x16x32_bf16 v[188:191], a[28:31], a[8:11], v[188:191]
ds_read_b64_tr_b16 a[82:83], v28 offset:6416
ds_read_b64_tr_b16 a[84:85], v28 offset:5144
v_mfma_f32_16x16x32_bf16 v[148:151], a[28:31], a[4:7], v[148:151]
ds_read_b64_tr_b16 a[86:87], v28 offset:6424
v_mfma_f32_16x16x32_bf16 v[108:111], a[28:31], a[0:3], v[108:111]
ds_read_b64_tr_b16 a[88:89], v28 offset:5152
v_mfma_f32_16x16x32_bf16 v[112:115], a[32:35], a[0:3], v[112:115]
ds_read_b64_tr_b16 a[90:91], v28 offset:6432
v_mfma_f32_16x16x32_bf16 v[152:155], a[32:35], a[4:7], v[152:155]
buffer_load_dwordx4 v17, s[32:35], s61 offen offset:1024  lds
v_mfma_f32_16x16x32_bf16 v[192:195], a[32:35], a[8:11], v[192:195]
ds_read_b64_tr_b16 a[92:93], v28 offset:15360
v_mfma_f32_16x16x32_bf16 v[232:235], a[32:35], a[12:15], v[232:235]
ds_read_b64_tr_b16 a[94:95], v28 offset:16640
v_mfma_f32_16x16x32_bf16 v[236:239], a[36:39], a[12:15], v[236:239]
ds_read_b64_tr_b16 a[96:97], v28 offset:15368
v_mfma_f32_16x16x32_bf16 v[196:199], a[36:39], a[8:11], v[196:199]
ds_read_b64_tr_b16 a[98:99], v28 offset:16648
v_mfma_f32_16x16x32_bf16 v[156:159], a[36:39], a[4:7], v[156:159]
v_mfma_f32_16x16x32_bf16 v[116:119], a[36:39], a[0:3], v[116:119]
ds_read_b64_tr_b16 a[100:101], v28 offset:15376
v_mfma_f32_16x16x32_bf16 v[120:123], a[40:43], a[0:3], v[120:123]
buffer_load_dwordx4 v18, s[32:35], s61 offen offset:2048  lds
v_mfma_f32_16x16x32_bf16 v[160:163], a[40:43], a[4:7], v[160:163]
ds_read_b64_tr_b16 a[102:103], v28 offset:16656
ds_read_b64_tr_b16 a[104:105], v28 offset:15384
v_mfma_f32_16x16x32_bf16 v[200:203], a[40:43], a[8:11], v[200:203]
ds_read_b64_tr_b16 a[106:107], v28 offset:16664
v_mfma_f32_16x16x32_bf16 v[240:243], a[40:43], a[12:15], v[240:243]
v_mfma_f32_16x16x32_bf16 v[244:247], a[44:47], a[12:15], v[244:247]
ds_read_b64_tr_b16 a[108:109], v28 offset:15392
v_mfma_f32_16x16x32_bf16 v[204:207], a[44:47], a[8:11], v[204:207]
ds_read_b64_tr_b16 a[110:111], v28 offset:16672
v_mfma_f32_16x16x32_bf16 v[164:167], a[44:47], a[4:7], v[164:167]
buffer_load_dwordx4 v19, s[32:35], s61 offen offset:3072  lds
v_mfma_f32_16x16x32_bf16 v[124:127], a[44:47], a[0:3], v[124:127]
v_mfma_f32_16x16x32_bf16 v[128:131], a[48:51], a[0:3], v[128:131]
v_mfma_f32_16x16x32_bf16 v[168:171], a[48:51], a[4:7], v[168:171]
v_mfma_f32_16x16x32_bf16 v[208:211], a[48:51], a[8:11], v[208:211]
v_mfma_f32_16x16x32_bf16 v[248:251], a[48:51], a[12:15], v[248:251]
v_mfma_f32_16x16x32_bf16 v[252:255], a[52:55], a[12:15], v[252:255]
s_add_u32 m0, s63, 110592
v_mfma_f32_16x16x32_bf16 v[212:215], a[52:55], a[8:11], v[212:215]
buffer_load_dwordx4 v20, s[32:35], s61 offen offset:0  lds
v_mfma_f32_16x16x32_bf16 v[172:175], a[52:55], a[4:7], v[172:175]
v_mfma_f32_16x16x32_bf16 v[132:135], a[52:55], a[0:3], v[132:135]
s_bitcmp1_b32 s72, 3
s_cbranch_scc1 Lcsq6
Lcrq6:
s_waitcnt lgkmcnt(0)
s_waitcnt vmcnt(13)
s_barrier
v_cmp_eq_u32 vcc, 0, v91
s_cbranch_vccz Lok5
s_mov_b32 s85, 40000
Lsp5:
buffer_load_dword v91, v90, s[48:51], 0 offen sc1
s_waitcnt vmcnt(0)
v_cmp_eq_u32 vcc, 0, v91
s_cbranch_vccz Lok5
s_sub_u32 s85, s85, 1
s_cmp_lg_u32 s85, 0
s_cbranch_scc1 Lsp5
Lok5:
v_mfma_f32_16x16x32_bf16 v[96:99], a[72:75], a[56:59], v[96:99]
ds_read_b128 a[0:3], v24 offset:0
v_mfma_f32_16x16x32_bf16 v[136:139], a[72:75], a[60:63], v[136:139]
ds_read_b128 a[4:7], v24 offset:2048
v_mfma_f32_16x16x32_bf16 v[176:179], a[72:75], a[64:67], v[176:179]
v_mfma_f32_16x16x32_bf16 v[216:219], a[72:75], a[68:71], v[216:219]
ds_read_b128 a[8:11], v24 offset:4096
v_mfma_f32_16x16x32_bf16 v[220:223], a[76:79], a[68:71], v[220:223]
ds_read_b128 a[12:15], v24 offset:6144
s_lshr_b64 s[74:75], s[74:75], 4
v_mfma_f32_16x16x32_bf16 v[180:183], a[76:79], a[64:67], v[180:183]
s_and_b32 s13, s74, 15
s_lshl_b32 s60, s13, 7
v_mfma_f32_16x16x32_bf16 v[140:143], a[76:79], a[60:63], v[140:143]
s_mul_i32 s61, s13, 245760
s_add_u32 m0, s62, 0
v_mfma_f32_16x16x32_bf16 v[100:103], a[76:79], a[56:59], v[100:103]
buffer_load_dwordx4 v8, s[28:31], s60 offen offset:0  lds
v_mfma_f32_16x16x32_bf16 v[104:107], a[80:83], a[56:59], v[104:107]
ds_read_b64_tr_b16 a[16:17], v30 offset:0
ds_read_b64_tr_b16 a[18:19], v30 offset:1280
v_mfma_f32_16x16x32_bf16 v[144:147], a[80:83], a[60:63], v[144:147]
ds_read_b64_tr_b16 a[20:21], v30 offset:8
ds_read_b64_tr_b16 a[22:23], v30 offset:1288
v_mfma_f32_16x16x32_bf16 v[184:187], a[80:83], a[64:67], v[184:187]
buffer_load_dwordx4 v9, s[28:31], s60 offen offset:1024  lds
v_mfma_f32_16x16x32_bf16 v[224:227], a[80:83], a[68:71], v[224:227]
ds_read_b64_tr_b16 a[24:25], v30 offset:16
ds_read_b64_tr_b16 a[26:27], v30 offset:1296
v_mfma_f32_16x16x32_bf16 v[228:231], a[84:87], a[68:71], v[228:231]
v_mfma_f32_16x16x32_bf16 v[188:191], a[84:87], a[64:67], v[188:191]
ds_read_b64_tr_b16 a[28:29], v30 offset:24
v_mfma_f32_16x16x32_bf16 v[148:151], a[84:87], a[60:63], v[148:151]
ds_read_b64_tr_b16 a[30:31], v30 offset:1304
v_mfma_f32_16x16x32_bf16 v[108:111], a[84:87], a[56:59], v[108:111]
buffer_load_dwordx4 v10, s[28:31], s60 offen offset:2048  lds
v_mfma_f32_16x16x32_bf16 v[112:115], a[88:91], a[56:59], v[112:115]
ds_read_b64_tr_b16 a[32:33], v30 offset:32
ds_read_b64_tr_b16 a[34:35], v30 offset:1312
v_mfma_f32_16x16x32_bf16 v[152:155], a[88:91], a[60:63], v[152:155]
v_mfma_f32_16x16x32_bf16 v[192:195], a[88:91], a[64:67], v[192:195]
ds_read_b64_tr_b16 a[36:37], v30 offset:10240
v_mfma_f32_16x16x32_bf16 v[232:235], a[88:91], a[68:71], v[232:235]
ds_read_b64_tr_b16 a[38:39], v30 offset:11520
v_mfma_f32_16x16x32_bf16 v[236:239], a[92:95], a[68:71], v[236:239]
ds_read_b64_tr_b16 a[40:41], v30 offset:10248
v_mfma_f32_16x16x32_bf16 v[196:199], a[92:95], a[64:67], v[196:199]
buffer_load_dwordx4 v11, s[28:31], s60 offen offset:3072  lds
v_mfma_f32_16x16x32_bf16 v[156:159], a[92:95], a[60:63], v[156:159]
ds_read_b64_tr_b16 a[42:43], v30 offset:11528
v_mfma_f32_16x16x32_bf16 v[116:119], a[92:95], a[56:59], v[116:119]
ds_read_b64_tr_b16 a[44:45], v30 offset:10256
v_mfma_f32_16x16x32_bf16 v[120:123], a[96:99], a[56:59], v[120:123]
ds_read_b64_tr_b16 a[46:47], v30 offset:11536
v_mfma_f32_16x16x32_bf16 v[160:163], a[96:99], a[60:63], v[160:163]
ds_read_b64_tr_b16 a[48:49], v30 offset:10264
v_mfma_f32_16x16x32_bf16 v[200:203], a[96:99], a[64:67], v[200:203]
s_add_u32 m0, s62, 4096
v_mfma_f32_16x16x32_bf16 v[240:243], a[96:99], a[68:71], v[240:243]
buffer_load_dwordx4 v12, s[28:31], s60 offen offset:0  lds
v_mfma_f32_16x16x32_bf16 v[244:247], a[100:103], a[68:71], v[244:247]
ds_read_b64_tr_b16 a[50:51], v30 offset:11544
ds_read_b64_tr_b16 a[52:53], v30 offset:10272
v_mfma_f32_16x16x32_bf16 v[204:207], a[100:103], a[64:67], v[204:207]
ds_read_b64_tr_b16 a[54:55], v30 offset:11552
v_mfma_f32_16x16x32_bf16 v[164:167], a[100:103], a[60:63], v[164:167]
v_mfma_f32_16x16x32_bf16 v[124:127], a[100:103], a[56:59], v[124:127]
buffer_load_dwordx4 v13, s[28:31], s60 offen offset:1024  lds
v_mfma_f32_16x16x32_bf16 v[128:131], a[104:107], a[56:59], v[128:131]
v_mfma_f32_16x16x32_bf16 v[168:171], a[104:107], a[60:63], v[168:171]
v_mfma_f32_16x16x32_bf16 v[208:211], a[104:107], a[64:67], v[208:211]
v_mfma_f32_16x16x32_bf16 v[248:251], a[104:107], a[68:71], v[248:251]
v_mfma_f32_16x16x32_bf16 v[252:255], a[108:111], a[68:71], v[252:255]
v_mfma_f32_16x16x32_bf16 v[212:215], a[108:111], a[64:67], v[212:215]
buffer_load_dwordx4 v14, s[28:31], s60 offen offset:2048  lds
v_mfma_f32_16x16x32_bf16 v[172:175], a[108:111], a[60:63], v[172:175]
v_mfma_f32_16x16x32_bf16 v[132:135], a[108:111], a[56:59], v[132:135]
s_bitcmp1_b32 s72, 3
s_cbranch_scc1 Lcsq7
Lcrq7:
s_waitcnt lgkmcnt(0)
v_mfma_f32_16x16x32_bf16 v[96:99], a[16:19], a[0:3], v[96:99]
ds_read_b128 a[56:59], v25 offset:0
v_mfma_f32_16x16x32_bf16 v[136:139], a[16:19], a[4:7], v[136:139]
ds_read_b128 a[60:63], v25 offset:2048
v_mfma_f32_16x16x32_bf16 v[176:179], a[16:19], a[8:11], v[176:179]
v_mfma_f32_16x16x32_bf16 v[216:219], a[16:19], a[12:15], v[216:219]
ds_read_b128 a[64:67], v25 offset:4096
v_mfma_f32_16x16x32_bf16 v[220:223], a[20:23], a[12:15], v[220:223]
ds_read_b128 a[68:71], v25 offset:6144
v_mfma_f32_16x16x32_bf16 v[180:183], a[20:23], a[8:11], v[180:183]
buffer_load_dwordx4 v15, s[28:31], s60 offen offset:3072  lds
v_mfma_f32_16x16x32_bf16 v[140:143], a[20:23], a[4:7], v[140:143]
ds_read_b64_tr_b16 a[72:73], v30 offset:5120
ds_read_b64_tr_b16 a[74:75], v30 offset:6400
v_mfma_f32_16x16x32_bf16 v[100:103], a[20:23], a[0:3], v[100:103]
v_mfma_f32_16x16x32_bf16 v[104:107], a[24:27], a[0:3], v[104:107]
ds_read_b64_tr_b16 a[76:77], v30 offset:5128
v_mfma_f32_16x16x32_bf16 v[144:147], a[24:27], a[4:7], v[144:147]
ds_read_b64_tr_b16 a[78:79], v30 offset:6408
v_mfma_f32_16x16x32_bf16 v[184:187], a[24:27], a[8:11], v[184:187]
ds_read_b64_tr_b16 a[80:81], v30 offset:5136
v_mfma_f32_16x16x32_bf16 v[224:227], a[24:27], a[12:15], v[224:227]
s_add_u32 m0, s63, 0
v_mfma_f32_16x16x32_bf16 v[228:231], a[28:31], a[12:15], v[228:231]
buffer_load_dwordx4 v16, s[32:35], s61 offen offset:0  lds
v_mfma_f32_16x16x32_bf16 v[188:191], a[28:31], a[8:11], v[188:191]
ds_read_b64_tr_b16 a[82:83], v30 offset:6416
ds_read_b64_tr_b16 a[84:85], v30 offset:5144
v_mfma_f32_16x16x32_bf16 v[148:151], a[28:31], a[4:7], v[148:151]
ds_read_b64_tr_b16 a[86:87], v30 offset:6424
v_mfma_f32_16x16x32_bf16 v[108:111], a[28:31], a[0:3], v[108:111]
ds_read_b64_tr_b16 a[88:89], v30 offset:5152
v_mfma_f32_16x16x32_bf16 v[112:115], a[32:35], a[0:3], v[112:115]
ds_read_b64_tr_b16 a[90:91], v30 offset:6432
v_mfma_f32_16x16x32_bf16 v[152:155], a[32:35], a[4:7], v[152:155]
buffer_load_dwordx4 v17, s[32:35], s61 offen offset:1024  lds
v_mfma_f32_16x16x32_bf16 v[192:195], a[32:35], a[8:11], v[192:195]
ds_read_b64_tr_b16 a[92:93], v30 offset:15360
v_mfma_f32_16x16x32_bf16 v[232:235], a[32:35], a[12:15], v[232:235]
ds_read_b64_tr_b16 a[94:95], v30 offset:16640
v_mfma_f32_16x16x32_bf16 v[236:239], a[36:39], a[12:15], v[236:239]
ds_read_b64_tr_b16 a[96:97], v30 offset:15368
v_mfma_f32_16x16x32_bf16 v[196:199], a[36:39], a[8:11], v[196:199]
ds_read_b64_tr_b16 a[98:99], v30 offset:16648
v_mfma_f32_16x16x32_bf16 v[156:159], a[36:39], a[4:7], v[156:159]
v_mfma_f32_16x16x32_bf16 v[116:119], a[36:39], a[0:3], v[116:119]
ds_read_b64_tr_b16 a[100:101], v30 offset:15376
v_mfma_f32_16x16x32_bf16 v[120:123], a[40:43], a[0:3], v[120:123]
buffer_load_dwordx4 v18, s[32:35], s61 offen offset:2048  lds
v_mfma_f32_16x16x32_bf16 v[160:163], a[40:43], a[4:7], v[160:163]
ds_read_b64_tr_b16 a[102:103], v30 offset:16656
ds_read_b64_tr_b16 a[104:105], v30 offset:15384
v_mfma_f32_16x16x32_bf16 v[200:203], a[40:43], a[8:11], v[200:203]
ds_read_b64_tr_b16 a[106:107], v30 offset:16664
v_mfma_f32_16x16x32_bf16 v[240:243], a[40:43], a[12:15], v[240:243]
v_mfma_f32_16x16x32_bf16 v[244:247], a[44:47], a[12:15], v[244:247]
ds_read_b64_tr_b16 a[108:109], v30 offset:15392
v_mfma_f32_16x16x32_bf16 v[204:207], a[44:47], a[8:11], v[204:207]
ds_read_b64_tr_b16 a[110:111], v30 offset:16672
v_mfma_f32_16x16x32_bf16 v[164:167], a[44:47], a[4:7], v[164:167]
buffer_load_dwordx4 v19, s[32:35], s61 offen offset:3072  lds
v_mfma_f32_16x16x32_bf16 v[124:127], a[44:47], a[0:3], v[124:127]
v_mfma_f32_16x16x32_bf16 v[128:131], a[48:51], a[0:3], v[128:131]
v_mfma_f32_16x16x32_bf16 v[168:171], a[48:51], a[4:7], v[168:171]
v_mfma_f32_16x16x32_bf16 v[208:211], a[48:51], a[8:11], v[208:211]
v_mfma_f32_16x16x32_bf16 v[248:251], a[48:51], a[12:15], v[248:251]
v_mfma_f32_16x16x32_bf16 v[252:255], a[52:55], a[12:15], v[252:255]
s_add_u32 m0, s63, 4096
v_mfma_f32_16x16x32_bf16 v[212:215], a[52:55], a[8:11], v[212:215]
buffer_load_dwordx4 v20, s[32:35], s61 offen offset:0  lds
v_mfma_f32_16x16x32_bf16 v[172:175], a[52:55], a[4:7], v[172:175]
v_mfma_f32_16x16x32_bf16 v[132:135], a[52:55], a[0:3], v[132:135]
s_waitcnt lgkmcnt(0)
s_waitcnt vmcnt(13)
s_barrier
v_mfma_f32_16x16x32_bf16 v[96:99], a[72:75], a[56:59], v[96:99]
ds_read_b128 a[0:3], v26 offset:0
v_mfma_f32_16x16x32_bf16 v[136:139], a[72:75], a[60:63], v[136:139]
ds_read_b128 a[4:7], v26 offset:2048
v_mfma_f32_16x16x32_bf16 v[176:179], a[72:75], a[64:67], v[176:179]
v_mfma_f32_16x16x32_bf16 v[216:219], a[72:75], a[68:71], v[216:219]
ds_read_b128 a[8:11], v26 offset:4096
v_mfma_f32_16x16x32_bf16 v[220:223], a[76:79], a[68:71], v[220:223]
ds_read_b128 a[12:15], v26 offset:6144
s_lshr_b64 s[74:75], s[74:75], 4
v_mfma_f32_16x16x32_bf16 v[180:183], a[76:79], a[64:67], v[180:183]
s_and_b32 s13, s74, 15
s_lshl_b32 s60, s13, 7
v_mfma_f32_16x16x32_bf16 v[140:143], a[76:79], a[60:63], v[140:143]
s_mul_i32 s61, s13, 245760
s_add_u32 m0, s62, 53248
v_mfma_f32_16x16x32_bf16 v[100:103], a[76:79], a[56:59], v[100:103]
buffer_load_dwordx4 v8, s[28:31], s60 offen offset:0  lds
v_mfma_f32_16x16x32_bf16 v[104:107], a[80:83], a[56:59], v[104:107]
ds_read_b64_tr_b16 a[16:17], v32 offset:0
ds_read_b64_tr_b16 a[18:19], v32 offset:1280
v_mfma_f32_16x16x32_bf16 v[144:147], a[80:83], a[60:63], v[144:147]
ds_read_b64_tr_b16 a[20:21], v32 offset:8
ds_read_b64_tr_b16 a[22:23], v32 offset:1288
v_mfma_f32_16x16x32_bf16 v[184:187], a[80:83], a[64:67], v[184:187]
s_mov_b32 s44, s8
s_mov_b32 s45, s9
v_mfma_f32_16x16x32_bf16 v[224:227], a[80:83], a[68:71], v[224:227]
s_mov_b32 s46, 25600
s_mov_b32 s47, 0x20000
v_mfma_f32_16x16x32_bf16 v[228:231], a[84:87], a[68:71], v[228:231]
buffer_load_dwordx4 v9, s[28:31], s60 offen offset:1024  lds
v_mfma_f32_16x16x32_bf16 v[188:191], a[84:87], a[64:67], v[188:191]
ds_read_b64_tr_b16 a[24:25], v32 offset:16
ds_read_b64_tr_b16 a[26:27], v32 offset:1296
v_mfma_f32_16x16x32_bf16 v[148:151], a[84:87], a[60:63], v[148:151]
ds_read_b64_tr_b16 a[28:29], v32 offset:24
ds_read_b64_tr_b16 a[30:31], v32 offset:1304
v_mfma_f32_16x16x32_bf16 v[108:111], a[84:87], a[56:59], v[108:111]
buffer_load_dwordx4 v10, s[28:31], s60 offen offset:2048  lds
v_mfma_f32_16x16x32_bf16 v[112:115], a[88:91], a[56:59], v[112:115]
ds_read_b64_tr_b16 a[32:33], v32 offset:32
ds_read_b64_tr_b16 a[34:35], v32 offset:1312
v_mfma_f32_16x16x32_bf16 v[152:155], a[88:91], a[60:63], v[152:155]
v_mfma_f32_16x16x32_bf16 v[192:195], a[88:91], a[64:67], v[192:195]
ds_read_b64_tr_b16 a[36:37], v32 offset:10240
v_mfma_f32_16x16x32_bf16 v[232:235], a[88:91], a[68:71], v[232:235]
ds_read_b64_tr_b16 a[38:39], v32 offset:11520
v_mfma_f32_16x16x32_bf16 v[236:239], a[92:95], a[68:71], v[236:239]
ds_read_b64_tr_b16 a[40:41], v32 offset:10248
v_mfma_f32_16x16x32_bf16 v[196:199], a[92:95], a[64:67], v[196:199]
buffer_load_dwordx4 v11, s[28:31], s60 offen offset:3072  lds
v_mfma_f32_16x16x32_bf16 v[156:159], a[92:95], a[60:63], v[156:159]
ds_read_b64_tr_b16 a[42:43], v32 offset:11528
v_mfma_f32_16x16x32_bf16 v[116:119], a[92:95], a[56:59], v[116:119]
ds_read_b64_tr_b16 a[44:45], v32 offset:10256
v_mfma_f32_16x16x32_bf16 v[120:123], a[96:99], a[56:59], v[120:123]
ds_read_b64_tr_b16 a[46:47], v32 offset:11536
v_mfma_f32_16x16x32_bf16 v[160:163], a[96:99], a[60:63], v[160:163]
ds_read_b64_tr_b16 a[48:49], v32 offset:10264
v_mfma_f32_16x16x32_bf16 v[200:203], a[96:99], a[64:67], v[200:203]
s_add_u32 m0, s62, 57344
v_mfma_f32_16x16x32_bf16 v[240:243], a[96:99], a[68:71], v[240:243]
buffer_load_dwordx4 v12, s[28:31], s60 offen offset:0  lds
v_mfma_f32_16x16x32_bf16 v[244:247], a[100:103], a[68:71], v[244:247]
ds_read_b64_tr_b16 a[50:51], v32 offset:11544
v_mfma_f32_16x16x32_bf16 v[204:207], a[100:103], a[64:67], v[204:207]
s_mul_i32 s64, s27, 800
s_mov_b32 s66, m0
s_mov_b32 m0, 159744
s_mov_b32 exec_hi, 0x3ffff
buffer_load_dwordx4 v6, s[44:47], s64 offen lds
s_mov_b32 exec_hi, -1
s_mov_b32 m0, s66
v_mfma_f32_16x16x32_bf16 v[164:167], a[100:103], a[60:63], v[164:167]
ds_read_b64_tr_b16 a[52:53], v32 offset:10272
ds_read_b64_tr_b16 a[54:55], v32 offset:11552
v_mfma_f32_16x16x32_bf16 v[124:127], a[100:103], a[56:59], v[124:127]
buffer_load_dwordx4 v13, s[28:31], s60 offen offset:1024  lds
v_mfma_f32_16x16x32_bf16 v[128:131], a[104:107], a[56:59], v[128:131]
v_mfma_f32_16x16x32_bf16 v[168:171], a[104:107], a[60:63], v[168:171]
v_mfma_f32_16x16x32_bf16 v[208:211], a[104:107], a[64:67], v[208:211]
v_mfma_f32_16x16x32_bf16 v[248:251], a[104:107], a[68:71], v[248:251]
v_mfma_f32_16x16x32_bf16 v[252:255], a[108:111], a[68:71], v[252:255]
v_mfma_f32_16x16x32_bf16 v[212:215], a[108:111], a[64:67], v[212:215]
buffer_load_dwordx4 v14, s[28:31], s60 offen offset:2048  lds
v_mfma_f32_16x16x32_bf16 v[172:175], a[108:111], a[60:63], v[172:175]
v_mfma_f32_16x16x32_bf16 v[132:135], a[108:111], a[56:59], v[132:135]
s_waitcnt lgkmcnt(0)
v_mfma_f32_16x16x32_bf16 v[96:99], a[16:19], a[0:3], v[96:99]
ds_read_b128 a[56:59], v27 offset:0
v_mfma_f32_16x16x32_bf16 v[136:139], a[16:19], a[4:7], v[136:139]
ds_read_b128 a[60:63], v27 offset:2048
v_mfma_f32_16x16x32_bf16 v[176:179], a[16:19], a[8:11], v[176:179]
v_mfma_f32_16x16x32_bf16 v[216:219], a[16:19], a[12:15], v[216:219]
ds_read_b128 a[64:67], v27 offset:4096
v_mfma_f32_16x16x32_bf16 v[220:223], a[20:23], a[12:15], v[220:223]
ds_read_b128 a[68:71], v27 offset:6144
v_mfma_f32_16x16x32_bf16 v[180:183], a[20:23], a[8:11], v[180:183]
buffer_load_dwordx4 v15, s[28:31], s60 offen offset:3072  lds
ds_read_b64_tr_b16 a[72:73], v32 offset:5120
v_mfma_f32_16x16x32_bf16 v[140:143], a[20:23], a[4:7], v[140:143]
ds_read_b64_tr_b16 a[74:75], v32 offset:6400
v_mfma_f32_16x16x32_bf16 v[100:103], a[20:23], a[0:3], v[100:103]
v_mfma_f32_16x16x32_bf16 v[104:107], a[24:27], a[0:3], v[104:107]
ds_read_b64_tr_b16 a[76:77], v32 offset:5128
v_mfma_f32_16x16x32_bf16 v[144:147], a[24:27], a[4:7], v[144:147]
ds_read_b64_tr_b16 a[78:79], v32 offset:6408
v_mfma_f32_16x16x32_bf16 v[184:187], a[24:27], a[8:11], v[184:187]
ds_read_b64_tr_b16 a[80:81], v32 offset:5136
v_mfma_f32_16x16x32_bf16 v[224:227], a[24:27], a[12:15], v[224:227]
s_add_u32 m0, s63, 53248
v_mfma_f32_16x16x32_bf16 v[228:231], a[28:31], a[12:15], v[228:231]
buffer_load_dwordx4 v16, s[32:35], s61 offen offset:0  lds
ds_read_b64_tr_b16 a[82:83], v32 offset:6416
v_mfma_f32_16x16x32_bf16 v[188:191], a[28:31], a[8:11], v[188:191]
ds_read_b64_tr_b16 a[84:85], v32 offset:5144
v_mfma_f32_16x16x32_bf16 v[148:151], a[28:31], a[4:7], v[148:151]
ds_read_b64_tr_b16 a[86:87], v32 offset:6424
v_mfma_f32_16x16x32_bf16 v[108:111], a[28:31], a[0:3], v[108:111]
ds_read_b64_tr_b16 a[88:89], v32 offset:5152
v_mfma_f32_16x16x32_bf16 v[112:115], a[32:35], a[0:3], v[112:115]
ds_read_b64_tr_b16 a[90:91], v32 offset:6432
v_mfma_f32_16x16x32_bf16 v[152:155], a[32:35], a[4:7], v[152:155]
buffer_load_dwordx4 v17, s[32:35], s61 offen offset:1024  lds
v_mfma_f32_16x16x32_bf16 v[192:195], a[32:35], a[8:11], v[192:195]
ds_read_b64_tr_b16 a[92:93], v32 offset:15360
v_mov_b32 v4, s57
s_and_b32 s65, s72, 15
v_mfma_f32_16x16x32_bf16 v[232:235], a[32:35], a[12:15], v[232:235]
v_mov_b32 v5, s65
s_add_u32 s64, s59, 8
s_mul_i32 s64, s64, 1280
v_mfma_f32_16x16x32_bf16 v[236:239], a[36:39], a[12:15], v[236:239]
s_add_u32 s64, s64, 17088512
v_lshlrev_b32 v2, 2, v1
v_lshrrev_b32 v3, v2, v4
v_mfma_f32_16x16x32_bf16 v[196:199], a[36:39], a[8:11], v[196:199]
v_and_b32_e64 v3, 15, v3
v_lshl_add_u32 v3, v3, 7, s64
v_lshrrev_b32_e64 v5, v1, v5
v_mfma_f32_16x16x32_bf16 v[156:159], a[36:39], a[4:7], v[156:159]
v_and_b32 v5, 1, v5
v_cmp_eq_u32 vcc, 1, v5
v_mov_b32 v5, 0x7f000000
v_mfma_f32_16x16x32_bf16 v[116:119], a[36:39], a[0:3], v[116:119]
v_min_u32 v2, 4, v1
v_cndmask_b32 v87, v5, v3, vcc
v_cmp_gt_u32 vcc, 4, v1
v_mfma_f32_16x16x32_bf16 v[120:123], a[40:43], a[0:3], v[120:123]
s_nop 0
v_mov_b32 v5, 0x7f000000
v_cndmask_b32_e64 v87, v5, v87, vcc
v_mfma_f32_16x16x32_bf16 v[160:163], a[40:43], a[4:7], v[160:163]
v_and_b32 v2, 15, v1
v_min_u32 v3, 9, v2
v_lshl_add_u32 v3, v3, 7, s64
v_mfma_f32_16x16x32_bf16 v[200:203], a[40:43], a[8:11], v[200:203]
s_mul_i32 s65, s58, 16
v_min_u32 v2, 15, v2
v_add_u32_e64 v2, s65, v2
v_mfma_f32_16x16x32_bf16 v[240:243], a[40:43], a[12:15], v[240:243]
v_min_u32 v2, 127, v2
v_lshlrev_b32_e64 v2, 7, v2
v_add_u32 v2, 17072128, v2
v_mfma_f32_16x16x32_bf16 v[244:247], a[44:47], a[12:15], v[244:247]
v_and_b32_e64 v5, 16, v1
v_cmp_eq_u32 vcc, 0, v5
s_nop 1
v_mfma_f32_16x16x32_bf16 v[204:207], a[44:47], a[8:11], v[204:207]
v_cndmask_b32_e64 v89, v3, v2, vcc
s_mul_i32 s65, s96, 5
s_lshr_b32 s65, s65, 2
v_mfma_f32_16x16x32_bf16 v[164:167], a[44:47], a[4:7], v[164:167]
s_mul_i32 s65, s65, 2176
s_add_u32 s65, s65, 17379328
v_min_u32_e64 v2, 33, v1
v_mfma_f32_16x16x32_bf16 v[124:127], a[44:47], a[0:3], v[124:127]
v_lshl_add_u32 v88, v2, 7, s65
s_lshr_b32 s65, s27, 2
s_mul_i32 s65, s65, 27
v_mfma_f32_16x16x32_bf16 v[128:131], a[48:51], a[0:3], v[128:131]
s_lshr_b32 s65, s65, 1
v_min_u32 v2, 14, v1
v_add_u32_e64 v2, s65, v2
v_mfma_f32_16x16x32_bf16 v[168:171], a[48:51], a[4:7], v[168:171]
v_min_u32 v2, 107, v2
s_mov_b32 s65, 17379328
v_lshl_add_u32 v85, v2, 7, s65
v_mfma_f32_16x16x32_bf16 v[208:211], a[48:51], a[8:11], v[208:211]
ds_read_b64_tr_b16 a[94:95], v32 offset:16640
ds_read_b64_tr_b16 a[96:97], v32 offset:15368
ds_read_b64_tr_b16 a[98:99], v32 offset:16648
v_mfma_f32_16x16x32_bf16 v[248:251], a[48:51], a[12:15], v[248:251]
ds_read_b64_tr_b16 a[100:101], v32 offset:15376
buffer_load_dwordx4 v18, s[32:35], s61 offen offset:2048  lds
v_mfma_f32_16x16x32_bf16 v[252:255], a[52:55], a[12:15], v[252:255]
ds_read_b64_tr_b16 a[102:103], v32 offset:16656
ds_read_b64_tr_b16 a[104:105], v32 offset:15384
ds_read_b64_tr_b16 a[106:107], v32 offset:16664
v_mfma_f32_16x16x32_bf16 v[212:215], a[52:55], a[8:11], v[212:215]
ds_read_b64_tr_b16 a[108:109], v32 offset:15392
ds_read_b64_tr_b16 a[110:111], v32 offset:16672
v_mfma_f32_16x16x32_bf16 v[172:175], a[52:55], a[4:7], v[172:175]
buffer_load_dwordx4 v19, s[32:35], s61 offen offset:3072  lds
s_add_u32 m0, s63, 57344
v_mfma_f32_16x16x32_bf16 v[132:135], a[52:55], a[0:3], v[132:135]
buffer_load_dwordx4 v20, s[32:35], s61 offen offset:0  lds
s_waitcnt lgkmcnt(0)
s_waitcnt vmcnt(14)
s_barrier
s_cmp_eq_u32 s56, 0
s_cbranch_scc0 Lw0_6
buffer_store_dword v21, v87, s[40:43], 0 offen sc1
Lw0_6:
v_mfma_f32_16x16x32_bf16 v[96:99], a[72:75], a[56:59], v[96:99]
ds_read_b128 a[0:3], v22 offset:0
v_mfma_f32_16x16x32_bf16 v[136:139], a[72:75], a[60:63], v[136:139]
ds_read_b128 a[4:7], v22 offset:2048
v_mfma_f32_16x16x32_bf16 v[176:179], a[72:75], a[64:67], v[176:179]
v_mfma_f32_16x16x32_bf16 v[216:219], a[72:75], a[68:71], v[216:219]
ds_read_b128 a[8:11], v22 offset:4096
v_mfma_f32_16x16x32_bf16 v[220:223], a[76:79], a[68:71], v[220:223]
ds_read_b128 a[12:15], v22 offset:6144
s_lshr_b64 s[74:75], s[74:75], 4
v_mfma_f32_16x16x32_bf16 v[180:183], a[76:79], a[64:67], v[180:183]
s_and_b32 s13, s74, 15
s_lshl_b32 s60, s13, 7
v_mfma_f32_16x16x32_bf16 v[140:143], a[76:79], a[60:63], v[140:143]
s_mul_i32 s61, s13, 245760
s_add_u32 m0, s62, 106496
v_mfma_f32_16x16x32_bf16 v[100:103], a[76:79], a[56:59], v[100:103]
buffer_load_dwordx4 v8, s[28:31], s60 offen offset:0  lds
v_mfma_f32_16x16x32_bf16 v[104:107], a[80:83], a[56:59], v[104:107]
ds_read_b64_tr_b16 a[16:17], v28 offset:0
ds_read_b64_tr_b16 a[18:19], v28 offset:1280
v_mfma_f32_16x16x32_bf16 v[144:147], a[80:83], a[60:63], v[144:147]
ds_read_b64_tr_b16 a[20:21], v28 offset:8
ds_read_b64_tr_b16 a[22:23], v28 offset:1288
v_mfma_f32_16x16x32_bf16 v[184:187], a[80:83], a[64:67], v[184:187]
buffer_load_dwordx4 v9, s[28:31], s60 offen offset:1024  lds
v_mfma_f32_16x16x32_bf16 v[224:227], a[80:83], a[68:71], v[224:227]
ds_read_b64_tr_b16 a[24:25], v28 offset:16
ds_read_b64_tr_b16 a[26:27], v28 offset:1296
v_mfma_f32_16x16x32_bf16 v[228:231], a[84:87], a[68:71], v[228:231]
v_mfma_f32_16x16x32_bf16 v[188:191], a[84:87], a[64:67], v[188:191]
ds_read_b64_tr_b16 a[28:29], v28 offset:24
v_mfma_f32_16x16x32_bf16 v[148:151], a[84:87], a[60:63], v[148:151]
ds_read_b64_tr_b16 a[30:31], v28 offset:1304
v_mfma_f32_16x16x32_bf16 v[108:111], a[84:87], a[56:59], v[108:111]
buffer_load_dwordx4 v10, s[28:31], s60 offen offset:2048  lds
v_mfma_f32_16x16x32_bf16 v[112:115], a[88:91], a[56:59], v[112:115]
ds_read_b64_tr_b16 a[32:33], v28 offset:32
ds_read_b64_tr_b16 a[34:35], v28 offset:1312
v_mfma_f32_16x16x32_bf16 v[152:155], a[88:91], a[60:63], v[152:155]
v_mfma_f32_16x16x32_bf16 v[192:195], a[88:91], a[64:67], v[192:195]
ds_read_b64_tr_b16 a[36:37], v28 offset:10240
v_mfma_f32_16x16x32_bf16 v[232:235], a[88:91], a[68:71], v[232:235]
ds_read_b64_tr_b16 a[38:39], v28 offset:11520
v_mfma_f32_16x16x32_bf16 v[236:239], a[92:95], a[68:71], v[236:239]
ds_read_b64_tr_b16 a[40:41], v28 offset:10248
v_mfma_f32_16x16x32_bf16 v[196:199], a[92:95], a[64:67], v[196:199]
buffer_load_dwordx4 v11, s[28:31], s60 offen offset:3072  lds
v_mfma_f32_16x16x32_bf16 v[156:159], a[92:95], a[60:63], v[156:159]
ds_read_b64_tr_b16 a[42:43], v28 offset:11528
v_mfma_f32_16x16x32_bf16 v[116:119], a[92:95], a[56:59], v[116:119]
ds_read_b64_tr_b16 a[44:45], v28 offset:10256
v_mfma_f32_16x16x32_bf16 v[120:123], a[96:99], a[56:59], v[120:123]
ds_read_b64_tr_b16 a[46:47], v28 offset:11536
v_mfma_f32_16x16x32_bf16 v[160:163], a[96:99], a[60:63], v[160:163]
ds_read_b64_tr_b16 a[48:49], v28 offset:10264
v_mfma_f32_16x16x32_bf16 v[200:203], a[96:99], a[64:67], v[200:203]
s_add_u32 m0, s62, 110592
v_mfma_f32_16x16x32_bf16 v[240:243], a[96:99], a[68:71], v[240:243]
buffer_load_dwordx4 v12, s[28:31], s60 offen offset:0  lds
v_mfma_f32_16x16x32_bf16 v[244:247], a[100:103], a[68:71], v[244:247]
ds_read_b64_tr_b16 a[50:51], v28 offset:11544
ds_read_b64_tr_b16 a[52:53], v28 offset:10272
v_mfma_f32_16x16x32_bf16 v[204:207], a[100:103], a[64:67], v[204:207]
ds_read_b64_tr_b16 a[54:55], v28 offset:11552
v_mfma_f32_16x16x32_bf16 v[164:167], a[100:103], a[60:63], v[164:167]
v_mfma_f32_16x16x32_bf16 v[124:127], a[100:103], a[56:59], v[124:127]
buffer_load_dwordx4 v13, s[28:31], s60 offen offset:1024  lds
v_mfma_f32_16x16x32_bf16 v[128:131], a[104:107], a[56:59], v[128:131]
v_mfma_f32_16x16x32_bf16 v[168:171], a[104:107], a[60:63], v[168:171]
v_mfma_f32_16x16x32_bf16 v[208:211], a[104:107], a[64:67], v[208:211]
v_mfma_f32_16x16x32_bf16 v[248:251], a[104:107], a[68:71], v[248:251]
v_mfma_f32_16x16x32_bf16 v[252:255], a[108:111], a[68:71], v[252:255]
v_mfma_f32_16x16x32_bf16 v[212:215], a[108:111], a[64:67], v[212:215]
buffer_load_dwordx4 v14, s[28:31], s60 offen offset:2048  lds
v_mfma_f32_16x16x32_bf16 v[172:175], a[108:111], a[60:63], v[172:175]
v_mfma_f32_16x16x32_bf16 v[132:135], a[108:111], a[56:59], v[132:135]
s_waitcnt lgkmcnt(0)
v_mfma_f32_16x16x32_bf16 v[96:99], a[16:19], a[0:3], v[96:99]
ds_read_b128 a[56:59], v23 offset:0
v_mfma_f32_16x16x32_bf16 v[136:139], a[16:19], a[4:7], v[136:139]
ds_read_b128 a[60:63], v23 offset:2048
v_mfma_f32_16x16x32_bf16 v[176:179], a[16:19], a[8:11], v[176:179]
v_mfma_f32_16x16x32_bf16 v[216:219], a[16:19], a[12:15], v[216:219]
ds_read_b128 a[64:67], v23 offset:4096
v_mfma_f32_16x16x32_bf16 v[220:223], a[20:23], a[12:15], v[220:223]
ds_read_b128 a[68:71], v23 offset:6144
v_mfma_f32_16x16x32_bf16 v[180:183], a[20:23], a[8:11], v[180:183]
buffer_load_dwordx4 v15, s[28:31], s60 offen offset:3072  lds
v_mfma_f32_16x16x32_bf16 v[140:143], a[20:23], a[4:7], v[140:143]
ds_read_b64_tr_b16 a[72:73], v28 offset:5120
ds_read_b64_tr_b16 a[74:75], v28 offset:6400
v_mfma_f32_16x16x32_bf16 v[100:103], a[20:23], a[0:3], v[100:103]
v_mfma_f32_16x16x32_bf16 v[104:107], a[24:27], a[0:3], v[104:107]
ds_read_b64_tr_b16 a[76:77], v28 offset:5128
v_mfma_f32_16x16x32_bf16 v[144:147], a[24:27], a[4:7], v[144:147]
ds_read_b64_tr_b16 a[78:79], v28 offset:6408
v_mfma_f32_16x16x32_bf16 v[184:187], a[24:27], a[8:11], v[184:187]
ds_read_b64_tr_b16 a[80:81], v28 offset:5136
v_mfma_f32_16x16x32_bf16 v[224:227], a[24:27], a[12:15], v[224:227]
s_add_u32 m0, s63, 106496
v_mfma_f32_16x16x32_bf16 v[228:231], a[28:31], a[12:15], v[228:231]
buffer_load_dwordx4 v16, s[32:35], s61 offen offset:0  lds
v_mfma_f32_16x16x32_bf16 v[188:191], a[28:31], a[8:11], v[188:191]
ds_read_b64_tr_b16 a[82:83], v28 offset:6416
ds_read_b64_tr_b16 a[84:85], v28 offset:5144
v_mfma_f32_16x16x32_bf16 v[148:151], a[28:31], a[4:7], v[148:151]
ds_read_b64_tr_b16 a[86:87], v28 offset:6424
v_mfma_f32_16x16x32_bf16 v[108:111], a[28:31], a[0:3], v[108:111]
ds_read_b64_tr_b16 a[88:89], v28 offset:5152
v_mfma_f32_16x16x32_bf16 v[112:115], a[32:35], a[0:3], v[112:115]
ds_read_b64_tr_b16 a[90:91], v28 offset:6432
v_mfma_f32_16x16x32_bf16 v[152:155], a[32:35], a[4:7], v[152:155]
buffer_load_dwordx4 v17, s[32:35], s61 offen offset:1024  lds
v_mfma_f32_16x16x32_bf16 v[192:195], a[32:35], a[8:11], v[192:195]
ds_read_b64_tr_b16 a[92:93], v28 offset:15360
s_lshr_b32 s64, s27, 3
v_mfma_f32_16x16x32_bf16 v[232:235], a[32:35], a[12:15], v[232:235]
s_lshl_b32 s64, s64, 12
s_add_u32 s97, s64, 17199104
v_mfma_f32_16x16x32_bf16 v[236:239], a[36:39], a[12:15], v[236:239]
s_mul_i32 s64, s95, 52429
s_lshr_b32 s64, s64, 17
v_mfma_f32_16x16x32_bf16 v[196:199], a[36:39], a[8:11], v[196:199]
s_lshl_b32 s65, s95, 6
s_add_u32 s65, s65, 63
v_mfma_f32_16x16x32_bf16 v[156:159], a[36:39], a[4:7], v[156:159]
s_mul_i32 s65, s65, 52429
s_lshr_b32 s65, s65, 23
v_mfma_f32_16x16x32_bf16 v[116:119], a[36:39], a[0:3], v[116:119]
s_sub_u32 s65, s65, s64
s_mul_i32 s77, s65, 384
v_mfma_f32_16x16x32_bf16 v[120:123], a[40:43], a[0:3], v[120:123]
s_mul_i32 s64, s64, 48
s_mul_i32 s66, s56, 12
v_mfma_f32_16x16x32_bf16 v[160:163], a[40:43], a[4:7], v[160:163]
s_add_u32 s64, s64, s66
s_lshl_b32 s64, s64, 7
v_mfma_f32_16x16x32_bf16 v[200:203], a[40:43], a[8:11], v[200:203]
s_add_u32 s98, s64, 17119232
s_mul_i32 s64, s27, 81920
v_mfma_f32_16x16x32_bf16 v[240:243], a[40:43], a[12:15], v[240:243]
s_add_u32 s99, s64, 12582912
s_min_u32 s76, s26, 127
v_mfma_f32_16x16x32_bf16 v[244:247], a[44:47], a[12:15], v[244:247]
s_lshl_b32 s76, s76, 4
ds_read_b64_tr_b16 a[94:95], v28 offset:16640
v_mfma_f32_16x16x32_bf16 v[204:207], a[44:47], a[8:11], v[204:207]
ds_read_b64_tr_b16 a[96:97], v28 offset:15368
ds_read_b64_tr_b16 a[98:99], v28 offset:16648
v_mfma_f32_16x16x32_bf16 v[164:167], a[44:47], a[4:7], v[164:167]
ds_read_b64_tr_b16 a[100:101], v28 offset:15376
v_mfma_f32_16x16x32_bf16 v[124:127], a[44:47], a[0:3], v[124:127]
buffer_load_dwordx4 v18, s[32:35], s61 offen offset:2048  lds
v_mfma_f32_16x16x32_bf16 v[128:131], a[48:51], a[0:3], v[128:131]
ds_read_b64_tr_b16 a[102:103], v28 offset:16656
ds_read_b64_tr_b16 a[104:105], v28 offset:15384
v_mfma_f32_16x16x32_bf16 v[168:171], a[48:51], a[4:7], v[168:171]
ds_read_b64_tr_b16 a[106:107], v28 offset:16664
ds_read_b64_tr_b16 a[108:109], v28 offset:15392
v_mfma_f32_16x16x32_bf16 v[208:211], a[48:51], a[8:11], v[208:211]
ds_read_b64_tr_b16 a[110:111], v28 offset:16672
v_mfma_f32_16x16x32_bf16 v[248:251], a[48:51], a[12:15], v[248:251]
buffer_load_dwordx4 v19, s[32:35], s61 offen offset:3072  lds
v_mfma_f32_16x16x32_bf16 v[252:255], a[52:55], a[12:15], v[252:255]
s_add_u32 m0, s63, 110592
v_mfma_f32_16x16x32_bf16 v[212:215], a[52:55], a[8:11], v[212:215]
buffer_load_dwordx4 v20, s[32:35], s61 offen offset:0  lds
v_mfma_f32_16x16x32_bf16 v[172:175], a[52:55], a[4:7], v[172:175]
v_mfma_f32_16x16x32_bf16 v[132:135], a[52:55], a[0:3], v[132:135]
s_waitcnt lgkmcnt(0)
s_waitcnt vmcnt(13)
s_barrier
v_mfma_f32_16x16x32_bf16 v[96:99], a[72:75], a[56:59], v[96:99]
ds_read_b128 a[0:3], v24 offset:0
v_mfma_f32_16x16x32_bf16 v[136:139], a[72:75], a[60:63], v[136:139]
ds_read_b128 a[4:7], v24 offset:2048
v_mfma_f32_16x16x32_bf16 v[176:179], a[72:75], a[64:67], v[176:179]
v_mfma_f32_16x16x32_bf16 v[216:219], a[72:75], a[68:71], v[216:219]
ds_read_b128 a[8:11], v24 offset:4096
v_mfma_f32_16x16x32_bf16 v[220:223], a[76:79], a[68:71], v[220:223]
ds_read_b128 a[12:15], v24 offset:6144
s_lshr_b64 s[74:75], s[74:75], 4
v_mfma_f32_16x16x32_bf16 v[180:183], a[76:79], a[64:67], v[180:183]
s_and_b32 s13, s74, 15
s_lshl_b32 s60, s13, 7
v_mfma_f32_16x16x32_bf16 v[140:143], a[76:79], a[60:63], v[140:143]
s_mul_i32 s61, s13, 245760
s_add_u32 m0, s62, 0
v_mfma_f32_16x16x32_bf16 v[100:103], a[76:79], a[56:59], v[100:103]
buffer_load_dwordx4 v8, s[28:31], s60 offen offset:0  lds
v_mfma_f32_16x16x32_bf16 v[104:107], a[80:83], a[56:59], v[104:107]
ds_read_b64_tr_b16 a[16:17], v30 offset:0
ds_read_b64_tr_b16 a[18:19], v30 offset:1280
v_mfma_f32_16x16x32_bf16 v[144:147], a[80:83], a[60:63], v[144:147]
ds_read_b64_tr_b16 a[20:21], v30 offset:8
ds_read_b64_tr_b16 a[22:23], v30 offset:1288
v_mfma_f32_16x16x32_bf16 v[184:187], a[80:83], a[64:67], v[184:187]
buffer_load_dwordx4 v9, s[28:31], s60 offen offset:1024  lds
v_mfma_f32_16x16x32_bf16 v[224:227], a[80:83], a[68:71], v[224:227]
ds_read_b64_tr_b16 a[24:25], v30 offset:16
ds_read_b64_tr_b16 a[26:27], v30 offset:1296
v_mfma_f32_16x16x32_bf16 v[228:231], a[84:87], a[68:71], v[228:231]
v_mfma_f32_16x16x32_bf16 v[188:191], a[84:87], a[64:67], v[188:191]
ds_read_b64_tr_b16 a[28:29], v30 offset:24
v_mfma_f32_16x16x32_bf16 v[148:151], a[84:87], a[60:63], v[148:151]
ds_read_b64_tr_b16 a[30:31], v30 offset:1304
v_mfma_f32_16x16x32_bf16 v[108:111], a[84:87], a[56:59], v[108:111]
buffer_load_dwordx4 v10, s[28:31], s60 offen offset:2048  lds
v_mfma_f32_16x16x32_bf16 v[112:115], a[88:91], a[56:59], v[112:115]
ds_read_b64_tr_b16 a[32:33], v30 offset:32
ds_read_b64_tr_b16 a[34:35], v30 offset:1312
v_mfma_f32_16x16x32_bf16 v[152:155], a[88:91], a[60:63], v[152:155]
v_mfma_f32_16x16x32_bf16 v[192:195], a[88:91], a[64:67], v[192:195]
ds_read_b64_tr_b16 a[36:37], v30 offset:10240
v_mfma_f32_16x16x32_bf16 v[232:235], a[88:91], a[68:71], v[232:235]
ds_read_b64_tr_b16 a[38:39], v30 offset:11520
v_mfma_f32_16x16x32_bf16 v[236:239], a[92:95], a[68:71], v[236:239]
ds_read_b64_tr_b16 a[40:41], v30 offset:10248
v_mfma_f32_16x16x32_bf16 v[196:199], a[92:95], a[64:67], v[196:199]
buffer_load_dwordx4 v11, s[28:31], s60 offen offset:3072  lds
v_mfma_f32_16x16x32_bf16 v[156:159], a[92:95], a[60:63], v[156:159]
ds_read_b64_tr_b16 a[42:43], v30 offset:11528
v_mfma_f32_16x16x32_bf16 v[116:119], a[92:95], a[56:59], v[116:119]
ds_read_b64_tr_b16 a[44:45], v30 offset:10256
v_mfma_f32_16x16x32_bf16 v[120:123], a[96:99], a[56:59], v[120:123]
ds_read_b64_tr_b16 a[46:47], v30 offset:11536
v_mfma_f32_16x16x32_bf16 v[160:163], a[96:99], a[60:63], v[160:163]
ds_read_b64_tr_b16 a[48:49], v30 offset:10264
v_mfma_f32_16x16x32_bf16 v[200:203], a[96:99], a[64:67], v[200:203]
s_add_u32 m0, s62, 4096
v_mfma_f32_16x16x32_bf16 v[240:243], a[96:99], a[68:71], v[240:243]
buffer_load_dwordx4 v12, s[28:31], s60 offen offset:0  lds
v_mfma_f32_16x16x32_bf16 v[244:247], a[100:103], a[68:71], v[244:247]
ds_read_b64_tr_b16 a[50:51], v30 offset:11544
ds_read_b64_tr_b16 a[52:53], v30 offset:10272
v_mfma_f32_16x16x32_bf16 v[204:207], a[100:103], a[64:67], v[204:207]
ds_read_b64_tr_b16 a[54:55], v30 offset:11552
v_mfma_f32_16x16x32_bf16 v[164:167], a[100:103], a[60:63], v[164:167]
v_mfma_f32_16x16x32_bf16 v[124:127], a[100:103], a[56:59], v[124:127]
buffer_load_dwordx4 v13, s[28:31], s60 offen offset:1024  lds
v_mfma_f32_16x16x32_bf16 v[128:131], a[104:107], a[56:59], v[128:131]
v_mfma_f32_16x16x32_bf16 v[168:171], a[104:107], a[60:63], v[168:171]
v_mfma_f32_16x16x32_bf16 v[208:211], a[104:107], a[64:67], v[208:211]
v_mfma_f32_16x16x32_bf16 v[248:251], a[104:107], a[68:71], v[248:251]
v_mfma_f32_16x16x32_bf16 v[252:255], a[108:111], a[68:71], v[252:255]
v_mfma_f32_16x16x32_bf16 v[212:215], a[108:111], a[64:67], v[212:215]
buffer_load_dwordx4 v14, s[28:31], s60 offen offset:2048  lds
v_mfma_f32_16x16x32_bf16 v[172:175], a[108:111], a[60:63], v[172:175]
v_mfma_f32_16x16x32_bf16 v[132:135], a[108:111], a[56:59], v[132:135]
s_waitcnt lgkmcnt(0)
v_mfma_f32_16x16x32_bf16 v[96:99], a[16:19], a[0:3], v[96:99]
ds_read_b128 a[56:59], v25 offset:0
v_mfma_f32_16x16x32_bf16 v[136:139], a[16:19], a[4:7], v[136:139]
ds_read_b128 a[60:63], v25 offset:2048
v_mfma_f32_16x16x32_bf16 v[176:179], a[16:19], a[8:11], v[176:179]
s_mov_b32 s64, 159744
v_bfe_u32 v2, v1, 2, 2
v_mfma_f32_16x16x32_bf16 v[216:219], a[16:19], a[12:15], v[216:219]
v_mul_u32_u24 v2, 10, v2
v_lshrrev_b32_e64 v3, 4, v1
v_mfma_f32_16x16x32_bf16 v[220:223], a[20:23], a[12:15], v[220:223]
v_mul_u32_u24 v4, 320, v3
v_add3_u32 v2, v2, v4, s64
v_mfma_f32_16x16x32_bf16 v[180:183], a[20:23], a[8:11], v[180:183]
v_and_b32_e64 v4, 3, v1
v_lshl_add_u32 v42, v4, 1, v2
v_mfma_f32_16x16x32_bf16 v[140:143], a[20:23], a[4:7], v[140:143]
v_add_u32 v43, 8, v2
ds_read_b128 a[64:67], v25 offset:4096
v_mfma_f32_16x16x32_bf16 v[100:103], a[20:23], a[0:3], v[100:103]
ds_read_b128 a[68:71], v25 offset:6144
v_mfma_f32_16x16x32_bf16 v[104:107], a[24:27], a[0:3], v[104:107]
buffer_load_dwordx4 v15, s[28:31], s60 offen offset:3072  lds
v_mfma_f32_16x16x32_bf16 v[144:147], a[24:27], a[4:7], v[144:147]
ds_read_b64_tr_b16 a[72:73], v30 offset:5120
ds_read_u16 v34, v42 offset:0
v_mfma_f32_16x16x32_bf16 v[184:187], a[24:27], a[8:11], v[184:187]
ds_read_b64_tr_b16 a[74:75], v30 offset:6400
ds_read_b64_tr_b16 a[76:77], v30 offset:5128
v_mfma_f32_16x16x32_bf16 v[224:227], a[24:27], a[12:15], v[224:227]
ds_read_b64_tr_b16 a[78:79], v30 offset:6408
ds_read_u16 v35, v42 offset:40
v_mfma_f32_16x16x32_bf16 v[228:231], a[28:31], a[12:15], v[228:231]
ds_read_b64_tr_b16 a[80:81], v30 offset:5136
s_add_u32 m0, s63, 0
v_mfma_f32_16x16x32_bf16 v[188:191], a[28:31], a[8:11], v[188:191]
buffer_load_dwordx4 v16, s[32:35], s61 offen offset:0  lds
v_mfma_f32_16x16x32_bf16 v[148:151], a[28:31], a[4:7], v[148:151]
ds_read_b64_tr_b16 a[82:83], v30 offset:6416
ds_read_b64_tr_b16 a[84:85], v30 offset:5144
v_mfma_f32_16x16x32_bf16 v[108:111], a[28:31], a[0:3], v[108:111]
ds_read_b64_tr_b16 a[86:87], v30 offset:6424
ds_read_u16 v36, v42 offset:80
v_mfma_f32_16x16x32_bf16 v[112:115], a[32:35], a[0:3], v[112:115]
ds_read_b64_tr_b16 a[88:89], v30 offset:5152
ds_read_b64_tr_b16 a[90:91], v30 offset:6432
v_mfma_f32_16x16x32_bf16 v[152:155], a[32:35], a[4:7], v[152:155]
buffer_load_dwordx4 v17, s[32:35], s61 offen offset:1024  lds
v_mfma_f32_16x16x32_bf16 v[192:195], a[32:35], a[8:11], v[192:195]
ds_read_b64_tr_b16 a[92:93], v30 offset:15360
ds_read_u16 v37, v42 offset:120
v_mfma_f32_16x16x32_bf16 v[232:235], a[32:35], a[12:15], v[232:235]
ds_read_b64_tr_b16 a[94:95], v30 offset:16640
v_mfma_f32_16x16x32_bf16 v[236:239], a[36:39], a[12:15], v[236:239]
ds_read_b64_tr_b16 a[96:97], v30 offset:15368
v_mfma_f32_16x16x32_bf16 v[196:199], a[36:39], a[8:11], v[196:199]
ds_read_b64_tr_b16 a[98:99], v30 offset:16648
v_mfma_f32_16x16x32_bf16 v[156:159], a[36:39], a[4:7], v[156:159]
ds_read_u16 v38, v42 offset:160
v_mfma_f32_16x16x32_bf16 v[116:119], a[36:39], a[0:3], v[116:119]
ds_read_b64_tr_b16 a[100:101], v30 offset:15376
v_mfma_f32_16x16x32_bf16 v[120:123], a[40:43], a[0:3], v[120:123]
buffer_load_dwordx4 v18, s[32:35], s61 offen offset:2048  lds
v_mfma_f32_16x16x32_bf16 v[160:163], a[40:43], a[4:7], v[160:163]
ds_read_b64_tr_b16 a[102:103], v30 offset:16656
ds_read_b64_tr_b16 a[104:105], v30 offset:15384
v_mfma_f32_16x16x32_bf16 v[200:203], a[40:43], a[8:11], v[200:203]
ds_read_u16 v39, v42 offset:200
ds_read_b64_tr_b16 a[106:107], v30 offset:16664
v_mfma_f32_16x16x32_bf16 v[240:243], a[40:43], a[12:15], v[240:243]
v_mfma_f32_16x16x32_bf16 v[244:247], a[44:47], a[12:15], v[244:247]
ds_read_b64_tr_b16 a[108:109], v30 offset:15392
v_mfma_f32_16x16x32_bf16 v[204:207], a[44:47], a[8:11], v[204:207]
ds_read_b64_tr_b16 a[110:111], v30 offset:16672
v_mfma_f32_16x16x32_bf16 v[164:167], a[44:47], a[4:7], v[164:167]
buffer_load_dwordx4 v19, s[32:35], s61 offen offset:3072  lds
v_mfma_f32_16x16x32_bf16 v[124:127], a[44:47], a[0:3], v[124:127]
ds_read_u16 v40, v42 offset:240
v_mfma_f32_16x16x32_bf16 v[128:131], a[48:51], a[0:3], v[128:131]
v_mfma_f32_16x16x32_bf16 v[168:171], a[48:51], a[4:7], v[168:171]
v_mfma_f32_16x16x32_bf16 v[208:211], a[48:51], a[8:11], v[208:211]
ds_read_u16 v41, v42 offset:280
v_mfma_f32_16x16x32_bf16 v[248:251], a[48:51], a[12:15], v[248:251]
v_mfma_f32_16x16x32_bf16 v[252:255], a[52:55], a[12:15], v[252:255]
s_add_u32 m0, s63, 4096
v_mfma_f32_16x16x32_bf16 v[212:215], a[52:55], a[8:11], v[212:215]
buffer_load_dwordx4 v20, s[32:35], s61 offen offset:0  lds
v_mfma_f32_16x16x32_bf16 v[172:175], a[52:55], a[4:7], v[172:175]
v_mfma_f32_16x16x32_bf16 v[132:135], a[52:55], a[0:3], v[132:135]
s_waitcnt lgkmcnt(0)
s_waitcnt vmcnt(13)
s_barrier
s_cmp_eq_u32 s56, 0
s_cbranch_scc0 Lw0_7
buffer_load_dword v83, v88, s[40:43], 0 offen sc1
buffer_load_dword v84, v85, s[40:43], 0 offen sc1
Lw0_7:
s_cmp_eq_u32 s56, 0
s_cbranch_scc0 Lw0_8
buffer_load_dword v86, v89, s[40:43], 0 offen sc1
Lw0_8:
v_mfma_f32_16x16x32_bf16 v[96:99], a[72:75], a[56:59], v[96:99]
ds_read_b128 a[0:3], v26 offset:0
v_mfma_f32_16x16x32_bf16 v[136:139], a[72:75], a[60:63], v[136:139]
v_lshl_or_b32 v8, v35, 16, v34
ds_read_b128 a[4:7], v26 offset:2048
v_mfma_f32_16x16x32_bf16 v[176:179], a[72:75], a[64:67], v[176:179]
v_mfma_f32_16x16x32_bf16 v[216:219], a[72:75], a[68:71], v[216:219]
ds_read_b128 a[8:11], v26 offset:4096
v_mfma_f32_16x16x32_bf16 v[220:223], a[76:79], a[68:71], v[220:223]
ds_read_b128 a[12:15], v26 offset:6144
v_lshl_or_b32 v9, v37, 16, v36
v_mfma_f32_16x16x32_bf16 v[180:183], a[76:79], a[64:67], v[180:183]
ds_read_b64_tr_b16 a[16:17], v32 offset:0
v_mfma_f32_16x16x32_bf16 v[140:143], a[76:79], a[60:63], v[140:143]
ds_read_b64_tr_b16 a[18:19], v32 offset:1280
v_mfma_f32_16x16x32_bf16 v[100:103], a[76:79], a[56:59], v[100:103]
v_lshl_or_b32 v10, v39, 16, v38
v_mfma_f32_16x16x32_bf16 v[104:107], a[80:83], a[56:59], v[104:107]
ds_read_b64_tr_b16 a[20:21], v32 offset:8
v_mfma_f32_16x16x32_bf16 v[144:147], a[80:83], a[60:63], v[144:147]
ds_read_b64_tr_b16 a[22:23], v32 offset:1288
v_mfma_f32_16x16x32_bf16 v[184:187], a[80:83], a[64:67], v[184:187]
ds_read_b64_tr_b16 a[24:25], v32 offset:16
v_lshl_or_b32 v11, v41, 16, v40
v_mfma_f32_16x16x32_bf16 v[224:227], a[80:83], a[68:71], v[224:227]
ds_read_b64_tr_b16 a[26:27], v32 offset:1296
v_mfma_f32_16x16x32_bf16 v[228:231], a[84:87], a[68:71], v[228:231]
v_mfma_f32_16x16x32_bf16 v[188:191], a[84:87], a[64:67], v[188:191]
ds_read_b64_tr_b16 a[28:29], v32 offset:24
ds_read_u16 v34, v43 offset:0
v_mfma_f32_16x16x32_bf16 v[148:151], a[84:87], a[60:63], v[148:151]
ds_read_b64_tr_b16 a[30:31], v32 offset:1304
v_mfma_f32_16x16x32_bf16 v[108:111], a[84:87], a[56:59], v[108:111]
ds_read_b64_tr_b16 a[32:33], v32 offset:32
v_mfma_f32_16x16x32_bf16 v[112:115], a[88:91], a[56:59], v[112:115]
ds_read_b64_tr_b16 a[34:35], v32 offset:1312
v_mfma_f32_16x16x32_bf16 v[152:155], a[88:91], a[60:63], v[152:155]
ds_read_u16 v35, v43 offset:40
v_mfma_f32_16x16x32_bf16 v[192:195], a[88:91], a[64:67], v[192:195]
ds_read_b64_tr_b16 a[36:37], v32 offset:10240
v_mfma_f32_16x16x32_bf16 v[232:235], a[88:91], a[68:71], v[232:235]
ds_read_b64_tr_b16 a[38:39], v32 offset:11520
v_mfma_f32_16x16x32_bf16 v[236:239], a[92:95], a[68:71], v[236:239]
ds_read_u16 v36, v43 offset:80
ds_read_b64_tr_b16 a[40:41], v32 offset:10248
v_mfma_f32_16x16x32_bf16 v[196:199], a[92:95], a[64:67], v[196:199]
ds_read_b64_tr_b16 a[42:43], v32 offset:11528
v_mfma_f32_16x16x32_bf16 v[156:159], a[92:95], a[60:63], v[156:159]
v_mfma_f32_16x16x32_bf16 v[116:119], a[92:95], a[56:59], v[116:119]
ds_read_b64_tr_b16 a[44:45], v32 offset:10256
ds_read_u16 v37, v43 offset:120
v_mfma_f32_16x16x32_bf16 v[120:123], a[96:99], a[56:59], v[120:123]
ds_read_b64_tr_b16 a[46:47], v32 offset:11536
v_mfma_f32_16x16x32_bf16 v[160:163], a[96:99], a[60:63], v[160:163]
ds_read_b64_tr_b16 a[48:49], v32 offset:10264
v_mfma_f32_16x16x32_bf16 v[200:203], a[96:99], a[64:67], v[200:203]
ds_read_u16 v38, v43 offset:160
ds_read_b64_tr_b16 a[50:51], v32 offset:11544
v_mfma_f32_16x16x32_bf16 v[240:243], a[96:99], a[68:71], v[240:243]
v_mfma_f32_16x16x32_bf16 v[244:247], a[100:103], a[68:71], v[244:247]
ds_read_b64_tr_b16 a[52:53], v32 offset:10272
v_mfma_f32_16x16x32_bf16 v[204:207], a[100:103], a[64:67], v[204:207]
ds_read_u16 v39, v43 offset:200
ds_read_b64_tr_b16 a[54:55], v32 offset:11552
v_mfma_f32_16x16x32_bf16 v[164:167], a[100:103], a[60:63], v[164:167]
v_mfma_f32_16x16x32_bf16 v[124:127], a[100:103], a[56:59], v[124:127]
v_mfma_f32_16x16x32_bf16 v[128:131], a[104:107], a[56:59], v[128:131]
ds_read_u16 v40, v43 offset:240
v_mfma_f32_16x16x32_bf16 v[168:171], a[104:107], a[60:63], v[168:171]
v_mfma_f32_16x16x32_bf16 v[208:211], a[104:107], a[64:67], v[208:211]
v_mfma_f32_16x16x32_bf16 v[248:251], a[104:107], a[68:71], v[248:251]
ds_read_u16 v41, v43 offset:280
v_mfma_f32_16x16x32_bf16 v[252:255], a[108:111], a[68:71], v[252:255]
v_mfma_f32_16x16x32_bf16 v[212:215], a[108:111], a[64:67], v[212:215]
v_mfma_f32_16x16x32_bf16 v[172:175], a[108:111], a[60:63], v[172:175]
v_mfma_f32_16x16x32_bf16 v[132:135], a[108:111], a[56:59], v[132:135]
s_waitcnt lgkmcnt(0)
v_mfma_f32_16x16x32_bf16 v[96:99], a[16:19], a[0:3], v[96:99]
ds_read_b128 a[56:59], v27 offset:0
v_mfma_f32_16x16x32_bf16 v[136:139], a[16:19], a[4:7], v[136:139]
ds_read_b128 a[60:63], v27 offset:2048
v_mfma_f32_16x16x32_bf16 v[176:179], a[16:19], a[8:11], v[176:179]
v_mfma_f32_16x16x32_bf16 v[216:219], a[16:19], a[12:15], v[216:219]
ds_read_b128 a[64:67], v27 offset:4096
v_lshl_or_b32 v12, v35, 16, v34
v_mfma_f32_16x16x32_bf16 v[220:223], a[20:23], a[12:15], v[220:223]
ds_read_b128 a[68:71], v27 offset:6144
v_mfma_f32_16x16x32_bf16 v[180:183], a[20:23], a[8:11], v[180:183]
ds_read_b64_tr_b16 a[72:73], v32 offset:5120
v_mfma_f32_16x16x32_bf16 v[140:143], a[20:23], a[4:7], v[140:143]
ds_read_b64_tr_b16 a[74:75], v32 offset:6400
v_mfma_f32_16x16x32_bf16 v[100:103], a[20:23], a[0:3], v[100:103]
v_mfma_f32_16x16x32_bf16 v[104:107], a[24:27], a[0:3], v[104:107]
ds_read_b64_tr_b16 a[76:77], v32 offset:5128
v_mfma_f32_16x16x32_bf16 v[144:147], a[24:27], a[4:7], v[144:147]
ds_read_b64_tr_b16 a[78:79], v32 offset:6408
v_mfma_f32_16x16x32_bf16 v[184:187], a[24:27], a[8:11], v[184:187]
ds_read_b64_tr_b16 a[80:81], v32 offset:5136
v_mfma_f32_16x16x32_bf16 v[224:227], a[24:27], a[12:15], v[224:227]
v_lshl_or_b32 v13, v37, 16, v36
ds_read_b64_tr_b16 a[82:83], v32 offset:6416
v_mfma_f32_16x16x32_bf16 v[228:231], a[28:31], a[12:15], v[228:231]
v_mfma_f32_16x16x32_bf16 v[188:191], a[28:31], a[8:11], v[188:191]
ds_read_b64_tr_b16 a[84:85], v32 offset:5144
v_mfma_f32_16x16x32_bf16 v[148:151], a[28:31], a[4:7], v[148:151]
ds_read_b64_tr_b16 a[86:87], v32 offset:6424
v_mfma_f32_16x16x32_bf16 v[108:111], a[28:31], a[0:3], v[108:111]
ds_read_b64_tr_b16 a[88:89], v32 offset:5152
v_mfma_f32_16x16x32_bf16 v[112:115], a[32:35], a[0:3], v[112:115]
ds_read_b64_tr_b16 a[90:91], v32 offset:6432
v_mfma_f32_16x16x32_bf16 v[152:155], a[32:35], a[4:7], v[152:155]
v_mfma_f32_16x16x32_bf16 v[192:195], a[32:35], a[8:11], v[192:195]
ds_read_b64_tr_b16 a[92:93], v32 offset:15360
v_lshl_or_b32 v14, v39, 16, v38
v_mfma_f32_16x16x32_bf16 v[232:235], a[32:35], a[12:15], v[232:235]
ds_read_b64_tr_b16 a[94:95], v32 offset:16640
v_mfma_f32_16x16x32_bf16 v[236:239], a[36:39], a[12:15], v[236:239]
ds_read_b64_tr_b16 a[96:97], v32 offset:15368
v_mfma_f32_16x16x32_bf16 v[196:199], a[36:39], a[8:11], v[196:199]
ds_read_b64_tr_b16 a[98:99], v32 offset:16648
v_mfma_f32_16x16x32_bf16 v[156:159], a[36:39], a[4:7], v[156:159]
v_mfma_f32_16x16x32_bf16 v[116:119], a[36:39], a[0:3], v[116:119]
ds_read_b64_tr_b16 a[100:101], v32 offset:15376
v_mfma_f32_16x16x32_bf16 v[120:123], a[40:43], a[0:3], v[120:123]
ds_read_b64_tr_b16 a[102:103], v32 offset:16656
v_mfma_f32_16x16x32_bf16 v[160:163], a[40:43], a[4:7], v[160:163]
ds_read_b64_tr_b16 a[104:105], v32 offset:15384
v_lshl_or_b32 v15, v41, 16, v40
v_mfma_f32_16x16x32_bf16 v[200:203], a[40:43], a[8:11], v[200:203]
ds_read_b64_tr_b16 a[106:107], v32 offset:16664
v_mfma_f32_16x16x32_bf16 v[240:243], a[40:43], a[12:15], v[240:243]
v_mfma_f32_16x16x32_bf16 v[244:247], a[44:47], a[12:15], v[244:247]
ds_read_b64_tr_b16 a[108:109], v32 offset:15392
v_mfma_f32_16x16x32_bf16 v[204:207], a[44:47], a[8:11], v[204:207]
ds_read_b64_tr_b16 a[110:111], v32 offset:16672
v_mfma_f32_16x16x32_bf16 v[164:167], a[44:47], a[4:7], v[164:167]
v_mfma_f32_16x16x32_bf16 v[124:127], a[44:47], a[0:3], v[124:127]
v_mfma_f32_16x16x32_bf16 v[128:131], a[48:51], a[0:3], v[128:131]
v_mfma_f32_16x16x32_bf16 v[168:171], a[48:51], a[4:7], v[168:171]
v_cmp_gt_u32 vcc, 48, v1
s_nop 1
v_cndmask_b32_e64 v8, 0, v8, vcc
v_mfma_f32_16x16x32_bf16 v[208:211], a[48:51], a[8:11], v[208:211]
v_cndmask_b32 v9, 0, v9, vcc
v_cndmask_b32 v12, 0, v12, vcc
v_mfma_f32_16x16x32_bf16 v[248:251], a[48:51], a[12:15], v[248:251]
v_cndmask_b32 v13, 0, v13, vcc
v_cmp_gt_u32 vcc, 32, v1
v_mfma_f32_16x16x32_bf16 v[252:255], a[52:55], a[12:15], v[252:255]
s_nop 0
v_cndmask_b32 v10, 0, v10, vcc
v_cndmask_b32_e64 v11, 0, v11, vcc
v_mfma_f32_16x16x32_bf16 v[212:215], a[52:55], a[8:11], v[212:215]
v_cndmask_b32 v14, 0, v14, vcc
v_cndmask_b32 v15, 0, v15, vcc
v_mfma_f32_16x16x32_bf16 v[172:175], a[52:55], a[4:7], v[172:175]
v_mfma_f32_16x16x32_bf16 v[132:135], a[52:55], a[0:3], v[132:135]
s_waitcnt lgkmcnt(0)
s_waitcnt vmcnt(0)
s_cmp_eq_u32 s56, 0
s_cbranch_scc0 Lw0_9
s_waitcnt vmcnt(0)
v_min_u32 v83, v83, v84
v_cmp_eq_u32 vcc, 0, v83
s_cbranch_vccz Lok6
s_mov_b32 s85, 40000
Lsp6:
buffer_load_dword v83, v88, s[40:43], 0 offen sc1
buffer_load_dword v84, v85, s[40:43], 0 offen sc1
s_waitcnt vmcnt(0)
v_min_u32 v83, v83, v84
v_cmp_eq_u32 vcc, 0, v83
s_cbranch_vccz Lok6
s_sub_u32 s85, s85, 1
s_cmp_lg_u32 s85, 0
s_cbranch_scc1 Lsp6
Lok6:
Lw0_9:
s_cmp_eq_u32 s56, 0
s_cbranch_scc0 Lw0_10
s_waitcnt vmcnt(0)
v_cmp_eq_u32 vcc, 0, v86
s_cbranch_vccz Lok7
s_mov_b32 s85, 40000
Lsp7:
buffer_load_dword v86, v89, s[40:43], 0 offen sc1
s_waitcnt vmcnt(0)
v_cmp_eq_u32_e64 vcc, 0, v86
s_cbranch_vccz Lok7
s_sub_u32 s85, s85, 1
s_cmp_lg_u32 s85, 0
s_cbranch_scc1 Lsp7
Lok7:
Lw0_10:
s_barrier
v_mfma_f32_16x16x32_bf16 v[96:99], a[72:75], a[56:59], v[96:99]
ds_read_b128 a[0:3], v22 offset:0
v_mfma_f32_16x16x32_bf16 v[136:139], a[72:75], a[60:63], v[136:139]
v_min_u32 v2, 39, v1
v_cmp_lt_u32 vcc, 19, v2
v_mfma_f32_16x16x32_bf16 v[176:179], a[72:75], a[64:67], v[176:179]
v_lshlrev_b32_e64 v91, 4, v2
s_mul_i32 s65, s59, 640
v_mfma_f32_16x16x32_bf16 v[216:219], a[72:75], a[68:71], v[216:219]
v_add_u32_e64 v3, 0, v91
s_add_u32 s65, s65, 16842752
v_mfma_f32_16x16x32_bf16 v[220:223], a[76:79], a[68:71], v[220:223]
v_cndmask_b32 v5, v91, v3, vcc
ds_read_b128 a[4:7], v22 offset:2048
v_mfma_f32_16x16x32_bf16 v[180:183], a[76:79], a[64:67], v[180:183]
s_mul_i32 s66, s56, 19968
s_add_u32 s65, s65, s66
v_mfma_f32_16x16x32_bf16 v[140:143], a[76:79], a[60:63], v[140:143]
s_cmp_lt_u32 s56, 2
s_cselect_b32 s66, 159744, s42
v_mfma_f32_16x16x32_bf16 v[100:103], a[76:79], a[56:59], v[100:103]
s_add_u32 s66, s66, s65
s_add_u32 s67, s65, 79872
v_mfma_f32_16x16x32_bf16 v[104:107], a[80:83], a[56:59], v[104:107]
ds_read_b128 a[8:11], v22 offset:4096
ds_read_b128 a[12:15], v22 offset:6144
v_mfma_f32_16x16x32_bf16 v[144:147], a[80:83], a[60:63], v[144:147]
buffer_load_dwordx4 v[42:45], v5, s[40:43], s65 offen sc1
v_mfma_f32_16x16x32_bf16 v[184:187], a[80:83], a[64:67], v[184:187]
ds_read_b64_tr_b16 a[16:17], v28 offset:0
ds_read_b64_tr_b16 a[18:19], v28 offset:1280
v_mfma_f32_16x16x32_bf16 v[224:227], a[80:83], a[68:71], v[224:227]
buffer_load_dwordx4 v[46:49], v5, s[40:43], s67 offen sc1
v_mfma_f32_16x16x32_bf16 v[228:231], a[84:87], a[68:71], v[228:231]
ds_read_b64_tr_b16 a[20:21], v28 offset:8
v_mfma_f32_16x16x32_bf16 v[188:191], a[84:87], a[64:67], v[188:191]
buffer_load_dwordx4 v[50:53], v5, s[40:43], s66 offen sc1
v_mfma_f32_16x16x32_bf16 v[148:151], a[84:87], a[60:63], v[148:151]
ds_read_b64_tr_b16 a[22:23], v28 offset:1288
ds_read_b64_tr_b16 a[24:25], v28 offset:16
v_mfma_f32_16x16x32_bf16 v[108:111], a[84:87], a[56:59], v[108:111]
v_and_b32 v20, 15, v1
v_lshlrev_b32 v20, 4, v20
v_mfma_f32_16x16x32_bf16 v[112:115], a[88:91], a[56:59], v[112:115]
s_lshl_b32 s65, s58, 12
s_add_u32 s65, s65, s12
v_mfma_f32_16x16x32_bf16 v[152:155], a[88:91], a[60:63], v[152:155]
s_add_u32 s65, s65, 16777216
ds_read_b64_tr_b16 a[26:27], v28 offset:1296
v_mfma_f32_16x16x32_bf16 v[192:195], a[88:91], a[64:67], v[192:195]
buffer_load_dwordx2 v[34:35], v20, s[40:43], s65 offen offset:0 sc1
v_mfma_f32_16x16x32_bf16 v[232:235], a[88:91], a[68:71], v[232:235]
ds_read_b64_tr_b16 a[28:29], v28 offset:24
ds_read_b64_tr_b16 a[30:31], v28 offset:1304
v_mfma_f32_16x16x32_bf16 v[236:239], a[92:95], a[68:71], v[236:239]
buffer_load_dwordx2 v[36:37], v20, s[40:43], s65 offen offset:256 sc1
v_mfma_f32_16x16x32_bf16 v[196:199], a[92:95], a[64:67], v[196:199]
ds_read_b64_tr_b16 a[32:33], v28 offset:32
v_mfma_f32_16x16x32_bf16 v[156:159], a[92:95], a[60:63], v[156:159]
buffer_load_dwordx2 v[38:39], v20, s[40:43], s65 offen offset:512 sc1
v_mfma_f32_16x16x32_bf16 v[116:119], a[92:95], a[56:59], v[116:119]
ds_read_b64_tr_b16 a[34:35], v28 offset:1312
ds_read_b64_tr_b16 a[36:37], v28 offset:10240
v_mfma_f32_16x16x32_bf16 v[120:123], a[96:99], a[56:59], v[120:123]
buffer_load_dwordx2 v[40:41], v20, s[40:43], s65 offen offset:768 sc1
v_mfma_f32_16x16x32_bf16 v[160:163], a[96:99], a[60:63], v[160:163]
ds_read_b64_tr_b16 a[38:39], v28 offset:11520
v_mfma_f32_16x16x32_bf16 v[200:203], a[96:99], a[64:67], v[200:203]
buffer_load_dwordx4 a[112:115], v6, s[40:43], s86 offen offset:0 sc1
v_mfma_f32_16x16x32_bf16 v[240:243], a[96:99], a[68:71], v[240:243]
ds_read_b64_tr_b16 a[40:41], v28 offset:10248
ds_read_b64_tr_b16 a[42:43], v28 offset:11528
v_mfma_f32_16x16x32_bf16 v[244:247], a[100:103], a[68:71], v[244:247]
buffer_load_dwordx4 a[116:119], v6, s[40:43], s87 offen offset:0 sc1
v_mfma_f32_16x16x32_bf16 v[204:207], a[100:103], a[64:67], v[204:207]
ds_read_b64_tr_b16 a[44:45], v28 offset:10256
ds_read_b64_tr_b16 a[46:47], v28 offset:11536
v_mfma_f32_16x16x32_bf16 v[164:167], a[100:103], a[60:63], v[164:167]
buffer_load_dwordx4 a[120:123], v6, s[40:43], s88 offen offset:0 sc1
v_mfma_f32_16x16x32_bf16 v[124:127], a[100:103], a[56:59], v[124:127]
ds_read_b64_tr_b16 a[48:49], v28 offset:10264
v_mfma_f32_16x16x32_bf16 v[128:131], a[104:107], a[56:59], v[128:131]
buffer_load_dwordx4 a[124:127], v6, s[40:43], s89 offen offset:0 sc1
v_mfma_f32_16x16x32_bf16 v[168:171], a[104:107], a[60:63], v[168:171]
ds_read_b64_tr_b16 a[50:51], v28 offset:11544
ds_read_b64_tr_b16 a[52:53], v28 offset:10272
v_mfma_f32_16x16x32_bf16 v[208:211], a[104:107], a[64:67], v[208:211]
buffer_load_dwordx4 a[128:131], v6, s[40:43], s90 offen offset:0 sc1
v_mfma_f32_16x16x32_bf16 v[248:251], a[104:107], a[68:71], v[248:251]
ds_read_b64_tr_b16 a[54:55], v28 offset:11552
v_mfma_f32_16x16x32_bf16 v[252:255], a[108:111], a[68:71], v[252:255]
buffer_load_dwordx4 a[132:135], v6, s[40:43], s86 offen offset:1024 sc1
v_mfma_f32_16x16x32_bf16 v[212:215], a[108:111], a[64:67], v[212:215]
buffer_load_dwordx4 a[136:139], v6, s[40:43], s87 offen offset:1024 sc1
v_mfma_f32_16x16x32_bf16 v[172:175], a[108:111], a[60:63], v[172:175]
buffer_load_dwordx4 a[140:143], v6, s[40:43], s88 offen offset:1024 sc1
v_mfma_f32_16x16x32_bf16 v[132:135], a[108:111], a[56:59], v[132:135]
buffer_load_dwordx4 a[144:147], v6, s[40:43], s89 offen offset:1024 sc1
s_waitcnt lgkmcnt(0)
v_mfma_f32_16x16x32_bf16 v[96:99], a[16:19], a[0:3], v[96:99]
ds_read_b128 a[56:59], v23 offset:0
v_mfma_f32_16x16x32_bf16 v[136:139], a[16:19], a[4:7], v[136:139]
s_waitcnt vmcnt(13)
ds_read_b128 a[60:63], v23 offset:2048
v_mfma_f32_16x16x32_bf16 v[176:179], a[16:19], a[8:11], v[176:179]
v_mfma_f32_16x16x32_bf16 v[216:219], a[16:19], a[12:15], v[216:219]
v_add_f32_e64 v82, v42, v46
ds_read_b128 a[64:67], v23 offset:4096
v_mfma_f32_16x16x32_bf16 v[220:223], a[20:23], a[12:15], v[220:223]
ds_read_b128 a[68:71], v23 offset:6144
v_mfma_f32_16x16x32_bf16 v[180:183], a[20:23], a[8:11], v[180:183]
v_add_f32_e64 v83, v43, v47
ds_read_b64_tr_b16 a[72:73], v28 offset:5120
v_mfma_f32_16x16x32_bf16 v[140:143], a[20:23], a[4:7], v[140:143]
ds_read_b64_tr_b16 a[74:75], v28 offset:6400
v_add_f32_e64 v84, v44, v48
v_mfma_f32_16x16x32_bf16 v[100:103], a[20:23], a[0:3], v[100:103]
v_mfma_f32_16x16x32_bf16 v[104:107], a[24:27], a[0:3], v[104:107]
ds_read_b64_tr_b16 a[76:77], v28 offset:5128
v_add_f32_e64 v85, v45, v49
v_mfma_f32_16x16x32_bf16 v[144:147], a[24:27], a[4:7], v[144:147]
ds_read_b64_tr_b16 a[78:79], v28 offset:6408
v_mfma_f32_16x16x32_bf16 v[184:187], a[24:27], a[8:11], v[184:187]
ds_read_b64_tr_b16 a[80:81], v28 offset:5136
v_add_f32_e64 v82, v82, v50
v_mfma_f32_16x16x32_bf16 v[224:227], a[24:27], a[12:15], v[224:227]
ds_read_b64_tr_b16 a[82:83], v28 offset:6416
v_mfma_f32_16x16x32_bf16 v[228:231], a[28:31], a[12:15], v[228:231]
v_add_f32_e64 v83, v83, v51
v_mfma_f32_16x16x32_bf16 v[188:191], a[28:31], a[8:11], v[188:191]
ds_read_b64_tr_b16 a[84:85], v28 offset:5144
v_mfma_f32_16x16x32_bf16 v[148:151], a[28:31], a[4:7], v[148:151]
ds_read_b64_tr_b16 a[86:87], v28 offset:6424
v_add_f32_e64 v84, v84, v52
v_mfma_f32_16x16x32_bf16 v[108:111], a[28:31], a[0:3], v[108:111]
ds_read_b64_tr_b16 a[88:89], v28 offset:5152
v_mfma_f32_16x16x32_bf16 v[112:115], a[32:35], a[0:3], v[112:115]
v_add_f32_e64 v85, v85, v53
ds_read_b64_tr_b16 a[90:91], v28 offset:6432
v_mfma_f32_16x16x32_bf16 v[152:155], a[32:35], a[4:7], v[152:155]
v_mfma_f32_16x16x32_bf16 v[192:195], a[32:35], a[8:11], v[192:195]
ds_read_b64_tr_b16 a[92:93], v28 offset:15360
s_mul_i32 s65, s56, 640
v_mfma_f32_16x16x32_bf16 v[232:235], a[32:35], a[12:15], v[232:235]
s_add_u32 s65, s65, 159744
v_add_u32_e64 v2, s65, v91
v_mfma_f32_16x16x32_bf16 v[236:239], a[36:39], a[12:15], v[236:239]
v_add_u32 v91, 159744, v91
ds_write_b128 v2, v[82:85]
v_mfma_f32_16x16x32_bf16 v[196:199], a[36:39], a[8:11], v[196:199]
v_lshrrev_b32_e64 v3, 4, v1
v_mul_u32_u24 v3, 80, v3
v_mfma_f32_16x16x32_bf16 v[156:159], a[36:39], a[4:7], v[156:159]
v_add_u32 v94, 162304, v3
ds_read_b64_tr_b16 a[94:95], v28 offset:16640
v_mfma_f32_16x16x32_bf16 v[116:119], a[36:39], a[0:3], v[116:119]
buffer_load_dwordx4 a[148:151], v6, s[40:43], s90 offen offset:1024 sc1
v_mfma_f32_16x16x32_bf16 v[120:123], a[40:43], a[0:3], v[120:123]
ds_read_b64_tr_b16 a[96:97], v28 offset:15368
ds_read_b64_tr_b16 a[98:99], v28 offset:16648
v_mfma_f32_16x16x32_bf16 v[160:163], a[40:43], a[4:7], v[160:163]
buffer_load_dwordx4 a[152:155], v6, s[40:43], s86 offen offset:2048 sc1
v_mfma_f32_16x16x32_bf16 v[200:203], a[40:43], a[8:11], v[200:203]
ds_read_b64_tr_b16 a[100:101], v28 offset:15376
ds_read_b64_tr_b16 a[102:103], v28 offset:16656
v_mfma_f32_16x16x32_bf16 v[240:243], a[40:43], a[12:15], v[240:243]
buffer_load_dwordx4 a[156:159], v6, s[40:43], s87 offen offset:2048 sc1
v_mfma_f32_16x16x32_bf16 v[244:247], a[44:47], a[12:15], v[244:247]
ds_read_b64_tr_b16 a[104:105], v28 offset:15384
v_mfma_f32_16x16x32_bf16 v[204:207], a[44:47], a[8:11], v[204:207]
buffer_load_dwordx4 a[160:163], v6, s[40:43], s88 offen offset:2048 sc1
v_mfma_f32_16x16x32_bf16 v[164:167], a[44:47], a[4:7], v[164:167]
ds_read_b64_tr_b16 a[106:107], v28 offset:16664
ds_read_b64_tr_b16 a[108:109], v28 offset:15392
v_mfma_f32_16x16x32_bf16 v[124:127], a[44:47], a[0:3], v[124:127]
buffer_load_dwordx4 a[164:167], v6, s[40:43], s89 offen offset:2048 sc1
v_mfma_f32_16x16x32_bf16 v[128:131], a[48:51], a[0:3], v[128:131]
ds_read_b64_tr_b16 a[110:111], v28 offset:16672
v_mfma_f32_16x16x32_bf16 v[168:171], a[48:51], a[4:7], v[168:171]
buffer_load_dwordx4 a[168:171], v6, s[40:43], s90 offen offset:2048 sc1
v_mfma_f32_16x16x32_bf16 v[208:211], a[48:51], a[8:11], v[208:211]
buffer_load_dwordx4 a[172:175], v6, s[40:43], s86 offen offset:3072 sc1
v_mfma_f32_16x16x32_bf16 v[248:251], a[48:51], a[12:15], v[248:251]
buffer_load_dwordx4 a[176:179], v6, s[40:43], s87 offen offset:3072 sc1
v_mfma_f32_16x16x32_bf16 v[252:255], a[52:55], a[12:15], v[252:255]
buffer_load_dwordx4 a[180:183], v6, s[40:43], s88 offen offset:3072 sc1
v_mfma_f32_16x16x32_bf16 v[212:215], a[52:55], a[8:11], v[212:215]
v_mfma_f32_16x16x32_bf16 v[172:175], a[52:55], a[4:7], v[172:175]
v_mfma_f32_16x16x32_bf16 v[132:135], a[52:55], a[0:3], v[132:135]
s_waitcnt lgkmcnt(0)
s_barrier
ds_read_b128 v[42:45], v91 offset:0
ds_read_b128 v[46:49], v91 offset:640
ds_read_b128 v[50:53], v91 offset:1280
ds_read_b128 v[54:57], v91 offset:1920
v_mfma_f32_16x16x32_bf16 v[96:99], a[72:75], a[56:59], v[96:99]
v_mfma_f32_16x16x32_bf16 v[136:139], a[72:75], a[60:63], v[136:139]
v_mfma_f32_16x16x32_bf16 v[176:179], a[72:75], a[64:67], v[176:179]
buffer_load_dwordx4 a[184:187], v6, s[40:43], s89 offen offset:3072 sc1
v_mfma_f32_16x16x32_bf16 v[216:219], a[72:75], a[68:71], v[216:219]
v_mfma_f32_16x16x32_bf16 v[220:223], a[76:79], a[68:71], v[220:223]
v_mfma_f32_16x16x32_bf16 v[180:183], a[76:79], a[64:67], v[180:183]
s_waitcnt lgkmcnt(0)
v_add_f32 v82, v42, v46
v_mfma_f32_16x16x32_bf16 v[140:143], a[76:79], a[60:63], v[140:143]
v_add_f32 v83, v43, v47
v_add_f32 v84, v44, v48
v_mfma_f32_16x16x32_bf16 v[100:103], a[76:79], a[56:59], v[100:103]
v_add_f32 v85, v45, v49
v_add_f32 v82, v82, v50
v_mfma_f32_16x16x32_bf16 v[104:107], a[80:83], a[56:59], v[104:107]
v_add_f32 v83, v83, v51
v_add_f32 v84, v84, v52
v_mfma_f32_16x16x32_bf16 v[144:147], a[80:83], a[60:63], v[144:147]
v_add_f32 v85, v85, v53
v_add_f32 v82, v82, v54
v_mfma_f32_16x16x32_bf16 v[184:187], a[80:83], a[64:67], v[184:187]
v_add_f32 v83, v83, v55
v_add_f32 v84, v84, v56
v_mfma_f32_16x16x32_bf16 v[224:227], a[80:83], a[68:71], v[224:227]
v_add_f32 v85, v85, v57
ds_write_b128 v91, v[82:85] offset:2560
v_mfma_f32_16x16x32_bf16 v[228:231], a[84:87], a[68:71], v[228:231]
buffer_load_dwordx4 a[188:191], v6, s[40:43], s90 offen offset:3072 sc1
v_mfma_f32_16x16x32_bf16 v[188:191], a[84:87], a[64:67], v[188:191]
buffer_load_dwordx4 a[192:195], v21, s[40:43], s86 offen offset:0 sc1
v_mfma_f32_16x16x32_bf16 v[148:151], a[84:87], a[60:63], v[148:151]
buffer_load_dwordx4 a[196:199], v0, s[40:43], s90 offen offset:1024 sc1
v_mfma_f32_16x16x32_bf16 v[108:111], a[84:87], a[56:59], v[108:111]
v_mfma_f32_16x16x32_bf16 v[112:115], a[88:91], a[56:59], v[112:115]
v_mfma_f32_16x16x32_bf16 v[152:155], a[88:91], a[60:63], v[152:155]
v_mfma_f32_16x16x32_bf16 v[192:195], a[88:91], a[64:67], v[192:195]
buffer_load_dwordx4 a[200:203], v0, s[40:43], s86 offen offset:2048 sc1
v_mfma_f32_16x16x32_bf16 v[232:235], a[88:91], a[68:71], v[232:235]
v_mfma_f32_16x16x32_bf16 v[236:239], a[92:95], a[68:71], v[236:239]
v_mfma_f32_16x16x32_bf16 v[196:199], a[92:95], a[64:67], v[196:199]
s_waitcnt lgkmcnt(0)
ds_read_b128 v[42:45], v94 offset:0
v_mfma_f32_16x16x32_bf16 v[156:159], a[92:95], a[60:63], v[156:159]
ds_read_b128 v[46:49], v94 offset:16
ds_read_b128 v[50:53], v94 offset:32
v_mfma_f32_16x16x32_bf16 v[116:119], a[92:95], a[56:59], v[116:119]
ds_read_b128 v[54:57], v94 offset:48
ds_read_b128 v[58:61], v94 offset:64
v_mfma_f32_16x16x32_bf16 v[120:123], a[96:99], a[56:59], v[120:123]
ds_read_b128 v[62:65], v94 offset:320
ds_read_b128 v[66:69], v94 offset:336
v_mfma_f32_16x16x32_bf16 v[160:163], a[96:99], a[60:63], v[160:163]
ds_read_b128 v[70:73], v94 offset:352
ds_read_b128 v[74:77], v94 offset:368
v_mfma_f32_16x16x32_bf16 v[200:203], a[96:99], a[64:67], v[200:203]
ds_read_b128 v[78:81], v94 offset:384
v_mfma_f32_16x16x32_bf16 v[240:243], a[96:99], a[68:71], v[240:243]
buffer_load_dwordx4 a[204:207], v0, s[40:43], s87 offen offset:2048 sc1
v_mfma_f32_16x16x32_bf16 v[244:247], a[100:103], a[68:71], v[244:247]
buffer_load_dwordx4 a[208:211], v0, s[40:43], s88 offen offset:2048 sc1
v_mfma_f32_16x16x32_bf16 v[204:207], a[100:103], a[64:67], v[204:207]
v_mfma_f32_16x16x32_bf16 v[164:167], a[100:103], a[60:63], v[164:167]
buffer_load_dwordx4 a[212:215], v0, s[40:43], s89 offen offset:2048 sc1
v_mfma_f32_16x16x32_bf16 v[124:127], a[100:103], a[56:59], v[124:127]
v_mfma_f32_16x16x32_bf16 v[128:131], a[104:107], a[56:59], v[128:131]
v_mfma_f32_16x16x32_bf16 v[168:171], a[104:107], a[60:63], v[168:171]
v_mfma_f32_16x16x32_bf16 v[208:211], a[104:107], a[64:67], v[208:211]
buffer_load_dwordx4 a[216:219], v0, s[40:43], s90 offen offset:2048 sc1
v_mfma_f32_16x16x32_bf16 v[248:251], a[104:107], a[68:71], v[248:251]
v_mfma_f32_16x16x32_bf16 v[252:255], a[108:111], a[68:71], v[252:255]
v_mfma_f32_16x16x32_bf16 v[212:215], a[108:111], a[64:67], v[212:215]
v_mfma_f32_16x16x32_bf16 v[172:175], a[108:111], a[60:63], v[172:175]
v_mfma_f32_16x16x32_bf16 v[132:135], a[108:111], a[56:59], v[132:135]
s_waitcnt vmcnt(27)
s_waitcnt lgkmcnt(0)
v_and_b32 v2, 15, v1
v_lshrrev_b32 v3, 4, v1
v_mul_u32_u24 v3, 81920, v3
v_lshl_add_u32 v20, v2, 4, v3
v_lshl_add_u32 v19, v2, 3, v3
s_lshl_b32 s65, s58, 2
s_add_u32 s65, s65, s56
s_mul_i32 s66, s59, 655360
s_add_u32 s66, s66, 12582912
s_lshl_b32 s67, s65, 9
s_add_u32 s67, s67, s66
s_lshl_b32 s64, s65, 10
s_add_u32 s66, s66, s64
s_add_u32 s68, s66, 0
s_add_u32 s69, s66, 32768
s_add_u32 s70, s67, 65536
s_add_u32 s71, s66, 327680
s_add_u32 s72, s66, 360448
s_add_u32 s73, s67, 393216
s_lshl_b32 s64, s59, 5
s_add_u32 s65, s65, s64
s_lshl_b32 s65, s65, 7
s_add_u32 s79, s65, 17199104
v_pk_fma_f32 v[96:97], v[42:43], v[34:35], v[96:97] op_sel:[0,1,0] op_sel_hi:[1,1,1]
v_pk_fma_f32 v[98:99], v[44:45], v[34:35], v[98:99] op_sel:[0,1,0] op_sel_hi:[1,1,1]
v_pk_fma_f32 v[100:101], v[46:47], v[34:35], v[100:101] op_sel:[0,1,0] op_sel_hi:[1,1,1]
v_pk_fma_f32 v[102:103], v[48:49], v[34:35], v[102:103] op_sel:[0,1,0] op_sel_hi:[1,1,1]
v_pk_fma_f32 v[104:105], v[50:51], v[34:35], v[104:105] op_sel:[0,1,0] op_sel_hi:[1,1,1]
v_pk_fma_f32 v[106:107], v[52:53], v[34:35], v[106:107] op_sel:[0,1,0] op_sel_hi:[1,1,1]
v_pk_fma_f32 v[108:109], v[54:55], v[34:35], v[108:109] op_sel:[0,1,0] op_sel_hi:[1,1,1]
v_pk_fma_f32 v[110:111], v[56:57], v[34:35], v[110:111] op_sel:[0,1,0] op_sel_hi:[1,1,1]
v_pk_fma_f32 v[112:113], v[58:59], v[34:35], v[112:113] op_sel:[0,1,0] op_sel_hi:[1,1,1]
v_pk_fma_f32 v[114:115], v[60:61], v[34:35], v[114:115] op_sel:[0,1,0] op_sel_hi:[1,1,1]
v_pk_mul_f32 v[96:97], v[96:97], v[34:35] op_sel_hi:[1,0]
v_pk_mul_f32 v[98:99], v[98:99], v[34:35] op_sel_hi:[1,0]
v_pk_mul_f32 v[100:101], v[100:101], v[34:35] op_sel_hi:[1,0]
v_pk_mul_f32 v[102:103], v[102:103], v[34:35] op_sel_hi:[1,0]
v_pk_mul_f32 v[104:105], v[104:105], v[34:35] op_sel_hi:[1,0]
v_pk_mul_f32 v[106:107], v[106:107], v[34:35] op_sel_hi:[1,0]
v_pk_mul_f32 v[108:109], v[108:109], v[34:35] op_sel_hi:[1,0]
v_pk_mul_f32 v[110:111], v[110:111], v[34:35] op_sel_hi:[1,0]
v_pk_mul_f32 v[112:113], v[112:113], v[34:35] op_sel_hi:[1,0]
v_pk_mul_f32 v[114:115], v[114:115], v[34:35] op_sel_hi:[1,0]
v_cvt_pk_bf16_f32 v22, v96, v97
v_cvt_pk_bf16_f32 v23, v98, v99
v_cvt_pk_bf16_f32 v24, v100, v101
v_cvt_pk_bf16_f32 v25, v102, v103
v_cvt_pk_bf16_f32 v26, v104, v105
v_cvt_pk_bf16_f32 v27, v106, v107
v_cvt_pk_bf16_f32 v28, v108, v109
v_cvt_pk_bf16_f32 v29, v110, v111
v_cvt_pk_bf16_f32 v30, v112, v113
v_cvt_pk_bf16_f32 v31, v114, v115
buffer_store_dwordx4 v[22:25], v20, s[40:43], s68 offen offset:0 sc1
buffer_store_dwordx4 v[26:29], v20, s[40:43], s69 offen offset:0 sc1
buffer_store_dwordx2 v[30:31], v19, s[40:43], s70 offen offset:0 sc1
v_pk_fma_f32 v[116:117], v[62:63], v[34:35], v[116:117] op_sel:[0,1,0] op_sel_hi:[1,1,1]
v_pk_fma_f32 v[118:119], v[64:65], v[34:35], v[118:119] op_sel:[0,1,0] op_sel_hi:[1,1,1]
v_pk_fma_f32 v[120:121], v[66:67], v[34:35], v[120:121] op_sel:[0,1,0] op_sel_hi:[1,1,1]
v_pk_fma_f32 v[122:123], v[68:69], v[34:35], v[122:123] op_sel:[0,1,0] op_sel_hi:[1,1,1]
v_pk_fma_f32 v[124:125], v[70:71], v[34:35], v[124:125] op_sel:[0,1,0] op_sel_hi:[1,1,1]
v_pk_fma_f32 v[126:127], v[72:73], v[34:35], v[126:127] op_sel:[0,1,0] op_sel_hi:[1,1,1]
v_pk_fma_f32 v[128:129], v[74:75], v[34:35], v[128:129] op_sel:[0,1,0] op_sel_hi:[1,1,1]
v_pk_fma_f32 v[130:131], v[76:77], v[34:35], v[130:131] op_sel:[0,1,0] op_sel_hi:[1,1,1]
v_pk_fma_f32 v[132:133], v[78:79], v[34:35], v[132:133] op_sel:[0,1,0] op_sel_hi:[1,1,1]
v_pk_fma_f32 v[134:135], v[80:81], v[34:35], v[134:135] op_sel:[0,1,0] op_sel_hi:[1,1,1]
v_pk_mul_f32 v[116:117], v[116:117], v[34:35] op_sel_hi:[1,0]
v_pk_mul_f32 v[118:119], v[118:119], v[34:35] op_sel_hi:[1,0]
v_pk_mul_f32 v[120:121], v[120:121], v[34:35] op_sel_hi:[1,0]
v_pk_mul_f32 v[122:123], v[122:123], v[34:35] op_sel_hi:[1,0]
v_pk_mul_f32 v[124:125], v[124:125], v[34:35] op_sel_hi:[1,0]
v_pk_mul_f32 v[126:127], v[126:127], v[34:35] op_sel_hi:[1,0]
v_pk_mul_f32 v[128:129], v[128:129], v[34:35] op_sel_hi:[1,0]
v_pk_mul_f32 v[130:131], v[130:131], v[34:35] op_sel_hi:[1,0]
v_pk_mul_f32 v[132:133], v[132:133], v[34:35] op_sel_hi:[1,0]
v_pk_mul_f32 v[134:135], v[134:135], v[34:35] op_sel_hi:[1,0]
v_cvt_pk_bf16_f32 v82, v116, v117
v_cvt_pk_bf16_f32 v83, v118, v119
v_cvt_pk_bf16_f32 v84, v120, v121
v_cvt_pk_bf16_f32 v85, v122, v123
v_cvt_pk_bf16_f32 v86, v124, v125
v_cvt_pk_bf16_f32 v87, v126, v127
v_cvt_pk_bf16_f32 v88, v128, v129
v_cvt_pk_bf16_f32 v89, v130, v131
v_cvt_pk_bf16_f32 v90, v132, v133
v_cvt_pk_bf16_f32 v91, v134, v135
buffer_store_dwordx4 v[82:85], v20, s[40:43], s71 offen offset:0 sc1
buffer_store_dwordx4 v[86:89], v20, s[40:43], s72 offen offset:0 sc1
buffer_store_dwordx2 v[90:91], v19, s[40:43], s73 offen offset:0 sc1
v_pk_fma_f32 v[136:137], v[42:43], v[36:37], v[136:137] op_sel:[0,1,0] op_sel_hi:[1,1,1]
v_pk_fma_f32 v[138:139], v[44:45], v[36:37], v[138:139] op_sel:[0,1,0] op_sel_hi:[1,1,1]
v_pk_fma_f32 v[140:141], v[46:47], v[36:37], v[140:141] op_sel:[0,1,0] op_sel_hi:[1,1,1]
v_pk_fma_f32 v[142:143], v[48:49], v[36:37], v[142:143] op_sel:[0,1,0] op_sel_hi:[1,1,1]
v_pk_fma_f32 v[144:145], v[50:51], v[36:37], v[144:145] op_sel:[0,1,0] op_sel_hi:[1,1,1]
v_pk_fma_f32 v[146:147], v[52:53], v[36:37], v[146:147] op_sel:[0,1,0] op_sel_hi:[1,1,1]
v_pk_fma_f32 v[148:149], v[54:55], v[36:37], v[148:149] op_sel:[0,1,0] op_sel_hi:[1,1,1]
v_pk_fma_f32 v[150:151], v[56:57], v[36:37], v[150:151] op_sel:[0,1,0] op_sel_hi:[1,1,1]
v_pk_fma_f32 v[152:153], v[58:59], v[36:37], v[152:153] op_sel:[0,1,0] op_sel_hi:[1,1,1]
v_pk_fma_f32 v[154:155], v[60:61], v[36:37], v[154:155] op_sel:[0,1,0] op_sel_hi:[1,1,1]
v_pk_mul_f32 v[136:137], v[136:137], v[36:37] op_sel_hi:[1,0]
v_pk_mul_f32 v[138:139], v[138:139], v[36:37] op_sel_hi:[1,0]
v_pk_mul_f32 v[140:141], v[140:141], v[36:37] op_sel_hi:[1,0]
v_pk_mul_f32 v[142:143], v[142:143], v[36:37] op_sel_hi:[1,0]
v_pk_mul_f32 v[144:145], v[144:145], v[36:37] op_sel_hi:[1,0]
v_pk_mul_f32 v[146:147], v[146:147], v[36:37] op_sel_hi:[1,0]
v_pk_mul_f32 v[148:149], v[148:149], v[36:37] op_sel_hi:[1,0]
v_pk_mul_f32 v[150:151], v[150:151], v[36:37] op_sel_hi:[1,0]
v_pk_mul_f32 v[152:153], v[152:153], v[36:37] op_sel_hi:[1,0]
v_pk_mul_f32 v[154:155], v[154:155], v[36:37] op_sel_hi:[1,0]
v_cvt_pk_bf16_f32 v22, v136, v137
v_cvt_pk_bf16_f32 v23, v138, v139
v_cvt_pk_bf16_f32 v24, v140, v141
v_cvt_pk_bf16_f32 v25, v142, v143
v_cvt_pk_bf16_f32 v26, v144, v145
v_cvt_pk_bf16_f32 v27, v146, v147
v_cvt_pk_bf16_f32 v28, v148, v149
v_cvt_pk_bf16_f32 v29, v150, v151
v_cvt_pk_bf16_f32 v30, v152, v153
v_cvt_pk_bf16_f32 v31, v154, v155
buffer_store_dwordx4 v[22:25], v20, s[40:43], s68 offen offset:256 sc1
buffer_store_dwordx4 v[26:29], v20, s[40:43], s69 offen offset:256 sc1
buffer_store_dwordx2 v[30:31], v19, s[40:43], s70 offen offset:128 sc1
v_pk_fma_f32 v[156:157], v[62:63], v[36:37], v[156:157] op_sel:[0,1,0] op_sel_hi:[1,1,1]
v_pk_fma_f32 v[158:159], v[64:65], v[36:37], v[158:159] op_sel:[0,1,0] op_sel_hi:[1,1,1]
v_pk_fma_f32 v[160:161], v[66:67], v[36:37], v[160:161] op_sel:[0,1,0] op_sel_hi:[1,1,1]
v_pk_fma_f32 v[162:163], v[68:69], v[36:37], v[162:163] op_sel:[0,1,0] op_sel_hi:[1,1,1]
v_pk_fma_f32 v[164:165], v[70:71], v[36:37], v[164:165] op_sel:[0,1,0] op_sel_hi:[1,1,1]
v_pk_fma_f32 v[166:167], v[72:73], v[36:37], v[166:167] op_sel:[0,1,0] op_sel_hi:[1,1,1]
v_pk_fma_f32 v[168:169], v[74:75], v[36:37], v[168:169] op_sel:[0,1,0] op_sel_hi:[1,1,1]
v_pk_fma_f32 v[170:171], v[76:77], v[36:37], v[170:171] op_sel:[0,1,0] op_sel_hi:[1,1,1]
v_pk_fma_f32 v[172:173], v[78:79], v[36:37], v[172:173] op_sel:[0,1,0] op_sel_hi:[1,1,1]
v_pk_fma_f32 v[174:175], v[80:81], v[36:37], v[174:175] op_sel:[0,1,0] op_sel_hi:[1,1,1]
v_pk_mul_f32 v[156:157], v[156:157], v[36:37] op_sel_hi:[1,0]
v_pk_mul_f32 v[158:159], v[158:159], v[36:37] op_sel_hi:[1,0]
v_pk_mul_f32 v[160:161], v[160:161], v[36:37] op_sel_hi:[1,0]
v_pk_mul_f32 v[162:163], v[162:163], v[36:37] op_sel_hi:[1,0]
v_pk_mul_f32 v[164:165], v[164:165], v[36:37] op_sel_hi:[1,0]
v_pk_mul_f32 v[166:167], v[166:167], v[36:37] op_sel_hi:[1,0]
v_pk_mul_f32 v[168:169], v[168:169], v[36:37] op_sel_hi:[1,0]
v_pk_mul_f32 v[170:171], v[170:171], v[36:37] op_sel_hi:[1,0]
v_pk_mul_f32 v[172:173], v[172:173], v[36:37] op_sel_hi:[1,0]
v_pk_mul_f32 v[174:175], v[174:175], v[36:37] op_sel_hi:[1,0]
v_cvt_pk_bf16_f32 v82, v156, v157
v_cvt_pk_bf16_f32 v83, v158, v159
v_cvt_pk_bf16_f32 v84, v160, v161
v_cvt_pk_bf16_f32 v85, v162, v163
v_cvt_pk_bf16_f32 v86, v164, v165
v_cvt_pk_bf16_f32 v87, v166, v167
v_cvt_pk_bf16_f32 v88, v168, v169
v_cvt_pk_bf16_f32 v89, v170, v171
v_cvt_pk_bf16_f32 v90, v172, v173
v_cvt_pk_bf16_f32 v91, v174, v175
buffer_store_dwordx4 v[82:85], v20, s[40:43], s71 offen offset:256 sc1
buffer_store_dwordx4 v[86:89], v20, s[40:43], s72 offen offset:256 sc1
buffer_store_dwordx2 v[90:91], v19, s[40:43], s73 offen offset:128 sc1
v_pk_fma_f32 v[176:177], v[42:43], v[38:39], v[176:177] op_sel:[0,1,0] op_sel_hi:[1,1,1]
v_pk_fma_f32 v[178:179], v[44:45], v[38:39], v[178:179] op_sel:[0,1,0] op_sel_hi:[1,1,1]
v_pk_fma_f32 v[180:181], v[46:47], v[38:39], v[180:181] op_sel:[0,1,0] op_sel_hi:[1,1,1]
v_pk_fma_f32 v[182:183], v[48:49], v[38:39], v[182:183] op_sel:[0,1,0] op_sel_hi:[1,1,1]
v_pk_fma_f32 v[184:185], v[50:51], v[38:39], v[184:185] op_sel:[0,1,0] op_sel_hi:[1,1,1]
v_pk_fma_f32 v[186:187], v[52:53], v[38:39], v[186:187] op_sel:[0,1,0] op_sel_hi:[1,1,1]
v_pk_fma_f32 v[188:189], v[54:55], v[38:39], v[188:189] op_sel:[0,1,0] op_sel_hi:[1,1,1]
v_pk_fma_f32 v[190:191], v[56:57], v[38:39], v[190:191] op_sel:[0,1,0] op_sel_hi:[1,1,1]
v_pk_fma_f32 v[192:193], v[58:59], v[38:39], v[192:193] op_sel:[0,1,0] op_sel_hi:[1,1,1]
v_pk_fma_f32 v[194:195], v[60:61], v[38:39], v[194:195] op_sel:[0,1,0] op_sel_hi:[1,1,1]
v_pk_mul_f32 v[176:177], v[176:177], v[38:39] op_sel_hi:[1,0]
v_pk_mul_f32 v[178:179], v[178:179], v[38:39] op_sel_hi:[1,0]
v_pk_mul_f32 v[180:181], v[180:181], v[38:39] op_sel_hi:[1,0]
v_pk_mul_f32 v[182:183], v[182:183], v[38:39] op_sel_hi:[1,0]
v_pk_mul_f32 v[184:185], v[184:185], v[38:39] op_sel_hi:[1,0]
v_pk_mul_f32 v[186:187], v[186:187], v[38:39] op_sel_hi:[1,0]
v_pk_mul_f32 v[188:189], v[188:189], v[38:39] op_sel_hi:[1,0]
v_pk_mul_f32 v[190:191], v[190:191], v[38:39] op_sel_hi:[1,0]
v_pk_mul_f32 v[192:193], v[192:193], v[38:39] op_sel_hi:[1,0]
v_pk_mul_f32 v[194:195], v[194:195], v[38:39] op_sel_hi:[1,0]
v_cvt_pk_bf16_f32 v22, v176, v177
v_cvt_pk_bf16_f32 v23, v178, v179
v_cvt_pk_bf16_f32 v24, v180, v181
v_cvt_pk_bf16_f32 v25, v182, v183
v_cvt_pk_bf16_f32 v26, v184, v185
v_cvt_pk_bf16_f32 v27, v186, v187
v_cvt_pk_bf16_f32 v28, v188, v189
v_cvt_pk_bf16_f32 v29, v190, v191
v_cvt_pk_bf16_f32 v30, v192, v193
v_cvt_pk_bf16_f32 v31, v194, v195
buffer_store_dwordx4 v[22:25], v20, s[40:43], s68 offen offset:512 sc1
buffer_store_dwordx4 v[26:29], v20, s[40:43], s69 offen offset:512 sc1
buffer_store_dwordx2 v[30:31], v19, s[40:43], s70 offen offset:256 sc1
v_pk_fma_f32 v[196:197], v[62:63], v[38:39], v[196:197] op_sel:[0,1,0] op_sel_hi:[1,1,1]
v_pk_fma_f32 v[198:199], v[64:65], v[38:39], v[198:199] op_sel:[0,1,0] op_sel_hi:[1,1,1]
v_pk_fma_f32 v[200:201], v[66:67], v[38:39], v[200:201] op_sel:[0,1,0] op_sel_hi:[1,1,1]
v_pk_fma_f32 v[202:203], v[68:69], v[38:39], v[202:203] op_sel:[0,1,0] op_sel_hi:[1,1,1]
v_pk_fma_f32 v[204:205], v[70:71], v[38:39], v[204:205] op_sel:[0,1,0] op_sel_hi:[1,1,1]
v_pk_fma_f32 v[206:207], v[72:73], v[38:39], v[206:207] op_sel:[0,1,0] op_sel_hi:[1,1,1]
v_pk_fma_f32 v[208:209], v[74:75], v[38:39], v[208:209] op_sel:[0,1,0] op_sel_hi:[1,1,1]
v_pk_fma_f32 v[210:211], v[76:77], v[38:39], v[210:211] op_sel:[0,1,0] op_sel_hi:[1,1,1]
v_pk_fma_f32 v[212:213], v[78:79], v[38:39], v[212:213] op_sel:[0,1,0] op_sel_hi:[1,1,1]
v_pk_fma_f32 v[214:215], v[80:81], v[38:39], v[214:215] op_sel:[0,1,0] op_sel_hi:[1,1,1]
v_pk_mul_f32 v[196:197], v[196:197], v[38:39] op_sel_hi:[1,0]
v_pk_mul_f32 v[198:199], v[198:199], v[38:39] op_sel_hi:[1,0]
v_pk_mul_f32 v[200:201], v[200:201], v[38:39] op_sel_hi:[1,0]
v_pk_mul_f32 v[202:203], v[202:203], v[38:39] op_sel_hi:[1,0]
v_pk_mul_f32 v[204:205], v[204:205], v[38:39] op_sel_hi:[1,0]
v_pk_mul_f32 v[206:207], v[206:207], v[38:39] op_sel_hi:[1,0]
v_pk_mul_f32 v[208:209], v[208:209], v[38:39] op_sel_hi:[1,0]
v_pk_mul_f32 v[210:211], v[210:211], v[38:39] op_sel_hi:[1,0]
v_pk_mul_f32 v[212:213], v[212:213], v[38:39] op_sel_hi:[1,0]
v_pk_mul_f32 v[214:215], v[214:215], v[38:39] op_sel_hi:[1,0]
v_cvt_pk_bf16_f32 v82, v196, v197
v_cvt_pk_bf16_f32 v83, v198, v199
v_cvt_pk_bf16_f32 v84, v200, v201
v_cvt_pk_bf16_f32 v85, v202, v203
v_cvt_pk_bf16_f32 v86, v204, v205
v_cvt_pk_bf16_f32 v87, v206, v207
v_cvt_pk_bf16_f32 v88, v208, v209
v_cvt_pk_bf16_f32 v89, v210, v211
v_cvt_pk_bf16_f32 v90, v212, v213
v_cvt_pk_bf16_f32 v91, v214, v215
buffer_store_dwordx4 v[82:85], v20, s[40:43], s71 offen offset:512 sc1
buffer_store_dwordx4 v[86:89], v20, s[40:43], s72 offen offset:512 sc1
buffer_store_dwordx2 v[90:91], v19, s[40:43], s73 offen offset:256 sc1
v_pk_fma_f32 v[216:217], v[42:43], v[40:41], v[216:217] op_sel:[0,1,0] op_sel_hi:[1,1,1]
v_pk_fma_f32 v[218:219], v[44:45], v[40:41], v[218:219] op_sel:[0,1,0] op_sel_hi:[1,1,1]
v_pk_fma_f32 v[220:221], v[46:47], v[40:41], v[220:221] op_sel:[0,1,0] op_sel_hi:[1,1,1]
v_pk_fma_f32 v[222:223], v[48:49], v[40:41], v[222:223] op_sel:[0,1,0] op_sel_hi:[1,1,1]
v_pk_fma_f32 v[224:225], v[50:51], v[40:41], v[224:225] op_sel:[0,1,0] op_sel_hi:[1,1,1]
v_pk_fma_f32 v[226:227], v[52:53], v[40:41], v[226:227] op_sel:[0,1,0] op_sel_hi:[1,1,1]
v_pk_fma_f32 v[228:229], v[54:55], v[40:41], v[228:229] op_sel:[0,1,0] op_sel_hi:[1,1,1]
v_pk_fma_f32 v[230:231], v[56:57], v[40:41], v[230:231] op_sel:[0,1,0] op_sel_hi:[1,1,1]
v_pk_fma_f32 v[232:233], v[58:59], v[40:41], v[232:233] op_sel:[0,1,0] op_sel_hi:[1,1,1]
v_pk_fma_f32 v[234:235], v[60:61], v[40:41], v[234:235] op_sel:[0,1,0] op_sel_hi:[1,1,1]
v_pk_mul_f32 v[216:217], v[216:217], v[40:41] op_sel_hi:[1,0]
v_pk_mul_f32 v[218:219], v[218:219], v[40:41] op_sel_hi:[1,0]
v_pk_mul_f32 v[220:221], v[220:221], v[40:41] op_sel_hi:[1,0]
v_pk_mul_f32 v[222:223], v[222:223], v[40:41] op_sel_hi:[1,0]
v_pk_mul_f32 v[224:225], v[224:225], v[40:41] op_sel_hi:[1,0]
v_pk_mul_f32 v[226:227], v[226:227], v[40:41] op_sel_hi:[1,0]
v_pk_mul_f32 v[228:229], v[228:229], v[40:41] op_sel_hi:[1,0]
v_pk_mul_f32 v[230:231], v[230:231], v[40:41] op_sel_hi:[1,0]
v_pk_mul_f32 v[232:233], v[232:233], v[40:41] op_sel_hi:[1,0]
v_pk_mul_f32 v[234:235], v[234:235], v[40:41] op_sel_hi:[1,0]
v_cvt_pk_bf16_f32 v22, v216, v217
v_cvt_pk_bf16_f32 v23, v218, v219
v_cvt_pk_bf16_f32 v24, v220, v221
v_cvt_pk_bf16_f32 v25, v222, v223
v_cvt_pk_bf16_f32 v26, v224, v225
v_cvt_pk_bf16_f32 v27, v226, v227
v_cvt_pk_bf16_f32 v28, v228, v229
v_cvt_pk_bf16_f32 v29, v230, v231
v_cvt_pk_bf16_f32 v30, v232, v233
v_cvt_pk_bf16_f32 v31, v234, v235
buffer_store_dwordx4 v[22:25], v20, s[40:43], s68 offen offset:768 sc1
buffer_store_dwordx4 v[26:29], v20, s[40:43], s69 offen offset:768 sc1
buffer_store_dwordx2 v[30:31], v19, s[40:43], s70 offen offset:384 sc1
v_pk_fma_f32 v[236:237], v[62:63], v[40:41], v[236:237] op_sel:[0,1,0] op_sel_hi:[1,1,1]
v_pk_fma_f32 v[238:239], v[64:65], v[40:41], v[238:239] op_sel:[0,1,0] op_sel_hi:[1,1,1]
v_pk_fma_f32 v[240:241], v[66:67], v[40:41], v[240:241] op_sel:[0,1,0] op_sel_hi:[1,1,1]
v_pk_fma_f32 v[242:243], v[68:69], v[40:41], v[242:243] op_sel:[0,1,0] op_sel_hi:[1,1,1]
v_pk_fma_f32 v[244:245], v[70:71], v[40:41], v[244:245] op_sel:[0,1,0] op_sel_hi:[1,1,1]
v_pk_fma_f32 v[246:247], v[72:73], v[40:41], v[246:247] op_sel:[0,1,0] op_sel_hi:[1,1,1]
v_pk_fma_f32 v[248:249], v[74:75], v[40:41], v[248:249] op_sel:[0,1,0] op_sel_hi:[1,1,1]
v_pk_fma_f32 v[250:251], v[76:77], v[40:41], v[250:251] op_sel:[0,1,0] op_sel_hi:[1,1,1]
v_pk_fma_f32 v[252:253], v[78:79], v[40:41], v[252:253] op_sel:[0,1,0] op_sel_hi:[1,1,1]
v_pk_fma_f32 v[254:255], v[80:81], v[40:41], v[254:255] op_sel:[0,1,0] op_sel_hi:[1,1,1]
v_pk_mul_f32 v[236:237], v[236:237], v[40:41] op_sel_hi:[1,0]
v_pk_mul_f32 v[238:239], v[238:239], v[40:41] op_sel_hi:[1,0]
v_pk_mul_f32 v[240:241], v[240:241], v[40:41] op_sel_hi:[1,0]
v_pk_mul_f32 v[242:243], v[242:243], v[40:41] op_sel_hi:[1,0]
v_pk_mul_f32 v[244:245], v[244:245], v[40:41] op_sel_hi:[1,0]
v_pk_mul_f32 v[246:247], v[246:247], v[40:41] op_sel_hi:[1,0]
v_pk_mul_f32 v[248:249], v[248:249], v[40:41] op_sel_hi:[1,0]
v_pk_mul_f32 v[250:251], v[250:251], v[40:41] op_sel_hi:[1,0]
v_pk_mul_f32 v[252:253], v[252:253], v[40:41] op_sel_hi:[1,0]
v_pk_mul_f32 v[254:255], v[254:255], v[40:41] op_sel_hi:[1,0]
v_cvt_pk_bf16_f32 v82, v236, v237
v_cvt_pk_bf16_f32 v83, v238, v239
v_cvt_pk_bf16_f32 v84, v240, v241
v_cvt_pk_bf16_f32 v85, v242, v243
v_cvt_pk_bf16_f32 v86, v244, v245
v_cvt_pk_bf16_f32 v87, v246, v247
v_cvt_pk_bf16_f32 v88, v248, v249
v_cvt_pk_bf16_f32 v89, v250, v251
v_cvt_pk_bf16_f32 v90, v252, v253
v_cvt_pk_bf16_f32 v91, v254, v255
buffer_store_dwordx4 v[82:85], v20, s[40:43], s71 offen offset:768 sc1
buffer_store_dwordx4 v[86:89], v20, s[40:43], s72 offen offset:768 sc1
buffer_store_dwordx2 v[90:91], v19, s[40:43], s73 offen offset:384 sc1
buffer_load_dwordx4 a[220:223], v0, s[40:43], s86 offen offset:3072 sc1
buffer_load_dwordx4 a[224:227], v0, s[40:43], s87 offen offset:3072 sc1
buffer_load_dwordx4 a[228:231], v0, s[40:43], s88 offen offset:3072 sc1
buffer_load_dwordx4 a[232:235], v0, s[40:43], s89 offen offset:3072 sc1
buffer_load_dwordx4 a[236:239], v0, s[40:43], s90 offen offset:3072 sc1
s_add_u32 s64, s86, s3
s_add_u32 m0, s12, 61440
s_nop 0
buffer_load_dwordx4 v6, s[40:43], s64 offen offset:0 sc1 lds
s_waitcnt vmcnt(6)
buffer_store_dword v21, v7, s[40:43], s79 offen sc1
s_add_u32 s64, s87, s3
s_add_u32 m0, s12, 65536
s_nop 0
buffer_load_dwordx4 v6, s[40:43], s64 offen offset:0 sc1 lds
s_add_u32 s64, s88, s3
s_add_u32 m0, s12, 69632
s_nop 0
buffer_load_dwordx4 v6, s[40:43], s64 offen offset:0 sc1 lds
s_add_u32 s64, s89, s3
s_add_u32 m0, s12, 73728
s_nop 0
buffer_load_dwordx4 v6, s[40:43], s64 offen offset:0 sc1 lds
s_add_u32 s64, s90, s3
s_add_u32 m0, s12, 77824
s_nop 0
buffer_load_dwordx4 v6, s[40:43], s64 offen offset:0 sc1 lds
s_add_u32 s64, s86, s3
s_add_u32 m0, s12, 80896
s_nop 0
buffer_load_dwordx4 v6, s[40:43], s64 offen offset:1024 sc1 lds
s_add_u32 s64, s87, s3
s_add_u32 m0, s12, 84992
s_nop 0
buffer_load_dwordx4 v6, s[40:43], s64 offen offset:1024 sc1 lds
s_add_u32 s64, s88, s3
s_add_u32 m0, s12, 89088
s_nop 0
buffer_load_dwordx4 v6, s[40:43], s64 offen offset:1024 sc1 lds
s_add_u32 s64, s89, s3
s_add_u32 m0, s12, 93184
s_nop 0
buffer_load_dwordx4 v6, s[40:43], s64 offen offset:1024 sc1 lds
s_add_u32 s64, s90, s3
s_add_u32 m0, s12, 97280
s_nop 0
buffer_load_dwordx4 v6, s[40:43], s64 offen offset:1024 sc1 lds
s_add_u32 s64, s86, s3
s_add_u32 m0, s12, 100352
s_nop 0
buffer_load_dwordx4 v6, s[40:43], s64 offen offset:2048 sc1 lds
buffer_load_dwordx4 a[0:3], v21, s[40:43], s87 offen offset:0 sc1
buffer_load_dwordx4 a[4:7], v21, s[40:43], s88 offen offset:0 sc1
buffer_load_dwordx4 a[8:11], v21, s[40:43], s89 offen offset:0 sc1
buffer_load_dwordx4 a[12:15], v21, s[40:43], s90 offen offset:0 sc1
buffer_load_dwordx4 a[16:19], v21, s[40:43], s86 offen offset:1024 sc1
buffer_load_dwordx4 a[20:23], v21, s[40:43], s87 offen offset:1024 sc1
buffer_load_dwordx4 a[24:27], v21, s[40:43], s88 offen offset:1024 sc1
buffer_load_dwordx4 a[28:31], v21, s[40:43], s89 offen offset:1024 sc1
buffer_load_dwordx4 a[32:35], v21, s[40:43], s90 offen offset:1024 sc1
buffer_load_dwordx4 a[36:39], v21, s[40:43], s86 offen offset:2048 sc1
buffer_load_dwordx4 a[40:43], v21, s[40:43], s87 offen offset:2048 sc1
buffer_load_dwordx4 a[44:47], v21, s[40:43], s88 offen offset:2048 sc1
buffer_load_dwordx4 a[48:51], v21, s[40:43], s89 offen offset:2048 sc1
buffer_load_dwordx4 a[52:55], v21, s[40:43], s90 offen offset:2048 sc1
s_branch Lcommon
Lcsq0:
s_cmp_eq_u32 s56, 0
s_cbranch_scc0 Lcsq0_0
v_mfma_f32_16x16x32_bf16 a[112:115], a[16:19], a[128:131], 0
v_mfma_f32_16x16x32_bf16 a[116:119], a[32:35], a[128:131], 0
v_mfma_f32_16x16x32_bf16 a[120:123], a[48:51], a[128:131], 0
s_branch Lcrq0
Lcsq0_0:
s_cmp_eq_u32 s56, 1
s_cbranch_scc0 Lcsq0_1
s_nop 0
v_mfma_f32_16x16x32_bf16 a[112:115], a[20:23], a[128:131], 0
v_mfma_f32_16x16x32_bf16 a[116:119], a[36:39], a[128:131], 0
v_mfma_f32_16x16x32_bf16 a[120:123], a[52:55], a[128:131], 0
s_branch Lcrq0
Lcsq0_1:
s_cmp_eq_u32 s56, 2
s_cbranch_scc0 Lcsq0_2
s_nop 0
v_mfma_f32_16x16x32_bf16 a[112:115], a[24:27], a[128:131], 0
v_mfma_f32_16x16x32_bf16 a[116:119], a[40:43], a[128:131], 0
s_branch Lcrq0
Lcsq0_2:
s_nop 3
v_mfma_f32_16x16x32_bf16 a[112:115], a[28:31], a[128:131], 0
v_mfma_f32_16x16x32_bf16 a[116:119], a[44:47], a[128:131], 0
s_branch Lcrq0
Lcsq1:
s_cmp_eq_u32 s56, 0
s_cbranch_scc0 Lcsq1_0
v_mfma_f32_16x16x32_bf16 a[112:115], a[72:75], a[128:131], a[112:115]
v_mfma_f32_16x16x32_bf16 a[116:119], a[88:91], a[128:131], a[116:119]
v_mfma_f32_16x16x32_bf16 a[120:123], a[104:107], a[128:131], a[120:123]
s_bfe_u32 s66, s57, 0x40000
s_mul_i32 s66, s66, 19968
s_add_u32 s66, s66, s73
s_add_u32 s67, s66, 6144
s_nop 4
buffer_store_dwordx4 a[112:115], v94, s[40:43], s66 offen offset:0 sc1
buffer_store_dwordx4 a[116:119], v94, s[40:43], s66 offen offset:64 sc1
buffer_store_dwordx4 a[120:123], v94, s[40:43], s66 offen offset:368 sc1
s_branch Lcrq1
Lcsq1_0:
s_cmp_eq_u32 s56, 1
s_cbranch_scc0 Lcsq1_1
v_mfma_f32_16x16x32_bf16 a[112:115], a[76:79], a[128:131], a[112:115]
v_mfma_f32_16x16x32_bf16 a[116:119], a[92:95], a[128:131], a[116:119]
v_mfma_f32_16x16x32_bf16 a[120:123], a[108:111], a[128:131], a[120:123]
s_bfe_u32 s66, s57, 0x40000
s_mul_i32 s66, s66, 19968
s_add_u32 s66, s66, s73
s_add_u32 s67, s66, 6144
s_nop 4
buffer_store_dwordx4 a[112:115], v94, s[40:43], s66 offen offset:16 sc1
buffer_store_dwordx4 a[116:119], v94, s[40:43], s66 offen offset:320 sc1
buffer_store_dwordx4 a[120:123], v94, s[40:43], s66 offen offset:384 sc1
s_branch Lcrq1
Lcsq1_1:
s_cmp_eq_u32 s56, 2
s_cbranch_scc0 Lcsq1_2
v_mfma_f32_16x16x32_bf16 a[112:115], a[80:83], a[128:131], a[112:115]
v_mfma_f32_16x16x32_bf16 a[116:119], a[96:99], a[128:131], a[116:119]
s_bfe_u32 s66, s57, 0x40000
s_mul_i32 s66, s66, 19968
s_add_u32 s66, s66, s73
s_add_u32 s67, s66, 6144
s_nop 4
buffer_store_dwordx4 a[112:115], v94, s[40:43], s66 offen offset:32 sc1
buffer_store_dwordx4 a[116:119], v94, s[40:43], s66 offen offset:336 sc1
s_branch Lcrq1
Lcsq1_2:
v_mfma_f32_16x16x32_bf16 a[112:115], a[84:87], a[128:131], a[112:115]
v_mfma_f32_16x16x32_bf16 a[116:119], a[100:103], a[128:131], a[116:119]
s_bfe_u32 s66, s57, 0x40000
s_mul_i32 s66, s66, 19968
s_add_u32 s66, s66, s73
s_add_u32 s67, s66, 6144
s_nop 4
buffer_store_dwordx4 a[112:115], v94, s[40:43], s66 offen offset:48 sc1
buffer_store_dwordx4 a[116:119], v94, s[40:43], s66 offen offset:352 sc1
s_branch Lcrq1
Lcsq2:
s_cmp_eq_u32 s56, 0
s_cbranch_scc0 Lcsq2_0
v_mfma_f32_16x16x32_bf16 a[112:115], a[16:19], a[128:131], 0
v_mfma_f32_16x16x32_bf16 a[116:119], a[32:35], a[128:131], 0
v_mfma_f32_16x16x32_bf16 a[120:123], a[48:51], a[128:131], 0
s_branch Lcrq2
Lcsq2_0:
s_cmp_eq_u32 s56, 1
s_cbranch_scc0 Lcsq2_1
s_nop 0
v_mfma_f32_16x16x32_bf16 a[112:115], a[20:23], a[128:131], 0
v_mfma_f32_16x16x32_bf16 a[116:119], a[36:39], a[128:131], 0
v_mfma_f32_16x16x32_bf16 a[120:123], a[52:55], a[128:131], 0
s_branch Lcrq2
Lcsq2_1:
s_cmp_eq_u32 s56, 2
s_cbranch_scc0 Lcsq2_2
s_nop 0
v_mfma_f32_16x16x32_bf16 a[112:115], a[24:27], a[128:131], 0
v_mfma_f32_16x16x32_bf16 a[116:119], a[40:43], a[128:131], 0
s_branch Lcrq2
Lcsq2_2:
s_nop 3
v_mfma_f32_16x16x32_bf16 a[112:115], a[28:31], a[128:131], 0
v_mfma_f32_16x16x32_bf16 a[116:119], a[44:47], a[128:131], 0
s_branch Lcrq2
Lcsq3:
s_cmp_eq_u32 s56, 0
s_cbranch_scc0 Lcsq3_0
v_mfma_f32_16x16x32_bf16 a[112:115], a[72:75], a[128:131], a[112:115]
v_mfma_f32_16x16x32_bf16 a[116:119], a[88:91], a[128:131], a[116:119]
v_mfma_f32_16x16x32_bf16 a[120:123], a[104:107], a[128:131], a[120:123]
s_bfe_u32 s66, s57, 0x40004
s_mul_i32 s66, s66, 19968
s_add_u32 s66, s66, s73
s_add_u32 s67, s66, 6144
s_nop 4
buffer_store_dwordx4 a[112:115], v94, s[40:43], s66 offen offset:0 sc1
buffer_store_dwordx4 a[116:119], v94, s[40:43], s66 offen offset:64 sc1
buffer_store_dwordx4 a[120:123], v94, s[40:43], s66 offen offset:368 sc1
s_branch Lcrq3
Lcsq3_0:
s_cmp_eq_u32 s56, 1
s_cbranch_scc0 Lcsq3_1
v_mfma_f32_16x16x32_bf16 a[112:115], a[76:79], a[128:131], a[112:115]
v_mfma_f32_16x16x32_bf16 a[116:119], a[92:95], a[128:131], a[116:119]
v_mfma_f32_16x16x32_bf16 a[120:123], a[108:111], a[128:131], a[120:123]
s_bfe_u32 s66, s57, 0x40004
s_mul_i32 s66, s66, 19968
s_add_u32 s66, s66, s73
s_add_u32 s67, s66, 6144
s_nop 4
buffer_store_dwordx4 a[112:115], v94, s[40:43], s66 offen offset:16 sc1
buffer_store_dwordx4 a[116:119], v94, s[40:43], s66 offen offset:320 sc1
buffer_store_dwordx4 a[120:123], v94, s[40:43], s66 offen offset:384 sc1
s_branch Lcrq3
Lcsq3_1:
s_cmp_eq_u32 s56, 2
s_cbranch_scc0 Lcsq3_2
v_mfma_f32_16x16x32_bf16 a[112:115], a[80:83], a[128:131], a[112:115]
v_mfma_f32_16x16x32_bf16 a[116:119], a[96:99], a[128:131], a[116:119]
s_bfe_u32 s66, s57, 0x40004
s_mul_i32 s66, s66, 19968
s_add_u32 s66, s66, s73
s_add_u32 s67, s66, 6144
s_nop 4
buffer_store_dwordx4 a[112:115], v94, s[40:43], s66 offen offset:32 sc1
buffer_store_dwordx4 a[116:119], v94, s[40:43], s66 offen offset:336 sc1
s_branch Lcrq3
Lcsq3_2:
v_mfma_f32_16x16x32_bf16 a[112:115], a[84:87], a[128:131], a[112:115]
v_mfma_f32_16x16x32_bf16 a[116:119], a[100:103], a[128:131], a[116:119]
s_bfe_u32 s66, s57, 0x40004
s_mul_i32 s66, s66, 19968
s_add_u32 s66, s66, s73
s_add_u32 s67, s66, 6144
s_nop 4
buffer_store_dwordx4 a[112:115], v94, s[40:43], s66 offen offset:48 sc1
buffer_store_dwordx4 a[116:119], v94, s[40:43], s66 offen offset:352 sc1
s_branch Lcrq3
Lcsq4:
s_cmp_eq_u32 s56, 0
s_cbranch_scc0 Lcsq4_0
v_mfma_f32_16x16x32_bf16 a[112:115], a[16:19], a[128:131], 0
v_mfma_f32_16x16x32_bf16 a[116:119], a[32:35], a[128:131], 0
v_mfma_f32_16x16x32_bf16 a[120:123], a[48:51], a[128:131], 0
s_branch Lcrq4
Lcsq4_0:
s_cmp_eq_u32 s56, 1
s_cbranch_scc0 Lcsq4_1
s_nop 0
v_mfma_f32_16x16x32_bf16 a[112:115], a[20:23], a[128:131], 0
v_mfma_f32_16x16x32_bf16 a[116:119], a[36:39], a[128:131], 0
v_mfma_f32_16x16x32_bf16 a[120:123], a[52:55], a[128:131], 0
s_branch Lcrq4
Lcsq4_1:
s_cmp_eq_u32 s56, 2
s_cbranch_scc0 Lcsq4_2
s_nop 0
v_mfma_f32_16x16x32_bf16 a[112:115], a[24:27], a[128:131], 0
v_mfma_f32_16x16x32_bf16 a[116:119], a[40:43], a[128:131], 0
s_branch Lcrq4
Lcsq4_2:
s_nop 3
v_mfma_f32_16x16x32_bf16 a[112:115], a[28:31], a[128:131], 0
v_mfma_f32_16x16x32_bf16 a[116:119], a[44:47], a[128:131], 0
s_branch Lcrq4
Lcsq5:
s_cmp_eq_u32 s56, 0
s_cbranch_scc0 Lcsq5_0
v_mfma_f32_16x16x32_bf16 a[112:115], a[72:75], a[128:131], a[112:115]
v_mfma_f32_16x16x32_bf16 a[116:119], a[88:91], a[128:131], a[116:119]
v_mfma_f32_16x16x32_bf16 a[120:123], a[104:107], a[128:131], a[120:123]
s_bfe_u32 s66, s57, 0x40008
s_mul_i32 s66, s66, 19968
s_add_u32 s66, s66, s73
s_add_u32 s67, s66, 6144
s_nop 4
buffer_store_dwordx4 a[112:115], v94, s[40:43], s66 offen offset:0 sc1
buffer_store_dwordx4 a[116:119], v94, s[40:43], s66 offen offset:64 sc1
buffer_store_dwordx4 a[120:123], v94, s[40:43], s66 offen offset:368 sc1
s_branch Lcrq5
Lcsq5_0:
s_cmp_eq_u32 s56, 1
s_cbranch_scc0 Lcsq5_1
v_mfma_f32_16x16x32_bf16 a[112:115], a[76:79], a[128:131], a[112:115]
v_mfma_f32_16x16x32_bf16 a[116:119], a[92:95], a[128:131], a[116:119]
v_mfma_f32_16x16x32_bf16 a[120:123], a[108:111], a[128:131], a[120:123]
s_bfe_u32 s66, s57, 0x40008
s_mul_i32 s66, s66, 19968
s_add_u32 s66, s66, s73
s_add_u32 s67, s66, 6144
s_nop 4
buffer_store_dwordx4 a[112:115], v94, s[40:43], s66 offen offset:16 sc1
buffer_store_dwordx4 a[116:119], v94, s[40:43], s66 offen offset:320 sc1
buffer_store_dwordx4 a[120:123], v94, s[40:43], s66 offen offset:384 sc1
s_branch Lcrq5
Lcsq5_1:
s_cmp_eq_u32 s56, 2
s_cbranch_scc0 Lcsq5_2
v_mfma_f32_16x16x32_bf16 a[112:115], a[80:83], a[128:131], a[112:115]
v_mfma_f32_16x16x32_bf16 a[116:119], a[96:99], a[128:131], a[116:119]
s_bfe_u32 s66, s57, 0x40008
s_mul_i32 s66, s66, 19968
s_add_u32 s66, s66, s73
s_add_u32 s67, s66, 6144
s_nop 4
buffer_store_dwordx4 a[112:115], v94, s[40:43], s66 offen offset:32 sc1
buffer_store_dwordx4 a[116:119], v94, s[40:43], s66 offen offset:336 sc1
s_branch Lcrq5
Lcsq5_2:
v_mfma_f32_16x16x32_bf16 a[112:115], a[84:87], a[128:131], a[112:115]
v_mfma_f32_16x16x32_bf16 a[116:119], a[100:103], a[128:131], a[116:119]
s_bfe_u32 s66, s57, 0x40008
s_mul_i32 s66, s66, 19968
s_add_u32 s66, s66, s73
s_add_u32 s67, s66, 6144
s_nop 4
buffer_store_dwordx4 a[112:115], v94, s[40:43], s66 offen offset:48 sc1
buffer_store_dwordx4 a[116:119], v94, s[40:43], s66 offen offset:352 sc1
s_branch Lcrq5
Lcsq6:
s_cmp_eq_u32 s56, 0
s_cbranch_scc0 Lcsq6_0
v_mfma_f32_16x16x32_bf16 a[112:115], a[16:19], a[128:131], 0
v_mfma_f32_16x16x32_bf16 a[116:119], a[32:35], a[128:131], 0
v_mfma_f32_16x16x32_bf16 a[120:123], a[48:51], a[128:131], 0
s_branch Lcrq6
Lcsq6_0:
s_cmp_eq_u32 s56, 1
s_cbranch_scc0 Lcsq6_1
s_nop 0
v_mfma_f32_16x16x32_bf16 a[112:115], a[20:23], a[128:131], 0
v_mfma_f32_16x16x32_bf16 a[116:119], a[36:39], a[128:131], 0
v_mfma_f32_16x16x32_bf16 a[120:123], a[52:55], a[128:131], 0
s_branch Lcrq6
Lcsq6_1:
s_cmp_eq_u32 s56, 2
s_cbranch_scc0 Lcsq6_2
s_nop 0
v_mfma_f32_16x16x32_bf16 a[112:115], a[24:27], a[128:131], 0
v_mfma_f32_16x16x32_bf16 a[116:119], a[40:43], a[128:131], 0
s_branch Lcrq6
Lcsq6_2:
s_nop 3
v_mfma_f32_16x16x32_bf16 a[112:115], a[28:31], a[128:131], 0
v_mfma_f32_16x16x32_bf16 a[116:119], a[44:47], a[128:131], 0
s_branch Lcrq6
Lcsq7:
s_cmp_eq_u32 s56, 0
s_cbranch_scc0 Lcsq7_0
v_mfma_f32_16x16x32_bf16 a[112:115], a[72:75], a[128:131], a[112:115]
v_mfma_f32_16x16x32_bf16 a[116:119], a[88:91], a[128:131], a[116:119]
v_mfma_f32_16x16x32_bf16 a[120:123], a[104:107], a[128:131], a[120:123]
s_bfe_u32 s66, s57, 0x4000c
s_mul_i32 s66, s66, 19968
s_add_u32 s66, s66, s73
s_add_u32 s67, s66, 6144
s_nop 4
buffer_store_dwordx4 a[112:115], v94, s[40:43], s66 offen offset:0 sc1
buffer_store_dwordx4 a[116:119], v94, s[40:43], s66 offen offset:64 sc1
buffer_store_dwordx4 a[120:123], v94, s[40:43], s66 offen offset:368 sc1
s_branch Lcrq7
Lcsq7_0:
s_cmp_eq_u32 s56, 1
s_cbranch_scc0 Lcsq7_1
v_mfma_f32_16x16x32_bf16 a[112:115], a[76:79], a[128:131], a[112:115]
v_mfma_f32_16x16x32_bf16 a[116:119], a[92:95], a[128:131], a[116:119]
v_mfma_f32_16x16x32_bf16 a[120:123], a[108:111], a[128:131], a[120:123]
s_bfe_u32 s66, s57, 0x4000c
s_mul_i32 s66, s66, 19968
s_add_u32 s66, s66, s73
s_add_u32 s67, s66, 6144
s_nop 4
buffer_store_dwordx4 a[112:115], v94, s[40:43], s66 offen offset:16 sc1
buffer_store_dwordx4 a[116:119], v94, s[40:43], s66 offen offset:320 sc1
buffer_store_dwordx4 a[120:123], v94, s[40:43], s66 offen offset:384 sc1
s_branch Lcrq7
Lcsq7_1:
s_cmp_eq_u32 s56, 2
s_cbranch_scc0 Lcsq7_2
v_mfma_f32_16x16x32_bf16 a[112:115], a[80:83], a[128:131], a[112:115]
v_mfma_f32_16x16x32_bf16 a[116:119], a[96:99], a[128:131], a[116:119]
s_bfe_u32 s66, s57, 0x4000c
s_mul_i32 s66, s66, 19968
s_add_u32 s66, s66, s73
s_add_u32 s67, s66, 6144
s_nop 4
buffer_store_dwordx4 a[112:115], v94, s[40:43], s66 offen offset:32 sc1
buffer_store_dwordx4 a[116:119], v94, s[40:43], s66 offen offset:336 sc1
s_branch Lcrq7
Lcsq7_2:
v_mfma_f32_16x16x32_bf16 a[112:115], a[84:87], a[128:131], a[112:115]
v_mfma_f32_16x16x32_bf16 a[116:119], a[100:103], a[128:131], a[116:119]
s_bfe_u32 s66, s57, 0x4000c
s_mul_i32 s66, s66, 19968
s_add_u32 s66, s66, s73
s_add_u32 s67, s66, 6144
s_nop 4
buffer_store_dwordx4 a[112:115], v94, s[40:43], s66 offen offset:48 sc1
buffer_store_dwordx4 a[116:119], v94, s[40:43], s66 offen offset:352 sc1
s_branch Lcrq7
Lrole_ffn:
s_sub_u32 s68, s65, 12
s_mul_i32 s69, s68, 43
s_lshr_b32 s69, s69, 7
s_mul_i32 s70, s69, 3
s_sub_u32 s70, s68, s70
s_mul_i32 s71, s66, 7
s_add_u32 s58, s69, s71
s_mul_i32 s71, s67, 3
s_add_u32 s59, s71, s70
s_cmp_lt_u32 s58, 13
s_cbranch_scc1 Lffn
s_mov_b32 s58, 6
s_add_u32 s59, s71, 2
s_cmp_eq_u32 s68, 19
s_cbranch_scc1 Lspare
Lffn:
s_mul_i32 s64, s58, 160
s_mul_i32 s65, s56, 40
s_add_u32 s64, s64, s65
s_mul_i32 s64, s64, 1280
v_lshrrev_b32 v2, 3, v1
v_mul_u32_u24 v2, 1280, v2
v_add_u32 v2, s64, v2
v_lshrrev_b32 v3, 4, v1
v_and_b32 v4, 7, v1
v_xor_b32 v3, v3, v4
s_and_b32 s65, s56, 1
s_lshl_b32 s65, s65, 2
v_xor_b32_e64 v3, s65, v3
v_lshl_add_u32 v4, v3, 4, v2
v_xor_b32_e64 v3, 4, v3
v_lshl_add_u32 v5, v3, 4, v2
v_add_u32_e64 v8, 0, v4
v_add_u32 v9, 9216, v5
v_add_u32 v10, 18432, v4
v_add_u32 v11, 27648, v5
v_add_u32 v12, 40960, v4
s_mul_i32 s62, s56, 5120
s_bfe_u32 s66, s2, 0x10002
s_mul_i32 s67, s66, 7
s_sub_u32 s67, s58, s67
s_mov_b32 s68, 0x76543210
s_mov_b32 s69, 0x76532104
s_cmp_eq_u32 s67, 4
s_cselect_b32 s74, s69, s68
s_mov_b32 s75, 0x98
s_cmp_eq_u32 s66, 0
s_cbranch_scc1 Lupf
s_sub_u32 s74, 0x99999999, s74
s_mov_b32 s75, 0x01
Lupf:
s_and_b32 s68, s74, 15
s_lshl_b32 s60, s68, 7
s_waitcnt lgkmcnt(0)
s_mov_b32 s28, s4
s_mov_b32 s29, s5
s_mov_b32 s30, 2621440
s_mov_b32 s31, 0x20000
s_add_u32 m0, s62, 0
s_nop 0
buffer_load_dwordx4 v8, s[28:31], s60 offen offset:0  lds
buffer_load_dwordx4 v9, s[28:31], s60 offen offset:1024  lds
buffer_load_dwordx4 v10, s[28:31], s60 offen offset:2048  lds
buffer_load_dwordx4 v11, s[28:31], s60 offen offset:3072  lds
s_add_u32 m0, s62, 4096
s_nop 0
buffer_load_dwordx4 v12, s[28:31], s60 offen offset:0  lds
s_mul_i32 s61, s68, 196608
s_and_b32 s69, s67, 3
s_lshl_b32 s72, 1, s69
s_cmp_lt_u32 s67, 5
s_cselect_b32 s72, s72, 0
s_mul_i32 s64, s56, 49152
s_lshl_b32 s65, s59, 8
s_add_u32 s64, s64, s65
v_lshrrev_b32 v2, 4, v1
v_mul_u32_u24 v3, 3072, v2
v_add_u32 v3, s64, v3
v_lshlrev_b32 v2, 1, v2
v_and_b32 v4, 15, v1
v_xor_b32 v2, v2, v4
v_lshl_add_u32 v4, v2, 4, v3
v_xor_b32_e64 v2, 8, v2
v_lshl_add_u32 v5, v2, 4, v3
v_add_u32 v16, 0, v4
v_add_u32 v17, 11264, v4
v_add_u32 v18, 22528, v5
v_add_u32 v19, 33792, v5
s_lshl_b32 s63, s56, 12
s_add_u32 s63, s63, 20480
s_mov_b32 s32, s14
s_mov_b32 s33, s15
s_mov_b32 s34, 1966080
s_mov_b32 s35, 0x20000
s_mov_b32 s36, s16
s_mov_b32 s37, s17
s_mov_b32 s38, 1966080
s_mov_b32 s39, 0x20000
s_add_u32 m0, s63, 0
s_nop 0
buffer_load_dwordx4 v16, s[32:35], s61 offen offset:0  lds
buffer_load_dwordx4 v17, s[32:35], s61 offen offset:1024  lds
buffer_load_dwordx4 v18, s[32:35], s61 offen offset:2048  lds
buffer_load_dwordx4 v19, s[32:35], s61 offen offset:3072  lds
s_add_u32 m0, s63, 16384
s_nop 0
buffer_load_dwordx4 v16, s[36:39], s61 offen offset:0  lds
buffer_load_dwordx4 v17, s[36:39], s61 offen offset:1024  lds
buffer_load_dwordx4 v18, s[36:39], s61 offen offset:2048  lds
buffer_load_dwordx4 v19, s[36:39], s61 offen offset:3072  lds
s_mov_b32 s57, s74
v_and_b32 v2, 15, v1
v_lshrrev_b32 v3, 4, v1
v_lshrrev_b32 v4, 1, v2
v_xor_b32 v4, v4, v3
v_lshlrev_b32_e64 v4, 4, v4
v_lshl_add_u32 v4, v2, 7, v4
v_xor_b32 v5, 64, v4
v_add_u32 v22, 0, v4
v_add_u32_e64 v23, 0, v5
v_add_u32 v24, 53248, v4
v_add_u32 v25, 53248, v5
v_add_u32 v26, 106496, v4
v_add_u32 v27, 106496, v5
v_bfe_u32 v2, v1, 2, 2
v_and_b32 v5, 3, v1
v_and_b32 v4, 1, v3
v_lshl_add_u32 v4, v4, 2, v2
s_lshl_b32 s64, s56, 1
v_xor_b32 v4, s64, v4
v_lshlrev_b32_e64 v4, 5, v4
v_lshl_add_u32 v4, v5, 3, v4
v_lshl_add_u32 v2, v3, 3, v2
v_lshl_add_u32 v4, v2, 8, v4
v_xor_b32_e64 v5, 32, v4
v_add_u32 v28, 20480, v4
v_add_u32 v29, 20480, v5
v_add_u32 v30, 73728, v4
v_add_u32 v31, 73728, v5
v_add_u32 v32, 126976, v4
v_add_u32 v33, 126976, v5
s_lshr_b64 s[74:75], s[74:75], 4
s_and_b32 s13, s74, 15
s_lshl_b32 s60, s13, 7
s_mul_i32 s61, s13, 196608
s_add_u32 m0, s62, 53248
s_nop 0
buffer_load_dwordx4 v8, s[28:31], s60 offen offset:0  lds
buffer_load_dwordx4 v9, s[28:31], s60 offen offset:1024  lds
buffer_load_dwordx4 v10, s[28:31], s60 offen offset:2048  lds
buffer_load_dwordx4 v11, s[28:31], s60 offen offset:3072  lds
s_add_u32 m0, s62, 57344
s_nop 0
buffer_load_dwordx4 v12, s[28:31], s60 offen offset:0  lds
s_add_u32 m0, s63, 53248
s_nop 0
buffer_load_dwordx4 v16, s[32:35], s61 offen offset:0  lds
buffer_load_dwordx4 v17, s[32:35], s61 offen offset:1024  lds
buffer_load_dwordx4 v18, s[32:35], s61 offen offset:2048  lds
buffer_load_dwordx4 v19, s[32:35], s61 offen offset:3072  lds
s_add_u32 m0, s63, 69632
s_nop 0
buffer_load_dwordx4 v16, s[36:39], s61 offen offset:0  lds
buffer_load_dwordx4 v17, s[36:39], s61 offen offset:1024  lds
buffer_load_dwordx4 v18, s[36:39], s61 offen offset:2048  lds
buffer_load_dwordx4 v19, s[36:39], s61 offen offset:3072  lds
s_mov_b32 s40, s24
s_mov_b32 s41, s25
s_mov_b32 s42, 17825792
s_mov_b32 s43, 0x20000
s_mov_b32 s48, s22
s_mov_b32 s49, s23
s_mov_b32 s50, 256
s_mov_b32 s51, 0x20000
v_lshlrev_b32 v6, 4, v1
v_add_u32 v21, 4096, v6
v_add_u32 v0, 8192, v6
v_mov_b32 v7, 0x7f000000
v_cmp_eq_u32 vcc, 0, v1
s_nop 1
v_cndmask_b32 v7, v7, 0, vcc
s_mov_b32 s80, 0x3fb8aa3b
s_mov_b32 s81, 0x3fb8aa3b
s_mov_b32 s82, 0x05040100
s_mov_b32 s83, 0x07060302
s_lshl_b32 s12, s56, 10
s_mov_b32 s78, 0xffff0000
s_and_b32 s64, s2, 7
s_lshr_b32 s65, s2, 3
s_sub_u32 s66, s65, 8
s_and_b32 s67, s66, 3
s_lshl_b32 s68, s64, 2
s_add_u32 s67, s67, s68
s_lshl_b32 s68, s59, 2
s_cmp_lt_u32 s65, 8
s_cselect_b32 s27, s68, s67
s_lshr_b32 s66, s66, 2
s_lshl_b32 s66, s66, 2
s_add_u32 s66, s66, s56
s_mul_i32 s26, s66, 6
s_lshl_b32 s95, s64, 2
s_and_b32 s66, s65, 3
s_add_u32 s95, s95, s66
s_lshr_b32 s96, s65, 2
s_mul_i32 s3, s56, -7168
s_add_u32 s3, s3, 49152
s_mul_i32 s64, s96, 348160
s_mul_i32 s65, s56, 12288
s_add_u32 s64, s64, s65
s_add_u32 s86, s64, 9437184
s_add_u32 s87, s86, 69632
s_add_u32 s88, s87, 69632
s_add_u32 s89, s88, 69632
s_add_u32 s90, s89, 69632
s_mul_i32 s64, s95, 278528
s_add_u32 s64, s64, s65
s_add_u32 s66, s56, 0
s_and_b32 s66, s66, 3
s_mul_i32 s66, s66, 69632
s_add_u32 s91, s64, s66
s_add_u32 s66, s56, 1
s_and_b32 s66, s66, 3
s_mul_i32 s66, s66, 69632
s_add_u32 s92, s64, s66
s_add_u32 s66, s56, 2
s_and_b32 s66, s66, 3
s_mul_i32 s66, s66, 69632
s_add_u32 s93, s64, s66
s_add_u32 s66, s56, 3
s_and_b32 s66, s66, 3
s_mul_i32 s66, s66, 69632
s_add_u32 s94, s64, s66
s_waitcnt vmcnt(13)
s_barrier
ds_read_b64_tr_b16 a[40:41], v28 offset:0
ds_read_b64_tr_b16 a[42:43], v28 offset:1024
ds_read_b64_tr_b16 a[44:45], v29 offset:0
ds_read_b64_tr_b16 a[46:47], v29 offset:1024
ds_read_b64_tr_b16 a[48:49], v28 offset:16384
ds_read_b64_tr_b16 a[50:51], v28 offset:17408
ds_read_b64_tr_b16 a[52:53], v29 offset:16384
ds_read_b64_tr_b16 a[54:55], v29 offset:17408
ds_read_b128 a[0:3], v22 offset:0
ds_read_b128 a[4:7], v22 offset:2048
ds_read_b128 a[8:11], v22 offset:4096
ds_read_b128 a[12:15], v22 offset:6144
ds_read_b128 a[16:19], v22 offset:8192
ds_read_b128 a[20:23], v22 offset:10240
ds_read_b128 a[24:27], v22 offset:12288
ds_read_b128 a[28:31], v22 offset:14336
ds_read_b128 a[32:35], v22 offset:16384
ds_read_b128 a[36:39], v22 offset:18432
s_waitcnt lgkmcnt(0)
v_mfma_f32_16x16x32_bf16 v[96:99], a[40:43], a[0:3], 0
ds_read_b64_tr_b16 a[96:97], v28 offset:8192
v_mfma_f32_16x16x32_bf16 v[100:103], a[44:47], a[0:3], 0
v_mfma_f32_16x16x32_bf16 v[104:107], a[48:51], a[0:3], 0
ds_read_b64_tr_b16 a[98:99], v28 offset:9216
v_mfma_f32_16x16x32_bf16 v[108:111], a[52:55], a[0:3], 0
s_lshr_b64 s[74:75], s[74:75], 4
s_and_b32 s13, s74, 15
s_lshl_b32 s60, s13, 7
v_mfma_f32_16x16x32_bf16 v[124:127], a[52:55], a[4:7], 0
s_mul_i32 s61, s13, 196608
s_add_u32 m0, s62, 106496
v_mfma_f32_16x16x32_bf16 v[120:123], a[48:51], a[4:7], 0
buffer_load_dwordx4 v8, s[28:31], s60 offen offset:0  lds
ds_read_b64_tr_b16 a[100:101], v29 offset:8192
v_mfma_f32_16x16x32_bf16 v[116:119], a[44:47], a[4:7], 0
ds_read_b64_tr_b16 a[102:103], v29 offset:9216
buffer_load_dwordx4 v9, s[28:31], s60 offen offset:1024  lds
v_mfma_f32_16x16x32_bf16 v[112:115], a[40:43], a[4:7], 0
ds_read_b64_tr_b16 a[104:105], v28 offset:24576
v_mfma_f32_16x16x32_bf16 v[128:131], a[40:43], a[8:11], 0
v_mfma_f32_16x16x32_bf16 v[132:135], a[44:47], a[8:11], 0
ds_read_b64_tr_b16 a[106:107], v28 offset:25600
buffer_load_dwordx4 v10, s[28:31], s60 offen offset:2048  lds
v_mfma_f32_16x16x32_bf16 v[136:139], a[48:51], a[8:11], 0
ds_read_b64_tr_b16 a[108:109], v29 offset:24576
v_mfma_f32_16x16x32_bf16 v[140:143], a[52:55], a[8:11], 0
v_mfma_f32_16x16x32_bf16 v[156:159], a[52:55], a[12:15], 0
buffer_load_dwordx4 v11, s[28:31], s60 offen offset:3072  lds
ds_read_b64_tr_b16 a[110:111], v29 offset:25600
v_mfma_f32_16x16x32_bf16 v[152:155], a[48:51], a[12:15], 0
v_mfma_f32_16x16x32_bf16 v[148:151], a[44:47], a[12:15], 0
ds_read_b128 a[56:59], v23 offset:0
v_mfma_f32_16x16x32_bf16 v[144:147], a[40:43], a[12:15], 0
s_add_u32 m0, s62, 110592
v_mfma_f32_16x16x32_bf16 v[160:163], a[40:43], a[16:19], 0
buffer_load_dwordx4 v12, s[28:31], s60 offen offset:0  lds
ds_read_b128 a[60:63], v23 offset:2048
v_mfma_f32_16x16x32_bf16 v[164:167], a[44:47], a[16:19], 0
ds_read_b128 a[64:67], v23 offset:4096
v_mfma_f32_16x16x32_bf16 v[168:171], a[48:51], a[16:19], 0
s_add_u32 m0, s63, 106496
v_mfma_f32_16x16x32_bf16 v[172:175], a[52:55], a[16:19], 0
buffer_load_dwordx4 v16, s[32:35], s61 offen offset:0  lds
v_mov_b32 v2, 0x3f803f80
v_mfma_f32_16x16x32_bf16 v[188:191], a[52:55], a[20:23], 0
v_accvgpr_write_b32 a128, v2
v_accvgpr_write_b32 a129, v2
v_accvgpr_write_b32 a130, v2
v_mfma_f32_16x16x32_bf16 v[184:187], a[48:51], a[20:23], 0
v_accvgpr_write_b32 a131, v2
v_lshrrev_b32 v2, 4, v1
v_mul_u32_u24 v2, 16, v2
v_mfma_f32_16x16x32_bf16 v[180:183], a[44:47], a[20:23], 0
v_and_b32 v3, 15, v1
v_cmp_eq_u32 vcc, 0, v3
v_mov_b32 v3, 0x7f000000
v_mfma_f32_16x16x32_bf16 v[176:179], a[40:43], a[20:23], 0
s_mov_b32 s64, 0
v_cndmask_b32 v94, v3, v2, vcc
s_lshl_b32 s65, s59, 9
v_mfma_f32_16x16x32_bf16 v[192:195], a[40:43], a[24:27], 0
s_add_u32 s64, s64, s65
s_lshl_b32 s65, s56, 7
s_add_u32 s64, s64, s65
v_mfma_f32_16x16x32_bf16 v[196:199], a[44:47], a[24:27], 0
s_add_u32 s73, s64, 16850432
ds_read_b128 a[68:71], v23 offset:6144
ds_read_b128 a[72:75], v23 offset:8192
v_mfma_f32_16x16x32_bf16 v[200:203], a[48:51], a[24:27], 0
buffer_load_dwordx4 v17, s[32:35], s61 offen offset:1024  lds
ds_read_b128 a[76:79], v23 offset:10240
v_mfma_f32_16x16x32_bf16 v[204:207], a[52:55], a[24:27], 0
buffer_load_dwordx4 v18, s[32:35], s61 offen offset:2048  lds
ds_read_b128 a[80:83], v23 offset:12288
v_mfma_f32_16x16x32_bf16 v[220:223], a[52:55], a[28:31], 0
ds_read_b128 a[84:87], v23 offset:14336
buffer_load_dwordx4 v19, s[32:35], s61 offen offset:3072  lds
v_mfma_f32_16x16x32_bf16 v[216:219], a[48:51], a[28:31], 0
ds_read_b128 a[88:91], v23 offset:16384
ds_read_b128 a[92:95], v23 offset:18432
s_add_u32 m0, s63, 122880
v_mfma_f32_16x16x32_bf16 v[212:215], a[44:47], a[28:31], 0
buffer_load_dwordx4 v16, s[36:39], s61 offen offset:0  lds
v_mfma_f32_16x16x32_bf16 v[208:211], a[40:43], a[28:31], 0
v_mfma_f32_16x16x32_bf16 v[224:227], a[40:43], a[32:35], 0
buffer_load_dwordx4 v17, s[36:39], s61 offen offset:1024  lds
v_mfma_f32_16x16x32_bf16 v[228:231], a[44:47], a[32:35], 0
v_mfma_f32_16x16x32_bf16 v[232:235], a[48:51], a[32:35], 0
v_mfma_f32_16x16x32_bf16 v[236:239], a[52:55], a[32:35], 0
buffer_load_dwordx4 v18, s[36:39], s61 offen offset:2048  lds
v_mfma_f32_16x16x32_bf16 v[252:255], a[52:55], a[36:39], 0
v_mfma_f32_16x16x32_bf16 v[248:251], a[48:51], a[36:39], 0
v_mfma_f32_16x16x32_bf16 v[244:247], a[44:47], a[36:39], 0
buffer_load_dwordx4 v19, s[36:39], s61 offen offset:3072  lds
v_mfma_f32_16x16x32_bf16 v[240:243], a[40:43], a[36:39], 0
s_bitcmp1_b32 s72, 0
s_cbranch_scc1 Lcsf0
Lcrf0:
s_waitcnt lgkmcnt(0)
s_waitcnt vmcnt(13)
s_barrier
v_mfma_f32_16x16x32_bf16 v[96:99], a[96:99], a[56:59], v[96:99]
ds_read_b64_tr_b16 a[40:41], v30 offset:0
v_mfma_f32_16x16x32_bf16 v[100:103], a[100:103], a[56:59], v[100:103]
v_mfma_f32_16x16x32_bf16 v[104:107], a[104:107], a[56:59], v[104:107]
ds_read_b64_tr_b16 a[42:43], v30 offset:1024
s_mul_i32 s84, s58, 12
s_add_u32 s84, s84, s59
v_mfma_f32_16x16x32_bf16 v[108:111], a[108:111], a[56:59], v[108:111]
s_lshl_b32 s84, s84, 2
s_add_u32 s84, s84, s56
v_mfma_f32_16x16x32_bf16 v[124:127], a[108:111], a[60:63], v[124:127]
ds_read_b64_tr_b16 a[44:45], v31 offset:0
s_lshr_b64 s[74:75], s[74:75], 4
s_and_b32 s13, s74, 15
v_mfma_f32_16x16x32_bf16 v[120:123], a[104:107], a[60:63], v[120:123]
s_lshl_b32 s60, s13, 7
s_mul_i32 s61, s13, 196608
s_add_u32 m0, s62, 0
v_mfma_f32_16x16x32_bf16 v[116:119], a[100:103], a[60:63], v[116:119]
buffer_load_dwordx4 v8, s[28:31], s60 offen offset:0  lds
ds_read_b64_tr_b16 a[46:47], v31 offset:1024
v_mfma_f32_16x16x32_bf16 v[112:115], a[96:99], a[60:63], v[112:115]
ds_read_b64_tr_b16 a[48:49], v30 offset:16384
v_mfma_f32_16x16x32_bf16 v[128:131], a[96:99], a[64:67], v[128:131]
s_mul_i32 s65, s84, 964
s_lshr_b32 s65, s65, 16
s_mul_i32 s64, s65, 68
v_mfma_f32_16x16x32_bf16 v[132:135], a[100:103], a[64:67], v[132:135]
s_sub_u32 s64, s84, s64
s_mul_i32 s98, s65, 272
s_add_u32 s98, s98, s64
v_mfma_f32_16x16x32_bf16 v[136:139], a[104:107], a[64:67], v[136:139]
s_lshl_b32 s98, s98, 10
s_add_u32 s98, s98, 9437184
s_mov_b32 s46, 819200
v_mfma_f32_16x16x32_bf16 v[140:143], a[108:111], a[64:67], v[140:143]
s_mov_b32 s76, 10240
s_mov_b32 s77, 5120
s_cmp_lt_u32 s64, 48
v_mfma_f32_16x16x32_bf16 v[156:159], a[108:111], a[68:71], v[156:159]
s_cselect_b32 s44, s18, s10
s_cselect_b32 s45, s19, s11
s_cselect_b32 s46, 1966080, s46
v_mfma_f32_16x16x32_bf16 v[152:155], a[104:107], a[68:71], v[152:155]
s_cselect_b32 s66, 0, 48
s_cselect_b32 s76, 5120, s76
s_cselect_b32 s77, 20480, s77
v_mfma_f32_16x16x32_bf16 v[148:151], a[100:103], a[68:71], v[148:151]
s_mov_b32 s47, 0x20000
s_sub_u32 s64, s64, s66
s_mul_i32 s64, s64, 40960
v_mfma_f32_16x16x32_bf16 v[144:147], a[96:99], a[68:71], v[144:147]
s_lshl_b32 s65, s65, 7
s_add_u32 s97, s64, s65
ds_read_b64_tr_b16 a[50:51], v30 offset:17408
v_mfma_f32_16x16x32_bf16 v[160:163], a[96:99], a[72:75], v[160:163]
buffer_load_dwordx4 v9, s[28:31], s60 offen offset:1024  lds
ds_read_b64_tr_b16 a[52:53], v31 offset:16384
v_mfma_f32_16x16x32_bf16 v[164:167], a[100:103], a[72:75], v[164:167]
ds_read_b64_tr_b16 a[54:55], v31 offset:17408
v_and_b32 v2, 15, v1
v_lshrrev_b32 v3, 4, v1
v_mfma_f32_16x16x32_bf16 v[168:171], a[104:107], a[72:75], v[168:171]
v_mul_u32_u24_e64 v90, s76, v3
v_lshl_add_u32 v90, v2, 3, v90
ds_read_b128 a[0:3], v24 offset:0
v_mfma_f32_16x16x32_bf16 v[172:175], a[108:111], a[72:75], v[172:175]
buffer_load_dwordx4 v10, s[28:31], s60 offen offset:2048  lds
ds_read_b128 a[4:7], v24 offset:2048
v_mfma_f32_16x16x32_bf16 v[188:191], a[108:111], a[76:79], v[188:191]
ds_read_b128 a[8:11], v24 offset:4096
v_lshrrev_b32_e64 v4, 2, v2
v_mul_u32_u24 v91, 69632, v4
v_mfma_f32_16x16x32_bf16 v[184:187], a[104:107], a[76:79], v[184:187]
v_and_b32_e64 v2, 3, v2
v_lshl_add_u32 v2, v3, 4, v2
v_lshl_add_u32 v91, v2, 4, v91
v_mfma_f32_16x16x32_bf16 v[180:183], a[100:103], a[76:79], v[180:183]
ds_read_b128 a[12:15], v24 offset:6144
ds_read_b128 a[16:19], v24 offset:8192
v_mfma_f32_16x16x32_bf16 v[176:179], a[96:99], a[76:79], v[176:179]
buffer_load_dwordx4 v11, s[28:31], s60 offen offset:3072  lds
ds_read_b128 a[20:23], v24 offset:10240
v_mfma_f32_16x16x32_bf16 v[192:195], a[96:99], a[80:83], v[192:195]
s_and_b32 s64, s2, 7
s_lshl_b32 s64, s64, 6
s_lshr_b32 s65, s2, 3
v_mfma_f32_16x16x32_bf16 v[196:199], a[100:103], a[80:83], v[196:199]
s_sub_u32 s65, s65, 12
s_lshl_b32 s65, s65, 2
s_add_u32 s65, s65, s56
v_mfma_f32_16x16x32_bf16 v[200:203], a[104:107], a[80:83], v[200:203]
s_add_u32 s64, s64, s65
s_cmp_lt_u32 s65, 64
s_cselect_b32 s79, s64, 0x8000
v_mfma_f32_16x16x32_bf16 v[204:207], a[108:111], a[80:83], v[204:207]
ds_read_b128 a[24:27], v24 offset:12288
ds_read_b128 a[28:31], v24 offset:14336
s_add_u32 m0, s62, 4096
v_mfma_f32_16x16x32_bf16 v[220:223], a[108:111], a[84:87], v[220:223]
buffer_load_dwordx4 v12, s[28:31], s60 offen offset:0  lds
ds_read_b128 a[32:35], v24 offset:16384
v_mfma_f32_16x16x32_bf16 v[216:219], a[104:107], a[84:87], v[216:219]
v_and_b32 v2, 15, v1
v_lshrrev_b32 v3, 4, v1
v_mul_u32_u24 v92, 1280, v3
v_mfma_f32_16x16x32_bf16 v[212:215], a[100:103], a[84:87], v[212:215]
v_lshl_add_u32 v92, v2, 4, v92
s_mul_i32 s99, s79, 5120
ds_read_b128 a[36:39], v24 offset:18432
v_mfma_f32_16x16x32_bf16 v[208:211], a[96:99], a[84:87], v[208:211]
s_add_u32 m0, s63, 0
v_mfma_f32_16x16x32_bf16 v[224:227], a[96:99], a[88:91], v[224:227]
buffer_load_dwordx4 v16, s[32:35], s61 offen offset:0  lds
v_mfma_f32_16x16x32_bf16 v[228:231], a[100:103], a[88:91], v[228:231]
v_mfma_f32_16x16x32_bf16 v[232:235], a[104:107], a[88:91], v[232:235]
v_cmp_eq_u32 vcc, 0, v2
v_and_b32_e64 v93, 48, v1
v_mov_b32 v3, 0x7f000000
v_mfma_f32_16x16x32_bf16 v[236:239], a[108:111], a[88:91], v[236:239]
s_lshl_b32 s79, s79, 6
v_cndmask_b32_e64 v93, v3, v93, vcc
s_add_u32 s79, s79, 16777216
v_mfma_f32_16x16x32_bf16 v[252:255], a[108:111], a[92:95], v[252:255]
v_mfma_f32_16x16x32_bf16 v[248:251], a[104:107], a[92:95], v[248:251]
buffer_load_dwordx4 v17, s[32:35], s61 offen offset:1024  lds
v_mfma_f32_16x16x32_bf16 v[244:247], a[100:103], a[92:95], v[244:247]
v_mfma_f32_16x16x32_bf16 v[240:243], a[96:99], a[92:95], v[240:243]
s_bitcmp1_b32 s72, 0
s_cbranch_scc1 Lcsf1
Lcrf1:
s_waitcnt lgkmcnt(0)
v_mfma_f32_16x16x32_bf16 v[96:99], a[40:43], a[0:3], v[96:99]
ds_read_b64_tr_b16 a[96:97], v30 offset:8192
v_mfma_f32_16x16x32_bf16 v[100:103], a[44:47], a[0:3], v[100:103]
v_mfma_f32_16x16x32_bf16 v[104:107], a[48:51], a[0:3], v[104:107]
ds_read_b64_tr_b16 a[98:99], v30 offset:9216
v_mfma_f32_16x16x32_bf16 v[108:111], a[52:55], a[0:3], v[108:111]
buffer_load_dwordx4 v[44:47], v92, s[28:31], s99 offen offset:0
v_mfma_f32_16x16x32_bf16 v[124:127], a[52:55], a[4:7], v[124:127]
ds_read_b64_tr_b16 a[100:101], v31 offset:8192
v_mfma_f32_16x16x32_bf16 v[120:123], a[48:51], a[4:7], v[120:123]
buffer_load_dwordx4 v18, s[32:35], s61 offen offset:2048  lds
v_mfma_f32_16x16x32_bf16 v[116:119], a[44:47], a[4:7], v[116:119]
ds_read_b64_tr_b16 a[102:103], v31 offset:9216
v_mfma_f32_16x16x32_bf16 v[112:115], a[40:43], a[4:7], v[112:115]
ds_read_b64_tr_b16 a[104:105], v30 offset:24576
v_mfma_f32_16x16x32_bf16 v[128:131], a[40:43], a[8:11], v[128:131]
v_mfma_f32_16x16x32_bf16 v[132:135], a[44:47], a[8:11], v[132:135]
ds_read_b64_tr_b16 a[106:107], v30 offset:25600
v_mfma_f32_16x16x32_bf16 v[136:139], a[48:51], a[8:11], v[136:139]
ds_read_b64_tr_b16 a[108:109], v31 offset:24576
v_mfma_f32_16x16x32_bf16 v[140:143], a[52:55], a[8:11], v[140:143]
buffer_load_dwordx4 v[48:51], v92, s[28:31], s99 offen offset:256
v_mfma_f32_16x16x32_bf16 v[156:159], a[52:55], a[12:15], v[156:159]
buffer_load_dwordx4 v19, s[32:35], s61 offen offset:3072  lds
v_mfma_f32_16x16x32_bf16 v[152:155], a[48:51], a[12:15], v[152:155]
ds_read_b64_tr_b16 a[110:111], v31 offset:25600
v_mfma_f32_16x16x32_bf16 v[148:151], a[44:47], a[12:15], v[148:151]
ds_read_b128 a[56:59], v25 offset:0
v_mfma_f32_16x16x32_bf16 v[144:147], a[40:43], a[12:15], v[144:147]
ds_read_b128 a[60:63], v25 offset:2048
v_mfma_f32_16x16x32_bf16 v[160:163], a[40:43], a[16:19], v[160:163]
v_mfma_f32_16x16x32_bf16 v[164:167], a[44:47], a[16:19], v[164:167]
ds_read_b128 a[64:67], v25 offset:4096
s_add_u32 m0, s63, 16384
v_mfma_f32_16x16x32_bf16 v[168:171], a[48:51], a[16:19], v[168:171]
buffer_load_dwordx4 v16, s[36:39], s61 offen offset:0  lds
v_mfma_f32_16x16x32_bf16 v[172:175], a[52:55], a[16:19], v[172:175]
buffer_load_dwordx4 v[52:55], v92, s[28:31], s99 offen offset:512
v_mfma_f32_16x16x32_bf16 v[188:191], a[52:55], a[20:23], v[188:191]
ds_read_b128 a[68:71], v25 offset:6144
ds_read_b128 a[72:75], v25 offset:8192
v_mfma_f32_16x16x32_bf16 v[184:187], a[48:51], a[20:23], v[184:187]
v_mfma_f32_16x16x32_bf16 v[180:183], a[44:47], a[20:23], v[180:183]
ds_read_b128 a[76:79], v25 offset:10240
v_mfma_f32_16x16x32_bf16 v[176:179], a[40:43], a[20:23], v[176:179]
v_mfma_f32_16x16x32_bf16 v[192:195], a[40:43], a[24:27], v[192:195]
buffer_load_dwordx4 v17, s[36:39], s61 offen offset:1024  lds
v_mfma_f32_16x16x32_bf16 v[196:199], a[44:47], a[24:27], v[196:199]
ds_read_b128 a[80:83], v25 offset:12288
ds_read_b128 a[84:87], v25 offset:14336
v_mfma_f32_16x16x32_bf16 v[200:203], a[48:51], a[24:27], v[200:203]
buffer_load_dwordx4 v[56:59], v92, s[28:31], s99 offen offset:768
v_mfma_f32_16x16x32_bf16 v[204:207], a[52:55], a[24:27], v[204:207]
ds_read_b128 a[88:91], v25 offset:16384
v_mfma_f32_16x16x32_bf16 v[220:223], a[52:55], a[28:31], v[220:223]
v_mfma_f32_16x16x32_bf16 v[216:219], a[48:51], a[28:31], v[216:219]
ds_read_b128 a[92:95], v25 offset:18432
v_mfma_f32_16x16x32_bf16 v[212:215], a[44:47], a[28:31], v[212:215]
buffer_load_dwordx4 v18, s[36:39], s61 offen offset:2048  lds
v_mfma_f32_16x16x32_bf16 v[208:211], a[40:43], a[28:31], v[208:211]
v_mfma_f32_16x16x32_bf16 v[224:227], a[40:43], a[32:35], v[224:227]
v_mfma_f32_16x16x32_bf16 v[228:231], a[44:47], a[32:35], v[228:231]
buffer_load_dwordx4 v[60:63], v92, s[28:31], s99 offen offset:1024
v_mfma_f32_16x16x32_bf16 v[232:235], a[48:51], a[32:35], v[232:235]
v_mfma_f32_16x16x32_bf16 v[236:239], a[52:55], a[32:35], v[236:239]
v_mfma_f32_16x16x32_bf16 v[252:255], a[52:55], a[36:39], v[252:255]
buffer_load_dwordx4 v19, s[36:39], s61 offen offset:3072  lds
v_mfma_f32_16x16x32_bf16 v[248:251], a[48:51], a[36:39], v[248:251]
v_mfma_f32_16x16x32_bf16 v[244:247], a[44:47], a[36:39], v[244:247]
v_mfma_f32_16x16x32_bf16 v[240:243], a[40:43], a[36:39], v[240:243]
s_bitcmp1_b32 s72, 1
s_cbranch_scc1 Lcsf2
Lcrf2:
s_waitcnt lgkmcnt(0)
s_waitcnt vmcnt(18)
s_barrier
v_mfma_f32_16x16x32_bf16 v[96:99], a[96:99], a[56:59], v[96:99]
ds_read_b64_tr_b16 a[40:41], v32 offset:0
v_mfma_f32_16x16x32_bf16 v[100:103], a[100:103], a[56:59], v[100:103]
s_lshl_b32 s64, s84, 11
s_add_u32 s64, s64, 15728640
v_mfma_f32_16x16x32_bf16 v[104:107], a[104:107], a[56:59], v[104:107]
s_cmp_lt_u32 s84, 432
s_cselect_b32 s68, s64, s42
v_mfma_f32_16x16x32_bf16 v[108:111], a[108:111], a[56:59], v[108:111]
v_accvgpr_write_b32 a132, -1
v_accvgpr_write_b32 a133, -1
v_mfma_f32_16x16x32_bf16 v[124:127], a[108:111], a[60:63], v[124:127]
v_accvgpr_write_b32 a134, -1
v_accvgpr_write_b32 a135, -1
v_mfma_f32_16x16x32_bf16 v[120:123], a[104:107], a[60:63], v[120:123]
ds_read_b64_tr_b16 a[42:43], v32 offset:1024
v_and_b32 v13, 3, v1
v_mfma_f32_16x16x32_bf16 v[116:119], a[100:103], a[60:63], v[116:119]
v_lshlrev_b32 v13, 2, v13
v_mfma_f32_16x16x32_bf16 v[112:115], a[96:99], a[60:63], v[112:115]
buffer_store_dwordx4 a[132:135], v6, s[40:43], s68 offen offset:0 sc1
v_mfma_f32_16x16x32_bf16 v[128:131], a[96:99], a[64:67], v[128:131]
ds_read_b64_tr_b16 a[44:45], v33 offset:0
s_lshr_b64 s[74:75], s[74:75], 4
v_mfma_f32_16x16x32_bf16 v[132:135], a[100:103], a[64:67], v[132:135]
s_and_b32 s13, s74, 15
s_lshl_b32 s60, s13, 7
v_mfma_f32_16x16x32_bf16 v[136:139], a[104:107], a[64:67], v[136:139]
s_mul_i32 s61, s13, 196608
s_add_u32 m0, s62, 53248
v_mfma_f32_16x16x32_bf16 v[140:143], a[108:111], a[64:67], v[140:143]
buffer_load_dwordx4 v8, s[28:31], s60 offen offset:0  lds
v_mfma_f32_16x16x32_bf16 v[156:159], a[108:111], a[68:71], v[156:159]
ds_read_b64_tr_b16 a[46:47], v33 offset:1024
v_mfma_f32_16x16x32_bf16 v[152:155], a[104:107], a[68:71], v[152:155]
buffer_store_dwordx4 a[132:135], v6, s[40:43], s68 offen offset:1024 sc1
v_mfma_f32_16x16x32_bf16 v[148:151], a[100:103], a[68:71], v[148:151]
ds_read_b64_tr_b16 a[48:49], v32 offset:16384
ds_read_b64_tr_b16 a[50:51], v32 offset:17408
v_mfma_f32_16x16x32_bf16 v[144:147], a[96:99], a[68:71], v[144:147]
buffer_load_dword v14, v13, s[48:51], 0 offen sc1
v_mfma_f32_16x16x32_bf16 v[160:163], a[96:99], a[72:75], v[160:163]
buffer_load_dwordx4 v9, s[28:31], s60 offen offset:1024  lds
v_mfma_f32_16x16x32_bf16 v[164:167], a[100:103], a[72:75], v[164:167]
ds_read_b64_tr_b16 a[52:53], v33 offset:16384
ds_read_b64_tr_b16 a[54:55], v33 offset:17408
v_mfma_f32_16x16x32_bf16 v[168:171], a[104:107], a[72:75], v[168:171]
ds_read_b128 a[0:3], v26 offset:0
v_mfma_f32_16x16x32_bf16 v[172:175], a[108:111], a[72:75], v[172:175]
buffer_load_dwordx2 v[64:65], v90, s[44:47], s97 offen offset:0
v_mfma_f32_16x16x32_bf16 v[188:191], a[108:111], a[76:79], v[188:191]
buffer_load_dwordx4 v10, s[28:31], s60 offen offset:2048  lds
v_mfma_f32_16x16x32_bf16 v[184:187], a[104:107], a[76:79], v[184:187]
ds_read_b128 a[4:7], v26 offset:2048
ds_read_b128 a[8:11], v26 offset:4096
v_mfma_f32_16x16x32_bf16 v[180:183], a[100:103], a[76:79], v[180:183]
ds_read_b128 a[12:15], v26 offset:6144
ds_read_b128 a[16:19], v26 offset:8192
v_mfma_f32_16x16x32_bf16 v[176:179], a[96:99], a[76:79], v[176:179]
buffer_load_dwordx4 v11, s[28:31], s60 offen offset:3072  lds
v_mfma_f32_16x16x32_bf16 v[192:195], a[96:99], a[80:83], v[192:195]
buffer_load_dwordx2 v[66:67], v90, s[44:47], s97 offen offset:1280
v_mfma_f32_16x16x32_bf16 v[196:199], a[100:103], a[80:83], v[196:199]
ds_read_b128 a[20:23], v26 offset:10240
ds_read_b128 a[24:27], v26 offset:12288
v_mfma_f32_16x16x32_bf16 v[200:203], a[104:107], a[80:83], v[200:203]
ds_read_b128 a[28:31], v26 offset:14336
s_add_u32 m0, s62, 57344
v_mfma_f32_16x16x32_bf16 v[204:207], a[108:111], a[80:83], v[204:207]
buffer_load_dwordx4 v12, s[28:31], s60 offen offset:0  lds
v_mfma_f32_16x16x32_bf16 v[220:223], a[108:111], a[84:87], v[220:223]
ds_read_b128 a[32:35], v26 offset:16384
v_mfma_f32_16x16x32_bf16 v[216:219], a[104:107], a[84:87], v[216:219]
buffer_load_dwordx2 v[68:69], v90, s[44:47], s97 offen offset:2560
v_mfma_f32_16x16x32_bf16 v[212:215], a[100:103], a[84:87], v[212:215]
ds_read_b128 a[36:39], v26 offset:18432
v_mfma_f32_16x16x32_bf16 v[208:211], a[96:99], a[84:87], v[208:211]
s_add_u32 m0, s63, 53248
v_mfma_f32_16x16x32_bf16 v[224:227], a[96:99], a[88:91], v[224:227]
buffer_load_dwordx4 v16, s[32:35], s61 offen offset:0  lds
v_mfma_f32_16x16x32_bf16 v[228:231], a[100:103], a[88:91], v[228:231]
buffer_load_dwordx2 v[70:71], v90, s[44:47], s97 offen offset:3840
v_mfma_f32_16x16x32_bf16 v[232:235], a[104:107], a[88:91], v[232:235]
v_mfma_f32_16x16x32_bf16 v[236:239], a[108:111], a[88:91], v[236:239]
v_mfma_f32_16x16x32_bf16 v[252:255], a[108:111], a[92:95], v[252:255]
v_mfma_f32_16x16x32_bf16 v[248:251], a[104:107], a[92:95], v[248:251]
buffer_load_dwordx4 v17, s[32:35], s61 offen offset:1024  lds
v_mfma_f32_16x16x32_bf16 v[244:247], a[100:103], a[92:95], v[244:247]
v_mfma_f32_16x16x32_bf16 v[240:243], a[96:99], a[92:95], v[240:243]
s_bitcmp1_b32 s72, 1
s_cbranch_scc1 Lcsf3
Lcrf3:
s_waitcnt lgkmcnt(0)
v_mfma_f32_16x16x32_bf16 v[96:99], a[40:43], a[0:3], v[96:99]
ds_read_b64_tr_b16 a[96:97], v32 offset:8192
v_mfma_f32_16x16x32_bf16 v[100:103], a[44:47], a[0:3], v[100:103]
v_mfma_f32_16x16x32_bf16 v[104:107], a[48:51], a[0:3], v[104:107]
ds_read_b64_tr_b16 a[98:99], v32 offset:9216
v_mfma_f32_16x16x32_bf16 v[108:111], a[52:55], a[0:3], v[108:111]
v_mfma_f32_16x16x32_bf16 v[124:127], a[52:55], a[4:7], v[124:127]
ds_read_b64_tr_b16 a[100:101], v33 offset:8192
s_add_u32 s97, s97, s77
v_mfma_f32_16x16x32_bf16 v[120:123], a[48:51], a[4:7], v[120:123]
buffer_load_dwordx2 v[72:73], v90, s[44:47], s97 offen offset:0
v_mfma_f32_16x16x32_bf16 v[116:119], a[44:47], a[4:7], v[116:119]
buffer_load_dwordx4 v18, s[32:35], s61 offen offset:2048  lds
v_mfma_f32_16x16x32_bf16 v[112:115], a[40:43], a[4:7], v[112:115]
ds_read_b64_tr_b16 a[102:103], v33 offset:9216
ds_read_b64_tr_b16 a[104:105], v32 offset:24576
v_mfma_f32_16x16x32_bf16 v[128:131], a[40:43], a[8:11], v[128:131]
v_mfma_f32_16x16x32_bf16 v[132:135], a[44:47], a[8:11], v[132:135]
ds_read_b64_tr_b16 a[106:107], v32 offset:25600
v_mfma_f32_16x16x32_bf16 v[136:139], a[48:51], a[8:11], v[136:139]
ds_read_b64_tr_b16 a[108:109], v33 offset:24576
v_mfma_f32_16x16x32_bf16 v[140:143], a[52:55], a[8:11], v[140:143]
buffer_load_dwordx4 v19, s[32:35], s61 offen offset:3072  lds
v_mfma_f32_16x16x32_bf16 v[156:159], a[52:55], a[12:15], v[156:159]
ds_read_b64_tr_b16 a[110:111], v33 offset:25600
v_mfma_f32_16x16x32_bf16 v[152:155], a[48:51], a[12:15], v[152:155]
buffer_load_dwordx2 v[74:75], v90, s[44:47], s97 offen offset:1280
v_mfma_f32_16x16x32_bf16 v[148:151], a[44:47], a[12:15], v[148:151]
ds_read_b128 a[56:59], v27 offset:0
v_mfma_f32_16x16x32_bf16 v[144:147], a[40:43], a[12:15], v[144:147]
ds_read_b128 a[60:63], v27 offset:2048
v_mfma_f32_16x16x32_bf16 v[160:163], a[40:43], a[16:19], v[160:163]
v_mfma_f32_16x16x32_bf16 v[164:167], a[44:47], a[16:19], v[164:167]
ds_read_b128 a[64:67], v27 offset:4096
s_add_u32 m0, s63, 69632
v_mfma_f32_16x16x32_bf16 v[168:171], a[48:51], a[16:19], v[168:171]
buffer_load_dwordx4 v16, s[36:39], s61 offen offset:0  lds
v_mfma_f32_16x16x32_bf16 v[172:175], a[52:55], a[16:19], v[172:175]
ds_read_b128 a[68:71], v27 offset:6144
v_mfma_f32_16x16x32_bf16 v[188:191], a[52:55], a[20:23], v[188:191]
ds_read_b128 a[72:75], v27 offset:8192
v_mfma_f32_16x16x32_bf16 v[184:187], a[48:51], a[20:23], v[184:187]
v_mfma_f32_16x16x32_bf16 v[180:183], a[44:47], a[20:23], v[180:183]
ds_read_b128 a[76:79], v27 offset:10240
v_mfma_f32_16x16x32_bf16 v[176:179], a[40:43], a[20:23], v[176:179]
buffer_load_dwordx2 v[76:77], v90, s[44:47], s97 offen offset:2560
v_mfma_f32_16x16x32_bf16 v[192:195], a[40:43], a[24:27], v[192:195]
buffer_load_dwordx4 v17, s[36:39], s61 offen offset:1024  lds
v_mfma_f32_16x16x32_bf16 v[196:199], a[44:47], a[24:27], v[196:199]
ds_read_b128 a[80:83], v27 offset:12288
ds_read_b128 a[84:87], v27 offset:14336
v_mfma_f32_16x16x32_bf16 v[200:203], a[48:51], a[24:27], v[200:203]
v_mfma_f32_16x16x32_bf16 v[204:207], a[52:55], a[24:27], v[204:207]
ds_read_b128 a[88:91], v27 offset:16384
v_mfma_f32_16x16x32_bf16 v[220:223], a[52:55], a[28:31], v[220:223]
v_mfma_f32_16x16x32_bf16 v[216:219], a[48:51], a[28:31], v[216:219]
ds_read_b128 a[92:95], v27 offset:18432
v_mfma_f32_16x16x32_bf16 v[212:215], a[44:47], a[28:31], v[212:215]
buffer_load_dwordx4 v18, s[36:39], s61 offen offset:2048  lds
v_mfma_f32_16x16x32_bf16 v[208:211], a[40:43], a[28:31], v[208:211]
v_mfma_f32_16x16x32_bf16 v[224:227], a[40:43], a[32:35], v[224:227]
buffer_load_dwordx2 v[78:79], v90, s[44:47], s97 offen offset:3840
v_mfma_f32_16x16x32_bf16 v[228:231], a[44:47], a[32:35], v[228:231]
v_mfma_f32_16x16x32_bf16 v[232:235], a[48:51], a[32:35], v[232:235]
v_mfma_f32_16x16x32_bf16 v[236:239], a[52:55], a[32:35], v[236:239]
v_mfma_f32_16x16x32_bf16 v[252:255], a[52:55], a[36:39], v[252:255]
buffer_load_dwordx4 v19, s[36:39], s61 offen offset:3072  lds
v_mfma_f32_16x16x32_bf16 v[248:251], a[48:51], a[36:39], v[248:251]
v_mfma_f32_16x16x32_bf16 v[244:247], a[44:47], a[36:39], v[244:247]
v_mfma_f32_16x16x32_bf16 v[240:243], a[40:43], a[36:39], v[240:243]
s_bitcmp1_b32 s72, 2
s_cbranch_scc1 Lcsf4
Lcrf4:
s_waitcnt lgkmcnt(0)
s_waitcnt vmcnt(24)
s_barrier
v_mfma_f32_16x16x32_bf16 v[96:99], a[96:99], a[56:59], v[96:99]
v_lshlrev_b32 v82, 16, v44
ds_read_b64_tr_b16 a[40:41], v28 offset:0
v_mfma_f32_16x16x32_bf16 v[100:103], a[100:103], a[56:59], v[100:103]
v_and_b32 v83, s78, v44
v_add_f32 v80, v82, v83
v_mfma_f32_16x16x32_bf16 v[104:107], a[104:107], a[56:59], v[104:107]
v_mul_f32_e64 v81, v82, v82
ds_read_b64_tr_b16 a[42:43], v28 offset:1024
v_fmac_f32_e64 v81, v83, v83
v_mfma_f32_16x16x32_bf16 v[108:111], a[108:111], a[56:59], v[108:111]
v_lshlrev_b32_e64 v82, 16, v45
v_mfma_f32_16x16x32_bf16 v[124:127], a[108:111], a[60:63], v[124:127]
ds_read_b64_tr_b16 a[44:45], v29 offset:0
v_and_b32 v83, s78, v45
s_lshr_b64 s[74:75], s[74:75], 4
v_mfma_f32_16x16x32_bf16 v[120:123], a[104:107], a[60:63], v[120:123]
s_and_b32 s13, s74, 15
s_lshl_b32 s60, s13, 7
s_mul_i32 s61, s13, 196608
v_mfma_f32_16x16x32_bf16 v[116:119], a[100:103], a[60:63], v[116:119]
s_add_u32 m0, s62, 106496
v_mfma_f32_16x16x32_bf16 v[112:115], a[96:99], a[60:63], v[112:115]
buffer_load_dwordx4 v8, s[28:31], s60 offen offset:0  lds
v_add_f32_e64 v80, v80, v82
v_mfma_f32_16x16x32_bf16 v[128:131], a[96:99], a[64:67], v[128:131]
v_fmac_f32_e64 v81, v82, v82
ds_read_b64_tr_b16 a[46:47], v29 offset:1024
v_add_f32_e64 v80, v80, v83
v_mfma_f32_16x16x32_bf16 v[132:135], a[100:103], a[64:67], v[132:135]
v_fmac_f32 v81, v83, v83
v_lshlrev_b32 v82, 16, v46
ds_read_b64_tr_b16 a[48:49], v28 offset:16384
v_mfma_f32_16x16x32_bf16 v[136:139], a[104:107], a[64:67], v[136:139]
v_and_b32 v83, s78, v46
v_add_f32 v80, v80, v82
v_fmac_f32_e64 v81, v82, v82
v_mfma_f32_16x16x32_bf16 v[140:143], a[108:111], a[64:67], v[140:143]
ds_read_b64_tr_b16 a[50:51], v28 offset:17408
v_add_f32_e64 v80, v80, v83
v_mfma_f32_16x16x32_bf16 v[156:159], a[108:111], a[68:71], v[156:159]
buffer_load_dwordx4 v9, s[28:31], s60 offen offset:1024  lds
v_fmac_f32_e64 v81, v83, v83
v_mfma_f32_16x16x32_bf16 v[152:155], a[104:107], a[68:71], v[152:155]
ds_read_b64_tr_b16 a[52:53], v29 offset:16384
v_lshlrev_b32 v82, 16, v47
v_and_b32 v83, s78, v47
v_mfma_f32_16x16x32_bf16 v[148:151], a[100:103], a[68:71], v[148:151]
v_add_f32_e64 v80, v80, v82
ds_read_b64_tr_b16 a[54:55], v29 offset:17408
v_fmac_f32_e64 v81, v82, v82
v_mfma_f32_16x16x32_bf16 v[144:147], a[96:99], a[68:71], v[144:147]
v_add_f32 v80, v80, v83
v_fmac_f32 v81, v83, v83
ds_read_b128 a[0:3], v22 offset:0
v_mfma_f32_16x16x32_bf16 v[160:163], a[96:99], a[72:75], v[160:163]
v_lshlrev_b32 v82, 16, v48
v_and_b32 v83, s78, v48
v_mfma_f32_16x16x32_bf16 v[164:167], a[100:103], a[72:75], v[164:167]
buffer_load_dwordx4 v10, s[28:31], s60 offen offset:2048  lds
ds_read_b128 a[4:7], v22 offset:2048
v_mfma_f32_16x16x32_bf16 v[168:171], a[104:107], a[72:75], v[168:171]
v_add_f32 v80, v80, v82
v_fmac_f32 v81, v82, v82
v_add_f32_e64 v80, v80, v83
v_mfma_f32_16x16x32_bf16 v[172:175], a[108:111], a[72:75], v[172:175]
ds_read_b128 a[8:11], v22 offset:4096
v_fmac_f32 v81, v83, v83
v_lshlrev_b32 v82, 16, v49
v_mfma_f32_16x16x32_bf16 v[188:191], a[108:111], a[76:79], v[188:191]
v_and_b32_e64 v83, s78, v49
ds_read_b128 a[12:15], v22 offset:6144
v_add_f32_e64 v80, v80, v82
v_mfma_f32_16x16x32_bf16 v[184:187], a[104:107], a[76:79], v[184:187]
v_fmac_f32 v81, v82, v82
v_add_f32 v80, v80, v83
ds_read_b128 a[16:19], v22 offset:8192
v_mfma_f32_16x16x32_bf16 v[180:183], a[100:103], a[76:79], v[180:183]
buffer_load_dwordx4 v11, s[28:31], s60 offen offset:3072  lds
v_fmac_f32_e64 v81, v83, v83
v_mfma_f32_16x16x32_bf16 v[176:179], a[96:99], a[76:79], v[176:179]
v_lshlrev_b32_e64 v82, 16, v50
ds_read_b128 a[20:23], v22 offset:10240
v_and_b32_e64 v83, s78, v50
v_mfma_f32_16x16x32_bf16 v[192:195], a[96:99], a[80:83], v[192:195]
v_add_f32 v80, v80, v82
v_fmac_f32 v81, v82, v82
ds_read_b128 a[24:27], v22 offset:12288
v_mfma_f32_16x16x32_bf16 v[196:199], a[100:103], a[80:83], v[196:199]
v_add_f32 v80, v80, v83
v_fmac_f32 v81, v83, v83
v_lshlrev_b32_e64 v82, 16, v51
v_mfma_f32_16x16x32_bf16 v[200:203], a[104:107], a[80:83], v[200:203]
ds_read_b128 a[28:31], v22 offset:14336
v_and_b32_e64 v83, s78, v51
s_add_u32 m0, s62, 110592
v_mfma_f32_16x16x32_bf16 v[204:207], a[108:111], a[80:83], v[204:207]
buffer_load_dwordx4 v12, s[28:31], s60 offen offset:0  lds
v_add_f32_e64 v80, v80, v82
v_mfma_f32_16x16x32_bf16 v[220:223], a[108:111], a[84:87], v[220:223]
v_fmac_f32_e64 v81, v82, v82
ds_read_b128 a[32:35], v22 offset:16384
v_add_f32_e64 v80, v80, v83
v_mfma_f32_16x16x32_bf16 v[216:219], a[104:107], a[84:87], v[216:219]
v_fmac_f32_e64 v81, v83, v83
ds_read_b128 a[36:39], v22 offset:18432
v_lshlrev_b32_e64 v82, 16, v52
v_mfma_f32_16x16x32_bf16 v[212:215], a[100:103], a[84:87], v[212:215]
v_and_b32 v83, s78, v52
v_add_f32 v80, v80, v82
v_mfma_f32_16x16x32_bf16 v[208:211], a[96:99], a[84:87], v[208:211]
v_fmac_f32_e64 v81, v82, v82
s_add_u32 m0, s63, 106496
v_mfma_f32_16x16x32_bf16 v[224:227], a[96:99], a[88:91], v[224:227]
buffer_load_dwordx4 v16, s[32:35], s61 offen offset:0  lds
v_add_f32_e64 v80, v80, v83
v_mfma_f32_16x16x32_bf16 v[228:231], a[100:103], a[88:91], v[228:231]
v_fmac_f32 v81, v83, v83
v_lshlrev_b32 v82, 16, v53
v_and_b32_e64 v83, s78, v53
v_mfma_f32_16x16x32_bf16 v[232:235], a[104:107], a[88:91], v[232:235]
v_add_f32 v80, v80, v82
v_fmac_f32 v81, v82, v82
v_mfma_f32_16x16x32_bf16 v[236:239], a[108:111], a[88:91], v[236:239]
v_add_f32_e64 v80, v80, v83
v_mfma_f32_16x16x32_bf16 v[252:255], a[108:111], a[92:95], v[252:255]
v_fmac_f32 v81, v83, v83
v_lshlrev_b32 v82, 16, v54
v_mfma_f32_16x16x32_bf16 v[248:251], a[104:107], a[92:95], v[248:251]
buffer_load_dwordx4 v17, s[32:35], s61 offen offset:1024  lds
v_mfma_f32_16x16x32_bf16 v[244:247], a[100:103], a[92:95], v[244:247]
v_mfma_f32_16x16x32_bf16 v[240:243], a[96:99], a[92:95], v[240:243]
s_bitcmp1_b32 s72, 2
s_cbranch_scc1 Lcsf5
Lcrf5:
s_waitcnt lgkmcnt(0)
v_mfma_f32_16x16x32_bf16 v[96:99], a[40:43], a[0:3], v[96:99]
v_and_b32 v83, s78, v54
ds_read_b64_tr_b16 a[96:97], v28 offset:8192
v_mfma_f32_16x16x32_bf16 v[100:103], a[44:47], a[0:3], v[100:103]
v_add_f32 v80, v80, v82
v_fmac_f32 v81, v82, v82
v_mfma_f32_16x16x32_bf16 v[104:107], a[48:51], a[0:3], v[104:107]
v_add_f32_e64 v80, v80, v83
ds_read_b64_tr_b16 a[98:99], v28 offset:9216
v_fmac_f32_e64 v81, v83, v83
v_mfma_f32_16x16x32_bf16 v[108:111], a[52:55], a[0:3], v[108:111]
v_lshlrev_b32_e64 v82, 16, v55
v_mfma_f32_16x16x32_bf16 v[124:127], a[52:55], a[4:7], v[124:127]
ds_read_b64_tr_b16 a[100:101], v29 offset:8192
v_and_b32 v83, s78, v55
v_add_f32 v80, v80, v82
v_mfma_f32_16x16x32_bf16 v[120:123], a[48:51], a[4:7], v[120:123]
buffer_load_dwordx4 v18, s[32:35], s61 offen offset:2048  lds
v_fmac_f32_e64 v81, v82, v82
v_mfma_f32_16x16x32_bf16 v[116:119], a[44:47], a[4:7], v[116:119]
ds_read_b64_tr_b16 a[102:103], v29 offset:9216
v_add_f32 v80, v80, v83
v_fmac_f32 v81, v83, v83
v_mfma_f32_16x16x32_bf16 v[112:115], a[40:43], a[4:7], v[112:115]
v_lshlrev_b32_e64 v82, 16, v56
ds_read_b64_tr_b16 a[104:105], v28 offset:24576
v_and_b32_e64 v83, s78, v56
v_mfma_f32_16x16x32_bf16 v[128:131], a[40:43], a[8:11], v[128:131]
v_add_f32_e64 v80, v80, v82
v_mfma_f32_16x16x32_bf16 v[132:135], a[44:47], a[8:11], v[132:135]
v_fmac_f32_e64 v81, v82, v82
ds_read_b64_tr_b16 a[106:107], v28 offset:25600
v_add_f32_e64 v80, v80, v83
v_mfma_f32_16x16x32_bf16 v[136:139], a[48:51], a[8:11], v[136:139]
v_fmac_f32_e64 v81, v83, v83
ds_read_b64_tr_b16 a[108:109], v29 offset:24576
v_lshlrev_b32_e64 v82, 16, v57
v_mfma_f32_16x16x32_bf16 v[140:143], a[52:55], a[8:11], v[140:143]
buffer_load_dwordx4 v19, s[32:35], s61 offen offset:3072  lds
v_and_b32_e64 v83, s78, v57
v_mfma_f32_16x16x32_bf16 v[156:159], a[52:55], a[12:15], v[156:159]
v_add_f32_e64 v80, v80, v82
ds_read_b64_tr_b16 a[110:111], v29 offset:25600
v_fmac_f32_e64 v81, v82, v82
v_mfma_f32_16x16x32_bf16 v[152:155], a[48:51], a[12:15], v[152:155]
v_add_f32 v80, v80, v83
v_fmac_f32 v81, v83, v83
v_mfma_f32_16x16x32_bf16 v[148:151], a[44:47], a[12:15], v[148:151]
ds_read_b128 a[56:59], v23 offset:0
v_lshlrev_b32_e64 v82, 16, v58
v_mfma_f32_16x16x32_bf16 v[144:147], a[40:43], a[12:15], v[144:147]
v_and_b32_e64 v83, s78, v58
ds_read_b128 a[60:63], v23 offset:2048
v_add_f32_e64 v80, v80, v82
v_mfma_f32_16x16x32_bf16 v[160:163], a[40:43], a[16:19], v[160:163]
v_fmac_f32_e64 v81, v82, v82
v_mfma_f32_16x16x32_bf16 v[164:167], a[44:47], a[16:19], v[164:167]
v_add_f32_e64 v80, v80, v83
ds_read_b128 a[64:67], v23 offset:4096
v_fmac_f32_e64 v81, v83, v83
v_mfma_f32_16x16x32_bf16 v[168:171], a[48:51], a[16:19], v[168:171]
s_add_u32 m0, s63, 122880
v_mfma_f32_16x16x32_bf16 v[172:175], a[52:55], a[16:19], v[172:175]
buffer_load_dwordx4 v16, s[36:39], s61 offen offset:0  lds
v_lshlrev_b32_e64 v82, 16, v59
v_mfma_f32_16x16x32_bf16 v[188:191], a[52:55], a[20:23], v[188:191]
v_and_b32_e64 v83, s78, v59
ds_read_b128 a[68:71], v23 offset:6144
v_add_f32_e64 v80, v80, v82
v_mfma_f32_16x16x32_bf16 v[184:187], a[48:51], a[20:23], v[184:187]
v_fmac_f32 v81, v82, v82
v_add_f32 v80, v80, v83
ds_read_b128 a[72:75], v23 offset:8192
v_mfma_f32_16x16x32_bf16 v[180:183], a[44:47], a[20:23], v[180:183]
v_fmac_f32 v81, v83, v83
v_lshlrev_b32 v82, 16, v60
ds_read_b128 a[76:79], v23 offset:10240
v_mfma_f32_16x16x32_bf16 v[176:179], a[40:43], a[20:23], v[176:179]
v_and_b32 v83, s78, v60
v_add_f32 v80, v80, v82
v_fmac_f32_e64 v81, v82, v82
v_mfma_f32_16x16x32_bf16 v[192:195], a[40:43], a[24:27], v[192:195]
buffer_load_dwordx4 v17, s[36:39], s61 offen offset:1024  lds
ds_read_b128 a[80:83], v23 offset:12288
v_mfma_f32_16x16x32_bf16 v[196:199], a[44:47], a[24:27], v[196:199]
v_add_f32 v80, v80, v83
v_fmac_f32 v81, v83, v83
v_lshlrev_b32_e64 v82, 16, v61
v_mfma_f32_16x16x32_bf16 v[200:203], a[48:51], a[24:27], v[200:203]
ds_read_b128 a[84:87], v23 offset:14336
v_and_b32 v83, s78, v61
v_add_f32 v80, v80, v82
v_mfma_f32_16x16x32_bf16 v[204:207], a[52:55], a[24:27], v[204:207]
v_fmac_f32_e64 v81, v82, v82
ds_read_b128 a[88:91], v23 offset:16384
v_mfma_f32_16x16x32_bf16 v[220:223], a[52:55], a[28:31], v[220:223]
v_add_f32 v80, v80, v83
v_fmac_f32 v81, v83, v83
v_mfma_f32_16x16x32_bf16 v[216:219], a[48:51], a[28:31], v[216:219]
ds_read_b128 a[92:95], v23 offset:18432
v_lshlrev_b32 v82, 16, v62
v_and_b32 v83, s78, v62
v_mfma_f32_16x16x32_bf16 v[212:215], a[44:47], a[28:31], v[212:215]
buffer_load_dwordx4 v18, s[36:39], s61 offen offset:2048  lds
v_add_f32_e64 v80, v80, v82
v_mfma_f32_16x16x32_bf16 v[208:211], a[40:43], a[28:31], v[208:211]
v_fmac_f32 v81, v82, v82
v_add_f32 v80, v80, v83
v_mfma_f32_16x16x32_bf16 v[224:227], a[40:43], a[32:35], v[224:227]
v_fmac_f32_e64 v81, v83, v83
v_mfma_f32_16x16x32_bf16 v[228:231], a[44:47], a[32:35], v[228:231]
v_lshlrev_b32 v82, 16, v63
v_and_b32 v83, s78, v63
v_mfma_f32_16x16x32_bf16 v[232:235], a[48:51], a[32:35], v[232:235]
v_add_f32 v80, v80, v82
v_fmac_f32 v81, v82, v82
v_mfma_f32_16x16x32_bf16 v[236:239], a[52:55], a[32:35], v[236:239]
v_add_f32_e64 v80, v80, v83
v_mfma_f32_16x16x32_bf16 v[252:255], a[52:55], a[36:39], v[252:255]
v_fmac_f32_e64 v81, v83, v83
v_add_f32_dpp v80, v80, v80 row_ror:8 row_mask:0xf bank_mask:0xf
v_mfma_f32_16x16x32_bf16 v[248:251], a[48:51], a[36:39], v[248:251]
buffer_load_dwordx4 v19, s[36:39], s61 offen offset:3072  lds
v_mfma_f32_16x16x32_bf16 v[244:247], a[44:47], a[36:39], v[244:247]
v_mfma_f32_16x16x32_bf16 v[240:243], a[40:43], a[36:39], v[240:243]
s_bitcmp1_b32 s72, 3
s_cbranch_scc1 Lcsf6
Lcrf6:
s_waitcnt lgkmcnt(0)
s_waitcnt vmcnt(13)
s_barrier
v_cmp_eq_u32_e64 vcc, 0, v14
s_cbranch_vccz Lok8
s_mov_b32 s85, 40000
Lsp8:
buffer_load_dword v14, v13, s[48:51], 0 offen sc1
s_waitcnt vmcnt(0)
v_cmp_eq_u32 vcc, 0, v14
s_cbranch_vccz Lok8
s_sub_u32 s85, s85, 1
s_cmp_lg_u32 s85, 0
s_cbranch_scc1 Lsp8
Lok8:
v_mfma_f32_16x16x32_bf16 v[96:99], a[96:99], a[56:59], v[96:99]
v_perm_b32 v34, v66, v64, s82
ds_read_b64_tr_b16 a[40:41], v30 offset:0
v_perm_b32 v35, v70, v68, s82
v_mfma_f32_16x16x32_bf16 v[100:103], a[100:103], a[56:59], v[100:103]
v_perm_b32 v36, v74, v72, s82
v_mfma_f32_16x16x32_bf16 v[104:107], a[104:107], a[56:59], v[104:107]
v_perm_b32 v37, v78, v76, s82
ds_read_b64_tr_b16 a[42:43], v30 offset:1024
v_mfma_f32_16x16x32_bf16 v[108:111], a[108:111], a[56:59], v[108:111]
buffer_store_dwordx4 v[34:37], v91, s[40:43], s98 offen offset:0 sc1
v_perm_b32 v38, v66, v64, s83
v_mfma_f32_16x16x32_bf16 v[124:127], a[108:111], a[60:63], v[124:127]
v_perm_b32 v39, v70, v68, s83
ds_read_b64_tr_b16 a[44:45], v31 offset:0
v_perm_b32 v40, v74, v72, s83
v_mfma_f32_16x16x32_bf16 v[120:123], a[104:107], a[60:63], v[120:123]
s_lshr_b64 s[74:75], s[74:75], 4
s_and_b32 s13, s74, 15
s_lshl_b32 s60, s13, 7
v_mfma_f32_16x16x32_bf16 v[116:119], a[100:103], a[60:63], v[116:119]
s_mul_i32 s61, s13, 196608
s_add_u32 m0, s62, 0
v_mfma_f32_16x16x32_bf16 v[112:115], a[96:99], a[60:63], v[112:115]
buffer_load_dwordx4 v8, s[28:31], s60 offen offset:0  lds
v_perm_b32 v41, v78, v76, s83
v_mfma_f32_16x16x32_bf16 v[128:131], a[96:99], a[64:67], v[128:131]
buffer_store_dwordx4 v[38:41], v91, s[40:43], s98 offen offset:64 sc1
ds_read_b64_tr_b16 a[46:47], v31 offset:1024
v_mfma_f32_16x16x32_bf16 v[132:135], a[100:103], a[64:67], v[132:135]
v_perm_b32 v84, v67, v65, s82
v_perm_b32 v85, v71, v69, s82
ds_read_b64_tr_b16 a[48:49], v30 offset:16384
v_mfma_f32_16x16x32_bf16 v[136:139], a[104:107], a[64:67], v[136:139]
v_perm_b32 v86, v75, v73, s82
v_perm_b32 v87, v79, v77, s82
v_mfma_f32_16x16x32_bf16 v[140:143], a[108:111], a[64:67], v[140:143]
buffer_store_dwordx4 v[84:87], v91, s[40:43], s98 offen offset:128 sc1
ds_read_b64_tr_b16 a[50:51], v30 offset:17408
v_mfma_f32_16x16x32_bf16 v[156:159], a[108:111], a[68:71], v[156:159]
v_perm_b32 v2, v67, v65, s83
v_perm_b32 v3, v71, v69, s83
v_mfma_f32_16x16x32_bf16 v[152:155], a[104:107], a[68:71], v[152:155]
buffer_load_dwordx4 v9, s[28:31], s60 offen offset:1024  lds
v_perm_b32 v4, v75, v73, s83
v_mfma_f32_16x16x32_bf16 v[148:151], a[100:103], a[68:71], v[148:151]
ds_read_b64_tr_b16 a[52:53], v31 offset:16384
v_perm_b32 v5, v79, v77, s83
v_mfma_f32_16x16x32_bf16 v[144:147], a[96:99], a[68:71], v[144:147]
buffer_store_dwordx4 v[2:5], v91, s[40:43], s98 offen offset:192 sc1
v_add_f32_dpp v81, v81, v81 row_ror:8 row_mask:0xf bank_mask:0xf
v_mfma_f32_16x16x32_bf16 v[160:163], a[96:99], a[72:75], v[160:163]
ds_read_b64_tr_b16 a[54:55], v31 offset:17408
v_add_f32_dpp v80, v80, v80 row_ror:4 row_mask:0xf bank_mask:0xf
v_add_f32_dpp v81, v81, v81 row_ror:4 row_mask:0xf bank_mask:0xf
v_mfma_f32_16x16x32_bf16 v[164:167], a[100:103], a[72:75], v[164:167]
v_add_f32_dpp v80, v80, v80 row_ror:2 row_mask:0xf bank_mask:0xf
ds_read_b128 a[0:3], v24 offset:0
v_add_f32_dpp v81, v81, v81 row_ror:2 row_mask:0xf bank_mask:0xf
v_mfma_f32_16x16x32_bf16 v[168:171], a[104:107], a[72:75], v[168:171]
v_add_f32_dpp v80, v80, v80 row_ror:1 row_mask:0xf bank_mask:0xf
buffer_load_dwordx4 v10, s[28:31], s60 offen offset:2048  lds
v_mfma_f32_16x16x32_bf16 v[172:175], a[108:111], a[72:75], v[172:175]
ds_read_b128 a[4:7], v24 offset:2048
v_add_f32_dpp v81, v81, v81 row_ror:1 row_mask:0xf bank_mask:0xf
v_mul_f32 v45, 0xbacccccd, v80
v_mfma_f32_16x16x32_bf16 v[188:191], a[108:111], a[76:79], v[188:191]
v_mul_f32 v81, 0x3acccccd, v81
ds_read_b128 a[8:11], v24 offset:4096
v_fma_f32 v81, -v45, v45, v81
v_mfma_f32_16x16x32_bf16 v[184:187], a[104:107], a[76:79], v[184:187]
v_max_f32_e64 v81, 0, v81
v_add_f32 v47, 0x3727c5ac, v81
ds_read_b128 a[12:15], v24 offset:6144
v_mfma_f32_16x16x32_bf16 v[180:183], a[100:103], a[76:79], v[180:183]
v_rsq_f32 v44, v47
s_nop 0
v_mul_f32 v46, 0xbfb8aa3b, v44
v_mfma_f32_16x16x32_bf16 v[176:179], a[96:99], a[76:79], v[176:179]
buffer_store_dwordx4 v[44:47], v93, s[40:43], s79 offen offset:0 sc1
ds_read_b128 a[16:19], v24 offset:8192
v_mfma_f32_16x16x32_bf16 v[192:195], a[96:99], a[80:83], v[192:195]
buffer_load_dwordx4 v11, s[28:31], s60 offen offset:3072  lds
ds_read_b128 a[20:23], v24 offset:10240
v_mfma_f32_16x16x32_bf16 v[196:199], a[100:103], a[80:83], v[196:199]
ds_read_b128 a[24:27], v24 offset:12288
ds_read_b128 a[28:31], v24 offset:14336
v_mfma_f32_16x16x32_bf16 v[200:203], a[104:107], a[80:83], v[200:203]
s_add_u32 m0, s62, 4096
v_mfma_f32_16x16x32_bf16 v[204:207], a[108:111], a[80:83], v[204:207]
buffer_load_dwordx4 v12, s[28:31], s60 offen offset:0  lds
ds_read_b128 a[32:35], v24 offset:16384
v_mfma_f32_16x16x32_bf16 v[220:223], a[108:111], a[84:87], v[220:223]
v_mfma_f32_16x16x32_bf16 v[216:219], a[104:107], a[84:87], v[216:219]
ds_read_b128 a[36:39], v24 offset:18432
v_mfma_f32_16x16x32_bf16 v[212:215], a[100:103], a[84:87], v[212:215]
v_mfma_f32_16x16x32_bf16 v[208:211], a[96:99], a[84:87], v[208:211]
s_add_u32 m0, s63, 0
v_mfma_f32_16x16x32_bf16 v[224:227], a[96:99], a[88:91], v[224:227]
buffer_load_dwordx4 v16, s[32:35], s61 offen offset:0  lds
v_mfma_f32_16x16x32_bf16 v[228:231], a[100:103], a[88:91], v[228:231]
v_mfma_f32_16x16x32_bf16 v[232:235], a[104:107], a[88:91], v[232:235]
v_mfma_f32_16x16x32_bf16 v[236:239], a[108:111], a[88:91], v[236:239]
v_mfma_f32_16x16x32_bf16 v[252:255], a[108:111], a[92:95], v[252:255]
v_mfma_f32_16x16x32_bf16 v[248:251], a[104:107], a[92:95], v[248:251]
buffer_load_dwordx4 v17, s[32:35], s61 offen offset:1024  lds
v_mfma_f32_16x16x32_bf16 v[244:247], a[100:103], a[92:95], v[244:247]
v_mfma_f32_16x16x32_bf16 v[240:243], a[96:99], a[92:95], v[240:243]
s_bitcmp1_b32 s72, 3
s_cbranch_scc1 Lcsf7
Lcrf7:
s_waitcnt lgkmcnt(0)
v_mfma_f32_16x16x32_bf16 v[96:99], a[40:43], a[0:3], v[96:99]
ds_read_b64_tr_b16 a[96:97], v30 offset:8192
v_mfma_f32_16x16x32_bf16 v[100:103], a[44:47], a[0:3], v[100:103]
v_mfma_f32_16x16x32_bf16 v[104:107], a[48:51], a[0:3], v[104:107]
ds_read_b64_tr_b16 a[98:99], v30 offset:9216
v_mfma_f32_16x16x32_bf16 v[108:111], a[52:55], a[0:3], v[108:111]
v_mfma_f32_16x16x32_bf16 v[124:127], a[52:55], a[4:7], v[124:127]
ds_read_b64_tr_b16 a[100:101], v31 offset:8192
v_mfma_f32_16x16x32_bf16 v[120:123], a[48:51], a[4:7], v[120:123]
buffer_load_dwordx4 v18, s[32:35], s61 offen offset:2048  lds
v_mfma_f32_16x16x32_bf16 v[116:119], a[44:47], a[4:7], v[116:119]
ds_read_b64_tr_b16 a[102:103], v31 offset:9216
v_mfma_f32_16x16x32_bf16 v[112:115], a[40:43], a[4:7], v[112:115]
ds_read_b64_tr_b16 a[104:105], v30 offset:24576
v_mfma_f32_16x16x32_bf16 v[128:131], a[40:43], a[8:11], v[128:131]
v_mfma_f32_16x16x32_bf16 v[132:135], a[44:47], a[8:11], v[132:135]
ds_read_b64_tr_b16 a[106:107], v30 offset:25600
v_mfma_f32_16x16x32_bf16 v[136:139], a[48:51], a[8:11], v[136:139]
ds_read_b64_tr_b16 a[108:109], v31 offset:24576
v_mfma_f32_16x16x32_bf16 v[140:143], a[52:55], a[8:11], v[140:143]
buffer_load_dwordx4 v19, s[32:35], s61 offen offset:3072  lds
v_mfma_f32_16x16x32_bf16 v[156:159], a[52:55], a[12:15], v[156:159]
ds_read_b64_tr_b16 a[110:111], v31 offset:25600
v_mfma_f32_16x16x32_bf16 v[152:155], a[48:51], a[12:15], v[152:155]
v_mfma_f32_16x16x32_bf16 v[148:151], a[44:47], a[12:15], v[148:151]
ds_read_b128 a[56:59], v25 offset:0
v_mfma_f32_16x16x32_bf16 v[144:147], a[40:43], a[12:15], v[144:147]
ds_read_b128 a[60:63], v25 offset:2048
v_mfma_f32_16x16x32_bf16 v[160:163], a[40:43], a[16:19], v[160:163]
v_mfma_f32_16x16x32_bf16 v[164:167], a[44:47], a[16:19], v[164:167]
ds_read_b128 a[64:67], v25 offset:4096
s_add_u32 m0, s63, 16384
v_mfma_f32_16x16x32_bf16 v[168:171], a[48:51], a[16:19], v[168:171]
buffer_load_dwordx4 v16, s[36:39], s61 offen offset:0  lds
v_mfma_f32_16x16x32_bf16 v[172:175], a[52:55], a[16:19], v[172:175]
ds_read_b128 a[68:71], v25 offset:6144
v_mfma_f32_16x16x32_bf16 v[188:191], a[52:55], a[20:23], v[188:191]
ds_read_b128 a[72:75], v25 offset:8192
v_mfma_f32_16x16x32_bf16 v[184:187], a[48:51], a[20:23], v[184:187]
v_mfma_f32_16x16x32_bf16 v[180:183], a[44:47], a[20:23], v[180:183]
ds_read_b128 a[76:79], v25 offset:10240
v_mfma_f32_16x16x32_bf16 v[176:179], a[40:43], a[20:23], v[176:179]
v_mfma_f32_16x16x32_bf16 v[192:195], a[40:43], a[24:27], v[192:195]
buffer_load_dwordx4 v17, s[36:39], s61 offen offset:1024  lds
v_mfma_f32_16x16x32_bf16 v[196:199], a[44:47], a[24:27], v[196:199]
ds_read_b128 a[80:83], v25 offset:12288
ds_read_b128 a[84:87], v25 offset:14336
v_mfma_f32_16x16x32_bf16 v[200:203], a[48:51], a[24:27], v[200:203]
v_mfma_f32_16x16x32_bf16 v[204:207], a[52:55], a[24:27], v[204:207]
ds_read_b128 a[88:91], v25 offset:16384
v_mfma_f32_16x16x32_bf16 v[220:223], a[52:55], a[28:31], v[220:223]
v_mfma_f32_16x16x32_bf16 v[216:219], a[48:51], a[28:31], v[216:219]
ds_read_b128 a[92:95], v25 offset:18432
v_mfma_f32_16x16x32_bf16 v[212:215], a[44:47], a[28:31], v[212:215]
buffer_load_dwordx4 v18, s[36:39], s61 offen offset:2048  lds
v_mfma_f32_16x16x32_bf16 v[208:211], a[40:43], a[28:31], v[208:211]
v_mfma_f32_16x16x32_bf16 v[224:227], a[40:43], a[32:35], v[224:227]
v_mfma_f32_16x16x32_bf16 v[228:231], a[44:47], a[32:35], v[228:231]
v_mfma_f32_16x16x32_bf16 v[232:235], a[48:51], a[32:35], v[232:235]
v_mfma_f32_16x16x32_bf16 v[236:239], a[52:55], a[32:35], v[236:239]
v_mfma_f32_16x16x32_bf16 v[252:255], a[52:55], a[36:39], v[252:255]
buffer_load_dwordx4 v19, s[36:39], s61 offen offset:3072  lds
v_mfma_f32_16x16x32_bf16 v[248:251], a[48:51], a[36:39], v[248:251]
v_mfma_f32_16x16x32_bf16 v[244:247], a[44:47], a[36:39], v[244:247]
v_mfma_f32_16x16x32_bf16 v[240:243], a[40:43], a[36:39], v[240:243]
s_waitcnt lgkmcnt(0)
s_waitcnt vmcnt(18)
s_barrier
v_mfma_f32_16x16x32_bf16 v[96:99], a[96:99], a[56:59], v[96:99]
ds_read_b64_tr_b16 a[40:41], v32 offset:0
v_mfma_f32_16x16x32_bf16 v[100:103], a[100:103], a[56:59], v[100:103]
v_mfma_f32_16x16x32_bf16 v[104:107], a[104:107], a[56:59], v[104:107]
ds_read_b64_tr_b16 a[42:43], v32 offset:1024
v_mfma_f32_16x16x32_bf16 v[108:111], a[108:111], a[56:59], v[108:111]
v_mfma_f32_16x16x32_bf16 v[124:127], a[108:111], a[60:63], v[124:127]
ds_read_b64_tr_b16 a[44:45], v33 offset:0
s_lshr_b64 s[74:75], s[74:75], 4
v_mfma_f32_16x16x32_bf16 v[120:123], a[104:107], a[60:63], v[120:123]
s_and_b32 s13, s74, 15
s_lshl_b32 s60, s13, 7
v_mfma_f32_16x16x32_bf16 v[116:119], a[100:103], a[60:63], v[116:119]
s_mul_i32 s61, s13, 196608
s_add_u32 m0, s62, 53248
v_mfma_f32_16x16x32_bf16 v[112:115], a[96:99], a[60:63], v[112:115]
buffer_load_dwordx4 v8, s[28:31], s60 offen offset:0  lds
v_mfma_f32_16x16x32_bf16 v[128:131], a[96:99], a[64:67], v[128:131]
ds_read_b64_tr_b16 a[46:47], v33 offset:1024
ds_read_b64_tr_b16 a[48:49], v32 offset:16384
v_mfma_f32_16x16x32_bf16 v[132:135], a[100:103], a[64:67], v[132:135]
ds_read_b64_tr_b16 a[50:51], v32 offset:17408
s_mov_b32 s44, s8
v_mfma_f32_16x16x32_bf16 v[136:139], a[104:107], a[64:67], v[136:139]
s_mov_b32 s45, s9
s_mov_b32 s46, 25600
v_mfma_f32_16x16x32_bf16 v[140:143], a[108:111], a[64:67], v[140:143]
s_mov_b32 s47, 0x20000
v_mfma_f32_16x16x32_bf16 v[156:159], a[108:111], a[68:71], v[156:159]
buffer_load_dwordx4 v9, s[28:31], s60 offen offset:1024  lds
v_mfma_f32_16x16x32_bf16 v[152:155], a[104:107], a[68:71], v[152:155]
ds_read_b64_tr_b16 a[52:53], v33 offset:16384
ds_read_b64_tr_b16 a[54:55], v33 offset:17408
v_mfma_f32_16x16x32_bf16 v[148:151], a[100:103], a[68:71], v[148:151]
ds_read_b128 a[0:3], v26 offset:0
v_mfma_f32_16x16x32_bf16 v[144:147], a[96:99], a[68:71], v[144:147]
buffer_load_dwordx4 v10, s[28:31], s60 offen offset:2048  lds
v_mfma_f32_16x16x32_bf16 v[160:163], a[96:99], a[72:75], v[160:163]
ds_read_b128 a[4:7], v26 offset:2048
v_mfma_f32_16x16x32_bf16 v[164:167], a[100:103], a[72:75], v[164:167]
ds_read_b128 a[8:11], v26 offset:4096
v_mfma_f32_16x16x32_bf16 v[168:171], a[104:107], a[72:75], v[168:171]
v_mfma_f32_16x16x32_bf16 v[172:175], a[108:111], a[72:75], v[172:175]
ds_read_b128 a[12:15], v26 offset:6144
v_mfma_f32_16x16x32_bf16 v[188:191], a[108:111], a[76:79], v[188:191]
ds_read_b128 a[16:19], v26 offset:8192
v_mfma_f32_16x16x32_bf16 v[184:187], a[104:107], a[76:79], v[184:187]
buffer_load_dwordx4 v11, s[28:31], s60 offen offset:3072  lds
v_mfma_f32_16x16x32_bf16 v[180:183], a[100:103], a[76:79], v[180:183]
ds_read_b128 a[20:23], v26 offset:10240
v_mfma_f32_16x16x32_bf16 v[176:179], a[96:99], a[76:79], v[176:179]
v_mfma_f32_16x16x32_bf16 v[192:195], a[96:99], a[80:83], v[192:195]
ds_read_b128 a[24:27], v26 offset:12288
v_mfma_f32_16x16x32_bf16 v[196:199], a[100:103], a[80:83], v[196:199]
ds_read_b128 a[28:31], v26 offset:14336
v_mfma_f32_16x16x32_bf16 v[200:203], a[104:107], a[80:83], v[200:203]
s_add_u32 m0, s62, 57344
v_mfma_f32_16x16x32_bf16 v[204:207], a[108:111], a[80:83], v[204:207]
buffer_load_dwordx4 v12, s[28:31], s60 offen offset:0  lds
v_mfma_f32_16x16x32_bf16 v[220:223], a[108:111], a[84:87], v[220:223]
ds_read_b128 a[32:35], v26 offset:16384
v_mfma_f32_16x16x32_bf16 v[216:219], a[104:107], a[84:87], v[216:219]
s_mul_i32 s64, s27, 800
s_mov_b32 s66, m0
s_mov_b32 m0, 159744
s_mov_b32 exec_hi, 0x3ffff
buffer_load_dwordx4 v6, s[44:47], s64 offen lds
s_mov_b32 exec_hi, -1
s_mov_b32 m0, s66
v_mfma_f32_16x16x32_bf16 v[212:215], a[100:103], a[84:87], v[212:215]
ds_read_b128 a[36:39], v26 offset:18432
v_mfma_f32_16x16x32_bf16 v[208:211], a[96:99], a[84:87], v[208:211]
s_add_u32 m0, s63, 53248
v_mfma_f32_16x16x32_bf16 v[224:227], a[96:99], a[88:91], v[224:227]
buffer_load_dwordx4 v16, s[32:35], s61 offen offset:0  lds
v_mfma_f32_16x16x32_bf16 v[228:231], a[100:103], a[88:91], v[228:231]
v_mfma_f32_16x16x32_bf16 v[232:235], a[104:107], a[88:91], v[232:235]
v_mfma_f32_16x16x32_bf16 v[236:239], a[108:111], a[88:91], v[236:239]
v_mfma_f32_16x16x32_bf16 v[252:255], a[108:111], a[92:95], v[252:255]
v_mfma_f32_16x16x32_bf16 v[248:251], a[104:107], a[92:95], v[248:251]
buffer_load_dwordx4 v17, s[32:35], s61 offen offset:1024  lds
v_mfma_f32_16x16x32_bf16 v[244:247], a[100:103], a[92:95], v[244:247]
v_mfma_f32_16x16x32_bf16 v[240:243], a[96:99], a[92:95], v[240:243]
s_waitcnt lgkmcnt(0)
v_mfma_f32_16x16x32_bf16 v[96:99], a[40:43], a[0:3], v[96:99]
ds_read_b64_tr_b16 a[96:97], v32 offset:8192
v_mfma_f32_16x16x32_bf16 v[100:103], a[44:47], a[0:3], v[100:103]
v_mfma_f32_16x16x32_bf16 v[104:107], a[48:51], a[0:3], v[104:107]
ds_read_b64_tr_b16 a[98:99], v32 offset:9216
v_mfma_f32_16x16x32_bf16 v[108:111], a[52:55], a[0:3], v[108:111]
v_mfma_f32_16x16x32_bf16 v[124:127], a[52:55], a[4:7], v[124:127]
ds_read_b64_tr_b16 a[100:101], v33 offset:8192
v_mfma_f32_16x16x32_bf16 v[120:123], a[48:51], a[4:7], v[120:123]
buffer_load_dwordx4 v18, s[32:35], s61 offen offset:2048  lds
ds_read_b64_tr_b16 a[102:103], v33 offset:9216
v_mfma_f32_16x16x32_bf16 v[116:119], a[44:47], a[4:7], v[116:119]
v_mfma_f32_16x16x32_bf16 v[112:115], a[40:43], a[4:7], v[112:115]
ds_read_b64_tr_b16 a[104:105], v32 offset:24576
v_mfma_f32_16x16x32_bf16 v[128:131], a[40:43], a[8:11], v[128:131]
v_mfma_f32_16x16x32_bf16 v[132:135], a[44:47], a[8:11], v[132:135]
ds_read_b64_tr_b16 a[106:107], v32 offset:25600
v_mfma_f32_16x16x32_bf16 v[136:139], a[48:51], a[8:11], v[136:139]
ds_read_b64_tr_b16 a[108:109], v33 offset:24576
v_mfma_f32_16x16x32_bf16 v[140:143], a[52:55], a[8:11], v[140:143]
buffer_load_dwordx4 v19, s[32:35], s61 offen offset:3072  lds
v_mfma_f32_16x16x32_bf16 v[156:159], a[52:55], a[12:15], v[156:159]
ds_read_b64_tr_b16 a[110:111], v33 offset:25600
v_mfma_f32_16x16x32_bf16 v[152:155], a[48:51], a[12:15], v[152:155]
v_mfma_f32_16x16x32_bf16 v[148:151], a[44:47], a[12:15], v[148:151]
ds_read_b128 a[56:59], v27 offset:0
v_mfma_f32_16x16x32_bf16 v[144:147], a[40:43], a[12:15], v[144:147]
ds_read_b128 a[60:63], v27 offset:2048
v_mfma_f32_16x16x32_bf16 v[160:163], a[40:43], a[16:19], v[160:163]
v_mfma_f32_16x16x32_bf16 v[164:167], a[44:47], a[16:19], v[164:167]
ds_read_b128 a[64:67], v27 offset:4096
s_add_u32 m0, s63, 69632
v_mfma_f32_16x16x32_bf16 v[168:171], a[48:51], a[16:19], v[168:171]
buffer_load_dwordx4 v16, s[36:39], s61 offen offset:0  lds
v_mov_b32 v4, s57
s_and_b32 s65, s72, 15
v_mfma_f32_16x16x32_bf16 v[172:175], a[52:55], a[16:19], v[172:175]
v_mov_b32 v5, s65
s_add_u32 s64, s59, 12
s_mul_i32 s64, s64, 1280
s_add_u32 s64, s64, 17088512
v_mfma_f32_16x16x32_bf16 v[188:191], a[52:55], a[20:23], v[188:191]
v_lshlrev_b32 v2, 2, v1
v_lshrrev_b32 v3, v2, v4
v_and_b32_e64 v3, 15, v3
v_lshl_add_u32 v3, v3, 7, s64
v_mfma_f32_16x16x32_bf16 v[184:187], a[48:51], a[20:23], v[184:187]
v_lshrrev_b32 v5, v1, v5
v_and_b32 v5, 1, v5
v_cmp_eq_u32_e64 vcc, 1, v5
v_mov_b32 v5, 0x7f000000
v_mfma_f32_16x16x32_bf16 v[180:183], a[44:47], a[20:23], v[180:183]
v_min_u32 v2, 4, v1
v_cndmask_b32 v87, v5, v3, vcc
v_cmp_gt_u32 vcc, 4, v1
s_nop 0
v_mfma_f32_16x16x32_bf16 v[176:179], a[40:43], a[20:23], v[176:179]
v_mov_b32 v5, 0x7f000000
v_cndmask_b32_e64 v87, v5, v87, vcc
s_lshr_b32 s65, s2, 3
s_sub_u32 s65, s65, 12
v_mfma_f32_16x16x32_bf16 v[192:195], a[40:43], a[24:27], v[192:195]
s_and_b32 s66, s2, 7
s_lshl_b32 s66, s66, 4
s_add_u32 s66, s66, s65
s_lshl_b32 s66, s66, 7
v_mfma_f32_16x16x32_bf16 v[196:199], a[44:47], a[24:27], v[196:199]
s_add_u32 s66, s66, 17072128
s_cmp_lt_u32 s65, 16
s_cselect_b32 s66, s66, 0x7f000000
v_cmp_eq_u32 vcc, 4, v1
v_mfma_f32_16x16x32_bf16 v[200:203], a[48:51], a[24:27], v[200:203]
v_mov_b32 v5, s66
s_nop 0
v_cndmask_b32 v87, v87, v5, vcc
v_and_b32 v2, 15, v1
v_mfma_f32_16x16x32_bf16 v[204:207], a[52:55], a[24:27], v[204:207]
v_min_u32_e64 v3, 9, v2
v_lshl_add_u32 v3, v3, 7, s64
s_mul_i32 s65, s58, 10
v_min_u32 v2, 9, v2
v_mfma_f32_16x16x32_bf16 v[220:223], a[52:55], a[28:31], v[220:223]
v_add_u32_e64 v2, s65, v2
v_min_u32 v2, 127, v2
v_lshlrev_b32_e64 v2, 7, v2
v_add_u32 v2, 17072128, v2
v_mfma_f32_16x16x32_bf16 v[216:219], a[48:51], a[28:31], v[216:219]
v_and_b32 v5, 16, v1
v_cmp_eq_u32 vcc, 0, v5
s_nop 1
v_cndmask_b32 v89, v3, v2, vcc
v_mfma_f32_16x16x32_bf16 v[212:215], a[44:47], a[28:31], v[212:215]
s_mul_i32 s65, s96, 5
s_lshr_b32 s65, s65, 2
s_mul_i32 s65, s65, 2176
s_add_u32 s65, s65, 17379328
v_mfma_f32_16x16x32_bf16 v[208:211], a[40:43], a[28:31], v[208:211]
v_min_u32_e64 v2, 33, v1
v_lshl_add_u32 v88, v2, 7, s65
s_lshr_b32 s65, s27, 2
s_mul_i32 s65, s65, 27
v_mfma_f32_16x16x32_bf16 v[224:227], a[40:43], a[32:35], v[224:227]
s_lshr_b32 s65, s65, 1
v_min_u32 v2, 14, v1
v_add_u32_e64 v2, s65, v2
v_min_u32 v2, 107, v2
v_mfma_f32_16x16x32_bf16 v[228:231], a[44:47], a[32:35], v[228:231]
s_mov_b32 s65, 17379328
v_lshl_add_u32 v85, v2, 7, s65
ds_read_b128 a[68:71], v27 offset:6144
ds_read_b128 a[72:75], v27 offset:8192
v_mfma_f32_16x16x32_bf16 v[232:235], a[48:51], a[32:35], v[232:235]
ds_read_b128 a[76:79], v27 offset:10240
buffer_load_dwordx4 v17, s[36:39], s61 offen offset:1024  lds
ds_read_b128 a[80:83], v27 offset:12288
v_mfma_f32_16x16x32_bf16 v[236:239], a[52:55], a[32:35], v[236:239]
ds_read_b128 a[84:87], v27 offset:14336
ds_read_b128 a[88:91], v27 offset:16384
ds_read_b128 a[92:95], v27 offset:18432
v_mfma_f32_16x16x32_bf16 v[252:255], a[52:55], a[36:39], v[252:255]
buffer_load_dwordx4 v18, s[36:39], s61 offen offset:2048  lds
buffer_load_dwordx4 v19, s[36:39], s61 offen offset:3072  lds
v_mfma_f32_16x16x32_bf16 v[248:251], a[48:51], a[36:39], v[248:251]
v_mfma_f32_16x16x32_bf16 v[244:247], a[44:47], a[36:39], v[244:247]
v_mfma_f32_16x16x32_bf16 v[240:243], a[40:43], a[36:39], v[240:243]
s_waitcnt lgkmcnt(0)
s_waitcnt vmcnt(14)
s_barrier
s_cmp_eq_u32 s56, 0
s_cbranch_scc0 Lw0_11
s_lshr_b32 s64, s84, 2
s_lshl_b32 s64, s64, 7
s_add_u32 s64, s64, 17379328
buffer_store_dword v21, v7, s[40:43], s64 offen sc1
Lw0_11:
s_cmp_eq_u32 s56, 0
s_cbranch_scc0 Lw0_12
buffer_store_dword v21, v87, s[40:43], 0 offen sc1
Lw0_12:
v_mfma_f32_16x16x32_bf16 v[96:99], a[96:99], a[56:59], v[96:99]
ds_read_b64_tr_b16 a[40:41], v28 offset:0
v_mfma_f32_16x16x32_bf16 v[100:103], a[100:103], a[56:59], v[100:103]
v_mfma_f32_16x16x32_bf16 v[104:107], a[104:107], a[56:59], v[104:107]
ds_read_b64_tr_b16 a[42:43], v28 offset:1024
v_mfma_f32_16x16x32_bf16 v[108:111], a[108:111], a[56:59], v[108:111]
v_mfma_f32_16x16x32_bf16 v[124:127], a[108:111], a[60:63], v[124:127]
ds_read_b64_tr_b16 a[44:45], v29 offset:0
s_lshr_b64 s[74:75], s[74:75], 4
v_mfma_f32_16x16x32_bf16 v[120:123], a[104:107], a[60:63], v[120:123]
s_and_b32 s13, s74, 15
s_lshl_b32 s60, s13, 7
v_mfma_f32_16x16x32_bf16 v[116:119], a[100:103], a[60:63], v[116:119]
s_mul_i32 s61, s13, 196608
s_add_u32 m0, s62, 106496
v_mfma_f32_16x16x32_bf16 v[112:115], a[96:99], a[60:63], v[112:115]
buffer_load_dwordx4 v8, s[28:31], s60 offen offset:0  lds
v_mfma_f32_16x16x32_bf16 v[128:131], a[96:99], a[64:67], v[128:131]
ds_read_b64_tr_b16 a[46:47], v29 offset:1024
ds_read_b64_tr_b16 a[48:49], v28 offset:16384
v_mfma_f32_16x16x32_bf16 v[132:135], a[100:103], a[64:67], v[132:135]
ds_read_b64_tr_b16 a[50:51], v28 offset:17408
v_mfma_f32_16x16x32_bf16 v[136:139], a[104:107], a[64:67], v[136:139]
buffer_load_dwordx4 v9, s[28:31], s60 offen offset:1024  lds
v_mfma_f32_16x16x32_bf16 v[140:143], a[108:111], a[64:67], v[140:143]
ds_read_b64_tr_b16 a[52:53], v29 offset:16384
v_mfma_f32_16x16x32_bf16 v[156:159], a[108:111], a[68:71], v[156:159]
ds_read_b64_tr_b16 a[54:55], v29 offset:17408
v_mfma_f32_16x16x32_bf16 v[152:155], a[104:107], a[68:71], v[152:155]
v_mfma_f32_16x16x32_bf16 v[148:151], a[100:103], a[68:71], v[148:151]
ds_read_b128 a[0:3], v22 offset:0
v_mfma_f32_16x16x32_bf16 v[144:147], a[96:99], a[68:71], v[144:147]
buffer_load_dwordx4 v10, s[28:31], s60 offen offset:2048  lds
v_mfma_f32_16x16x32_bf16 v[160:163], a[96:99], a[72:75], v[160:163]
ds_read_b128 a[4:7], v22 offset:2048
v_mfma_f32_16x16x32_bf16 v[164:167], a[100:103], a[72:75], v[164:167]
ds_read_b128 a[8:11], v22 offset:4096
v_mfma_f32_16x16x32_bf16 v[168:171], a[104:107], a[72:75], v[168:171]
v_mfma_f32_16x16x32_bf16 v[172:175], a[108:111], a[72:75], v[172:175]
ds_read_b128 a[12:15], v22 offset:6144
v_mfma_f32_16x16x32_bf16 v[188:191], a[108:111], a[76:79], v[188:191]
ds_read_b128 a[16:19], v22 offset:8192
v_mfma_f32_16x16x32_bf16 v[184:187], a[104:107], a[76:79], v[184:187]
buffer_load_dwordx4 v11, s[28:31], s60 offen offset:3072  lds
v_mfma_f32_16x16x32_bf16 v[180:183], a[100:103], a[76:79], v[180:183]
ds_read_b128 a[20:23], v22 offset:10240
v_mfma_f32_16x16x32_bf16 v[176:179], a[96:99], a[76:79], v[176:179]
v_mfma_f32_16x16x32_bf16 v[192:195], a[96:99], a[80:83], v[192:195]
ds_read_b128 a[24:27], v22 offset:12288
v_mfma_f32_16x16x32_bf16 v[196:199], a[100:103], a[80:83], v[196:199]
ds_read_b128 a[28:31], v22 offset:14336
v_mfma_f32_16x16x32_bf16 v[200:203], a[104:107], a[80:83], v[200:203]
s_add_u32 m0, s62, 110592
v_mfma_f32_16x16x32_bf16 v[204:207], a[108:111], a[80:83], v[204:207]
buffer_load_dwordx4 v12, s[28:31], s60 offen offset:0  lds
v_mfma_f32_16x16x32_bf16 v[220:223], a[108:111], a[84:87], v[220:223]
ds_read_b128 a[32:35], v22 offset:16384
v_mfma_f32_16x16x32_bf16 v[216:219], a[104:107], a[84:87], v[216:219]
ds_read_b128 a[36:39], v22 offset:18432
v_mfma_f32_16x16x32_bf16 v[212:215], a[100:103], a[84:87], v[212:215]
v_mfma_f32_16x16x32_bf16 v[208:211], a[96:99], a[84:87], v[208:211]
s_add_u32 m0, s63, 106496
v_mfma_f32_16x16x32_bf16 v[224:227], a[96:99], a[88:91], v[224:227]
buffer_load_dwordx4 v16, s[32:35], s61 offen offset:0  lds
v_mfma_f32_16x16x32_bf16 v[228:231], a[100:103], a[88:91], v[228:231]
v_mfma_f32_16x16x32_bf16 v[232:235], a[104:107], a[88:91], v[232:235]
v_mfma_f32_16x16x32_bf16 v[236:239], a[108:111], a[88:91], v[236:239]
v_mfma_f32_16x16x32_bf16 v[252:255], a[108:111], a[92:95], v[252:255]
v_mfma_f32_16x16x32_bf16 v[248:251], a[104:107], a[92:95], v[248:251]
buffer_load_dwordx4 v17, s[32:35], s61 offen offset:1024  lds
v_mfma_f32_16x16x32_bf16 v[244:247], a[100:103], a[92:95], v[244:247]
v_mfma_f32_16x16x32_bf16 v[240:243], a[96:99], a[92:95], v[240:243]
s_waitcnt lgkmcnt(0)
v_mfma_f32_16x16x32_bf16 v[96:99], a[40:43], a[0:3], v[96:99]
ds_read_b64_tr_b16 a[96:97], v28 offset:8192
v_mfma_f32_16x16x32_bf16 v[100:103], a[44:47], a[0:3], v[100:103]
v_mfma_f32_16x16x32_bf16 v[104:107], a[48:51], a[0:3], v[104:107]
ds_read_b64_tr_b16 a[98:99], v28 offset:9216
v_mfma_f32_16x16x32_bf16 v[108:111], a[52:55], a[0:3], v[108:111]
v_mfma_f32_16x16x32_bf16 v[124:127], a[52:55], a[4:7], v[124:127]
ds_read_b64_tr_b16 a[100:101], v29 offset:8192
v_mfma_f32_16x16x32_bf16 v[120:123], a[48:51], a[4:7], v[120:123]
buffer_load_dwordx4 v18, s[32:35], s61 offen offset:2048  lds
v_mfma_f32_16x16x32_bf16 v[116:119], a[44:47], a[4:7], v[116:119]
ds_read_b64_tr_b16 a[102:103], v29 offset:9216
v_mfma_f32_16x16x32_bf16 v[112:115], a[40:43], a[4:7], v[112:115]
ds_read_b64_tr_b16 a[104:105], v28 offset:24576
v_mfma_f32_16x16x32_bf16 v[128:131], a[40:43], a[8:11], v[128:131]
v_mfma_f32_16x16x32_bf16 v[132:135], a[44:47], a[8:11], v[132:135]
ds_read_b64_tr_b16 a[106:107], v28 offset:25600
v_mfma_f32_16x16x32_bf16 v[136:139], a[48:51], a[8:11], v[136:139]
ds_read_b64_tr_b16 a[108:109], v29 offset:24576
v_mfma_f32_16x16x32_bf16 v[140:143], a[52:55], a[8:11], v[140:143]
buffer_load_dwordx4 v19, s[32:35], s61 offen offset:3072  lds
v_mfma_f32_16x16x32_bf16 v[156:159], a[52:55], a[12:15], v[156:159]
ds_read_b64_tr_b16 a[110:111], v29 offset:25600
v_mfma_f32_16x16x32_bf16 v[152:155], a[48:51], a[12:15], v[152:155]
v_mfma_f32_16x16x32_bf16 v[148:151], a[44:47], a[12:15], v[148:151]
ds_read_b128 a[56:59], v23 offset:0
v_mfma_f32_16x16x32_bf16 v[144:147], a[40:43], a[12:15], v[144:147]
ds_read_b128 a[60:63], v23 offset:2048
v_mfma_f32_16x16x32_bf16 v[160:163], a[40:43], a[16:19], v[160:163]
v_mfma_f32_16x16x32_bf16 v[164:167], a[44:47], a[16:19], v[164:167]
ds_read_b128 a[64:67], v23 offset:4096
s_add_u32 m0, s63, 122880
v_mfma_f32_16x16x32_bf16 v[168:171], a[48:51], a[16:19], v[168:171]
buffer_load_dwordx4 v16, s[36:39], s61 offen offset:0  lds
v_mfma_f32_16x16x32_bf16 v[172:175], a[52:55], a[16:19], v[172:175]
s_lshr_b32 s64, s27, 3
s_lshl_b32 s64, s64, 12
v_mfma_f32_16x16x32_bf16 v[188:191], a[52:55], a[20:23], v[188:191]
s_add_u32 s97, s64, 17199104
s_mul_i32 s64, s95, 52429
v_mfma_f32_16x16x32_bf16 v[184:187], a[48:51], a[20:23], v[184:187]
s_lshr_b32 s64, s64, 17
s_lshl_b32 s65, s95, 6
v_mfma_f32_16x16x32_bf16 v[180:183], a[44:47], a[20:23], v[180:183]
s_add_u32 s65, s65, 63
s_mul_i32 s65, s65, 52429
v_mfma_f32_16x16x32_bf16 v[176:179], a[40:43], a[20:23], v[176:179]
s_lshr_b32 s65, s65, 23
s_sub_u32 s65, s65, s64
v_mfma_f32_16x16x32_bf16 v[192:195], a[40:43], a[24:27], v[192:195]
s_mul_i32 s77, s65, 384
s_mul_i32 s64, s64, 48
v_mfma_f32_16x16x32_bf16 v[196:199], a[44:47], a[24:27], v[196:199]
s_mul_i32 s66, s56, 12
s_add_u32 s64, s64, s66
v_mfma_f32_16x16x32_bf16 v[200:203], a[48:51], a[24:27], v[200:203]
s_lshl_b32 s64, s64, 7
s_add_u32 s98, s64, 17119232
v_mfma_f32_16x16x32_bf16 v[204:207], a[52:55], a[24:27], v[204:207]
s_mul_i32 s64, s27, 81920
s_add_u32 s99, s64, 12582912
v_mfma_f32_16x16x32_bf16 v[220:223], a[52:55], a[28:31], v[220:223]
s_min_u32 s76, s26, 127
s_lshl_b32 s76, s76, 4
v_mfma_f32_16x16x32_bf16 v[216:219], a[48:51], a[28:31], v[216:219]
ds_read_b128 a[68:71], v23 offset:6144
ds_read_b128 a[72:75], v23 offset:8192
v_mfma_f32_16x16x32_bf16 v[212:215], a[44:47], a[28:31], v[212:215]
ds_read_b128 a[76:79], v23 offset:10240
v_mfma_f32_16x16x32_bf16 v[208:211], a[40:43], a[28:31], v[208:211]
buffer_load_dwordx4 v17, s[36:39], s61 offen offset:1024  lds
v_mfma_f32_16x16x32_bf16 v[224:227], a[40:43], a[32:35], v[224:227]
ds_read_b128 a[80:83], v23 offset:12288
ds_read_b128 a[84:87], v23 offset:14336
v_mfma_f32_16x16x32_bf16 v[228:231], a[44:47], a[32:35], v[228:231]
ds_read_b128 a[88:91], v23 offset:16384
ds_read_b128 a[92:95], v23 offset:18432
v_mfma_f32_16x16x32_bf16 v[232:235], a[48:51], a[32:35], v[232:235]
buffer_load_dwordx4 v18, s[36:39], s61 offen offset:2048  lds
v_mfma_f32_16x16x32_bf16 v[236:239], a[52:55], a[32:35], v[236:239]
v_mfma_f32_16x16x32_bf16 v[252:255], a[52:55], a[36:39], v[252:255]
buffer_load_dwordx4 v19, s[36:39], s61 offen offset:3072  lds
v_mfma_f32_16x16x32_bf16 v[248:251], a[48:51], a[36:39], v[248:251]
v_mfma_f32_16x16x32_bf16 v[244:247], a[44:47], a[36:39], v[244:247]
v_mfma_f32_16x16x32_bf16 v[240:243], a[40:43], a[36:39], v[240:243]
s_waitcnt lgkmcnt(0)
s_waitcnt vmcnt(13)
s_barrier
v_mfma_f32_16x16x32_bf16 v[96:99], a[96:99], a[56:59], v[96:99]
ds_read_b64_tr_b16 a[40:41], v30 offset:0
v_mfma_f32_16x16x32_bf16 v[100:103], a[100:103], a[56:59], v[100:103]
v_mfma_f32_16x16x32_bf16 v[104:107], a[104:107], a[56:59], v[104:107]
ds_read_b64_tr_b16 a[42:43], v30 offset:1024
v_mfma_f32_16x16x32_bf16 v[108:111], a[108:111], a[56:59], v[108:111]
v_mfma_f32_16x16x32_bf16 v[124:127], a[108:111], a[60:63], v[124:127]
ds_read_b64_tr_b16 a[44:45], v31 offset:0
s_lshr_b64 s[74:75], s[74:75], 4
v_mfma_f32_16x16x32_bf16 v[120:123], a[104:107], a[60:63], v[120:123]
s_and_b32 s13, s74, 15
s_lshl_b32 s60, s13, 7
v_mfma_f32_16x16x32_bf16 v[116:119], a[100:103], a[60:63], v[116:119]
s_mul_i32 s61, s13, 196608
s_add_u32 m0, s62, 0
v_mfma_f32_16x16x32_bf16 v[112:115], a[96:99], a[60:63], v[112:115]
buffer_load_dwordx4 v8, s[28:31], s60 offen offset:0  lds
v_mfma_f32_16x16x32_bf16 v[128:131], a[96:99], a[64:67], v[128:131]
ds_read_b64_tr_b16 a[46:47], v31 offset:1024
ds_read_b64_tr_b16 a[48:49], v30 offset:16384
v_mfma_f32_16x16x32_bf16 v[132:135], a[100:103], a[64:67], v[132:135]
ds_read_b64_tr_b16 a[50:51], v30 offset:17408
v_mfma_f32_16x16x32_bf16 v[136:139], a[104:107], a[64:67], v[136:139]
buffer_load_dwordx4 v9, s[28:31], s60 offen offset:1024  lds
v_mfma_f32_16x16x32_bf16 v[140:143], a[108:111], a[64:67], v[140:143]
ds_read_b64_tr_b16 a[52:53], v31 offset:16384
v_mfma_f32_16x16x32_bf16 v[156:159], a[108:111], a[68:71], v[156:159]
ds_read_b64_tr_b16 a[54:55], v31 offset:17408
v_mfma_f32_16x16x32_bf16 v[152:155], a[104:107], a[68:71], v[152:155]
v_mfma_f32_16x16x32_bf16 v[148:151], a[100:103], a[68:71], v[148:151]
ds_read_b128 a[0:3], v24 offset:0
v_mfma_f32_16x16x32_bf16 v[144:147], a[96:99], a[68:71], v[144:147]
buffer_load_dwordx4 v10, s[28:31], s60 offen offset:2048  lds
v_mfma_f32_16x16x32_bf16 v[160:163], a[96:99], a[72:75], v[160:163]
ds_read_b128 a[4:7], v24 offset:2048
v_mfma_f32_16x16x32_bf16 v[164:167], a[100:103], a[72:75], v[164:167]
ds_read_b128 a[8:11], v24 offset:4096
v_mfma_f32_16x16x32_bf16 v[168:171], a[104:107], a[72:75], v[168:171]
v_mfma_f32_16x16x32_bf16 v[172:175], a[108:111], a[72:75], v[172:175]
ds_read_b128 a[12:15], v24 offset:6144
v_mfma_f32_16x16x32_bf16 v[188:191], a[108:111], a[76:79], v[188:191]
ds_read_b128 a[16:19], v24 offset:8192
v_mfma_f32_16x16x32_bf16 v[184:187], a[104:107], a[76:79], v[184:187]
buffer_load_dwordx4 v11, s[28:31], s60 offen offset:3072  lds
v_mfma_f32_16x16x32_bf16 v[180:183], a[100:103], a[76:79], v[180:183]
ds_read_b128 a[20:23], v24 offset:10240
v_mfma_f32_16x16x32_bf16 v[176:179], a[96:99], a[76:79], v[176:179]
v_mfma_f32_16x16x32_bf16 v[192:195], a[96:99], a[80:83], v[192:195]
ds_read_b128 a[24:27], v24 offset:12288
v_mfma_f32_16x16x32_bf16 v[196:199], a[100:103], a[80:83], v[196:199]
ds_read_b128 a[28:31], v24 offset:14336
v_mfma_f32_16x16x32_bf16 v[200:203], a[104:107], a[80:83], v[200:203]
s_add_u32 m0, s62, 4096
v_mfma_f32_16x16x32_bf16 v[204:207], a[108:111], a[80:83], v[204:207]
buffer_load_dwordx4 v12, s[28:31], s60 offen offset:0  lds
v_mfma_f32_16x16x32_bf16 v[220:223], a[108:111], a[84:87], v[220:223]
ds_read_b128 a[32:35], v24 offset:16384
v_mfma_f32_16x16x32_bf16 v[216:219], a[104:107], a[84:87], v[216:219]
ds_read_b128 a[36:39], v24 offset:18432
v_mfma_f32_16x16x32_bf16 v[212:215], a[100:103], a[84:87], v[212:215]
v_mfma_f32_16x16x32_bf16 v[208:211], a[96:99], a[84:87], v[208:211]
s_add_u32 m0, s63, 0
v_mfma_f32_16x16x32_bf16 v[224:227], a[96:99], a[88:91], v[224:227]
buffer_load_dwordx4 v16, s[32:35], s61 offen offset:0  lds
v_mfma_f32_16x16x32_bf16 v[228:231], a[100:103], a[88:91], v[228:231]
v_mfma_f32_16x16x32_bf16 v[232:235], a[104:107], a[88:91], v[232:235]
v_mfma_f32_16x16x32_bf16 v[236:239], a[108:111], a[88:91], v[236:239]
v_mfma_f32_16x16x32_bf16 v[252:255], a[108:111], a[92:95], v[252:255]
v_mfma_f32_16x16x32_bf16 v[248:251], a[104:107], a[92:95], v[248:251]
buffer_load_dwordx4 v17, s[32:35], s61 offen offset:1024  lds
v_mfma_f32_16x16x32_bf16 v[244:247], a[100:103], a[92:95], v[244:247]
v_mfma_f32_16x16x32_bf16 v[240:243], a[96:99], a[92:95], v[240:243]
s_waitcnt lgkmcnt(0)
s_cmp_eq_u32 s56, 0
s_cbranch_scc0 Lw0_13
buffer_load_dword v83, v88, s[40:43], 0 offen sc1
buffer_load_dword v84, v85, s[40:43], 0 offen sc1
Lw0_13:
v_mfma_f32_16x16x32_bf16 v[96:99], a[40:43], a[0:3], v[96:99]
ds_read_b64_tr_b16 a[96:97], v30 offset:8192
v_mfma_f32_16x16x32_bf16 v[100:103], a[44:47], a[0:3], v[100:103]
v_mfma_f32_16x16x32_bf16 v[104:107], a[48:51], a[0:3], v[104:107]
s_mov_b32 s64, 159744
v_bfe_u32 v2, v1, 2, 2
v_mfma_f32_16x16x32_bf16 v[108:111], a[52:55], a[0:3], v[108:111]
v_mul_u32_u24 v2, 10, v2
v_lshrrev_b32 v3, 4, v1
v_mfma_f32_16x16x32_bf16 v[124:127], a[52:55], a[4:7], v[124:127]
v_mul_u32_u24 v4, 320, v3
v_add3_u32 v2, v2, v4, s64
v_mfma_f32_16x16x32_bf16 v[120:123], a[48:51], a[4:7], v[120:123]
v_and_b32_e64 v4, 3, v1
v_lshl_add_u32 v42, v4, 1, v2
v_mfma_f32_16x16x32_bf16 v[116:119], a[44:47], a[4:7], v[116:119]
v_add_u32_e64 v43, 8, v2
ds_read_b64_tr_b16 a[98:99], v30 offset:9216
v_mfma_f32_16x16x32_bf16 v[112:115], a[40:43], a[4:7], v[112:115]
ds_read_b64_tr_b16 a[100:101], v31 offset:8192
v_mfma_f32_16x16x32_bf16 v[128:131], a[40:43], a[8:11], v[128:131]
buffer_load_dwordx4 v18, s[32:35], s61 offen offset:2048  lds
v_mfma_f32_16x16x32_bf16 v[132:135], a[44:47], a[8:11], v[132:135]
ds_read_b64_tr_b16 a[102:103], v31 offset:9216
ds_read_u16 v34, v42 offset:0
v_mfma_f32_16x16x32_bf16 v[136:139], a[48:51], a[8:11], v[136:139]
ds_read_b64_tr_b16 a[104:105], v30 offset:24576
ds_read_b64_tr_b16 a[106:107], v30 offset:25600
v_mfma_f32_16x16x32_bf16 v[140:143], a[52:55], a[8:11], v[140:143]
ds_read_u16 v35, v42 offset:40
ds_read_b64_tr_b16 a[108:109], v31 offset:24576
v_mfma_f32_16x16x32_bf16 v[156:159], a[52:55], a[12:15], v[156:159]
buffer_load_dwordx4 v19, s[32:35], s61 offen offset:3072  lds
v_mfma_f32_16x16x32_bf16 v[152:155], a[48:51], a[12:15], v[152:155]
ds_read_b64_tr_b16 a[110:111], v31 offset:25600
v_mfma_f32_16x16x32_bf16 v[148:151], a[44:47], a[12:15], v[148:151]
ds_read_b128 a[56:59], v25 offset:0
ds_read_u16 v36, v42 offset:80
v_mfma_f32_16x16x32_bf16 v[144:147], a[40:43], a[12:15], v[144:147]
ds_read_b128 a[60:63], v25 offset:2048
v_mfma_f32_16x16x32_bf16 v[160:163], a[40:43], a[16:19], v[160:163]
v_mfma_f32_16x16x32_bf16 v[164:167], a[44:47], a[16:19], v[164:167]
ds_read_b128 a[64:67], v25 offset:4096
s_add_u32 m0, s63, 16384
v_mfma_f32_16x16x32_bf16 v[168:171], a[48:51], a[16:19], v[168:171]
buffer_load_dwordx4 v16, s[36:39], s61 offen offset:0  lds
v_mfma_f32_16x16x32_bf16 v[172:175], a[52:55], a[16:19], v[172:175]
ds_read_u16 v37, v42 offset:120
ds_read_b128 a[68:71], v25 offset:6144
v_mfma_f32_16x16x32_bf16 v[188:191], a[52:55], a[20:23], v[188:191]
ds_read_b128 a[72:75], v25 offset:8192
v_mfma_f32_16x16x32_bf16 v[184:187], a[48:51], a[20:23], v[184:187]
v_mfma_f32_16x16x32_bf16 v[180:183], a[44:47], a[20:23], v[180:183]
ds_read_b128 a[76:79], v25 offset:10240
ds_read_u16 v38, v42 offset:160
v_mfma_f32_16x16x32_bf16 v[176:179], a[40:43], a[20:23], v[176:179]
v_mfma_f32_16x16x32_bf16 v[192:195], a[40:43], a[24:27], v[192:195]
buffer_load_dwordx4 v17, s[36:39], s61 offen offset:1024  lds
v_mfma_f32_16x16x32_bf16 v[196:199], a[44:47], a[24:27], v[196:199]
ds_read_b128 a[80:83], v25 offset:12288
ds_read_b128 a[84:87], v25 offset:14336
v_mfma_f32_16x16x32_bf16 v[200:203], a[48:51], a[24:27], v[200:203]
ds_read_u16 v39, v42 offset:200
v_mfma_f32_16x16x32_bf16 v[204:207], a[52:55], a[24:27], v[204:207]
ds_read_b128 a[88:91], v25 offset:16384
v_mfma_f32_16x16x32_bf16 v[220:223], a[52:55], a[28:31], v[220:223]
v_mfma_f32_16x16x32_bf16 v[216:219], a[48:51], a[28:31], v[216:219]
ds_read_b128 a[92:95], v25 offset:18432
v_mfma_f32_16x16x32_bf16 v[212:215], a[44:47], a[28:31], v[212:215]
buffer_load_dwordx4 v18, s[36:39], s61 offen offset:2048  lds
v_mfma_f32_16x16x32_bf16 v[208:211], a[40:43], a[28:31], v[208:211]
ds_read_u16 v40, v42 offset:240
v_mfma_f32_16x16x32_bf16 v[224:227], a[40:43], a[32:35], v[224:227]
v_mfma_f32_16x16x32_bf16 v[228:231], a[44:47], a[32:35], v[228:231]
v_mfma_f32_16x16x32_bf16 v[232:235], a[48:51], a[32:35], v[232:235]
ds_read_u16 v41, v42 offset:280
v_mfma_f32_16x16x32_bf16 v[236:239], a[52:55], a[32:35], v[236:239]
v_mfma_f32_16x16x32_bf16 v[252:255], a[52:55], a[36:39], v[252:255]
buffer_load_dwordx4 v19, s[36:39], s61 offen offset:3072  lds
v_mfma_f32_16x16x32_bf16 v[248:251], a[48:51], a[36:39], v[248:251]
v_mfma_f32_16x16x32_bf16 v[244:247], a[44:47], a[36:39], v[244:247]
v_mfma_f32_16x16x32_bf16 v[240:243], a[40:43], a[36:39], v[240:243]
s_waitcnt lgkmcnt(0)
s_waitcnt vmcnt(13)
s_cmp_eq_u32 s56, 0
s_cbranch_scc0 Lw0_14
s_waitcnt vmcnt(6)
v_min_u32 v83, v83, v84
v_cmp_eq_u32 vcc, 0, v83
s_cbranch_vccz Lok9
s_mov_b32 s85, 40000
Lsp9:
buffer_load_dword v83, v88, s[40:43], 0 offen sc1
buffer_load_dword v84, v85, s[40:43], 0 offen sc1
s_waitcnt vmcnt(0)
v_min_u32 v83, v83, v84
v_cmp_eq_u32 vcc, 0, v83
s_cbranch_vccz Lok9
s_sub_u32 s85, s85, 1
s_cmp_lg_u32 s85, 0
s_cbranch_scc1 Lsp9
Lok9:
Lw0_14:
s_barrier
s_cmp_eq_u32 s56, 0
s_cbranch_scc0 Lw0_15
buffer_load_dword v86, v89, s[40:43], 0 offen sc1
Lw0_15:
v_mfma_f32_16x16x32_bf16 v[96:99], a[96:99], a[56:59], v[96:99]
ds_read_b64_tr_b16 a[40:41], v32 offset:0
v_mfma_f32_16x16x32_bf16 v[100:103], a[100:103], a[56:59], v[100:103]
v_lshl_or_b32 v8, v35, 16, v34
v_mfma_f32_16x16x32_bf16 v[104:107], a[104:107], a[56:59], v[104:107]
ds_read_b64_tr_b16 a[42:43], v32 offset:1024
v_lshl_or_b32 v9, v37, 16, v36
v_mfma_f32_16x16x32_bf16 v[108:111], a[108:111], a[56:59], v[108:111]
v_mfma_f32_16x16x32_bf16 v[124:127], a[108:111], a[60:63], v[124:127]
ds_read_b64_tr_b16 a[44:45], v33 offset:0
v_lshl_or_b32 v10, v39, 16, v38
v_mfma_f32_16x16x32_bf16 v[120:123], a[104:107], a[60:63], v[120:123]
ds_read_b64_tr_b16 a[46:47], v33 offset:1024
v_mfma_f32_16x16x32_bf16 v[116:119], a[100:103], a[60:63], v[116:119]
v_lshl_or_b32 v11, v41, 16, v40
v_mfma_f32_16x16x32_bf16 v[112:115], a[96:99], a[60:63], v[112:115]
ds_read_b64_tr_b16 a[48:49], v32 offset:16384
v_mfma_f32_16x16x32_bf16 v[128:131], a[96:99], a[64:67], v[128:131]
ds_read_u16 v34, v43 offset:0
v_mfma_f32_16x16x32_bf16 v[132:135], a[100:103], a[64:67], v[132:135]
ds_read_b64_tr_b16 a[50:51], v32 offset:17408
ds_read_u16 v35, v43 offset:40
v_mfma_f32_16x16x32_bf16 v[136:139], a[104:107], a[64:67], v[136:139]
ds_read_b64_tr_b16 a[52:53], v33 offset:16384
v_mfma_f32_16x16x32_bf16 v[140:143], a[108:111], a[64:67], v[140:143]
ds_read_u16 v36, v43 offset:80
v_mfma_f32_16x16x32_bf16 v[156:159], a[108:111], a[68:71], v[156:159]
ds_read_b64_tr_b16 a[54:55], v33 offset:17408
v_mfma_f32_16x16x32_bf16 v[152:155], a[104:107], a[68:71], v[152:155]
ds_read_u16 v37, v43 offset:120
v_mfma_f32_16x16x32_bf16 v[148:151], a[100:103], a[68:71], v[148:151]
ds_read_b128 a[0:3], v26 offset:0
v_mfma_f32_16x16x32_bf16 v[144:147], a[96:99], a[68:71], v[144:147]
ds_read_u16 v38, v43 offset:160
ds_read_b128 a[4:7], v26 offset:2048
v_mfma_f32_16x16x32_bf16 v[160:163], a[96:99], a[72:75], v[160:163]
ds_read_u16 v39, v43 offset:200
v_mfma_f32_16x16x32_bf16 v[164:167], a[100:103], a[72:75], v[164:167]
ds_read_b128 a[8:11], v26 offset:4096
v_mfma_f32_16x16x32_bf16 v[168:171], a[104:107], a[72:75], v[168:171]
ds_read_u16 v40, v43 offset:240
v_mfma_f32_16x16x32_bf16 v[172:175], a[108:111], a[72:75], v[172:175]
ds_read_b128 a[12:15], v26 offset:6144
v_mfma_f32_16x16x32_bf16 v[188:191], a[108:111], a[76:79], v[188:191]
ds_read_u16 v41, v43 offset:280
ds_read_b128 a[16:19], v26 offset:8192
v_mfma_f32_16x16x32_bf16 v[184:187], a[104:107], a[76:79], v[184:187]
v_mfma_f32_16x16x32_bf16 v[180:183], a[100:103], a[76:79], v[180:183]
buffer_load_dwordx4 a[112:115], v6, s[40:43], s86 offen offset:0 sc1
v_mfma_f32_16x16x32_bf16 v[176:179], a[96:99], a[76:79], v[176:179]
ds_read_b128 a[20:23], v26 offset:10240
v_mfma_f32_16x16x32_bf16 v[192:195], a[96:99], a[80:83], v[192:195]
buffer_load_dwordx4 a[116:119], v6, s[40:43], s87 offen offset:0 sc1
v_mfma_f32_16x16x32_bf16 v[196:199], a[100:103], a[80:83], v[196:199]
ds_read_b128 a[24:27], v26 offset:12288
v_mfma_f32_16x16x32_bf16 v[200:203], a[104:107], a[80:83], v[200:203]
buffer_load_dwordx4 a[120:123], v6, s[40:43], s88 offen offset:0 sc1
v_mfma_f32_16x16x32_bf16 v[204:207], a[108:111], a[80:83], v[204:207]
ds_read_b128 a[28:31], v26 offset:14336
v_mfma_f32_16x16x32_bf16 v[220:223], a[108:111], a[84:87], v[220:223]
buffer_load_dwordx4 a[124:127], v6, s[40:43], s89 offen offset:0 sc1
v_mfma_f32_16x16x32_bf16 v[216:219], a[104:107], a[84:87], v[216:219]
ds_read_b128 a[32:35], v26 offset:16384
v_mfma_f32_16x16x32_bf16 v[212:215], a[100:103], a[84:87], v[212:215]
buffer_load_dwordx4 a[128:131], v6, s[40:43], s90 offen offset:0 sc1
v_mfma_f32_16x16x32_bf16 v[208:211], a[96:99], a[84:87], v[208:211]
ds_read_b128 a[36:39], v26 offset:18432
v_mfma_f32_16x16x32_bf16 v[224:227], a[96:99], a[88:91], v[224:227]
buffer_load_dwordx4 a[132:135], v6, s[40:43], s86 offen offset:1024 sc1
v_mfma_f32_16x16x32_bf16 v[228:231], a[100:103], a[88:91], v[228:231]
buffer_load_dwordx4 a[136:139], v6, s[40:43], s87 offen offset:1024 sc1
v_mfma_f32_16x16x32_bf16 v[232:235], a[104:107], a[88:91], v[232:235]
buffer_load_dwordx4 a[140:143], v6, s[40:43], s88 offen offset:1024 sc1
v_mfma_f32_16x16x32_bf16 v[236:239], a[108:111], a[88:91], v[236:239]
v_mfma_f32_16x16x32_bf16 v[252:255], a[108:111], a[92:95], v[252:255]
buffer_load_dwordx4 a[144:147], v6, s[40:43], s89 offen offset:1024 sc1
v_mfma_f32_16x16x32_bf16 v[248:251], a[104:107], a[92:95], v[248:251]
v_mfma_f32_16x16x32_bf16 v[244:247], a[100:103], a[92:95], v[244:247]
v_mfma_f32_16x16x32_bf16 v[240:243], a[96:99], a[92:95], v[240:243]
s_waitcnt lgkmcnt(0)
v_mfma_f32_16x16x32_bf16 v[96:99], a[40:43], a[0:3], v[96:99]
ds_read_b64_tr_b16 a[96:97], v32 offset:8192
v_mfma_f32_16x16x32_bf16 v[100:103], a[44:47], a[0:3], v[100:103]
v_lshl_or_b32 v12, v35, 16, v34
v_mfma_f32_16x16x32_bf16 v[104:107], a[48:51], a[0:3], v[104:107]
ds_read_b64_tr_b16 a[98:99], v32 offset:9216
v_mfma_f32_16x16x32_bf16 v[108:111], a[52:55], a[0:3], v[108:111]
v_mfma_f32_16x16x32_bf16 v[124:127], a[52:55], a[4:7], v[124:127]
v_lshl_or_b32 v13, v37, 16, v36
ds_read_b64_tr_b16 a[100:101], v33 offset:8192
v_mfma_f32_16x16x32_bf16 v[120:123], a[48:51], a[4:7], v[120:123]
ds_read_b64_tr_b16 a[102:103], v33 offset:9216
v_mfma_f32_16x16x32_bf16 v[116:119], a[44:47], a[4:7], v[116:119]
v_lshl_or_b32 v14, v39, 16, v38
v_mfma_f32_16x16x32_bf16 v[112:115], a[40:43], a[4:7], v[112:115]
ds_read_b64_tr_b16 a[104:105], v32 offset:24576
v_mfma_f32_16x16x32_bf16 v[128:131], a[40:43], a[8:11], v[128:131]
v_mfma_f32_16x16x32_bf16 v[132:135], a[44:47], a[8:11], v[132:135]
ds_read_b64_tr_b16 a[106:107], v32 offset:25600
v_lshl_or_b32 v15, v41, 16, v40
v_mfma_f32_16x16x32_bf16 v[136:139], a[48:51], a[8:11], v[136:139]
ds_read_b64_tr_b16 a[108:109], v33 offset:24576
v_mfma_f32_16x16x32_bf16 v[140:143], a[52:55], a[8:11], v[140:143]
v_mfma_f32_16x16x32_bf16 v[156:159], a[52:55], a[12:15], v[156:159]
v_cmp_gt_u32 vcc, 48, v1
s_nop 1
v_cndmask_b32 v8, 0, v8, vcc
v_mfma_f32_16x16x32_bf16 v[152:155], a[48:51], a[12:15], v[152:155]
v_cndmask_b32 v9, 0, v9, vcc
v_cndmask_b32 v12, 0, v12, vcc
v_mfma_f32_16x16x32_bf16 v[148:151], a[44:47], a[12:15], v[148:151]
v_cndmask_b32 v13, 0, v13, vcc
v_cmp_gt_u32 vcc, 32, v1
v_mfma_f32_16x16x32_bf16 v[144:147], a[40:43], a[12:15], v[144:147]
s_nop 0
v_cndmask_b32 v10, 0, v10, vcc
v_cndmask_b32_e64 v11, 0, v11, vcc
v_mfma_f32_16x16x32_bf16 v[160:163], a[40:43], a[16:19], v[160:163]
v_cndmask_b32 v14, 0, v14, vcc
v_cndmask_b32 v15, 0, v15, vcc
v_mfma_f32_16x16x32_bf16 v[164:167], a[44:47], a[16:19], v[164:167]
ds_read_b64_tr_b16 a[110:111], v33 offset:25600
ds_read_b128 a[56:59], v27 offset:0
v_mfma_f32_16x16x32_bf16 v[168:171], a[48:51], a[16:19], v[168:171]
buffer_load_dwordx4 a[148:151], v6, s[40:43], s90 offen offset:1024 sc1
v_mfma_f32_16x16x32_bf16 v[172:175], a[52:55], a[16:19], v[172:175]
ds_read_b128 a[60:63], v27 offset:2048
v_mfma_f32_16x16x32_bf16 v[188:191], a[52:55], a[20:23], v[188:191]
buffer_load_dwordx4 a[152:155], v6, s[40:43], s86 offen offset:2048 sc1
v_mfma_f32_16x16x32_bf16 v[184:187], a[48:51], a[20:23], v[184:187]
ds_read_b128 a[64:67], v27 offset:4096
ds_read_b128 a[68:71], v27 offset:6144
v_mfma_f32_16x16x32_bf16 v[180:183], a[44:47], a[20:23], v[180:183]
buffer_load_dwordx4 a[156:159], v6, s[40:43], s87 offen offset:2048 sc1
v_mfma_f32_16x16x32_bf16 v[176:179], a[40:43], a[20:23], v[176:179]
ds_read_b128 a[72:75], v27 offset:8192
ds_read_b128 a[76:79], v27 offset:10240
v_mfma_f32_16x16x32_bf16 v[192:195], a[40:43], a[24:27], v[192:195]
buffer_load_dwordx4 a[160:163], v6, s[40:43], s88 offen offset:2048 sc1
v_mfma_f32_16x16x32_bf16 v[196:199], a[44:47], a[24:27], v[196:199]
ds_read_b128 a[80:83], v27 offset:12288
v_mfma_f32_16x16x32_bf16 v[200:203], a[48:51], a[24:27], v[200:203]
buffer_load_dwordx4 a[164:167], v6, s[40:43], s89 offen offset:2048 sc1
v_mfma_f32_16x16x32_bf16 v[204:207], a[52:55], a[24:27], v[204:207]
ds_read_b128 a[84:87], v27 offset:14336
ds_read_b128 a[88:91], v27 offset:16384
v_mfma_f32_16x16x32_bf16 v[220:223], a[52:55], a[28:31], v[220:223]
buffer_load_dwordx4 a[168:171], v6, s[40:43], s90 offen offset:2048 sc1
v_mfma_f32_16x16x32_bf16 v[216:219], a[48:51], a[28:31], v[216:219]
ds_read_b128 a[92:95], v27 offset:18432
v_mfma_f32_16x16x32_bf16 v[212:215], a[44:47], a[28:31], v[212:215]
buffer_load_dwordx4 a[172:175], v6, s[40:43], s86 offen offset:3072 sc1
v_mfma_f32_16x16x32_bf16 v[208:211], a[40:43], a[28:31], v[208:211]
v_mfma_f32_16x16x32_bf16 v[224:227], a[40:43], a[32:35], v[224:227]
v_mfma_f32_16x16x32_bf16 v[228:231], a[44:47], a[32:35], v[228:231]
buffer_load_dwordx4 a[176:179], v6, s[40:43], s87 offen offset:3072 sc1
v_mfma_f32_16x16x32_bf16 v[232:235], a[48:51], a[32:35], v[232:235]
v_mfma_f32_16x16x32_bf16 v[236:239], a[52:55], a[32:35], v[236:239]
buffer_load_dwordx4 a[180:183], v6, s[40:43], s88 offen offset:3072 sc1
v_mfma_f32_16x16x32_bf16 v[252:255], a[52:55], a[36:39], v[252:255]
v_mfma_f32_16x16x32_bf16 v[248:251], a[48:51], a[36:39], v[248:251]
v_mfma_f32_16x16x32_bf16 v[244:247], a[44:47], a[36:39], v[244:247]
v_mfma_f32_16x16x32_bf16 v[240:243], a[40:43], a[36:39], v[240:243]
s_waitcnt lgkmcnt(0)
s_waitcnt vmcnt(18)
s_cmp_eq_u32 s56, 0
s_cbranch_scc0 Lw0_16
s_waitcnt vmcnt(18)
v_cmp_eq_u32 vcc, 0, v86
s_cbranch_vccz Lok10
s_mov_b32 s85, 40000
Lsp10:
buffer_load_dword v86, v89, s[40:43], 0 offen sc1
s_waitcnt vmcnt(0)
v_cmp_eq_u32 vcc, 0, v86
s_cbranch_vccz Lok10
s_sub_u32 s85, s85, 1
s_cmp_lg_u32 s85, 0
s_cbranch_scc1 Lsp10
Lok10:
Lw0_16:
s_barrier
v_mfma_f32_16x16x32_bf16 v[96:99], a[96:99], a[56:59], v[96:99]
ds_read_b64_tr_b16 a[40:41], v28 offset:0
v_mfma_f32_16x16x32_bf16 v[100:103], a[100:103], a[56:59], v[100:103]
s_lshl_b32 s65, s59, 9
s_lshl_b32 s66, s56, 7
s_add_u32 s65, s65, s66
v_mfma_f32_16x16x32_bf16 v[104:107], a[104:107], a[56:59], v[104:107]
s_add_u32 s65, s65, 16850432
v_lshrrev_b32 v2, 4, v1
v_mul_u32_u24 v4, 19968, v2
v_mfma_f32_16x16x32_bf16 v[108:111], a[108:111], a[56:59], v[108:111]
v_and_b32_e64 v3, 7, v1
v_lshl_add_u32 v4, v3, 4, v4
v_bfe_u32 v3, v1, 3, 1
v_mfma_f32_16x16x32_bf16 v[124:127], a[108:111], a[60:63], v[124:127]
v_mul_u32_u24 v3, 6144, v3
v_add_u32 v94, v3, v4
v_cmp_gt_u32 vcc, 2, v2
v_mfma_f32_16x16x32_bf16 v[120:123], a[104:107], a[60:63], v[120:123]
v_mov_b32 v3, 0x7f000000
s_nop 0
v_cndmask_b32 v20, v3, v94, vcc
v_mfma_f32_16x16x32_bf16 v[116:119], a[100:103], a[60:63], v[116:119]
ds_read_b64_tr_b16 a[42:43], v28 offset:1024
buffer_load_dwordx4 v[74:77], v94, s[40:43], s65 offen sc1
v_mfma_f32_16x16x32_bf16 v[112:115], a[96:99], a[60:63], v[112:115]
ds_read_b64_tr_b16 a[44:45], v29 offset:0
s_add_u32 s65, s65, 79872
v_mfma_f32_16x16x32_bf16 v[128:131], a[96:99], a[64:67], v[128:131]
buffer_load_dwordx4 v[78:81], v94, s[40:43], s65 offen sc1
ds_read_b64_tr_b16 a[46:47], v29 offset:1024
v_mfma_f32_16x16x32_bf16 v[132:135], a[100:103], a[64:67], v[132:135]
s_add_u32 s65, s65, 79872
buffer_load_dwordx4 v[82:85], v20, s[40:43], s65 offen sc1
v_mfma_f32_16x16x32_bf16 v[136:139], a[104:107], a[64:67], v[136:139]
ds_read_b64_tr_b16 a[48:49], v28 offset:16384
v_and_b32 v20, 15, v1
v_lshlrev_b32 v20, 4, v20
v_mfma_f32_16x16x32_bf16 v[140:143], a[108:111], a[64:67], v[140:143]
s_mul_i32 s65, s58, 2560
s_add_u32 s65, s65, 16777216
ds_read_b64_tr_b16 a[50:51], v28 offset:17408
v_mfma_f32_16x16x32_bf16 v[156:159], a[108:111], a[68:71], v[156:159]
buffer_load_dwordx3 v[34:36], v20, s[40:43], s65 offen offset:4 sc1
ds_read_b64_tr_b16 a[52:53], v29 offset:16384
v_mfma_f32_16x16x32_bf16 v[152:155], a[104:107], a[68:71], v[152:155]
buffer_load_dwordx3 v[38:40], v20, s[40:43], s65 offen offset:260 sc1
ds_read_b64_tr_b16 a[54:55], v29 offset:17408
v_mfma_f32_16x16x32_bf16 v[148:151], a[100:103], a[68:71], v[148:151]
buffer_load_dwordx3 v[42:44], v20, s[40:43], s65 offen offset:516 sc1
ds_read_b128 a[0:3], v22 offset:0
v_mfma_f32_16x16x32_bf16 v[144:147], a[96:99], a[68:71], v[144:147]
buffer_load_dwordx3 v[46:48], v20, s[40:43], s65 offen offset:772 sc1
ds_read_b128 a[4:7], v22 offset:2048
v_mfma_f32_16x16x32_bf16 v[160:163], a[96:99], a[72:75], v[160:163]
buffer_load_dwordx3 v[50:52], v20, s[40:43], s65 offen offset:1028 sc1
v_mfma_f32_16x16x32_bf16 v[164:167], a[100:103], a[72:75], v[164:167]
ds_read_b128 a[8:11], v22 offset:4096
buffer_load_dwordx3 v[54:56], v20, s[40:43], s65 offen offset:1284 sc1
v_mfma_f32_16x16x32_bf16 v[168:171], a[104:107], a[72:75], v[168:171]
v_mfma_f32_16x16x32_bf16 v[172:175], a[108:111], a[72:75], v[172:175]
ds_read_b128 a[12:15], v22 offset:6144
buffer_load_dwordx3 v[58:60], v20, s[40:43], s65 offen offset:1540 sc1
v_mfma_f32_16x16x32_bf16 v[188:191], a[108:111], a[76:79], v[188:191]
ds_read_b128 a[16:19], v22 offset:8192
v_mfma_f32_16x16x32_bf16 v[184:187], a[104:107], a[76:79], v[184:187]
buffer_load_dwordx3 v[62:64], v20, s[40:43], s65 offen offset:1796 sc1
v_mfma_f32_16x16x32_bf16 v[180:183], a[100:103], a[76:79], v[180:183]
ds_read_b128 a[20:23], v22 offset:10240
buffer_load_dwordx3 v[66:68], v20, s[40:43], s65 offen offset:2052 sc1
v_mfma_f32_16x16x32_bf16 v[176:179], a[96:99], a[76:79], v[176:179]
v_mfma_f32_16x16x32_bf16 v[192:195], a[96:99], a[80:83], v[192:195]
ds_read_b128 a[24:27], v22 offset:12288
buffer_load_dwordx3 v[70:72], v20, s[40:43], s65 offen offset:2308 sc1
v_mfma_f32_16x16x32_bf16 v[196:199], a[100:103], a[80:83], v[196:199]
ds_read_b128 a[28:31], v22 offset:14336
v_mfma_f32_16x16x32_bf16 v[200:203], a[104:107], a[80:83], v[200:203]
buffer_load_dwordx4 a[184:187], v6, s[40:43], s89 offen offset:3072 sc1
v_mfma_f32_16x16x32_bf16 v[204:207], a[108:111], a[80:83], v[204:207]
ds_read_b128 a[32:35], v22 offset:16384
buffer_load_dwordx4 a[188:191], v6, s[40:43], s90 offen offset:3072 sc1
v_mfma_f32_16x16x32_bf16 v[220:223], a[108:111], a[84:87], v[220:223]
v_mfma_f32_16x16x32_bf16 v[216:219], a[104:107], a[84:87], v[216:219]
ds_read_b128 a[36:39], v22 offset:18432
buffer_load_dwordx4 a[192:195], v21, s[40:43], s86 offen offset:0 sc1
v_mfma_f32_16x16x32_bf16 v[212:215], a[100:103], a[84:87], v[212:215]
v_mfma_f32_16x16x32_bf16 v[208:211], a[96:99], a[84:87], v[208:211]
buffer_load_dwordx4 a[196:199], v0, s[40:43], s90 offen offset:1024 sc1
v_mfma_f32_16x16x32_bf16 v[224:227], a[96:99], a[88:91], v[224:227]
buffer_load_dwordx4 a[200:203], v0, s[40:43], s86 offen offset:2048 sc1
v_mfma_f32_16x16x32_bf16 v[228:231], a[100:103], a[88:91], v[228:231]
v_mfma_f32_16x16x32_bf16 v[232:235], a[104:107], a[88:91], v[232:235]
buffer_load_dwordx4 a[204:207], v0, s[40:43], s87 offen offset:2048 sc1
v_mfma_f32_16x16x32_bf16 v[236:239], a[108:111], a[88:91], v[236:239]
v_mfma_f32_16x16x32_bf16 v[252:255], a[108:111], a[92:95], v[252:255]
buffer_load_dwordx4 a[208:211], v0, s[40:43], s88 offen offset:2048 sc1
v_mfma_f32_16x16x32_bf16 v[248:251], a[104:107], a[92:95], v[248:251]
v_mfma_f32_16x16x32_bf16 v[244:247], a[100:103], a[92:95], v[244:247]
v_mfma_f32_16x16x32_bf16 v[240:243], a[96:99], a[92:95], v[240:243]
s_waitcnt lgkmcnt(0)
v_mfma_f32_16x16x32_bf16 v[96:99], a[40:43], a[0:3], v[96:99]
s_waitcnt vmcnt(17)
ds_read_b64_tr_b16 a[96:97], v28 offset:8192
v_mfma_f32_16x16x32_bf16 v[100:103], a[44:47], a[0:3], v[100:103]
v_add_f32_e64 v90, v74, v78
v_mfma_f32_16x16x32_bf16 v[104:107], a[48:51], a[0:3], v[104:107]
v_add_f32_e64 v91, v75, v79
ds_read_b64_tr_b16 a[98:99], v28 offset:9216
v_mfma_f32_16x16x32_bf16 v[108:111], a[52:55], a[0:3], v[108:111]
v_add_f32_e64 v92, v76, v80
v_mfma_f32_16x16x32_bf16 v[124:127], a[52:55], a[4:7], v[124:127]
v_add_f32_e64 v93, v77, v81
ds_read_b64_tr_b16 a[100:101], v29 offset:8192
v_mfma_f32_16x16x32_bf16 v[120:123], a[48:51], a[4:7], v[120:123]
v_add_f32_e64 v90, v90, v82
ds_read_b64_tr_b16 a[102:103], v29 offset:9216
v_add_f32_e64 v91, v91, v83
v_mfma_f32_16x16x32_bf16 v[116:119], a[44:47], a[4:7], v[116:119]
v_add_f32_e64 v92, v92, v84
v_mfma_f32_16x16x32_bf16 v[112:115], a[40:43], a[4:7], v[112:115]
ds_read_b64_tr_b16 a[104:105], v28 offset:24576
v_add_f32_e64 v93, v93, v85
v_mfma_f32_16x16x32_bf16 v[128:131], a[40:43], a[8:11], v[128:131]
v_mov_b32_e64 v2, v90
v_mfma_f32_16x16x32_bf16 v[132:135], a[44:47], a[8:11], v[132:135]
ds_read_b64_tr_b16 a[106:107], v28 offset:25600
v_mov_b32_e64 v3, v91
v_mfma_f32_16x16x32_bf16 v[136:139], a[48:51], a[8:11], v[136:139]
v_mov_b32_e64 v4, v92
ds_read_b64_tr_b16 a[108:109], v29 offset:24576
v_mfma_f32_16x16x32_bf16 v[140:143], a[52:55], a[8:11], v[140:143]
v_mov_b32_e64 v5, v93
v_mfma_f32_16x16x32_bf16 v[156:159], a[52:55], a[12:15], v[156:159]
v_permlane32_swap_b32_e64 v90, v2
ds_read_b64_tr_b16 a[110:111], v29 offset:25600
v_mfma_f32_16x16x32_bf16 v[152:155], a[48:51], a[12:15], v[152:155]
v_permlane32_swap_b32_e64 v91, v3
v_mfma_f32_16x16x32_bf16 v[148:151], a[44:47], a[12:15], v[148:151]
v_permlane32_swap_b32_e64 v92, v4
ds_read_b128 a[56:59], v23 offset:0
v_mfma_f32_16x16x32_bf16 v[144:147], a[40:43], a[12:15], v[144:147]
v_permlane32_swap_b32 v93, v5
v_add_f32 v90, v90, v2
v_mfma_f32_16x16x32_bf16 v[160:163], a[40:43], a[16:19], v[160:163]
ds_read_b128 a[60:63], v23 offset:2048
v_add_f32_e64 v91, v91, v3
v_mfma_f32_16x16x32_bf16 v[164:167], a[44:47], a[16:19], v[164:167]
v_add_f32_e64 v92, v92, v4
ds_read_b128 a[64:67], v23 offset:4096
v_mfma_f32_16x16x32_bf16 v[168:171], a[48:51], a[16:19], v[168:171]
v_add_f32_e64 v93, v93, v5
v_mfma_f32_16x16x32_bf16 v[172:175], a[52:55], a[16:19], v[172:175]
v_mov_b32_e64 v2, v90
ds_read_b128 a[68:71], v23 offset:6144
v_mov_b32_e64 v3, v91
v_mfma_f32_16x16x32_bf16 v[188:191], a[52:55], a[20:23], v[188:191]
v_mov_b32_e64 v4, v92
ds_read_b128 a[72:75], v23 offset:8192
v_mfma_f32_16x16x32_bf16 v[184:187], a[48:51], a[20:23], v[184:187]
v_mov_b32_e64 v5, v93
v_mfma_f32_16x16x32_bf16 v[180:183], a[44:47], a[20:23], v[180:183]
ds_read_b128 a[76:79], v23 offset:10240
v_permlane16_swap_b32_e64 v90, v2
v_mfma_f32_16x16x32_bf16 v[176:179], a[40:43], a[20:23], v[176:179]
v_permlane16_swap_b32_e64 v91, v3
v_mfma_f32_16x16x32_bf16 v[192:195], a[40:43], a[24:27], v[192:195]
ds_read_b128 a[80:83], v23 offset:12288
v_permlane16_swap_b32_e64 v92, v4
v_mfma_f32_16x16x32_bf16 v[196:199], a[44:47], a[24:27], v[196:199]
v_permlane16_swap_b32_e64 v93, v5
ds_read_b128 a[84:87], v23 offset:14336
v_mfma_f32_16x16x32_bf16 v[200:203], a[48:51], a[24:27], v[200:203]
v_add_f32 v90, v90, v2
v_add_f32 v91, v91, v3
v_mfma_f32_16x16x32_bf16 v[204:207], a[52:55], a[24:27], v[204:207]
ds_read_b128 a[88:91], v23 offset:16384
v_add_f32_e64 v92, v92, v4
v_mfma_f32_16x16x32_bf16 v[220:223], a[52:55], a[28:31], v[220:223]
v_add_f32_e64 v93, v93, v5
v_mfma_f32_16x16x32_bf16 v[216:219], a[48:51], a[28:31], v[216:219]
ds_read_b128 a[92:95], v23 offset:18432
buffer_load_dwordx4 a[212:215], v0, s[40:43], s89 offen offset:2048 sc1
v_mfma_f32_16x16x32_bf16 v[212:215], a[44:47], a[28:31], v[212:215]
buffer_load_dwordx4 a[216:219], v0, s[40:43], s90 offen offset:2048 sc1
v_mfma_f32_16x16x32_bf16 v[208:211], a[40:43], a[28:31], v[208:211]
buffer_load_dwordx4 a[220:223], v0, s[40:43], s86 offen offset:3072 sc1
v_mfma_f32_16x16x32_bf16 v[224:227], a[40:43], a[32:35], v[224:227]
buffer_load_dwordx4 a[224:227], v0, s[40:43], s87 offen offset:3072 sc1
v_mfma_f32_16x16x32_bf16 v[228:231], a[44:47], a[32:35], v[228:231]
buffer_load_dwordx4 a[228:231], v0, s[40:43], s88 offen offset:3072 sc1
v_mfma_f32_16x16x32_bf16 v[232:235], a[48:51], a[32:35], v[232:235]
buffer_load_dwordx4 a[232:235], v0, s[40:43], s89 offen offset:3072 sc1
v_mfma_f32_16x16x32_bf16 v[236:239], a[52:55], a[32:35], v[236:239]
buffer_load_dwordx4 a[236:239], v0, s[40:43], s90 offen offset:3072 sc1
s_add_u32 s64, s86, s3
v_mfma_f32_16x16x32_bf16 v[252:255], a[52:55], a[36:39], v[252:255]
s_add_u32 m0, s12, 61440
v_mfma_f32_16x16x32_bf16 v[248:251], a[48:51], a[36:39], v[248:251]
buffer_load_dwordx4 v6, s[40:43], s64 offen offset:0 sc1 lds
s_add_u32 s64, s87, s3
v_mfma_f32_16x16x32_bf16 v[244:247], a[44:47], a[36:39], v[244:247]
s_add_u32 m0, s12, 65536
v_mfma_f32_16x16x32_bf16 v[240:243], a[40:43], a[36:39], v[240:243]
buffer_load_dwordx4 v6, s[40:43], s64 offen offset:0 sc1 lds
s_waitcnt lgkmcnt(0)
s_barrier
v_mfma_f32_16x16x32_bf16 v[96:99], a[96:99], a[56:59], v[96:99]
v_lshrrev_b32_e64 v5, 4, v1
v_mfma_f32_16x16x32_bf16 v[100:103], a[100:103], a[56:59], v[100:103]
v_mfma_f32_16x16x32_bf16 v[104:107], a[104:107], a[56:59], v[104:107]
v_lshlrev_b32_e64 v5, 2, v5
v_mfma_f32_16x16x32_bf16 v[108:111], a[108:111], a[56:59], v[108:111]
ds_bpermute_b32 v74, v5, v90 offset:0
v_mfma_f32_16x16x32_bf16 v[124:127], a[108:111], a[60:63], v[124:127]
ds_bpermute_b32 v75, v5, v91 offset:0
v_mfma_f32_16x16x32_bf16 v[120:123], a[104:107], a[60:63], v[120:123]
v_mfma_f32_16x16x32_bf16 v[116:119], a[100:103], a[60:63], v[116:119]
ds_bpermute_b32 v76, v5, v92 offset:0
v_mfma_f32_16x16x32_bf16 v[112:115], a[96:99], a[60:63], v[112:115]
ds_bpermute_b32 v77, v5, v93 offset:0
v_mfma_f32_16x16x32_bf16 v[128:131], a[96:99], a[64:67], v[128:131]
v_mfma_f32_16x16x32_bf16 v[132:135], a[100:103], a[64:67], v[132:135]
ds_bpermute_b32 v78, v5, v90 offset:16
v_mfma_f32_16x16x32_bf16 v[136:139], a[104:107], a[64:67], v[136:139]
ds_bpermute_b32 v79, v5, v91 offset:16
v_mfma_f32_16x16x32_bf16 v[140:143], a[108:111], a[64:67], v[140:143]
ds_bpermute_b32 v80, v5, v92 offset:16
v_mfma_f32_16x16x32_bf16 v[156:159], a[108:111], a[68:71], v[156:159]
v_mfma_f32_16x16x32_bf16 v[152:155], a[104:107], a[68:71], v[152:155]
ds_bpermute_b32 v81, v5, v93 offset:16
v_mfma_f32_16x16x32_bf16 v[148:151], a[100:103], a[68:71], v[148:151]
ds_bpermute_b32 v82, v5, v90 offset:32
v_mfma_f32_16x16x32_bf16 v[144:147], a[96:99], a[68:71], v[144:147]
ds_bpermute_b32 v83, v5, v91 offset:32
v_mfma_f32_16x16x32_bf16 v[160:163], a[96:99], a[72:75], v[160:163]
v_mfma_f32_16x16x32_bf16 v[164:167], a[100:103], a[72:75], v[164:167]
ds_bpermute_b32 v84, v5, v92 offset:32
v_mfma_f32_16x16x32_bf16 v[168:171], a[104:107], a[72:75], v[168:171]
ds_bpermute_b32 v85, v5, v93 offset:32
v_mfma_f32_16x16x32_bf16 v[172:175], a[108:111], a[72:75], v[172:175]
ds_bpermute_b32 v86, v5, v90 offset:48
v_mfma_f32_16x16x32_bf16 v[188:191], a[108:111], a[76:79], v[188:191]
v_mfma_f32_16x16x32_bf16 v[184:187], a[104:107], a[76:79], v[184:187]
ds_bpermute_b32 v87, v5, v91 offset:48
v_mfma_f32_16x16x32_bf16 v[180:183], a[100:103], a[76:79], v[180:183]
ds_bpermute_b32 v88, v5, v92 offset:48
v_mfma_f32_16x16x32_bf16 v[176:179], a[96:99], a[76:79], v[176:179]
v_mfma_f32_16x16x32_bf16 v[192:195], a[96:99], a[80:83], v[192:195]
ds_bpermute_b32 v89, v5, v93 offset:48
v_mfma_f32_16x16x32_bf16 v[196:199], a[100:103], a[80:83], v[196:199]
s_add_u32 s64, s88, s3
s_add_u32 m0, s12, 69632
v_mfma_f32_16x16x32_bf16 v[200:203], a[104:107], a[80:83], v[200:203]
buffer_load_dwordx4 v6, s[40:43], s64 offen offset:0 sc1 lds
s_add_u32 s64, s89, s3
s_add_u32 m0, s12, 73728
v_mfma_f32_16x16x32_bf16 v[204:207], a[108:111], a[80:83], v[204:207]
buffer_load_dwordx4 v6, s[40:43], s64 offen offset:0 sc1 lds
v_mfma_f32_16x16x32_bf16 v[220:223], a[108:111], a[84:87], v[220:223]
s_add_u32 s64, s90, s3
s_add_u32 m0, s12, 77824
v_mfma_f32_16x16x32_bf16 v[216:219], a[104:107], a[84:87], v[216:219]
buffer_load_dwordx4 v6, s[40:43], s64 offen offset:0 sc1 lds
s_add_u32 s64, s86, s3
s_add_u32 m0, s12, 80896
v_mfma_f32_16x16x32_bf16 v[212:215], a[100:103], a[84:87], v[212:215]
buffer_load_dwordx4 v6, s[40:43], s64 offen offset:1024 sc1 lds
s_add_u32 s64, s87, s3
s_add_u32 m0, s12, 84992
v_mfma_f32_16x16x32_bf16 v[208:211], a[96:99], a[84:87], v[208:211]
buffer_load_dwordx4 v6, s[40:43], s64 offen offset:1024 sc1 lds
v_mfma_f32_16x16x32_bf16 v[224:227], a[96:99], a[88:91], v[224:227]
s_add_u32 s64, s88, s3
s_add_u32 m0, s12, 89088
v_mfma_f32_16x16x32_bf16 v[228:231], a[100:103], a[88:91], v[228:231]
buffer_load_dwordx4 v6, s[40:43], s64 offen offset:1024 sc1 lds
s_add_u32 s64, s89, s3
s_add_u32 m0, s12, 93184
v_mfma_f32_16x16x32_bf16 v[232:235], a[104:107], a[88:91], v[232:235]
buffer_load_dwordx4 v6, s[40:43], s64 offen offset:1024 sc1 lds
s_add_u32 s64, s90, s3
s_add_u32 m0, s12, 97280
v_mfma_f32_16x16x32_bf16 v[236:239], a[108:111], a[88:91], v[236:239]
buffer_load_dwordx4 v6, s[40:43], s64 offen offset:1024 sc1 lds
v_mfma_f32_16x16x32_bf16 v[252:255], a[108:111], a[92:95], v[252:255]
s_add_u32 s64, s86, s3
s_add_u32 m0, s12, 100352
v_mfma_f32_16x16x32_bf16 v[248:251], a[104:107], a[92:95], v[248:251]
buffer_load_dwordx4 v6, s[40:43], s64 offen offset:2048 sc1 lds
v_mfma_f32_16x16x32_bf16 v[244:247], a[100:103], a[92:95], v[244:247]
v_mfma_f32_16x16x32_bf16 v[240:243], a[96:99], a[92:95], v[240:243]
s_mul_i32 s65, s58, 680
s_lshl_b32 s66, s59, 2
s_add_u32 s65, s65, s66
s_add_u32 s65, s65, s56
s_lshl_b32 s65, s65, 10
s_waitcnt vmcnt(25)
s_waitcnt lgkmcnt(0)
v_pk_fma_f32 v[96:97], v[74:75], v[34:35], v[96:97] op_sel_hi:[1,0,1]
v_pk_fma_f32 v[98:99], v[76:77], v[34:35], v[98:99] op_sel_hi:[1,0,1]
v_pk_fma_f32 v[100:101], v[78:79], v[34:35], v[100:101] op_sel_hi:[1,0,1]
v_pk_fma_f32 v[102:103], v[80:81], v[34:35], v[102:103] op_sel_hi:[1,0,1]
v_pk_fma_f32 v[104:105], v[82:83], v[34:35], v[104:105] op_sel_hi:[1,0,1]
v_pk_fma_f32 v[106:107], v[84:85], v[34:35], v[106:107] op_sel_hi:[1,0,1]
v_pk_fma_f32 v[108:109], v[86:87], v[34:35], v[108:109] op_sel_hi:[1,0,1]
v_pk_fma_f32 v[110:111], v[88:89], v[34:35], v[110:111] op_sel_hi:[1,0,1]
v_pk_mul_f32 v[22:23], v[96:97], v[34:35] op_sel:[0,1] op_sel_hi:[1,1]
v_pk_mul_f32 v[24:25], v[98:99], v[34:35] op_sel:[0,1] op_sel_hi:[1,1]
v_pk_mul_f32 v[26:27], v[100:101], v[34:35] op_sel:[0,1] op_sel_hi:[1,1]
v_pk_mul_f32 v[28:29], v[102:103], v[34:35] op_sel:[0,1] op_sel_hi:[1,1]
v_exp_f32 v22, v22
v_exp_f32 v23, v23
v_exp_f32 v24, v24
v_exp_f32 v25, v25
v_exp_f32 v26, v26
v_exp_f32 v27, v27
v_exp_f32 v28, v28
v_exp_f32_e64 v29, v29
v_pk_mul_f32 v[96:97], v[96:97], v[104:105]
buffer_load_dwordx4 a[0:3], v21, s[40:43], s87 offen offset:0 sc1
v_pk_mul_f32 v[98:99], v[98:99], v[106:107]
v_pk_mul_f32 v[100:101], v[100:101], v[108:109]
v_pk_mul_f32 v[102:103], v[102:103], v[110:111]
v_pk_fma_f32 v[22:23], v[22:23], v[36:37], v[36:37] op_sel_hi:[1,0,0]
v_pk_fma_f32 v[24:25], v[24:25], v[36:37], v[36:37] op_sel_hi:[1,0,0]
v_pk_fma_f32 v[26:27], v[26:27], v[36:37], v[36:37] op_sel_hi:[1,0,0]
v_pk_fma_f32 v[28:29], v[28:29], v[36:37], v[36:37] op_sel_hi:[1,0,0]
v_rcp_f32 v22, v22
v_rcp_f32 v23, v23
v_rcp_f32 v24, v24
v_rcp_f32 v25, v25
v_rcp_f32 v26, v26
v_rcp_f32 v27, v27
v_rcp_f32 v28, v28
v_rcp_f32 v29, v29
v_pk_mul_f32 v[96:97], v[96:97], v[22:23]
v_pk_mul_f32 v[98:99], v[98:99], v[24:25]
v_pk_mul_f32 v[100:101], v[100:101], v[26:27]
v_pk_mul_f32 v[102:103], v[102:103], v[28:29]
v_cvt_pk_bf16_f32 v30, v96, v97
v_cvt_pk_bf16_f32 v31, v98, v99
v_cvt_pk_bf16_f32 v32, v100, v101
v_cvt_pk_bf16_f32 v33, v102, v103
buffer_store_dwordx4 v[30:33], v6, s[40:43], s65 offen sc1
s_add_u32 s65, s65, 69632
v_pk_fma_f32 v[112:113], v[74:75], v[38:39], v[112:113] op_sel_hi:[1,0,1]
v_pk_fma_f32 v[114:115], v[76:77], v[38:39], v[114:115] op_sel_hi:[1,0,1]
v_pk_fma_f32 v[116:117], v[78:79], v[38:39], v[116:117] op_sel_hi:[1,0,1]
v_pk_fma_f32 v[118:119], v[80:81], v[38:39], v[118:119] op_sel_hi:[1,0,1]
v_pk_fma_f32 v[120:121], v[82:83], v[38:39], v[120:121] op_sel_hi:[1,0,1]
v_pk_fma_f32 v[122:123], v[84:85], v[38:39], v[122:123] op_sel_hi:[1,0,1]
v_pk_fma_f32 v[124:125], v[86:87], v[38:39], v[124:125] op_sel_hi:[1,0,1]
v_pk_fma_f32 v[126:127], v[88:89], v[38:39], v[126:127] op_sel_hi:[1,0,1]
v_pk_mul_f32 v[22:23], v[112:113], v[38:39] op_sel:[0,1] op_sel_hi:[1,1]
v_pk_mul_f32 v[24:25], v[114:115], v[38:39] op_sel:[0,1] op_sel_hi:[1,1]
v_pk_mul_f32 v[26:27], v[116:117], v[38:39] op_sel:[0,1] op_sel_hi:[1,1]
v_pk_mul_f32 v[28:29], v[118:119], v[38:39] op_sel:[0,1] op_sel_hi:[1,1]
v_exp_f32 v22, v22
v_exp_f32 v23, v23
v_exp_f32 v24, v24
v_exp_f32 v25, v25
v_exp_f32 v26, v26
v_exp_f32 v27, v27
v_exp_f32 v28, v28
v_exp_f32 v29, v29
v_pk_mul_f32 v[112:113], v[112:113], v[120:121]
buffer_load_dwordx4 a[4:7], v21, s[40:43], s88 offen offset:0 sc1
v_pk_mul_f32 v[114:115], v[114:115], v[122:123]
v_pk_mul_f32 v[116:117], v[116:117], v[124:125]
v_pk_mul_f32 v[118:119], v[118:119], v[126:127]
v_pk_fma_f32 v[22:23], v[22:23], v[40:41], v[40:41] op_sel_hi:[1,0,0]
v_pk_fma_f32 v[24:25], v[24:25], v[40:41], v[40:41] op_sel_hi:[1,0,0]
v_pk_fma_f32 v[26:27], v[26:27], v[40:41], v[40:41] op_sel_hi:[1,0,0]
v_pk_fma_f32 v[28:29], v[28:29], v[40:41], v[40:41] op_sel_hi:[1,0,0]
v_rcp_f32 v22, v22
v_rcp_f32 v23, v23
v_rcp_f32 v24, v24
v_rcp_f32 v25, v25
v_rcp_f32 v26, v26
v_rcp_f32 v27, v27
v_rcp_f32 v28, v28
v_rcp_f32 v29, v29
v_pk_mul_f32 v[112:113], v[112:113], v[22:23]
v_pk_mul_f32 v[114:115], v[114:115], v[24:25]
v_pk_mul_f32 v[116:117], v[116:117], v[26:27]
v_pk_mul_f32 v[118:119], v[118:119], v[28:29]
v_cvt_pk_bf16_f32 v16, v112, v113
v_cvt_pk_bf16_f32 v17, v114, v115
v_cvt_pk_bf16_f32 v18, v116, v117
v_cvt_pk_bf16_f32 v19, v118, v119
buffer_store_dwordx4 v[16:19], v6, s[40:43], s65 offen sc1
s_add_u32 s65, s65, 69632
v_pk_fma_f32 v[128:129], v[74:75], v[42:43], v[128:129] op_sel_hi:[1,0,1]
v_pk_fma_f32 v[130:131], v[76:77], v[42:43], v[130:131] op_sel_hi:[1,0,1]
v_pk_fma_f32 v[132:133], v[78:79], v[42:43], v[132:133] op_sel_hi:[1,0,1]
v_pk_fma_f32 v[134:135], v[80:81], v[42:43], v[134:135] op_sel_hi:[1,0,1]
v_pk_fma_f32 v[136:137], v[82:83], v[42:43], v[136:137] op_sel_hi:[1,0,1]
v_pk_fma_f32 v[138:139], v[84:85], v[42:43], v[138:139] op_sel_hi:[1,0,1]
v_pk_fma_f32 v[140:141], v[86:87], v[42:43], v[140:141] op_sel_hi:[1,0,1]
v_pk_fma_f32 v[142:143], v[88:89], v[42:43], v[142:143] op_sel_hi:[1,0,1]
v_pk_mul_f32 v[22:23], v[128:129], v[42:43] op_sel:[0,1] op_sel_hi:[1,1]
v_pk_mul_f32 v[24:25], v[130:131], v[42:43] op_sel:[0,1] op_sel_hi:[1,1]
v_pk_mul_f32 v[26:27], v[132:133], v[42:43] op_sel:[0,1] op_sel_hi:[1,1]
v_pk_mul_f32 v[28:29], v[134:135], v[42:43] op_sel:[0,1] op_sel_hi:[1,1]
v_exp_f32 v22, v22
v_exp_f32 v23, v23
v_exp_f32 v24, v24
v_exp_f32 v25, v25
v_exp_f32 v26, v26
v_exp_f32 v27, v27
v_exp_f32 v28, v28
v_exp_f32 v29, v29
v_pk_mul_f32 v[128:129], v[128:129], v[136:137]
buffer_load_dwordx4 a[8:11], v21, s[40:43], s89 offen offset:0 sc1
v_pk_mul_f32 v[130:131], v[130:131], v[138:139]
v_pk_mul_f32 v[132:133], v[132:133], v[140:141]
v_pk_mul_f32 v[134:135], v[134:135], v[142:143]
v_pk_fma_f32 v[22:23], v[22:23], v[44:45], v[44:45] op_sel_hi:[1,0,0]
v_pk_fma_f32 v[24:25], v[24:25], v[44:45], v[44:45] op_sel_hi:[1,0,0]
v_pk_fma_f32 v[26:27], v[26:27], v[44:45], v[44:45] op_sel_hi:[1,0,0]
v_pk_fma_f32 v[28:29], v[28:29], v[44:45], v[44:45] op_sel_hi:[1,0,0]
v_rcp_f32 v22, v22
v_rcp_f32 v23, v23
v_rcp_f32 v24, v24
v_rcp_f32 v25, v25
v_rcp_f32 v26, v26
v_rcp_f32 v27, v27
v_rcp_f32 v28, v28
v_rcp_f32 v29, v29
v_pk_mul_f32 v[128:129], v[128:129], v[22:23]
v_pk_mul_f32 v[130:131], v[130:131], v[24:25]
v_pk_mul_f32 v[132:133], v[132:133], v[26:27]
v_pk_mul_f32 v[134:135], v[134:135], v[28:29]
v_cvt_pk_bf16_f32 v30, v128, v129
v_cvt_pk_bf16_f32 v31, v130, v131
v_cvt_pk_bf16_f32 v32, v132, v133
v_cvt_pk_bf16_f32 v33, v134, v135
buffer_store_dwordx4 v[30:33], v6, s[40:43], s65 offen sc1
s_add_u32 s65, s65, 69632
v_pk_fma_f32 v[144:145], v[74:75], v[46:47], v[144:145] op_sel_hi:[1,0,1]
v_pk_fma_f32 v[146:147], v[76:77], v[46:47], v[146:147] op_sel_hi:[1,0,1]
v_pk_fma_f32 v[148:149], v[78:79], v[46:47], v[148:149] op_sel_hi:[1,0,1]
v_pk_fma_f32 v[150:151], v[80:81], v[46:47], v[150:151] op_sel_hi:[1,0,1]
v_pk_fma_f32 v[152:153], v[82:83], v[46:47], v[152:153] op_sel_hi:[1,0,1]
v_pk_fma_f32 v[154:155], v[84:85], v[46:47], v[154:155] op_sel_hi:[1,0,1]
v_pk_fma_f32 v[156:157], v[86:87], v[46:47], v[156:157] op_sel_hi:[1,0,1]
v_pk_fma_f32 v[158:159], v[88:89], v[46:47], v[158:159] op_sel_hi:[1,0,1]
v_pk_mul_f32 v[22:23], v[144:145], v[46:47] op_sel:[0,1] op_sel_hi:[1,1]
v_pk_mul_f32 v[24:25], v[146:147], v[46:47] op_sel:[0,1] op_sel_hi:[1,1]
v_pk_mul_f32 v[26:27], v[148:149], v[46:47] op_sel:[0,1] op_sel_hi:[1,1]
v_pk_mul_f32 v[28:29], v[150:151], v[46:47] op_sel:[0,1] op_sel_hi:[1,1]
buffer_load_dwordx4 a[12:15], v21, s[40:43], s90 offen offset:0 sc1
v_exp_f32 v22, v22
v_exp_f32 v23, v23
v_exp_f32 v24, v24
v_exp_f32 v25, v25
v_exp_f32 v26, v26
v_exp_f32 v27, v27
v_exp_f32 v28, v28
v_exp_f32 v29, v29
v_pk_mul_f32 v[144:145], v[144:145], v[152:153]
v_pk_mul_f32 v[146:147], v[146:147], v[154:155]
v_pk_mul_f32 v[148:149], v[148:149], v[156:157]
v_pk_mul_f32 v[150:151], v[150:151], v[158:159]
v_pk_fma_f32 v[22:23], v[22:23], v[48:49], v[48:49] op_sel_hi:[1,0,0]
v_pk_fma_f32 v[24:25], v[24:25], v[48:49], v[48:49] op_sel_hi:[1,0,0]
v_pk_fma_f32 v[26:27], v[26:27], v[48:49], v[48:49] op_sel_hi:[1,0,0]
v_pk_fma_f32 v[28:29], v[28:29], v[48:49], v[48:49] op_sel_hi:[1,0,0]
v_rcp_f32 v22, v22
v_rcp_f32 v23, v23
v_rcp_f32_e64 v24, v24
buffer_load_dwordx4 a[16:19], v21, s[40:43], s86 offen offset:1024 sc1
v_rcp_f32 v25, v25
v_rcp_f32 v26, v26
v_rcp_f32 v27, v27
v_rcp_f32 v28, v28
v_rcp_f32_e64 v29, v29
v_pk_mul_f32 v[144:145], v[144:145], v[22:23]
v_pk_mul_f32 v[146:147], v[146:147], v[24:25]
v_pk_mul_f32 v[148:149], v[148:149], v[26:27]
v_pk_mul_f32 v[150:151], v[150:151], v[28:29]
v_cvt_pk_bf16_f32 v16, v144, v145
v_cvt_pk_bf16_f32 v17, v146, v147
v_cvt_pk_bf16_f32 v18, v148, v149
v_cvt_pk_bf16_f32 v19, v150, v151
buffer_store_dwordx4 v[16:19], v6, s[40:43], s65 offen sc1
s_add_u32 s65, s65, 69632
v_pk_fma_f32 v[160:161], v[74:75], v[50:51], v[160:161] op_sel_hi:[1,0,1]
v_pk_fma_f32 v[162:163], v[76:77], v[50:51], v[162:163] op_sel_hi:[1,0,1]
v_pk_fma_f32 v[164:165], v[78:79], v[50:51], v[164:165] op_sel_hi:[1,0,1]
v_pk_fma_f32 v[166:167], v[80:81], v[50:51], v[166:167] op_sel_hi:[1,0,1]
v_pk_fma_f32 v[168:169], v[82:83], v[50:51], v[168:169] op_sel_hi:[1,0,1]
v_pk_fma_f32 v[170:171], v[84:85], v[50:51], v[170:171] op_sel_hi:[1,0,1]
v_pk_fma_f32 v[172:173], v[86:87], v[50:51], v[172:173] op_sel_hi:[1,0,1]
v_pk_fma_f32 v[174:175], v[88:89], v[50:51], v[174:175] op_sel_hi:[1,0,1]
v_pk_mul_f32 v[22:23], v[160:161], v[50:51] op_sel:[0,1] op_sel_hi:[1,1]
v_pk_mul_f32 v[24:25], v[162:163], v[50:51] op_sel:[0,1] op_sel_hi:[1,1]
v_pk_mul_f32 v[26:27], v[164:165], v[50:51] op_sel:[0,1] op_sel_hi:[1,1]
v_pk_mul_f32 v[28:29], v[166:167], v[50:51] op_sel:[0,1] op_sel_hi:[1,1]
v_exp_f32 v22, v22
v_exp_f32 v23, v23
v_exp_f32 v24, v24
v_exp_f32 v25, v25
v_exp_f32 v26, v26
v_exp_f32 v27, v27
v_exp_f32 v28, v28
v_exp_f32 v29, v29
v_pk_mul_f32 v[160:161], v[160:161], v[168:169]
buffer_load_dwordx4 a[20:23], v21, s[40:43], s87 offen offset:1024 sc1
v_pk_mul_f32 v[162:163], v[162:163], v[170:171]
v_pk_mul_f32 v[164:165], v[164:165], v[172:173]
v_pk_mul_f32 v[166:167], v[166:167], v[174:175]
v_pk_fma_f32 v[22:23], v[22:23], v[52:53], v[52:53] op_sel_hi:[1,0,0]
v_pk_fma_f32 v[24:25], v[24:25], v[52:53], v[52:53] op_sel_hi:[1,0,0]
v_pk_fma_f32 v[26:27], v[26:27], v[52:53], v[52:53] op_sel_hi:[1,0,0]
v_pk_fma_f32 v[28:29], v[28:29], v[52:53], v[52:53] op_sel_hi:[1,0,0]
v_rcp_f32 v22, v22
v_rcp_f32 v23, v23
v_rcp_f32 v24, v24
v_rcp_f32 v25, v25
v_rcp_f32 v26, v26
v_rcp_f32 v27, v27
v_rcp_f32 v28, v28
v_rcp_f32 v29, v29
v_pk_mul_f32 v[160:161], v[160:161], v[22:23]
v_pk_mul_f32 v[162:163], v[162:163], v[24:25]
v_pk_mul_f32 v[164:165], v[164:165], v[26:27]
v_pk_mul_f32 v[166:167], v[166:167], v[28:29]
v_cvt_pk_bf16_f32 v30, v160, v161
v_cvt_pk_bf16_f32 v31, v162, v163
v_cvt_pk_bf16_f32 v32, v164, v165
v_cvt_pk_bf16_f32 v33, v166, v167
buffer_store_dwordx4 v[30:33], v6, s[40:43], s65 offen sc1
s_add_u32 s65, s65, 69632
v_pk_fma_f32 v[176:177], v[74:75], v[54:55], v[176:177] op_sel_hi:[1,0,1]
v_pk_fma_f32 v[178:179], v[76:77], v[54:55], v[178:179] op_sel_hi:[1,0,1]
v_pk_fma_f32 v[180:181], v[78:79], v[54:55], v[180:181] op_sel_hi:[1,0,1]
v_pk_fma_f32 v[182:183], v[80:81], v[54:55], v[182:183] op_sel_hi:[1,0,1]
v_pk_fma_f32 v[184:185], v[82:83], v[54:55], v[184:185] op_sel_hi:[1,0,1]
v_pk_fma_f32 v[186:187], v[84:85], v[54:55], v[186:187] op_sel_hi:[1,0,1]
v_pk_fma_f32 v[188:189], v[86:87], v[54:55], v[188:189] op_sel_hi:[1,0,1]
v_pk_fma_f32 v[190:191], v[88:89], v[54:55], v[190:191] op_sel_hi:[1,0,1]
v_pk_mul_f32 v[22:23], v[176:177], v[54:55] op_sel:[0,1] op_sel_hi:[1,1]
v_pk_mul_f32 v[24:25], v[178:179], v[54:55] op_sel:[0,1] op_sel_hi:[1,1]
v_pk_mul_f32 v[26:27], v[180:181], v[54:55] op_sel:[0,1] op_sel_hi:[1,1]
v_pk_mul_f32 v[28:29], v[182:183], v[54:55] op_sel:[0,1] op_sel_hi:[1,1]
v_exp_f32 v22, v22
v_exp_f32 v23, v23
v_exp_f32 v24, v24
v_exp_f32 v25, v25
v_exp_f32 v26, v26
v_exp_f32 v27, v27
v_exp_f32 v28, v28
v_exp_f32 v29, v29
v_pk_mul_f32 v[176:177], v[176:177], v[184:185]
buffer_load_dwordx4 a[24:27], v21, s[40:43], s88 offen offset:1024 sc1
v_pk_mul_f32 v[178:179], v[178:179], v[186:187]
v_pk_mul_f32 v[180:181], v[180:181], v[188:189]
v_pk_mul_f32 v[182:183], v[182:183], v[190:191]
v_pk_fma_f32 v[22:23], v[22:23], v[56:57], v[56:57] op_sel_hi:[1,0,0]
v_pk_fma_f32 v[24:25], v[24:25], v[56:57], v[56:57] op_sel_hi:[1,0,0]
v_pk_fma_f32 v[26:27], v[26:27], v[56:57], v[56:57] op_sel_hi:[1,0,0]
v_pk_fma_f32 v[28:29], v[28:29], v[56:57], v[56:57] op_sel_hi:[1,0,0]
v_rcp_f32 v22, v22
v_rcp_f32 v23, v23
v_rcp_f32 v24, v24
v_rcp_f32 v25, v25
v_rcp_f32 v26, v26
v_rcp_f32 v27, v27
v_rcp_f32 v28, v28
v_rcp_f32 v29, v29
v_pk_mul_f32 v[176:177], v[176:177], v[22:23]
v_pk_mul_f32 v[178:179], v[178:179], v[24:25]
v_pk_mul_f32 v[180:181], v[180:181], v[26:27]
v_pk_mul_f32 v[182:183], v[182:183], v[28:29]
v_cvt_pk_bf16_f32 v16, v176, v177
v_cvt_pk_bf16_f32 v17, v178, v179
v_cvt_pk_bf16_f32 v18, v180, v181
v_cvt_pk_bf16_f32 v19, v182, v183
buffer_store_dwordx4 v[16:19], v6, s[40:43], s65 offen sc1
s_add_u32 s65, s65, 69632
v_pk_fma_f32 v[192:193], v[74:75], v[58:59], v[192:193] op_sel_hi:[1,0,1]
v_pk_fma_f32 v[194:195], v[76:77], v[58:59], v[194:195] op_sel_hi:[1,0,1]
v_pk_fma_f32 v[196:197], v[78:79], v[58:59], v[196:197] op_sel_hi:[1,0,1]
v_pk_fma_f32 v[198:199], v[80:81], v[58:59], v[198:199] op_sel_hi:[1,0,1]
v_pk_fma_f32 v[200:201], v[82:83], v[58:59], v[200:201] op_sel_hi:[1,0,1]
v_pk_fma_f32 v[202:203], v[84:85], v[58:59], v[202:203] op_sel_hi:[1,0,1]
v_pk_fma_f32 v[204:205], v[86:87], v[58:59], v[204:205] op_sel_hi:[1,0,1]
v_pk_fma_f32 v[206:207], v[88:89], v[58:59], v[206:207] op_sel_hi:[1,0,1]
v_pk_mul_f32 v[22:23], v[192:193], v[58:59] op_sel:[0,1] op_sel_hi:[1,1]
v_pk_mul_f32 v[24:25], v[194:195], v[58:59] op_sel:[0,1] op_sel_hi:[1,1]
v_pk_mul_f32 v[26:27], v[196:197], v[58:59] op_sel:[0,1] op_sel_hi:[1,1]
v_pk_mul_f32 v[28:29], v[198:199], v[58:59] op_sel:[0,1] op_sel_hi:[1,1]
v_exp_f32 v22, v22
v_exp_f32 v23, v23
v_exp_f32 v24, v24
v_exp_f32 v25, v25
v_exp_f32 v26, v26
v_exp_f32 v27, v27
v_exp_f32 v28, v28
v_exp_f32 v29, v29
v_pk_mul_f32 v[192:193], v[192:193], v[200:201]
buffer_load_dwordx4 a[28:31], v21, s[40:43], s89 offen offset:1024 sc1
v_pk_mul_f32 v[194:195], v[194:195], v[202:203]
v_pk_mul_f32 v[196:197], v[196:197], v[204:205]
v_pk_mul_f32 v[198:199], v[198:199], v[206:207]
v_pk_fma_f32 v[22:23], v[22:23], v[60:61], v[60:61] op_sel_hi:[1,0,0]
v_pk_fma_f32 v[24:25], v[24:25], v[60:61], v[60:61] op_sel_hi:[1,0,0]
v_pk_fma_f32 v[26:27], v[26:27], v[60:61], v[60:61] op_sel_hi:[1,0,0]
v_pk_fma_f32 v[28:29], v[28:29], v[60:61], v[60:61] op_sel_hi:[1,0,0]
v_rcp_f32 v22, v22
v_rcp_f32 v23, v23
v_rcp_f32 v24, v24
v_rcp_f32 v25, v25
v_rcp_f32 v26, v26
v_rcp_f32 v27, v27
v_rcp_f32 v28, v28
v_rcp_f32 v29, v29
v_pk_mul_f32 v[192:193], v[192:193], v[22:23]
v_pk_mul_f32 v[194:195], v[194:195], v[24:25]
v_pk_mul_f32 v[196:197], v[196:197], v[26:27]
v_pk_mul_f32 v[198:199], v[198:199], v[28:29]
v_cvt_pk_bf16_f32 v30, v192, v193
v_cvt_pk_bf16_f32 v31, v194, v195
v_cvt_pk_bf16_f32 v32, v196, v197
v_cvt_pk_bf16_f32 v33, v198, v199
buffer_store_dwordx4 v[30:33], v6, s[40:43], s65 offen sc1
s_add_u32 s65, s65, 69632
v_pk_fma_f32 v[208:209], v[74:75], v[62:63], v[208:209] op_sel_hi:[1,0,1]
v_pk_fma_f32 v[210:211], v[76:77], v[62:63], v[210:211] op_sel_hi:[1,0,1]
v_pk_fma_f32 v[212:213], v[78:79], v[62:63], v[212:213] op_sel_hi:[1,0,1]
v_pk_fma_f32 v[214:215], v[80:81], v[62:63], v[214:215] op_sel_hi:[1,0,1]
v_pk_fma_f32 v[216:217], v[82:83], v[62:63], v[216:217] op_sel_hi:[1,0,1]
v_pk_fma_f32 v[218:219], v[84:85], v[62:63], v[218:219] op_sel_hi:[1,0,1]
v_pk_fma_f32 v[220:221], v[86:87], v[62:63], v[220:221] op_sel_hi:[1,0,1]
v_pk_fma_f32 v[222:223], v[88:89], v[62:63], v[222:223] op_sel_hi:[1,0,1]
v_pk_mul_f32 v[22:23], v[208:209], v[62:63] op_sel:[0,1] op_sel_hi:[1,1]
v_pk_mul_f32 v[24:25], v[210:211], v[62:63] op_sel:[0,1] op_sel_hi:[1,1]
v_pk_mul_f32 v[26:27], v[212:213], v[62:63] op_sel:[0,1] op_sel_hi:[1,1]
v_pk_mul_f32 v[28:29], v[214:215], v[62:63] op_sel:[0,1] op_sel_hi:[1,1]
buffer_load_dwordx4 a[32:35], v21, s[40:43], s90 offen offset:1024 sc1
v_exp_f32 v22, v22
v_exp_f32 v23, v23
v_exp_f32 v24, v24
v_exp_f32 v25, v25
v_exp_f32 v26, v26
v_exp_f32 v27, v27
v_exp_f32 v28, v28
v_exp_f32 v29, v29
v_pk_mul_f32 v[208:209], v[208:209], v[216:217]
v_pk_mul_f32 v[210:211], v[210:211], v[218:219]
v_pk_mul_f32 v[212:213], v[212:213], v[220:221]
v_pk_mul_f32 v[214:215], v[214:215], v[222:223]
v_pk_fma_f32 v[22:23], v[22:23], v[64:65], v[64:65] op_sel_hi:[1,0,0]
v_pk_fma_f32 v[24:25], v[24:25], v[64:65], v[64:65] op_sel_hi:[1,0,0]
v_pk_fma_f32 v[26:27], v[26:27], v[64:65], v[64:65] op_sel_hi:[1,0,0]
v_pk_fma_f32 v[28:29], v[28:29], v[64:65], v[64:65] op_sel_hi:[1,0,0]
v_rcp_f32 v22, v22
v_rcp_f32 v23, v23
v_rcp_f32_e64 v24, v24
buffer_load_dwordx4 a[36:39], v21, s[40:43], s86 offen offset:2048 sc1
v_rcp_f32 v25, v25
v_rcp_f32 v26, v26
v_rcp_f32 v27, v27
v_rcp_f32 v28, v28
v_rcp_f32_e64 v29, v29
v_pk_mul_f32 v[208:209], v[208:209], v[22:23]
v_pk_mul_f32 v[210:211], v[210:211], v[24:25]
v_pk_mul_f32 v[212:213], v[212:213], v[26:27]
v_pk_mul_f32 v[214:215], v[214:215], v[28:29]
v_cvt_pk_bf16_f32 v16, v208, v209
v_cvt_pk_bf16_f32 v17, v210, v211
v_cvt_pk_bf16_f32 v18, v212, v213
v_cvt_pk_bf16_f32 v19, v214, v215
buffer_store_dwordx4 v[16:19], v6, s[40:43], s65 offen sc1
s_add_u32 s65, s65, 69632
s_cmp_eq_u32 s58, 12
s_cbranch_scc1 Lffn_skip
v_pk_fma_f32 v[224:225], v[74:75], v[66:67], v[224:225] op_sel_hi:[1,0,1]
v_pk_fma_f32 v[226:227], v[76:77], v[66:67], v[226:227] op_sel_hi:[1,0,1]
v_pk_fma_f32 v[228:229], v[78:79], v[66:67], v[228:229] op_sel_hi:[1,0,1]
v_pk_fma_f32 v[230:231], v[80:81], v[66:67], v[230:231] op_sel_hi:[1,0,1]
v_pk_fma_f32 v[232:233], v[82:83], v[66:67], v[232:233] op_sel_hi:[1,0,1]
v_pk_fma_f32 v[234:235], v[84:85], v[66:67], v[234:235] op_sel_hi:[1,0,1]
v_pk_fma_f32 v[236:237], v[86:87], v[66:67], v[236:237] op_sel_hi:[1,0,1]
v_pk_fma_f32 v[238:239], v[88:89], v[66:67], v[238:239] op_sel_hi:[1,0,1]
v_pk_mul_f32 v[22:23], v[224:225], v[66:67] op_sel:[0,1] op_sel_hi:[1,1]
v_pk_mul_f32 v[24:25], v[226:227], v[66:67] op_sel:[0,1] op_sel_hi:[1,1]
v_pk_mul_f32 v[26:27], v[228:229], v[66:67] op_sel:[0,1] op_sel_hi:[1,1]
v_pk_mul_f32 v[28:29], v[230:231], v[66:67] op_sel:[0,1] op_sel_hi:[1,1]
v_exp_f32 v22, v22
v_exp_f32 v23, v23
v_exp_f32 v24, v24
v_exp_f32 v25, v25
v_exp_f32 v26, v26
v_exp_f32 v27, v27
v_exp_f32 v28, v28
v_exp_f32 v29, v29
v_pk_mul_f32 v[224:225], v[224:225], v[232:233]
v_pk_mul_f32 v[226:227], v[226:227], v[234:235]
v_pk_mul_f32 v[228:229], v[228:229], v[236:237]
v_pk_mul_f32 v[230:231], v[230:231], v[238:239]
v_pk_fma_f32 v[22:23], v[22:23], v[68:69], v[68:69] op_sel_hi:[1,0,0]
v_pk_fma_f32 v[24:25], v[24:25], v[68:69], v[68:69] op_sel_hi:[1,0,0]
v_pk_fma_f32 v[26:27], v[26:27], v[68:69], v[68:69] op_sel_hi:[1,0,0]
v_pk_fma_f32 v[28:29], v[28:29], v[68:69], v[68:69] op_sel_hi:[1,0,0]
v_rcp_f32 v22, v22
v_rcp_f32 v23, v23
v_rcp_f32 v24, v24
v_rcp_f32 v25, v25
v_rcp_f32 v26, v26
v_rcp_f32 v27, v27
v_rcp_f32 v28, v28
v_rcp_f32 v29, v29
v_pk_mul_f32 v[224:225], v[224:225], v[22:23]
v_pk_mul_f32 v[226:227], v[226:227], v[24:25]
v_pk_mul_f32 v[228:229], v[228:229], v[26:27]
v_pk_mul_f32 v[230:231], v[230:231], v[28:29]
v_cvt_pk_bf16_f32 v30, v224, v225
v_cvt_pk_bf16_f32 v31, v226, v227
v_cvt_pk_bf16_f32 v32, v228, v229
v_cvt_pk_bf16_f32 v33, v230, v231
buffer_store_dwordx4 v[30:33], v6, s[40:43], s65 offen sc1
s_add_u32 s65, s65, 69632
v_pk_fma_f32 v[240:241], v[74:75], v[70:71], v[240:241] op_sel_hi:[1,0,1]
v_pk_fma_f32 v[242:243], v[76:77], v[70:71], v[242:243] op_sel_hi:[1,0,1]
v_pk_fma_f32 v[244:245], v[78:79], v[70:71], v[244:245] op_sel_hi:[1,0,1]
v_pk_fma_f32 v[246:247], v[80:81], v[70:71], v[246:247] op_sel_hi:[1,0,1]
v_pk_fma_f32 v[248:249], v[82:83], v[70:71], v[248:249] op_sel_hi:[1,0,1]
v_pk_fma_f32 v[250:251], v[84:85], v[70:71], v[250:251] op_sel_hi:[1,0,1]
v_pk_fma_f32 v[252:253], v[86:87], v[70:71], v[252:253] op_sel_hi:[1,0,1]
v_pk_fma_f32 v[254:255], v[88:89], v[70:71], v[254:255] op_sel_hi:[1,0,1]
v_pk_mul_f32 v[22:23], v[240:241], v[70:71] op_sel:[0,1] op_sel_hi:[1,1]
v_pk_mul_f32 v[24:25], v[242:243], v[70:71] op_sel:[0,1] op_sel_hi:[1,1]
v_pk_mul_f32 v[26:27], v[244:245], v[70:71] op_sel:[0,1] op_sel_hi:[1,1]
v_pk_mul_f32 v[28:29], v[246:247], v[70:71] op_sel:[0,1] op_sel_hi:[1,1]
v_exp_f32 v22, v22
v_exp_f32 v23, v23
v_exp_f32 v24, v24
v_exp_f32 v25, v25
v_exp_f32 v26, v26
v_exp_f32 v27, v27
v_exp_f32 v28, v28
v_exp_f32 v29, v29
v_pk_mul_f32 v[240:241], v[240:241], v[248:249]
v_pk_mul_f32 v[242:243], v[242:243], v[250:251]
v_pk_mul_f32 v[244:245], v[244:245], v[252:253]
v_pk_mul_f32 v[246:247], v[246:247], v[254:255]
v_pk_fma_f32 v[22:23], v[22:23], v[72:73], v[72:73] op_sel_hi:[1,0,0]
v_pk_fma_f32 v[24:25], v[24:25], v[72:73], v[72:73] op_sel_hi:[1,0,0]
v_pk_fma_f32 v[26:27], v[26:27], v[72:73], v[72:73] op_sel_hi:[1,0,0]
v_pk_fma_f32 v[28:29], v[28:29], v[72:73], v[72:73] op_sel_hi:[1,0,0]
v_rcp_f32 v22, v22
v_rcp_f32 v23, v23
v_rcp_f32 v24, v24
v_rcp_f32 v25, v25
v_rcp_f32 v26, v26
v_rcp_f32 v27, v27
v_rcp_f32_e64 v28, v28
v_rcp_f32 v29, v29
v_pk_mul_f32 v[240:241], v[240:241], v[22:23]
v_pk_mul_f32 v[242:243], v[242:243], v[24:25]
v_pk_mul_f32 v[244:245], v[244:245], v[26:27]
v_pk_mul_f32 v[246:247], v[246:247], v[28:29]
v_cvt_pk_bf16_f32 v16, v240, v241
v_cvt_pk_bf16_f32 v17, v242, v243
v_cvt_pk_bf16_f32 v18, v244, v245
v_cvt_pk_bf16_f32 v19, v246, v247
buffer_store_dwordx4 v[16:19], v6, s[40:43], s65 offen sc1
s_add_u32 s65, s65, 69632
Lffn_skip:
s_mul_i32 s65, s58, 48
s_lshl_b32 s66, s59, 2
s_add_u32 s65, s65, s66
s_add_u32 s65, s65, s56
s_lshl_b32 s65, s65, 7
s_add_u32 s79, s65, 17119232
buffer_load_dwordx4 a[40:43], v21, s[40:43], s87 offen offset:2048 sc1
buffer_load_dwordx4 a[44:47], v21, s[40:43], s88 offen offset:2048 sc1
buffer_load_dwordx4 a[48:51], v21, s[40:43], s89 offen offset:2048 sc1
buffer_load_dwordx4 a[52:55], v21, s[40:43], s90 offen offset:2048 sc1
s_branch Lcommon
Lcsf0:
v_mfma_f32_16x16x32_bf16 a[112:115], a[40:43], a[128:131], 0
v_mfma_f32_16x16x32_bf16 a[116:119], a[44:47], a[128:131], 0
v_mfma_f32_16x16x32_bf16 a[120:123], a[48:51], a[128:131], 0
v_mfma_f32_16x16x32_bf16 a[124:127], a[52:55], a[128:131], 0
s_branch Lcrf0
Lcsf1:
v_mfma_f32_16x16x32_bf16 a[112:115], a[96:99], a[128:131], a[112:115]
v_mfma_f32_16x16x32_bf16 a[116:119], a[100:103], a[128:131], a[116:119]
v_mfma_f32_16x16x32_bf16 a[120:123], a[104:107], a[128:131], a[120:123]
v_mfma_f32_16x16x32_bf16 a[124:127], a[108:111], a[128:131], a[124:127]
s_bfe_u32 s66, s57, 0x40000
s_mul_i32 s66, s66, 19968
s_add_u32 s66, s66, s73
s_add_u32 s67, s66, 6144
s_nop 4
buffer_store_dwordx4 a[112:115], v94, s[40:43], s66 offen offset:0 sc1
buffer_store_dwordx4 a[116:119], v94, s[40:43], s66 offen offset:64 sc1
buffer_store_dwordx4 a[120:123], v94, s[40:43], s67 offen offset:0 sc1
buffer_store_dwordx4 a[124:127], v94, s[40:43], s67 offen offset:64 sc1
s_branch Lcrf1
Lcsf2:
v_mfma_f32_16x16x32_bf16 a[112:115], a[40:43], a[128:131], 0
v_mfma_f32_16x16x32_bf16 a[116:119], a[44:47], a[128:131], 0
v_mfma_f32_16x16x32_bf16 a[120:123], a[48:51], a[128:131], 0
v_mfma_f32_16x16x32_bf16 a[124:127], a[52:55], a[128:131], 0
s_branch Lcrf2
Lcsf3:
v_mfma_f32_16x16x32_bf16 a[112:115], a[96:99], a[128:131], a[112:115]
v_mfma_f32_16x16x32_bf16 a[116:119], a[100:103], a[128:131], a[116:119]
v_mfma_f32_16x16x32_bf16 a[120:123], a[104:107], a[128:131], a[120:123]
v_mfma_f32_16x16x32_bf16 a[124:127], a[108:111], a[128:131], a[124:127]
s_bfe_u32 s66, s57, 0x40004
s_mul_i32 s66, s66, 19968
s_add_u32 s66, s66, s73
s_add_u32 s67, s66, 6144
s_nop 4
buffer_store_dwordx4 a[112:115], v94, s[40:43], s66 offen offset:0 sc1
buffer_store_dwordx4 a[116:119], v94, s[40:43], s66 offen offset:64 sc1
buffer_store_dwordx4 a[120:123], v94, s[40:43], s67 offen offset:0 sc1
buffer_store_dwordx4 a[124:127], v94, s[40:43], s67 offen offset:64 sc1
s_branch Lcrf3
Lcsf4:
v_mfma_f32_16x16x32_bf16 a[112:115], a[40:43], a[128:131], 0
v_mfma_f32_16x16x32_bf16 a[116:119], a[44:47], a[128:131], 0
v_mfma_f32_16x16x32_bf16 a[120:123], a[48:51], a[128:131], 0
v_mfma_f32_16x16x32_bf16 a[124:127], a[52:55], a[128:131], 0
s_branch Lcrf4
Lcsf5:
v_mfma_f32_16x16x32_bf16 a[112:115], a[96:99], a[128:131], a[112:115]
v_mfma_f32_16x16x32_bf16 a[116:119], a[100:103], a[128:131], a[116:119]
v_mfma_f32_16x16x32_bf16 a[120:123], a[104:107], a[128:131], a[120:123]
v_mfma_f32_16x16x32_bf16 a[124:127], a[108:111], a[128:131], a[124:127]
s_bfe_u32 s66, s57, 0x40008
s_mul_i32 s66, s66, 19968
s_add_u32 s66, s66, s73
s_add_u32 s67, s66, 6144
s_nop 4
buffer_store_dwordx4 a[112:115], v94, s[40:43], s66 offen offset:0 sc1
buffer_store_dwordx4 a[116:119], v94, s[40:43], s66 offen offset:64 sc1
buffer_store_dwordx4 a[120:123], v94, s[40:43], s67 offen offset:0 sc1
buffer_store_dwordx4 a[124:127], v94, s[40:43], s67 offen offset:64 sc1
s_branch Lcrf5
Lcsf6:
v_mfma_f32_16x16x32_bf16 a[112:115], a[40:43], a[128:131], 0
v_mfma_f32_16x16x32_bf16 a[116:119], a[44:47], a[128:131], 0
v_mfma_f32_16x16x32_bf16 a[120:123], a[48:51], a[128:131], 0
v_mfma_f32_16x16x32_bf16 a[124:127], a[52:55], a[128:131], 0
s_branch Lcrf6
Lcsf7:
v_mfma_f32_16x16x32_bf16 a[112:115], a[96:99], a[128:131], a[112:115]
v_mfma_f32_16x16x32_bf16 a[116:119], a[100:103], a[128:131], a[116:119]
v_mfma_f32_16x16x32_bf16 a[120:123], a[104:107], a[128:131], a[120:123]
v_mfma_f32_16x16x32_bf16 a[124:127], a[108:111], a[128:131], a[124:127]
s_bfe_u32 s66, s57, 0x4000c
s_mul_i32 s66, s66, 19968
s_add_u32 s66, s66, s73
s_add_u32 s67, s66, 6144
s_nop 4
buffer_store_dwordx4 a[112:115], v94, s[40:43], s66 offen offset:0 sc1
buffer_store_dwordx4 a[116:119], v94, s[40:43], s66 offen offset:64 sc1
buffer_store_dwordx4 a[120:123], v94, s[40:43], s67 offen offset:0 sc1
buffer_store_dwordx4 a[124:127], v94, s[40:43], s67 offen offset:64 sc1
s_branch Lcrf7
Lspare:
s_waitcnt lgkmcnt(0)
s_mov_b32 s40, s24
s_mov_b32 s41, s25
s_mov_b32 s42, 17825792
s_mov_b32 s43, 0x20000
s_mov_b32 s48, s22
s_mov_b32 s49, s23
s_mov_b32 s50, 256
s_mov_b32 s51, 0x20000
v_lshlrev_b32_e64 v6, 4, v1
v_add_u32 v21, 4096, v6
v_add_u32 v0, 8192, v6
v_mov_b32 v7, 0x7f000000
v_cmp_eq_u32 vcc, 0, v1
s_nop 1
v_cndmask_b32 v7, v7, 0, vcc
s_mov_b32 s80, 0x3fb8aa3b
s_mov_b32 s81, 0x3fb8aa3b
s_mov_b32 s82, 0x05040100
s_mov_b32 s83, 0x07060302
s_lshl_b32 s12, s56, 10
s_mov_b32 s78, 0xffff0000
s_and_b32 s64, s2, 7
s_lshr_b32 s65, s2, 3
s_sub_u32 s66, s65, 8
s_and_b32 s67, s66, 3
s_lshl_b32 s68, s64, 2
s_add_u32 s67, s67, s68
s_lshl_b32 s68, s59, 2
s_cmp_lt_u32 s65, 8
s_cselect_b32 s27, s68, s67
s_lshr_b32 s66, s66, 2
s_lshl_b32 s66, s66, 2
s_add_u32 s66, s66, s56
s_mul_i32 s26, s66, 6
s_lshl_b32 s95, s64, 2
s_and_b32 s66, s65, 3
s_add_u32 s95, s95, s66
s_lshr_b32 s96, s65, 2
s_mul_i32 s3, s56, -7168
s_add_u32 s3, s3, 49152
s_mul_i32 s64, s96, 348160
s_mul_i32 s65, s56, 12288
s_add_u32 s64, s64, s65
s_add_u32 s86, s64, 9437184
s_add_u32 s87, s86, 69632
s_add_u32 s88, s87, 69632
s_add_u32 s89, s88, 69632
s_add_u32 s90, s89, 69632
s_mul_i32 s64, s95, 278528
s_add_u32 s64, s64, s65
s_add_u32 s66, s56, 0
s_and_b32 s66, s66, 3
s_mul_i32 s66, s66, 69632
s_add_u32 s91, s64, s66
s_add_u32 s66, s56, 1
s_and_b32 s66, s66, 3
s_mul_i32 s66, s66, 69632
s_add_u32 s92, s64, s66
s_add_u32 s66, s56, 2
s_and_b32 s66, s66, 3
s_mul_i32 s66, s66, 69632
s_add_u32 s93, s64, s66
s_add_u32 s66, s56, 3
s_and_b32 s66, s66, 3
s_mul_i32 s66, s66, 69632
s_add_u32 s94, s64, s66
s_sub_u32 s70, s2, 252
s_lshl_b32 s64, s70, 2
s_add_u32 s64, s64, s56
s_add_u32 s84, s64, 624
s_mul_i32 s64, s64, 24576
s_add_u32 s64, s64, 17072128
v_lshlrev_b32_e64 v2, 7, v1
v_mov_b32 v34, 0
buffer_store_dword v34, v2, s[40:43], s64 offen sc1
s_add_u32 s64, s64, 8192
buffer_store_dword v34, v2, s[40:43], s64 offen sc1
s_add_u32 s64, s64, 8192
buffer_store_dword v34, v2, s[40:43], s64 offen sc1
s_add_u32 s64, s64, 8192
s_waitcnt vmcnt(0)
s_barrier
s_lshl_b32 s64, s70, 2
s_cmp_eq_u32 s56, 0
s_cbranch_scc0 Lw0_17
buffer_store_dword v21, v7, s[48:51], s64 offen sc1
Lw0_17:
Lsp_loop:
s_mul_i32 s65, s84, 964
s_lshr_b32 s65, s65, 16
s_mul_i32 s64, s65, 68
s_sub_u32 s64, s84, s64
s_mul_i32 s98, s65, 272
s_add_u32 s98, s98, s64
s_lshl_b32 s98, s98, 10
s_add_u32 s98, s98, 9437184
s_mov_b32 s46, 819200
s_mov_b32 s76, 10240
s_mov_b32 s77, 5120
s_cmp_lt_u32 s64, 48
s_cselect_b32 s44, s18, s10
s_cselect_b32 s45, s19, s11
s_cselect_b32 s46, 1966080, s46
s_cselect_b32 s66, 0, 48
s_cselect_b32 s76, 5120, s76
s_cselect_b32 s77, 20480, s77
s_mov_b32 s47, 0x20000
s_sub_u32 s64, s64, s66
s_mul_i32 s64, s64, 40960
s_lshl_b32 s65, s65, 7
s_add_u32 s97, s64, s65
v_and_b32 v2, 15, v1
v_lshrrev_b32 v3, 4, v1
v_mul_u32_u24 v90, s76, v3
v_lshl_add_u32 v90, v2, 3, v90
v_lshrrev_b32_e64 v4, 2, v2
v_mul_u32_u24 v91, 69632, v4
v_and_b32_e64 v2, 3, v2
v_lshl_add_u32 v2, v3, 4, v2
v_lshl_add_u32 v91, v2, 4, v91
buffer_load_dwordx2 v[64:65], v90, s[44:47], s97 offen offset:0
buffer_load_dwordx2 v[66:67], v90, s[44:47], s97 offen offset:1280
buffer_load_dwordx2 v[68:69], v90, s[44:47], s97 offen offset:2560
buffer_load_dwordx2 v[70:71], v90, s[44:47], s97 offen offset:3840
s_add_u32 s97, s97, s77
buffer_load_dwordx2 v[72:73], v90, s[44:47], s97 offen offset:0
buffer_load_dwordx2 v[74:75], v90, s[44:47], s97 offen offset:1280
buffer_load_dwordx2 v[76:77], v90, s[44:47], s97 offen offset:2560
buffer_load_dwordx2 v[78:79], v90, s[44:47], s97 offen offset:3840
s_waitcnt vmcnt(0)
v_perm_b32 v34, v66, v64, s82
v_perm_b32 v35, v70, v68, s82
v_perm_b32 v36, v74, v72, s82
v_perm_b32 v37, v78, v76, s82
buffer_store_dwordx4 v[34:37], v91, s[40:43], s98 offen offset:0 sc1
v_perm_b32 v38, v66, v64, s83
v_perm_b32 v39, v70, v68, s83
v_perm_b32 v40, v74, v72, s83
v_perm_b32 v41, v78, v76, s83
buffer_store_dwordx4 v[38:41], v91, s[40:43], s98 offen offset:64 sc1
v_perm_b32 v84, v67, v65, s82
v_perm_b32 v85, v71, v69, s82
v_perm_b32 v86, v75, v73, s82
v_perm_b32 v87, v79, v77, s82
buffer_store_dwordx4 v[84:87], v91, s[40:43], s98 offen offset:128 sc1
v_perm_b32 v2, v67, v65, s83
v_perm_b32 v3, v71, v69, s83
v_perm_b32 v4, v75, v73, s83
v_perm_b32 v5, v79, v77, s83
buffer_store_dwordx4 v[2:5], v91, s[40:43], s98 offen offset:192 sc1
s_add_u32 s84, s84, 16
s_cmp_lt_u32 s84, 680
s_cbranch_scc1 Lsp_loop
s_mov_b32 s44, s8
s_mov_b32 s45, s9
s_mov_b32 s46, 25600
s_mov_b32 s47, 0x20000
s_mul_i32 s64, s27, 800
s_mov_b32 s66, m0
s_mov_b32 m0, 159744
s_mov_b32 exec_hi, 0x3ffff
buffer_load_dwordx4 v6, s[44:47], s64 offen lds
s_mov_b32 exec_hi, -1
s_mov_b32 m0, s66
v_and_b32 v13, 3, v1
v_lshlrev_b32_e64 v13, 2, v13
buffer_load_dword v14, v13, s[48:51], 0 offen sc1
s_waitcnt vmcnt(0)
s_barrier
v_cmp_eq_u32 vcc, 0, v14
s_cbranch_vccz Lok11
s_mov_b32 s85, 40000
Lsp11:
buffer_load_dword v14, v13, s[48:51], 0 offen sc1
s_waitcnt vmcnt(0)
v_cmp_eq_u32 vcc, 0, v14
s_cbranch_vccz Lok11
s_sub_u32 s85, s85, 1
s_cmp_lg_u32 s85, 0
s_cbranch_scc1 Lsp11
Lok11:
v_lshl_add_u32 v2, v1, 2, s70
v_cmp_gt_u32 vcc, 14, v2
v_lshlrev_b32 v2, 7, v2
v_add_u32 v2, 17399296, v2
v_mov_b32 v3, 0x7f000000
v_cndmask_b32_e64 v87, v3, v2, vcc
s_cmp_eq_u32 s56, 0
s_cbranch_scc0 Lw0_18
buffer_store_dword v21, v87, s[40:43], 0 offen sc1
Lw0_18:
s_mov_b32 s64, 159744
v_bfe_u32 v2, v1, 2, 2
v_mul_u32_u24 v2, 10, v2
v_lshrrev_b32 v3, 4, v1
v_mul_u32_u24 v4, 320, v3
v_add3_u32 v2, v2, v4, s64
v_and_b32_e64 v4, 3, v1
v_lshl_add_u32 v42, v4, 1, v2
v_add_u32 v43, 8, v2
ds_read_u16 v34, v42 offset:0
ds_read_u16 v35, v42 offset:40
ds_read_u16 v36, v42 offset:80
ds_read_u16 v37, v42 offset:120
ds_read_u16 v38, v42 offset:160
ds_read_u16 v39, v42 offset:200
ds_read_u16 v40, v42 offset:240
ds_read_u16 v41, v42 offset:280
s_waitcnt lgkmcnt(0)
v_lshl_or_b32 v8, v35, 16, v34
v_lshl_or_b32 v9, v37, 16, v36
v_lshl_or_b32 v10, v39, 16, v38
v_lshl_or_b32 v11, v41, 16, v40
ds_read_u16 v34, v43 offset:0
ds_read_u16 v35, v43 offset:40
ds_read_u16 v36, v43 offset:80
ds_read_u16 v37, v43 offset:120
ds_read_u16 v38, v43 offset:160
ds_read_u16 v39, v43 offset:200
ds_read_u16 v40, v43 offset:240
ds_read_u16 v41, v43 offset:280
s_waitcnt lgkmcnt(0)
v_lshl_or_b32 v12, v35, 16, v34
v_lshl_or_b32 v13, v37, 16, v36
v_lshl_or_b32 v14, v39, 16, v38
v_lshl_or_b32 v15, v41, 16, v40
v_cmp_gt_u32 vcc, 48, v1
s_nop 1
v_cndmask_b32 v8, 0, v8, vcc
v_cndmask_b32 v9, 0, v9, vcc
v_cndmask_b32 v12, 0, v12, vcc
v_cndmask_b32 v13, 0, v13, vcc
v_cmp_gt_u32 vcc, 32, v1
s_nop 1
v_cndmask_b32 v10, 0, v10, vcc
v_cndmask_b32 v11, 0, v11, vcc
v_cndmask_b32 v14, 0, v14, vcc
v_cndmask_b32 v15, 0, v15, vcc
s_waitcnt lgkmcnt(0)
s_mul_i32 s65, s96, 5
s_lshr_b32 s65, s65, 2
s_mul_i32 s65, s65, 2176
s_add_u32 s65, s65, 17379328
v_min_u32_e64 v2, 33, v1
v_lshl_add_u32 v88, v2, 7, s65
s_lshr_b32 s65, s27, 2
s_mul_i32 s65, s65, 27
s_lshr_b32 s65, s65, 1
v_min_u32 v2, 14, v1
v_add_u32_e64 v2, s65, v2
v_min_u32 v2, 107, v2
s_mov_b32 s65, 17379328
v_lshl_add_u32 v85, v2, 7, s65
buffer_load_dword v83, v88, s[40:43], 0 offen sc1
buffer_load_dword v84, v85, s[40:43], 0 offen sc1
s_waitcnt vmcnt(0)
v_min_u32 v83, v83, v84
v_cmp_eq_u32 vcc, 0, v83
s_cbranch_vccz Lok12
s_mov_b32 s85, 40000
Lsp12:
buffer_load_dword v83, v88, s[40:43], 0 offen sc1
buffer_load_dword v84, v85, s[40:43], 0 offen sc1
s_waitcnt vmcnt(0)
v_min_u32 v83, v83, v84
v_cmp_eq_u32_e64 vcc, 0, v83
s_cbranch_vccz Lok12
s_sub_u32 s85, s85, 1
s_cmp_lg_u32 s85, 0
s_cbranch_scc1 Lsp12
Lok12:
s_lshr_b32 s64, s27, 3
s_lshl_b32 s64, s64, 12
s_add_u32 s97, s64, 17199104
s_mul_i32 s64, s95, 52429
s_lshr_b32 s64, s64, 17
s_lshl_b32 s65, s95, 6
s_add_u32 s65, s65, 63
s_mul_i32 s65, s65, 52429
s_lshr_b32 s65, s65, 23
s_sub_u32 s65, s65, s64
s_mul_i32 s77, s65, 384
s_mul_i32 s64, s64, 48
s_mul_i32 s66, s56, 12
s_add_u32 s64, s64, s66
s_lshl_b32 s64, s64, 7
s_add_u32 s98, s64, 17119232
s_mul_i32 s64, s27, 81920
s_add_u32 s99, s64, 12582912
s_min_u32 s76, s26, 127
s_lshl_b32 s76, s76, 4
buffer_load_dwordx4 a[112:115], v6, s[40:43], s86 offen offset:0 sc1
buffer_load_dwordx4 a[116:119], v6, s[40:43], s87 offen offset:0 sc1
buffer_load_dwordx4 a[120:123], v6, s[40:43], s88 offen offset:0 sc1
buffer_load_dwordx4 a[124:127], v6, s[40:43], s89 offen offset:0 sc1
buffer_load_dwordx4 a[128:131], v6, s[40:43], s90 offen offset:0 sc1
buffer_load_dwordx4 a[132:135], v6, s[40:43], s86 offen offset:1024 sc1
buffer_load_dwordx4 a[136:139], v6, s[40:43], s87 offen offset:1024 sc1
buffer_load_dwordx4 a[140:143], v6, s[40:43], s88 offen offset:1024 sc1
buffer_load_dwordx4 a[144:147], v6, s[40:43], s89 offen offset:1024 sc1
buffer_load_dwordx4 a[148:151], v6, s[40:43], s90 offen offset:1024 sc1
buffer_load_dwordx4 a[152:155], v6, s[40:43], s86 offen offset:2048 sc1
buffer_load_dwordx4 a[156:159], v6, s[40:43], s87 offen offset:2048 sc1
buffer_load_dwordx4 a[160:163], v6, s[40:43], s88 offen offset:2048 sc1
buffer_load_dwordx4 a[164:167], v6, s[40:43], s89 offen offset:2048 sc1
buffer_load_dwordx4 a[168:171], v6, s[40:43], s90 offen offset:2048 sc1
buffer_load_dwordx4 a[172:175], v6, s[40:43], s86 offen offset:3072 sc1
buffer_load_dwordx4 a[176:179], v6, s[40:43], s87 offen offset:3072 sc1
buffer_load_dwordx4 a[180:183], v6, s[40:43], s88 offen offset:3072 sc1
buffer_load_dwordx4 a[184:187], v6, s[40:43], s89 offen offset:3072 sc1
buffer_load_dwordx4 a[188:191], v6, s[40:43], s90 offen offset:3072 sc1
buffer_load_dwordx4 a[192:195], v21, s[40:43], s86 offen offset:0 sc1
buffer_load_dwordx4 a[196:199], v0, s[40:43], s90 offen offset:1024 sc1
buffer_load_dwordx4 a[200:203], v0, s[40:43], s86 offen offset:2048 sc1
buffer_load_dwordx4 a[204:207], v0, s[40:43], s87 offen offset:2048 sc1
buffer_load_dwordx4 a[208:211], v0, s[40:43], s88 offen offset:2048 sc1
buffer_load_dwordx4 a[212:215], v0, s[40:43], s89 offen offset:2048 sc1
buffer_load_dwordx4 a[216:219], v0, s[40:43], s90 offen offset:2048 sc1
buffer_load_dwordx4 a[220:223], v0, s[40:43], s86 offen offset:3072 sc1
buffer_load_dwordx4 a[224:227], v0, s[40:43], s87 offen offset:3072 sc1
buffer_load_dwordx4 a[228:231], v0, s[40:43], s88 offen offset:3072 sc1
buffer_load_dwordx4 a[232:235], v0, s[40:43], s89 offen offset:3072 sc1
buffer_load_dwordx4 a[236:239], v0, s[40:43], s90 offen offset:3072 sc1
s_add_u32 s64, s86, s3
s_add_u32 m0, s12, 61440
s_nop 0
buffer_load_dwordx4 v6, s[40:43], s64 offen offset:0 sc1 lds
s_add_u32 s64, s87, s3
s_add_u32 m0, s12, 65536
s_nop 0
buffer_load_dwordx4 v6, s[40:43], s64 offen offset:0 sc1 lds
s_add_u32 s64, s88, s3
s_add_u32 m0, s12, 69632
s_nop 0
buffer_load_dwordx4 v6, s[40:43], s64 offen offset:0 sc1 lds
s_add_u32 s64, s89, s3
s_add_u32 m0, s12, 73728
s_nop 0
buffer_load_dwordx4 v6, s[40:43], s64 offen offset:0 sc1 lds
s_add_u32 s64, s90, s3
s_add_u32 m0, s12, 77824
s_nop 0
buffer_load_dwordx4 v6, s[40:43], s64 offen offset:0 sc1 lds
s_add_u32 s64, s86, s3
s_add_u32 m0, s12, 80896
s_nop 0
buffer_load_dwordx4 v6, s[40:43], s64 offen offset:1024 sc1 lds
s_add_u32 s64, s87, s3
s_add_u32 m0, s12, 84992
s_nop 0
buffer_load_dwordx4 v6, s[40:43], s64 offen offset:1024 sc1 lds
s_add_u32 s64, s88, s3
s_add_u32 m0, s12, 89088
s_nop 0
buffer_load_dwordx4 v6, s[40:43], s64 offen offset:1024 sc1 lds
s_add_u32 s64, s89, s3
s_add_u32 m0, s12, 93184
s_nop 0
buffer_load_dwordx4 v6, s[40:43], s64 offen offset:1024 sc1 lds
s_add_u32 s64, s90, s3
s_add_u32 m0, s12, 97280
s_nop 0
buffer_load_dwordx4 v6, s[40:43], s64 offen offset:1024 sc1 lds
s_add_u32 s64, s86, s3
s_add_u32 m0, s12, 100352
s_nop 0
buffer_load_dwordx4 v6, s[40:43], s64 offen offset:2048 sc1 lds
buffer_load_dwordx4 a[0:3], v21, s[40:43], s87 offen offset:0 sc1
buffer_load_dwordx4 a[4:7], v21, s[40:43], s88 offen offset:0 sc1
buffer_load_dwordx4 a[8:11], v21, s[40:43], s89 offen offset:0 sc1
buffer_load_dwordx4 a[12:15], v21, s[40:43], s90 offen offset:0 sc1
buffer_load_dwordx4 a[16:19], v21, s[40:43], s86 offen offset:1024 sc1
buffer_load_dwordx4 a[20:23], v21, s[40:43], s87 offen offset:1024 sc1
buffer_load_dwordx4 a[24:27], v21, s[40:43], s88 offen offset:1024 sc1
buffer_load_dwordx4 a[28:31], v21, s[40:43], s89 offen offset:1024 sc1
buffer_load_dwordx4 a[32:35], v21, s[40:43], s90 offen offset:1024 sc1
buffer_load_dwordx4 a[36:39], v21, s[40:43], s86 offen offset:2048 sc1
buffer_load_dwordx4 a[40:43], v21, s[40:43], s87 offen offset:2048 sc1
buffer_load_dwordx4 a[44:47], v21, s[40:43], s88 offen offset:2048 sc1
buffer_load_dwordx4 a[48:51], v21, s[40:43], s89 offen offset:2048 sc1
buffer_load_dwordx4 a[52:55], v21, s[40:43], s90 offen offset:2048 sc1
s_mov_b32 s79, s42
Lcommon:
v_and_b32 v2, 15, v1
v_min_u32 v3, 11, v2
v_and_b32 v4, 16, v1
v_mul_u32_u24_e64 v4, s77, v4
v_lshl_add_u32 v84, v3, 7, v4
s_lshr_b32 s64, s26, 2
v_and_b32 v4, 1, v1
v_add_u32 v4, s64, v4
v_min_u32 v4, 31, v4
v_lshlrev_b32 v85, 7, v4
v_lshrrev_b32 v3, 4, v1
v_add_u32 v2, s76, v2
v_cmp_eq_u32 vcc, 1, v3
v_lshlrev_b32_e64 v5, 4, v2
v_cmp_eq_u32 s[70:71], 2, v3
v_cndmask_b32 v4, 0, 1, vcc
v_lshl_add_u32 v5, v4, 15, v5
v_lshlrev_b32_e64 v2, 3, v2
v_add_u32 v2, 0x10000, v2
v_cndmask_b32 v4, 2, 1, s[70:71]
v_cndmask_b32 v86, v5, v2, s[70:71]
v_lshlrev_b32_e64 v87, 7, v4
buffer_load_dword v89, v85, s[40:43], s97 offen sc1
v_mov_b32 v16, 0
v_mov_b32 v17, 0
v_mov_b32 v18, 0
v_mov_b32 v19, 0
v_lshl_add_u32 v2, s56, 6, v1
v_min_u32 v2, 188, v2
v_lshlrev_b32_e64 v2, 4, v2
v_add_u32 v2, 0, v2
ds_write_b128 v2, v[16:19]
s_waitcnt vmcnt(0)
buffer_store_dword v21, v7, s[40:43], s79 offen sc1
v_cmp_eq_u32 vcc, 0, v89
s_cbranch_vccz Lok13
s_mov_b32 s85, 40000
Lsp13:
buffer_load_dword v89, v85, s[40:43], s97 offen sc1
s_waitcnt vmcnt(0)
v_cmp_eq_u32 vcc, 0, v89
s_cbranch_vccz Lok13
s_sub_u32 s85, s85, 1
s_cmp_lg_u32 s85, 0
s_cbranch_scc1 Lsp13
Lok13:
buffer_load_dwordx4 v[30:33], v86, s[40:43], s99 offen sc1
s_cmp_lt_u32 s26, 127
s_cselect_b32 s64, 1, 0
v_mad_u32_u24 v86, v87, s64, v86
buffer_load_dwordx4 v[34:37], v86, s[40:43], s99 offen sc1
s_cmp_lt_u32 s26, 126
s_cselect_b32 s64, 1, 0
v_mad_u32_u24 v86, v87, s64, v86
buffer_load_dwordx4 v[38:41], v86, s[40:43], s99 offen sc1
s_cmp_lt_u32 s26, 125
s_cselect_b32 s64, 1, 0
v_mad_u32_u24 v86, v87, s64, v86
buffer_load_dwordx4 v[48:51], v86, s[40:43], s99 offen sc1
s_cmp_lt_u32 s26, 124
s_cselect_b32 s64, 1, 0
v_mad_u32_u24 v86, v87, s64, v86
buffer_load_dwordx4 v[52:55], v86, s[40:43], s99 offen sc1
s_cmp_lt_u32 s26, 123
s_cselect_b32 s64, 1, 0
v_mad_u32_u24 v86, v87, s64, v86
buffer_load_dwordx4 v[56:59], v86, s[40:43], s99 offen sc1
buffer_load_dwordx4 a[56:59], v21, s[40:43], s86 offen offset:3072 sc1
buffer_load_dwordx4 a[60:63], v21, s[40:43], s87 offen offset:3072 sc1
buffer_load_dwordx4 a[64:67], v21, s[40:43], s88 offen offset:3072 sc1
buffer_load_dwordx4 a[68:71], v21, s[40:43], s89 offen offset:3072 sc1
s_waitcnt vmcnt(7)
v_cndmask_b32 v32, v32, 0, s[70:71]
v_cndmask_b32 v33, v33, 0, s[70:71]
v_cndmask_b32 v36, v36, 0, s[70:71]
v_cndmask_b32 v37, v37, 0, s[70:71]
v_cndmask_b32 v40, v40, 0, s[70:71]
v_cndmask_b32 v41, v41, 0, s[70:71]
buffer_load_dwordx4 a[72:75], v21, s[40:43], s90 offen offset:3072 sc1
v_mfma_f32_16x16x32_bf16 v[60:63], v[8:11], v[30:33], 0
v_mfma_f32_16x16x32_bf16 v[72:75], v[12:15], v[30:33], 0
v_mfma_f32_16x16x32_bf16 v[64:67], v[8:11], v[34:37], 0
v_mfma_f32_16x16x32_bf16 v[76:79], v[12:15], v[34:37], 0
v_mfma_f32_16x16x32_bf16 v[68:71], v[8:11], v[38:41], 0
v_mfma_f32_16x16x32_bf16 v[80:83], v[12:15], v[38:41], 0
s_nop 2
v_max3_f32 v30, v60, v61, v62
s_nop 0
v_max3_f32 v34, v64, v65, v66
buffer_load_dwordx4 a[76:79], v0, s[40:43], s86 offen offset:0 sc1
v_max3_f32 v38, v68, v69, v70
v_max3_f32 v31, -v60, -v61, -v62
v_max3_f32 v35, -v64, -v65, -v66
v_max3_f32 v39, -v68, -v69, -v70
v_max3_f32 v30, v30, v63, v72
v_max3_f32 v34, v34, v67, v76
v_max3_f32 v38, v38, v71, v80
v_max3_f32 v31, v31, -v63, -v72
v_max3_f32 v35, v35, -v67, -v76
buffer_load_dwordx4 a[80:83], v0, s[40:43], s87 offen offset:0 sc1
v_max3_f32 v39, v39, -v71, -v80
v_permlane32_swap_b32 v30, v31
v_permlane32_swap_b32 v34, v35
v_permlane32_swap_b32 v38, v39
v_max_f32 v30, v30, v31
v_max_f32 v34, v34, v35
v_max_f32 v38, v38, v39
v_mov_b32_e64 v31, v30
buffer_load_dwordx4 a[84:87], v0, s[40:43], s88 offen offset:0 sc1
v_mov_b32 v35, v34
v_mov_b32 v39, v38
v_permlane16_swap_b32 v30, v31
v_permlane16_swap_b32 v34, v35
v_permlane16_swap_b32 v38, v39
v_max_f32 v30, v30, v31
v_max_f32 v34, v34, v35
v_max_f32 v38, v38, v39
v_mov_b32_e64 v31, v30
buffer_load_dwordx4 a[88:91], v0, s[40:43], s89 offen offset:0 sc1
v_mov_b32 v35, v34
v_mov_b32 v39, v38
v_permlane32_swap_b32 v30, v31
v_permlane32_swap_b32 v34, v35
v_permlane32_swap_b32 v38, v39
v_mul_f32 v30, 0xbfb8aa3b, v30
v_mul_f32 v31, 0xbfb8aa3b, v31
v_mul_f32 v34, 0xbfb8aa3b, v34
v_mul_f32 v35, 0xbfb8aa3b, v35
buffer_load_dwordx4 a[92:95], v0, s[40:43], s90 offen offset:0 sc1
v_mul_f32 v38, 0xbfb8aa3b, v38
v_mul_f32 v39, 0xbfb8aa3b, v39
v_fma_f32 v73, -v60, s80, v31
v_fma_f32 v74, -v61, s80, v31
v_fma_f32 v75, -v62, s80, v31
v_fma_f32 v32, -v63, s80, v31
v_fma_f32 v33, -v72, s80, v31
v_fma_f32 v60, v60, s80, v30
buffer_load_dwordx4 a[96:99], v0, s[40:43], s86 offen offset:1024 sc1
v_fma_f32 v61, v61, s80, v30
v_fma_f32 v62, v62, s80, v30
v_fma_f32 v63, v63, s80, v30
s_waitcnt vmcnt(11)
v_fma_f32 v72, v72, s80, v30
v_fma_f32 v77, -v64, s80, v35
v_fma_f32 v78, -v65, s80, v35
v_fma_f32 v79, -v66, s80, v35
v_fma_f32 v36, -v67, s80, v35
v_fma_f32 v37, -v76, s80, v35
buffer_load_dwordx4 a[100:103], v0, s[40:43], s87 offen offset:1024 sc1
v_fma_f32 v64, v64, s80, v34
v_fma_f32 v65, v65, s80, v34
v_fma_f32 v66, v66, s80, v34
v_fma_f32 v67, v67, s80, v34
v_fma_f32 v76, v76, s80, v34
v_fma_f32 v81, -v68, s80, v39
v_fma_f32 v82, -v69, s80, v39
v_fma_f32 v83, -v70, s80, v39
buffer_load_dwordx4 a[104:107], v0, s[40:43], s88 offen offset:1024 sc1
v_fma_f32 v40, -v71, s80, v39
v_fma_f32 v41, -v80, s80, v39
v_fma_f32 v68, v68, s80, v38
v_fma_f32 v69, v69, s80, v38
v_fma_f32 v70, v70, s80, v38
v_fma_f32 v71, v71, s80, v38
v_fma_f32 v80, v80, s80, v38
v_exp_f32 v60, v60
v_exp_f32 v61, v61
buffer_load_dwordx4 a[108:111], v0, s[40:43], s89 offen offset:1024 sc1
v_exp_f32 v62, v62
v_exp_f32 v63, v63
v_exp_f32 v72, v72
v_exp_f32 v73, v73
v_exp_f32 v74, v74
v_exp_f32 v75, v75
v_exp_f32_e64 v32, v32
v_exp_f32 v33, v33
s_add_u32 s64, s87, s3
s_add_u32 m0, s12, 104448
v_exp_f32_e64 v64, v64
buffer_load_dwordx4 v6, s[40:43], s64 offen offset:2048 sc1 lds
v_exp_f32 v65, v65
v_exp_f32 v66, v66
v_exp_f32 v67, v67
v_exp_f32 v76, v76
v_exp_f32 v77, v77
v_exp_f32 v78, v78
v_exp_f32_e64 v79, v79
v_exp_f32 v36, v36
s_add_u32 s64, s88, s3
s_add_u32 m0, s12, 108544
v_exp_f32_e64 v37, v37
buffer_load_dwordx4 v6, s[40:43], s64 offen offset:2048 sc1 lds
v_exp_f32 v68, v68
v_exp_f32 v69, v69
v_exp_f32 v70, v70
v_exp_f32 v71, v71
v_exp_f32 v80, v80
v_exp_f32 v81, v81
v_exp_f32 v82, v82
s_add_u32 s64, s89, s3
s_add_u32 m0, s12, 112640
v_exp_f32_e64 v83, v83
buffer_load_dwordx4 v6, s[40:43], s64 offen offset:2048 sc1 lds
v_exp_f32 v40, v40
v_exp_f32 v41, v41
v_add_f32 v30, v60, v61
v_add_f32 v31, v73, v74
v_add_f32 v34, v64, v65
v_add_f32 v35, v77, v78
v_add_f32_e64 v38, v68, v69
v_add_f32 v39, v81, v82
s_add_u32 s64, s90, s3
s_add_u32 m0, s12, 116736
v_add_f32_e64 v30, v30, v62
buffer_load_dwordx4 v6, s[40:43], s64 offen offset:2048 sc1 lds
v_add_f32 v31, v31, v75
v_add_f32 v34, v34, v66
v_add_f32 v35, v35, v79
v_add_f32 v38, v38, v70
v_add_f32 v39, v39, v83
v_add_f32 v30, v30, v63
v_add_f32 v31, v31, v32
s_add_u32 s64, s86, s3
s_add_u32 m0, s12, 119808
v_add_f32_e64 v34, v34, v67
buffer_load_dwordx4 v6, s[40:43], s64 offen offset:3072 sc1 lds
v_add_f32 v35, v35, v36
v_add_f32 v38, v38, v71
v_add_f32 v39, v39, v40
v_add_f32 v30, v30, v72
v_add_f32 v31, v31, v33
v_add_f32 v34, v34, v76
v_add_f32_e64 v35, v35, v37
v_add_f32 v38, v38, v80
s_add_u32 s64, s87, s3
s_add_u32 m0, s12, 123904
v_add_f32_e64 v39, v39, v41
buffer_load_dwordx4 v6, s[40:43], s64 offen offset:3072 sc1 lds
v_permlane32_swap_b32 v30, v31
v_permlane32_swap_b32 v34, v35
v_permlane32_swap_b32 v38, v39
v_add_f32 v30, v30, v31
v_add_f32 v34, v34, v35
v_add_f32 v38, v38, v39
v_mov_b32_e64 v31, v30
v_mov_b32 v35, v34
s_add_u32 s64, s88, s3
s_add_u32 m0, s12, 128000
v_mov_b32_e64 v39, v38
buffer_load_dwordx4 v6, s[40:43], s64 offen offset:3072 sc1 lds
v_permlane16_swap_b32 v30, v31
v_permlane16_swap_b32 v34, v35
v_permlane16_swap_b32 v38, v39
v_add_f32 v30, v30, v31
v_add_f32 v34, v34, v35
v_add_f32 v38, v38, v39
v_mov_b32 v31, v30
s_add_u32 s64, s89, s3
s_add_u32 m0, s12, 132096
v_mov_b32_e64 v35, v34
buffer_load_dwordx4 v6, s[40:43], s64 offen offset:3072 sc1 lds
v_mov_b32 v39, v38
v_permlane32_swap_b32 v30, v31
v_permlane32_swap_b32 v34, v35
v_permlane32_swap_b32 v38, v39
v_rcp_f32 v30, v30
v_rcp_f32 v34, v34
v_rcp_f32_e64 v38, v38
v_rcp_f32 v31, v31
s_add_u32 s64, s90, s3
s_add_u32 m0, s12, 136192
v_rcp_f32_e64 v35, v35
buffer_load_dwordx4 v6, s[40:43], s64 offen offset:3072 sc1 lds
v_rcp_f32 v39, v39
v_mul_f32 v60, v60, v30
v_mul_f32 v61, v61, v30
v_mul_f32 v62, v62, v30
v_mul_f32 v63, v63, v30
v_mul_f32 v72, v72, v30
v_mul_f32 v73, v73, v31
s_add_u32 s64, s86, s3
s_add_u32 m0, s12, 143360
v_mul_f32_e64 v74, v74, v31
buffer_load_dwordx4 v21, s[40:43], s64 offen offset:0 sc1 lds
v_mul_f32 v75, v75, v31
v_mul_f32 v32, v32, v31
v_mul_f32 v33, v33, v31
v_mul_f32 v64, v64, v34
v_mul_f32 v65, v65, v34
v_mul_f32 v66, v66, v34
v_mul_f32 v67, v67, v34
v_mul_f32 v76, v76, v34
v_mul_f32 v77, v77, v35
v_mul_f32 v78, v78, v35
v_mul_f32 v79, v79, v35
v_mul_f32 v36, v36, v35
v_mul_f32_e64 v37, v37, v35
buffer_load_dword v88, v84, s[40:43], s98 offen sc1
v_mul_f32 v68, v68, v38
v_mul_f32 v69, v69, v38
v_mul_f32 v70, v70, v38
v_mul_f32 v71, v71, v38
v_mul_f32 v80, v80, v38
v_mul_f32 v81, v81, v39
v_mul_f32 v82, v82, v39
v_mul_f32 v83, v83, v39
v_mul_f32 v40, v40, v39
v_mul_f32 v41, v41, v39
v_cvt_pk_bf16_f32 v22, v60, v61
v_cvt_pk_bf16_f32 v23, v62, v63
v_cvt_pk_bf16_f32 v24, v72, v73
v_cvt_pk_bf16_f32 v25, v74, v75
v_cvt_pk_bf16_f32 v26, v32, v33
v_mov_b32_e64 v27, 0
v_cvt_pk_bf16_f32 v28, v64, v65
v_cvt_pk_bf16_f32 v29, v66, v67
v_cvt_pk_bf16_f32 v30, v76, v77
v_cvt_pk_bf16_f32 v31, v78, v79
v_cvt_pk_bf16_f32 v32, v36, v37
v_mov_b32_e64 v33, 0
v_cvt_pk_bf16_f32 v34, v68, v69
v_cvt_pk_bf16_f32 v35, v70, v71
v_cvt_pk_bf16_f32 v36, v80, v81
v_cvt_pk_bf16_f32 v37, v82, v83
v_cvt_pk_bf16_f32 v38, v40, v41
v_mov_b32_e64 v39, 0
v_cndmask_b32 v50, v50, 0, s[70:71]
v_cndmask_b32 v51, v51, 0, s[70:71]
s_waitcnt vmcnt(0)
v_cmp_eq_u32_e64 vcc, 0, v88
s_cbranch_vccz Lok14
s_mov_b32 s85, 40000
Lsp14:
buffer_load_dword v88, v84, s[40:43], s98 offen sc1
s_waitcnt vmcnt(0)
v_cmp_eq_u32 vcc, 0, v88
s_cbranch_vccz Lok14
s_sub_u32 s85, s85, 1
s_cmp_lg_u32 s85, 0
s_cbranch_scc1 Lsp14
Lok14:
v_cndmask_b32 v54, v54, 0, s[70:71]
v_cndmask_b32 v55, v55, 0, s[70:71]
v_cndmask_b32 v58, v58, 0, s[70:71]
v_cndmask_b32 v59, v59, 0, s[70:71]
v_mfma_f32_16x16x32_bf16 v[60:63], v[8:11], v[48:51], 0
v_mfma_f32_16x16x32_bf16 v[72:75], v[12:15], v[48:51], 0
buffer_load_dwordx4 v[96:99], v6, s[40:43], s91 offen offset:0 sc1
v_mfma_f32_16x16x32_bf16 v[64:67], v[8:11], v[52:55], 0
v_mfma_f32_16x16x32_bf16 v[76:79], v[12:15], v[52:55], 0
v_mfma_f32_16x16x32_bf16 v[68:71], v[8:11], v[56:59], 0
v_mfma_f32_16x16x32_bf16 v[80:83], v[12:15], v[56:59], 0
s_nop 1
v_max3_f32 v48, v60, v61, v62
s_nop 1
v_max3_f32 v52, v64, v65, v66
s_nop 0
v_max3_f32 v56, v68, v69, v70
v_max3_f32 v49, -v60, -v61, -v62
v_max3_f32 v53, -v64, -v65, -v66
v_max3_f32 v57, -v68, -v69, -v70
buffer_load_dwordx4 v[100:103], v6, s[40:43], s92 offen offset:0 sc1
v_max3_f32 v48, v48, v63, v72
v_max3_f32 v52, v52, v67, v76
v_max3_f32 v56, v56, v71, v80
v_max3_f32 v49, v49, -v63, -v72
v_max3_f32 v53, v53, -v67, -v76
v_max3_f32 v57, v57, -v71, -v80
v_permlane32_swap_b32 v48, v49
v_permlane32_swap_b32 v52, v53
v_permlane32_swap_b32 v56, v57
v_max_f32 v48, v48, v49
v_max_f32 v52, v52, v53
buffer_load_dwordx4 v[104:107], v6, s[40:43], s93 offen offset:0 sc1
v_max_f32 v56, v56, v57
v_mov_b32 v49, v48
v_mov_b32 v53, v52
v_mov_b32 v57, v56
v_permlane16_swap_b32 v48, v49
v_permlane16_swap_b32 v52, v53
v_permlane16_swap_b32 v56, v57
v_max_f32 v48, v48, v49
v_max_f32 v52, v52, v53
v_max_f32 v56, v56, v57
v_mov_b32_e64 v49, v48
buffer_load_dwordx4 v[108:111], v6, s[40:43], s94 offen offset:0 sc1
v_mov_b32 v53, v52
v_mov_b32 v57, v56
v_permlane32_swap_b32 v48, v49
v_permlane32_swap_b32 v52, v53
v_permlane32_swap_b32_e64 v56, v57
v_mul_f32 v48, 0xbfb8aa3b, v48
v_mul_f32 v49, 0xbfb8aa3b, v49
v_mul_f32 v52, 0xbfb8aa3b, v52
v_mul_f32 v53, 0xbfb8aa3b, v53
v_mul_f32 v56, 0xbfb8aa3b, v56
buffer_load_dwordx4 v[112:115], v6, s[40:43], s91 offen offset:1024 sc1
v_mul_f32 v57, 0xbfb8aa3b, v57
v_fma_f32 v73, -v60, s80, v49
v_fma_f32 v74, -v61, s80, v49
v_fma_f32 v75, -v62, s80, v49
v_fma_f32 v50, -v63, s80, v49
v_fma_f32 v51, -v72, s80, v49
v_fma_f32 v60, v60, s80, v48
v_fma_f32 v61, v61, s80, v48
v_fma_f32 v62, v62, s80, v48
v_fma_f32 v63, v63, s80, v48
v_fma_f32 v72, v72, s80, v48
buffer_load_dwordx4 v[116:119], v6, s[40:43], s92 offen offset:1024 sc1
v_fma_f32 v77, -v64, s80, v53
v_fma_f32 v78, -v65, s80, v53
v_fma_f32 v79, -v66, s80, v53
v_fma_f32 v54, -v67, s80, v53
v_fma_f32 v55, -v76, s80, v53
v_fma_f32 v64, v64, s80, v52
v_fma_f32 v65, v65, s80, v52
v_fma_f32 v66, v66, s80, v52
v_fma_f32 v67, v67, s80, v52
v_fma_f32 v76, v76, s80, v52
buffer_load_dwordx4 v[120:123], v6, s[40:43], s93 offen offset:1024 sc1
v_fma_f32 v81, -v68, s80, v57
v_fma_f32 v82, -v69, s80, v57
v_fma_f32 v83, -v70, s80, v57
v_fma_f32 v58, -v71, s80, v57
v_fma_f32 v59, -v80, s80, v57
v_fma_f32 v68, v68, s80, v56
v_fma_f32 v69, v69, s80, v56
v_fma_f32 v70, v70, s80, v56
v_fma_f32 v71, v71, s80, v56
v_fma_f32 v80, v80, s80, v56
v_exp_f32_e64 v60, v60
buffer_load_dwordx4 v[124:127], v6, s[40:43], s94 offen offset:1024 sc1
v_exp_f32 v61, v61
v_exp_f32 v62, v62
v_exp_f32 v63, v63
v_exp_f32 v72, v72
v_exp_f32 v73, v73
v_exp_f32 v74, v74
v_exp_f32 v75, v75
v_exp_f32 v50, v50
v_exp_f32 v51, v51
v_exp_f32 v64, v64
v_exp_f32_e64 v65, v65
buffer_load_dwordx4 v[128:131], v6, s[40:43], s91 offen offset:2048 sc1
v_exp_f32 v66, v66
v_exp_f32 v67, v67
v_exp_f32 v76, v76
v_exp_f32 v77, v77
v_exp_f32 v78, v78
v_exp_f32 v79, v79
v_exp_f32 v54, v54
v_exp_f32 v55, v55
v_exp_f32 v68, v68
v_exp_f32 v69, v69
buffer_load_dwordx4 v[132:135], v6, s[40:43], s92 offen offset:2048 sc1
v_exp_f32 v70, v70
v_exp_f32 v71, v71
v_exp_f32 v80, v80
v_exp_f32 v81, v81
v_exp_f32 v82, v82
v_exp_f32 v83, v83
v_exp_f32 v58, v58
v_exp_f32 v59, v59
v_add_f32 v48, v60, v61
v_add_f32 v49, v73, v74
v_add_f32_e64 v52, v64, v65
buffer_load_dwordx4 v[136:139], v6, s[40:43], s93 offen offset:2048 sc1
v_add_f32 v53, v77, v78
v_add_f32 v56, v68, v69
v_add_f32 v57, v81, v82
v_add_f32 v48, v48, v62
v_add_f32 v49, v49, v75
v_add_f32 v52, v52, v66
v_add_f32 v53, v53, v79
v_add_f32 v56, v56, v70
v_add_f32 v57, v57, v83
v_add_f32 v48, v48, v63
buffer_load_dwordx4 v[140:143], v6, s[40:43], s94 offen offset:2048 sc1
v_add_f32 v49, v49, v50
v_add_f32 v52, v52, v67
v_add_f32 v53, v53, v54
v_add_f32 v56, v56, v71
v_add_f32 v57, v57, v58
v_add_f32 v48, v48, v72
v_add_f32 v49, v49, v51
v_add_f32 v52, v52, v76
v_add_f32 v53, v53, v55
v_add_f32 v56, v56, v80
v_add_f32_e64 v57, v57, v59
buffer_load_dwordx4 v[144:147], v6, s[40:43], s91 offen offset:3072 sc1
v_permlane32_swap_b32 v48, v49
v_permlane32_swap_b32 v52, v53
v_permlane32_swap_b32 v56, v57
v_add_f32 v48, v48, v49
v_add_f32 v52, v52, v53
v_add_f32 v56, v56, v57
v_mov_b32 v49, v48
v_mov_b32 v53, v52
v_mov_b32 v57, v56
v_permlane16_swap_b32 v48, v49
v_permlane16_swap_b32_e64 v52, v53
buffer_load_dwordx4 v[148:151], v6, s[40:43], s92 offen offset:3072 sc1
v_permlane16_swap_b32 v56, v57
v_add_f32 v48, v48, v49
v_add_f32 v52, v52, v53
v_add_f32 v56, v56, v57
v_mov_b32 v49, v48
v_mov_b32 v53, v52
v_mov_b32 v57, v56
v_permlane32_swap_b32 v48, v49
v_permlane32_swap_b32 v52, v53
v_permlane32_swap_b32 v56, v57
buffer_load_dwordx4 v[152:155], v6, s[40:43], s93 offen offset:3072 sc1
v_rcp_f32 v48, v48
v_rcp_f32 v52, v52
v_rcp_f32 v56, v56
v_rcp_f32 v49, v49
v_rcp_f32 v53, v53
v_rcp_f32 v57, v57
v_mul_f32 v60, v60, v48
v_mul_f32 v61, v61, v48
v_mul_f32 v62, v62, v48
v_mul_f32 v63, v63, v48
v_mul_f32_e64 v72, v72, v48
buffer_load_dwordx4 v[156:159], v6, s[40:43], s94 offen offset:3072 sc1
v_mul_f32 v73, v73, v49
v_mul_f32 v74, v74, v49
v_mul_f32 v75, v75, v49
v_mul_f32 v50, v50, v49
v_mul_f32 v51, v51, v49
v_mul_f32 v64, v64, v52
v_mul_f32 v65, v65, v52
v_mul_f32 v66, v66, v52
v_mul_f32 v67, v67, v52
v_mul_f32 v76, v76, v52
buffer_load_dwordx4 v[160:163], v21, s[40:43], s91 offen offset:0 sc1
v_mul_f32 v77, v77, v53
v_mul_f32 v78, v78, v53
v_mul_f32 v79, v79, v53
v_mul_f32 v54, v54, v53
v_mul_f32 v55, v55, v53
v_mul_f32 v68, v68, v56
v_mul_f32 v69, v69, v56
v_mul_f32 v70, v70, v56
v_mul_f32 v71, v71, v56
v_mul_f32 v80, v80, v56
v_mul_f32_e64 v81, v81, v57
buffer_load_dwordx4 v[164:167], v21, s[40:43], s92 offen offset:0 sc1
v_mul_f32 v82, v82, v57
v_mul_f32 v83, v83, v57
v_mul_f32 v58, v58, v57
v_mul_f32 v59, v59, v57
v_cvt_pk_bf16_f32 v40, v60, v61
v_cvt_pk_bf16_f32 v41, v62, v63
v_cvt_pk_bf16_f32 v42, v72, v73
v_cvt_pk_bf16_f32 v43, v74, v75
v_cvt_pk_bf16_f32 v44, v50, v51
v_mov_b32_e64 v45, 0
v_cvt_pk_bf16_f32 v46, v64, v65
buffer_load_dwordx4 v[168:171], v21, s[40:43], s93 offen offset:0 sc1
v_cvt_pk_bf16_f32 v47, v66, v67
v_cvt_pk_bf16_f32 v48, v76, v77
v_cvt_pk_bf16_f32 v49, v78, v79
v_cvt_pk_bf16_f32 v50, v54, v55
v_mov_b32_e64 v51, 0
v_cvt_pk_bf16_f32 v52, v68, v69
v_cvt_pk_bf16_f32 v53, v70, v71
v_cvt_pk_bf16_f32 v54, v80, v81
v_cvt_pk_bf16_f32 v55, v82, v83
v_cvt_pk_bf16_f32 v56, v58, v59
buffer_load_dwordx4 v[172:175], v21, s[40:43], s94 offen offset:0 sc1
v_mov_b32 v57, 0
v_mov_b32 v58, 0
v_mov_b32_e64 v59, 0
s_waitcnt vmcnt(16)
v_mfma_f32_16x16x32_bf16 v[176:179], a[112:115], v[96:99], 0
v_mfma_f32_16x16x32_bf16 v[180:183], a[116:119], v[96:99], 0
v_mfma_f32_16x16x32_bf16 v[184:187], a[120:123], v[96:99], 0
v_mfma_f32_16x16x32_bf16 v[188:191], a[124:127], v[96:99], 0
s_add_u32 s64, s87, s3
s_add_u32 m0, s12, 147456
v_mfma_f32_16x16x32_bf16 v[192:195], a[128:131], v[96:99], 0
buffer_load_dwordx4 v21, s[40:43], s64 offen offset:0 sc1 lds
v_lshl_add_u32 v2, s56, 6, v1
v_mfma_f32_16x16x32_bf16 v[212:215], a[128:131], v[100:103], 0
v_min_u32 v2, 209, v2
v_lshlrev_b32_e64 v8, 4, v2
v_mul_u32_u24 v3, 3121, v2
v_mfma_f32_16x16x32_bf16 v[208:211], a[124:127], v[100:103], 0
v_lshrrev_b32 v3, 16, v3
v_mul_u32_u24 v5, 21, v3
v_sub_u32_e64 v2, v2, v5
v_mfma_f32_16x16x32_bf16 v[204:207], a[120:123], v[100:103], 0
v_mul_u32_u24 v2, 144, v2
v_add_u32 v2, 0, v2
v_mfma_f32_16x16x32_bf16 v[200:203], a[116:119], v[100:103], 0
buffer_load_dwordx4 v[96:99], v21, s[40:43], s91 offen offset:1024 sc1
v_mfma_f32_16x16x32_bf16 v[196:199], a[112:115], v[100:103], 0
s_add_u32 s64, s88, s3
s_add_u32 m0, s12, 151552
v_mfma_f32_16x16x32_bf16 v[216:219], a[112:115], v[104:107], 0
buffer_load_dwordx4 v21, s[40:43], s64 offen offset:0 sc1 lds
v_mfma_f32_16x16x32_bf16 v[220:223], a[116:119], v[104:107], 0
buffer_load_dwordx4 v[100:103], v21, s[40:43], s92 offen offset:1024 sc1
v_mfma_f32_16x16x32_bf16 v[224:227], a[120:123], v[104:107], 0
v_mfma_f32_16x16x32_bf16 v[228:231], a[124:127], v[104:107], 0
v_mfma_f32_16x16x32_bf16 v[232:235], a[128:131], v[104:107], 0
v_lshl_add_u32 v5, v3, 2, 0
v_mul_u32_u24 v4, 6554, v5
v_lshrrev_b32_e64 v4, 16, v4
v_mfma_f32_16x16x32_bf16 v[252:255], a[128:131], v[108:111], 0
v_mul_u32_u24_e64 v4, 12, v4
v_lshl_add_u32 v5, v5, 1, v4
v_add_u32_e64 v9, v2, v5
v_mfma_f32_16x16x32_bf16 v[248:251], a[124:127], v[108:111], 0
buffer_load_dwordx4 v[104:107], v21, s[40:43], s93 offen offset:1024 sc1
s_add_u32 s64, s89, s3
v_mfma_f32_16x16x32_bf16 v[244:247], a[120:123], v[108:111], 0
s_add_u32 m0, s12, 155648
v_mfma_f32_16x16x32_bf16 v[240:243], a[116:119], v[108:111], 0
buffer_load_dwordx4 v21, s[40:43], s64 offen offset:0 sc1 lds
v_mfma_f32_16x16x32_bf16 v[236:239], a[112:115], v[108:111], 0
buffer_load_dwordx4 v[108:111], v21, s[40:43], s94 offen offset:1024 sc1
s_waitcnt vmcnt(19)
v_mfma_f32_16x16x32_bf16 v[176:179], a[132:135], v[112:115], v[176:179]
v_mfma_f32_16x16x32_bf16 v[180:183], a[136:139], v[112:115], v[180:183]
v_mfma_f32_16x16x32_bf16 v[184:187], a[140:143], v[112:115], v[184:187]
v_lshl_add_u32 v5, v3, 2, 2
v_mul_u32_u24 v4, 6554, v5
v_mfma_f32_16x16x32_bf16 v[188:191], a[144:147], v[112:115], v[188:191]
v_lshrrev_b32 v4, 16, v4
v_mul_u32_u24 v4, 12, v4
v_mfma_f32_16x16x32_bf16 v[192:195], a[148:151], v[112:115], v[192:195]
v_lshl_add_u32 v5, v5, 1, v4
v_add_u32_e64 v10, v2, v5
v_mfma_f32_16x16x32_bf16 v[212:215], a[148:151], v[116:119], v[212:215]
buffer_load_dwordx4 v[112:115], v21, s[40:43], s91 offen offset:2048 sc1
v_mfma_f32_16x16x32_bf16 v[208:211], a[144:147], v[116:119], v[208:211]
v_mfma_f32_16x16x32_bf16 v[204:207], a[140:143], v[116:119], v[204:207]
s_and_b32 s64, s27, 1
s_lshl_b32 s65, s64, 2
v_mfma_f32_16x16x32_bf16 v[200:203], a[136:139], v[116:119], v[200:203]
s_lshl_b32 s66, s64, 4
s_sub_u32 s66, 16, s66
v_mfma_f32_16x16x32_bf16 v[196:199], a[132:135], v[116:119], v[196:199]
s_mul_i32 s67, s27, 20
v_mfma_f32_16x16x32_bf16 v[216:219], a[132:135], v[120:123], v[216:219]
buffer_load_dwordx4 v[116:119], v21, s[40:43], s92 offen offset:2048 sc1
v_mfma_f32_16x16x32_bf16 v[220:223], a[136:139], v[120:123], v[220:223]
v_mfma_f32_16x16x32_bf16 v[224:227], a[140:143], v[120:123], v[224:227]
v_lshrrev_b32 v2, 4, v1
v_bfe_u32 v3, v1, 2, 2
v_mfma_f32_16x16x32_bf16 v[228:231], a[144:147], v[120:123], v[228:231]
v_mfma_f32_16x16x32_bf16 v[232:235], a[148:151], v[120:123], v[232:235]
buffer_load_dwordx4 v[120:123], v21, s[40:43], s93 offen offset:2048 sc1
v_mfma_f32_16x16x32_bf16 v[252:255], a[148:151], v[124:127], v[252:255]
v_mfma_f32_16x16x32_bf16 v[248:251], a[144:147], v[124:127], v[248:251]
v_mfma_f32_16x16x32_bf16 v[244:247], a[140:143], v[124:127], v[244:247]
v_cmp_gt_u32_e64 vcc, 2, v3
v_lshl_add_u32 v5, v3, 3, s65
v_mfma_f32_16x16x32_bf16 v[240:243], a[136:139], v[124:127], v[240:243]
v_mov_b32_e64 v4, s66
v_cndmask_b32 v5, v4, v5, vcc
v_mfma_f32_16x16x32_bf16 v[236:239], a[132:135], v[124:127], v[236:239]
buffer_load_dwordx4 v[124:127], v21, s[40:43], s94 offen offset:2048 sc1
s_waitcnt vmcnt(19)
v_mfma_f32_16x16x32_bf16 v[176:179], a[152:155], v[128:131], v[176:179]
v_mfma_f32_16x16x32_bf16 v[180:183], a[156:159], v[128:131], v[180:183]
v_mfma_f32_16x16x32_bf16 v[184:187], a[160:163], v[128:131], v[184:187]
v_mfma_f32_16x16x32_bf16 v[188:191], a[164:167], v[128:131], v[188:191]
v_mfma_f32_16x16x32_bf16 v[192:195], a[168:171], v[128:131], v[192:195]
v_and_b32 v4, 3, v1
v_add_u32 v5, v5, v4
v_mfma_f32_16x16x32_bf16 v[212:215], a[168:171], v[132:135], v[212:215]
v_mul_u32_u24 v5, 144, v5
v_lshl_add_u32 v4, v2, 5, v5
v_mfma_f32_16x16x32_bf16 v[208:211], a[164:167], v[132:135], v[208:211]
v_add_u32_e64 v11, 0, v4
v_add_u32 v4, 576, v11
v_mfma_f32_16x16x32_bf16 v[204:207], a[160:163], v[132:135], v[204:207]
v_cndmask_b32 v12, v11, v4, vcc
v_lshlrev_b32 v4, 5, v2
v_mfma_f32_16x16x32_bf16 v[200:203], a[156:159], v[132:135], v[200:203]
v_add_u32 v13, 2880, v4
v_mfma_f32_16x16x32_bf16 v[196:199], a[152:155], v[132:135], v[196:199]
buffer_load_dwordx4 v[128:131], v21, s[40:43], s91 offen offset:3072 sc1
v_mfma_f32_16x16x32_bf16 v[216:219], a[152:155], v[136:139], v[216:219]
buffer_load_dwordx4 v[132:135], v21, s[40:43], s92 offen offset:3072 sc1
v_mfma_f32_16x16x32_bf16 v[220:223], a[156:159], v[136:139], v[220:223]
v_mfma_f32_16x16x32_bf16 v[224:227], a[160:163], v[136:139], v[224:227]
v_mfma_f32_16x16x32_bf16 v[228:231], a[164:167], v[136:139], v[228:231]
v_mfma_f32_16x16x32_bf16 v[232:235], a[168:171], v[136:139], v[232:235]
v_cmp_gt_u32_e64 vcc, 2, v2
v_lshl_add_u32 v5, v2, 3, s65
v_mfma_f32_16x16x32_bf16 v[252:255], a[168:171], v[140:143], v[252:255]
v_mov_b32 v4, s66
v_cndmask_b32 v5, v4, v5, vcc
v_mfma_f32_16x16x32_bf16 v[248:251], a[164:167], v[140:143], v[248:251]
buffer_load_dwordx4 v[136:139], v21, s[40:43], s93 offen offset:3072 sc1
v_mfma_f32_16x16x32_bf16 v[244:247], a[160:163], v[140:143], v[244:247]
v_mfma_f32_16x16x32_bf16 v[240:243], a[156:159], v[140:143], v[240:243]
v_mfma_f32_16x16x32_bf16 v[236:239], a[152:155], v[140:143], v[236:239]
buffer_load_dwordx4 v[140:143], v21, s[40:43], s94 offen offset:3072 sc1
s_waitcnt vmcnt(19)
v_mfma_f32_16x16x32_bf16 v[176:179], a[172:175], v[144:147], v[176:179]
v_mfma_f32_16x16x32_bf16 v[180:183], a[176:179], v[144:147], v[180:183]
v_mfma_f32_16x16x32_bf16 v[184:187], a[180:183], v[144:147], v[184:187]
v_mfma_f32_16x16x32_bf16 v[188:191], a[184:187], v[144:147], v[188:191]
v_mfma_f32_16x16x32_bf16 v[192:195], a[188:191], v[144:147], v[192:195]
v_add_u32 v5, s67, v5
v_lshrrev_b32 v4, 5, v5
v_lshlrev_b32 v4, 10, v4
v_mfma_f32_16x16x32_bf16 v[212:215], a[188:191], v[148:151], v[212:215]
v_bfe_u32 v3, v5, 3, 2
v_lshl_add_u32 v4, v3, 8, v4
v_bfe_u32 v3, v5, 2, 1
v_mfma_f32_16x16x32_bf16 v[208:211], a[184:187], v[148:151], v[208:211]
v_lshl_add_u32 v4, v3, 3, v4
v_and_b32_e64 v3, 15, v1
v_lshl_add_u32 v4, v3, 4, v4
v_mfma_f32_16x16x32_bf16 v[204:207], a[180:183], v[148:151], v[204:207]
v_mov_b32 v3, 0x7f000000
v_cndmask_b32 v92, v3, v4, vcc
v_cmp_eq_u32 vcc, 2, v2
v_mfma_f32_16x16x32_bf16 v[200:203], a[176:179], v[148:151], v[200:203]
s_nop 0
v_cndmask_b32 v93, v3, v4, vcc
v_mfma_f32_16x16x32_bf16 v[196:199], a[172:175], v[148:151], v[196:199]
buffer_load_dwordx4 v[144:147], v0, s[40:43], s91 offen offset:0 sc1
v_mfma_f32_16x16x32_bf16 v[216:219], a[172:175], v[152:155], v[216:219]
buffer_load_dwordx4 v[148:151], v0, s[40:43], s92 offen offset:0 sc1
v_mfma_f32_16x16x32_bf16 v[220:223], a[176:179], v[152:155], v[220:223]
v_mfma_f32_16x16x32_bf16 v[224:227], a[180:183], v[152:155], v[224:227]
v_mfma_f32_16x16x32_bf16 v[228:231], a[184:187], v[152:155], v[228:231]
v_mfma_f32_16x16x32_bf16 v[232:235], a[188:191], v[152:155], v[232:235]
s_mul_i32 s64, s27, 27648
s_add_u32 s73, s64, 15728640
s_mul_i32 s74, s26, 69632
v_mfma_f32_16x16x32_bf16 v[252:255], a[188:191], v[156:159], v[252:255]
s_add_u32 s74, s74, 49152
s_mul_i32 s64, s26, 171
s_lshr_b32 s64, s64, 10
v_mfma_f32_16x16x32_bf16 v[248:251], a[184:187], v[156:159], v[248:251]
s_lshl_b32 s64, s64, 5
s_add_u32 s64, s64, s27
s_lshl_b32 s64, s64, 7
v_mfma_f32_16x16x32_bf16 v[244:247], a[180:183], v[156:159], v[244:247]
s_add_u32 s75, s64, 17248256
buffer_load_dwordx4 v[152:155], v0, s[40:43], s93 offen offset:0 sc1
v_mfma_f32_16x16x32_bf16 v[240:243], a[176:179], v[156:159], v[240:243]
v_mfma_f32_16x16x32_bf16 v[236:239], a[172:175], v[156:159], v[236:239]
buffer_load_dwordx4 v[156:159], v0, s[40:43], s94 offen offset:0 sc1
s_waitcnt lgkmcnt(0)
s_barrier
s_add_u32 s64, s73, 0
buffer_load_dwordx4 v[60:63], v8, s[40:43], s64 offen offset:0 sc1
buffer_load_dwordx4 v[64:67], v8, s[40:43], s64 offen offset:3456 sc1
s_add_u32 s64, s73, 6912
buffer_load_dwordx4 v[68:71], v8, s[40:43], s64 offen offset:0 sc1
buffer_load_dwordx4 v[72:75], v8, s[40:43], s64 offen offset:3456 sc1
s_add_u32 s64, s73, 13824
buffer_load_dwordx4 v[76:79], v8, s[40:43], s64 offen offset:0 sc1
buffer_load_dwordx4 v[80:83], v8, s[40:43], s64 offen offset:3456 sc1
s_add_u32 s64, s73, 20736
buffer_load_dwordx4 v[84:87], v8, s[40:43], s64 offen offset:0 sc1
buffer_load_dwordx4 v[88:91], v8, s[40:43], s64 offen offset:3456 sc1
s_waitcnt vmcnt(27)
v_mfma_f32_16x16x32_bf16 v[176:179], a[192:195], v[160:163], v[176:179]
v_mfma_f32_16x16x32_bf16 v[180:183], a[0:3], v[160:163], v[180:183]
v_mfma_f32_16x16x32_bf16 v[184:187], a[4:7], v[160:163], v[184:187]
v_mfma_f32_16x16x32_bf16 v[188:191], a[8:11], v[160:163], v[188:191]
v_mfma_f32_16x16x32_bf16 v[192:195], a[12:15], v[160:163], v[192:195]
buffer_load_dwordx4 v[160:163], v0, s[40:43], s91 offen offset:1024 sc1
v_mfma_f32_16x16x32_bf16 v[212:215], a[12:15], v[164:167], v[212:215]
v_mfma_f32_16x16x32_bf16 v[208:211], a[8:11], v[164:167], v[208:211]
v_mfma_f32_16x16x32_bf16 v[204:207], a[4:7], v[164:167], v[204:207]
v_mfma_f32_16x16x32_bf16 v[200:203], a[0:3], v[164:167], v[200:203]
v_mfma_f32_16x16x32_bf16 v[196:199], a[192:195], v[164:167], v[196:199]
buffer_load_dwordx4 v[164:167], v0, s[40:43], s92 offen offset:1024 sc1
v_mfma_f32_16x16x32_bf16 v[216:219], a[192:195], v[168:171], v[216:219]
v_mfma_f32_16x16x32_bf16 v[220:223], a[0:3], v[168:171], v[220:223]
v_mfma_f32_16x16x32_bf16 v[224:227], a[4:7], v[168:171], v[224:227]
v_mfma_f32_16x16x32_bf16 v[228:231], a[8:11], v[168:171], v[228:231]
v_mfma_f32_16x16x32_bf16 v[232:235], a[12:15], v[168:171], v[232:235]
buffer_load_dwordx4 v[168:171], v0, s[40:43], s93 offen offset:1024 sc1
v_mfma_f32_16x16x32_bf16 v[252:255], a[12:15], v[172:175], v[252:255]
v_mfma_f32_16x16x32_bf16 v[248:251], a[8:11], v[172:175], v[248:251]
v_mfma_f32_16x16x32_bf16 v[244:247], a[4:7], v[172:175], v[244:247]
v_mfma_f32_16x16x32_bf16 v[240:243], a[0:3], v[172:175], v[240:243]
v_mfma_f32_16x16x32_bf16 v[236:239], a[192:195], v[172:175], v[236:239]
buffer_load_dwordx4 v[172:175], v0, s[40:43], s94 offen offset:1024 sc1
s_waitcnt vmcnt(4)
v_max3_u32 v20, v60, v64, v68
v_max3_u32 v20, v20, v72, v76
v_max3_u32 v20, v20, v80, v84
v_max_u32 v20, v20, v88
v_cmp_eq_u32 vcc, -1, v20
s_cbranch_vccz Lok15
s_mov_b32 s85, 40000
Lsp15:
s_sleep 4
s_add_u32 s64, s73, 0
buffer_load_dwordx4 v[60:63], v8, s[40:43], s64 offen offset:0 sc1
buffer_load_dwordx4 v[64:67], v8, s[40:43], s64 offen offset:3456 sc1
s_add_u32 s64, s73, 6912
buffer_load_dwordx4 v[68:71], v8, s[40:43], s64 offen offset:0 sc1
buffer_load_dwordx4 v[72:75], v8, s[40:43], s64 offen offset:3456 sc1
s_add_u32 s64, s73, 13824
buffer_load_dwordx4 v[76:79], v8, s[40:43], s64 offen offset:0 sc1
buffer_load_dwordx4 v[80:83], v8, s[40:43], s64 offen offset:3456 sc1
s_add_u32 s64, s73, 20736
buffer_load_dwordx4 v[84:87], v8, s[40:43], s64 offen offset:0 sc1
buffer_load_dwordx4 v[88:91], v8, s[40:43], s64 offen offset:3456 sc1
s_waitcnt vmcnt(0)
v_max3_u32 v20, v60, v64, v68
v_max3_u32 v20, v20, v72, v76
v_max3_u32 v20, v20, v80, v84
v_max_u32 v20, v20, v88
v_cmp_eq_u32_e64 vcc, -1, v20
s_cbranch_vccz Lok15
s_sub_u32 s85, s85, 1
s_cmp_lg_u32 s85, 0
s_cbranch_scc1 Lsp15
Lok15:
v_pk_add_f32 v[60:61], v[60:61], v[76:77]
v_pk_add_f32 v[62:63], v[62:63], v[78:79]
v_pk_add_f32 v[64:65], v[64:65], v[80:81]
v_pk_add_f32 v[66:67], v[66:67], v[82:83]
v_pk_add_f32 v[68:69], v[68:69], v[84:85]
v_pk_add_f32 v[70:71], v[70:71], v[86:87]
v_pk_add_f32 v[72:73], v[72:73], v[88:89]
v_pk_add_f32 v[74:75], v[74:75], v[90:91]
v_pk_add_f32 v[60:61], v[60:61], v[68:69]
v_pk_add_f32 v[62:63], v[62:63], v[70:71]
v_pk_add_f32 v[64:65], v[64:65], v[72:73]
v_pk_add_f32 v[66:67], v[66:67], v[74:75]
v_pk_add_f32 v[60:61], v[60:61], v[64:65]
v_pk_add_f32 v[62:63], v[62:63], v[66:67]
v_cvt_pk_bf16_f32 v2, v60, v61
v_cvt_pk_bf16_f32 v3, v62, v63
ds_write_b32 v9, v2
ds_write_b32 v10, v3
s_waitcnt lgkmcnt(0)
s_barrier
ds_read_b128 v[76:79], v13 offset:0
ds_read_b128 v[80:83], v13 offset:16
ds_read_b128 v[60:63], v11 offset:0
ds_read_b128 v[64:67], v11 offset:16
ds_read_b128 v[68:71], v12 offset:0
ds_read_b128 v[72:75], v12 offset:16
s_waitcnt lgkmcnt(0)
v_mfma_f32_16x16x32_bf16 v[2:5], v[76:79], v[22:25], 0
v_mfma_f32_16x16x32_bf16 v[84:87], v[60:63], v[22:25], 0
v_mfma_f32_16x16x32_bf16 v[88:91], v[68:71], v[22:25], 0
v_mfma_f32_16x16x32_bf16 v[2:5], v[80:83], v[26:29], v[2:5]
v_mfma_f32_16x16x32_bf16 v[84:87], v[64:67], v[26:29], v[84:87]
v_mfma_f32_16x16x32_bf16 v[88:91], v[72:75], v[26:29], v[88:91]
v_mfma_f32_16x16x32_bf16 v[16:19], v[76:79], v[28:31], 0
s_nop 4
v_add_f32 v2, 0x358637bd, v2
v_rcp_f32_e64 v2, v2
v_mfma_f32_16x16x32_bf16 v[8:11], v[60:63], v[28:31], 0
s_cmp_lt_u32 s74, 8912896
s_cselect_b32 s64, s74, s42
v_mul_f32 v84, v84, v2
v_mfma_f32_16x16x32_bf16 v[12:15], v[68:71], v[28:31], 0
v_mul_f32 v85, v85, v2
v_mul_f32 v86, v86, v2
v_mul_f32 v87, v87, v2
v_mul_f32 v88, v88, v2
v_mfma_f32_16x16x32_bf16 v[16:19], v[80:83], v[32:35], v[16:19]
v_mul_f32 v89, v89, v2
v_mul_f32 v90, v90, v2
v_mul_f32_e64 v91, v91, v2
v_mfma_f32_16x16x32_bf16 v[8:11], v[64:67], v[32:35], v[8:11]
v_cvt_pk_bf16_f32 v2, v84, v85
v_cvt_pk_bf16_f32 v3, v86, v87
v_cvt_pk_bf16_f32 v4, v88, v89
v_cvt_pk_bf16_f32 v5, v90, v91
v_mfma_f32_16x16x32_bf16 v[12:15], v[72:75], v[32:35], v[12:15]
buffer_store_dwordx4 v[2:5], v92, s[40:43], s64 offen sc1
buffer_store_dwordx2 v[2:3], v93, s[40:43], s64 offen sc1
s_add_u32 s74, s74, 69632
v_mfma_f32_16x16x32_bf16 v[2:5], v[76:79], v[34:37], 0
v_add_f32 v16, 0x358637bd, v16
v_rcp_f32_e64 v16, v16
v_mfma_f32_16x16x32_bf16 v[84:87], v[60:63], v[34:37], 0
s_cmp_lt_u32 s74, 8912896
s_cselect_b32 s64, s74, s42
v_mul_f32 v8, v8, v16
v_mfma_f32_16x16x32_bf16 v[88:91], v[68:71], v[34:37], 0
v_mul_f32 v9, v9, v16
v_mul_f32 v10, v10, v16
v_mul_f32 v11, v11, v16
v_mul_f32 v12, v12, v16
v_mfma_f32_16x16x32_bf16 v[2:5], v[80:83], v[38:41], v[2:5]
v_mul_f32 v13, v13, v16
v_mul_f32 v14, v14, v16
v_mul_f32_e64 v15, v15, v16
v_mfma_f32_16x16x32_bf16 v[84:87], v[64:67], v[38:41], v[84:87]
v_cvt_pk_bf16_f32 v16, v8, v9
v_cvt_pk_bf16_f32 v17, v10, v11
v_cvt_pk_bf16_f32 v18, v12, v13
v_cvt_pk_bf16_f32 v19, v14, v15
v_mfma_f32_16x16x32_bf16 v[88:91], v[72:75], v[38:41], v[88:91]
buffer_store_dwordx4 v[16:19], v92, s[40:43], s64 offen sc1
buffer_store_dwordx2 v[16:17], v93, s[40:43], s64 offen sc1
s_add_u32 s74, s74, 69632
v_mfma_f32_16x16x32_bf16 v[16:19], v[76:79], v[40:43], 0
v_add_f32 v2, 0x358637bd, v2
v_rcp_f32_e64 v2, v2
v_mfma_f32_16x16x32_bf16 v[8:11], v[60:63], v[40:43], 0
s_cmp_lt_u32 s74, 8912896
s_cselect_b32 s64, s74, s42
v_mul_f32 v84, v84, v2
v_mfma_f32_16x16x32_bf16 v[12:15], v[68:71], v[40:43], 0
v_mul_f32 v85, v85, v2
v_mul_f32 v86, v86, v2
v_mul_f32 v87, v87, v2
v_mul_f32 v88, v88, v2
v_mfma_f32_16x16x32_bf16 v[16:19], v[80:83], v[44:47], v[16:19]
v_mul_f32 v89, v89, v2
v_mul_f32 v90, v90, v2
v_mul_f32_e64 v91, v91, v2
v_mfma_f32_16x16x32_bf16 v[8:11], v[64:67], v[44:47], v[8:11]
v_cvt_pk_bf16_f32 v2, v84, v85
v_cvt_pk_bf16_f32 v3, v86, v87
v_cvt_pk_bf16_f32 v4, v88, v89
v_cvt_pk_bf16_f32 v5, v90, v91
v_mfma_f32_16x16x32_bf16 v[12:15], v[72:75], v[44:47], v[12:15]
buffer_store_dwordx4 v[2:5], v92, s[40:43], s64 offen sc1
buffer_store_dwordx2 v[2:3], v93, s[40:43], s64 offen sc1
s_add_u32 s74, s74, 69632
v_mfma_f32_16x16x32_bf16 v[2:5], v[76:79], v[46:49], 0
v_add_f32 v16, 0x358637bd, v16
v_rcp_f32_e64 v16, v16
v_mfma_f32_16x16x32_bf16 v[84:87], v[60:63], v[46:49], 0
s_cmp_lt_u32 s74, 8912896
s_cselect_b32 s64, s74, s42
v_mul_f32 v8, v8, v16
v_mfma_f32_16x16x32_bf16 v[88:91], v[68:71], v[46:49], 0
v_mul_f32 v9, v9, v16
v_mul_f32 v10, v10, v16
v_mul_f32 v11, v11, v16
v_mul_f32 v12, v12, v16
v_mfma_f32_16x16x32_bf16 v[2:5], v[80:83], v[50:53], v[2:5]
v_mul_f32 v13, v13, v16
v_mul_f32 v14, v14, v16
v_mul_f32_e64 v15, v15, v16
v_mfma_f32_16x16x32_bf16 v[84:87], v[64:67], v[50:53], v[84:87]
v_cvt_pk_bf16_f32 v16, v8, v9
v_cvt_pk_bf16_f32 v17, v10, v11
v_cvt_pk_bf16_f32 v18, v12, v13
v_cvt_pk_bf16_f32 v19, v14, v15
v_mfma_f32_16x16x32_bf16 v[88:91], v[72:75], v[50:53], v[88:91]
buffer_store_dwordx4 v[16:19], v92, s[40:43], s64 offen sc1
buffer_store_dwordx2 v[16:17], v93, s[40:43], s64 offen sc1
s_add_u32 s74, s74, 69632
v_mfma_f32_16x16x32_bf16 v[16:19], v[76:79], v[52:55], 0
v_add_f32 v2, 0x358637bd, v2
v_rcp_f32_e64 v2, v2
v_mfma_f32_16x16x32_bf16 v[8:11], v[60:63], v[52:55], 0
s_cmp_lt_u32 s74, 8912896
s_cselect_b32 s64, s74, s42
v_mul_f32 v84, v84, v2
v_mfma_f32_16x16x32_bf16 v[12:15], v[68:71], v[52:55], 0
v_mul_f32 v85, v85, v2
v_mul_f32 v86, v86, v2
v_mul_f32 v87, v87, v2
v_mul_f32 v88, v88, v2
v_mfma_f32_16x16x32_bf16 v[16:19], v[80:83], v[56:59], v[16:19]
v_mul_f32 v89, v89, v2
v_mul_f32 v90, v90, v2
v_mul_f32_e64 v91, v91, v2
v_mfma_f32_16x16x32_bf16 v[8:11], v[64:67], v[56:59], v[8:11]
v_cvt_pk_bf16_f32 v2, v84, v85
v_cvt_pk_bf16_f32 v3, v86, v87
v_cvt_pk_bf16_f32 v4, v88, v89
v_cvt_pk_bf16_f32 v5, v90, v91
v_mfma_f32_16x16x32_bf16 v[12:15], v[72:75], v[56:59], v[12:15]
buffer_store_dwordx4 v[2:5], v92, s[40:43], s64 offen sc1
buffer_store_dwordx2 v[2:3], v93, s[40:43], s64 offen sc1
s_add_u32 s74, s74, 69632
v_add_f32 v16, 0x358637bd, v16
v_rcp_f32_e64 v16, v16
s_cmp_lt_u32 s74, 8912896
s_cselect_b32 s64, s74, s42
v_mul_f32 v8, v8, v16
v_mul_f32 v9, v9, v16
v_mul_f32 v10, v10, v16
v_mul_f32 v11, v11, v16
v_mul_f32 v12, v12, v16
v_mul_f32 v13, v13, v16
v_mul_f32 v14, v14, v16
v_mul_f32_e64 v15, v15, v16
v_cvt_pk_bf16_f32 v16, v8, v9
v_cvt_pk_bf16_f32 v17, v10, v11
v_cvt_pk_bf16_f32 v18, v12, v13
v_cvt_pk_bf16_f32 v19, v14, v15
buffer_store_dwordx4 v[16:19], v92, s[40:43], s64 offen sc1
buffer_store_dwordx2 v[16:17], v93, s[40:43], s64 offen sc1
s_add_u32 s74, s74, 69632
s_waitcnt vmcnt(36)
v_mfma_f32_16x16x32_bf16 v[176:179], a[16:19], v[96:99], v[176:179]
s_add_u32 s64, s56, 1
s_and_b32 s64, s64, 3
s_mul_i32 s64, s64, 15360
v_add_u32 v48, s64, v6
v_mfma_f32_16x16x32_bf16 v[180:183], a[20:23], v[96:99], v[180:183]
s_add_u32 s64, s56, 2
s_and_b32 s64, s64, 3
s_mul_i32 s64, s64, 15360
v_add_u32_e64 v49, s64, v6
v_mfma_f32_16x16x32_bf16 v[184:187], a[24:27], v[96:99], v[184:187]
s_add_u32 s64, s56, 3
s_and_b32 s64, s64, 3
s_mul_i32 s64, s64, 15360
v_add_u32_e64 v50, s64, v6
v_mfma_f32_16x16x32_bf16 v[188:191], a[28:31], v[96:99], v[188:191]
s_mul_i32 s65, s56, 15360
v_add_u32 v51, s65, v6
v_and_b32 v2, 15, v1
v_mul_u32_u24 v2, 336, v2
v_and_b32_e64 v3, 48, v1
v_add3_u32 v52, v2, v3, s65
v_mfma_f32_16x16x32_bf16 v[192:195], a[32:35], v[96:99], v[192:195]
v_add_u32 v20, 61440, v6
v_add_u32 v94, 0x10000, v20
buffer_load_dwordx4 v[96:99], v0, s[40:43], s91 offen offset:2048 sc1
v_mfma_f32_16x16x32_bf16 v[212:215], a[32:35], v[100:103], v[212:215]
v_add_u32_e64 v2, 0, v1
v_mul_u32_u24 v3, 6554, v2
v_lshrrev_b32 v3, 16, v3
v_mul_u32_u24 v18, 10, v3
v_sub_u32_e64 v2, v2, v18
v_mfma_f32_16x16x32_bf16 v[208:211], a[28:31], v[100:103], v[208:211]
v_mul_u32_u24 v18, 1280, v3
v_lshl_add_u32 v53, v2, 4, v18
v_mul_u32_u24 v3, 336, v3
v_lshrrev_b32_e64 v18, 1, v2
v_mfma_f32_16x16x32_bf16 v[204:207], a[24:27], v[100:103], v[204:207]
v_lshl_add_u32 v3, v18, 6, v3
v_and_b32_e64 v2, 1, v2
v_lshl_add_u32 v3, v2, 3, v3
v_add_u32_e64 v68, s65, v3
v_mfma_f32_16x16x32_bf16 v[200:203], a[20:23], v[100:103], v[200:203]
v_add_u32_e64 v2, 64, v1
v_mul_u32_u24 v3, 6554, v2
v_lshrrev_b32 v3, 16, v3
v_mul_u32_u24 v18, 10, v3
v_sub_u32_e64 v2, v2, v18
v_mfma_f32_16x16x32_bf16 v[196:199], a[16:19], v[100:103], v[196:199]
v_mul_u32_u24 v18, 1280, v3
v_lshl_add_u32 v54, v2, 4, v18
v_mul_u32_u24 v3, 336, v3
v_lshrrev_b32 v18, 1, v2
s_add_u32 s64, s90, s3
s_add_u32 m0, s12, 159744
v_mfma_f32_16x16x32_bf16 v[216:219], a[16:19], v[104:107], v[216:219]
buffer_load_dwordx4 v21, s[40:43], s64 offen offset:0 sc1 lds
buffer_load_dwordx4 v[100:103], v0, s[40:43], s92 offen offset:2048 sc1
v_lshl_add_u32 v3, v18, 6, v3
v_and_b32_e64 v2, 1, v2
v_mfma_f32_16x16x32_bf16 v[220:223], a[20:23], v[104:107], v[220:223]
v_lshl_add_u32 v3, v2, 3, v3
v_add_u32_e64 v69, s65, v3
v_add_u32 v2, 128, v1
v_mul_u32_u24 v3, 6554, v2
v_lshrrev_b32 v3, 16, v3
v_mul_u32_u24 v18, 10, v3
v_mfma_f32_16x16x32_bf16 v[224:227], a[24:27], v[104:107], v[224:227]
v_sub_u32_e64 v2, v2, v18
v_mul_u32_u24 v18, 1280, v3
v_lshl_add_u32 v55, v2, 4, v18
v_mul_u32_u24 v3, 336, v3
v_lshrrev_b32_e64 v18, 1, v2
v_mfma_f32_16x16x32_bf16 v[228:231], a[28:31], v[104:107], v[228:231]
v_lshl_add_u32 v3, v18, 6, v3
v_and_b32_e64 v2, 1, v2
v_lshl_add_u32 v3, v2, 3, v3
v_add_u32_e64 v70, s65, v3
v_mfma_f32_16x16x32_bf16 v[232:235], a[32:35], v[104:107], v[232:235]
buffer_load_dwordx4 v[104:107], v0, s[40:43], s93 offen offset:2048 sc1
v_mfma_f32_16x16x32_bf16 v[252:255], a[32:35], v[108:111], v[252:255]
v_mov_b32 v3, 0x7f000000
v_cmp_gt_u32 vcc, 32, v1
s_lshl_b32 s76, s95, 2
s_add_u32 s76, s76, s56
v_cndmask_b32 v55, v3, v55, vcc
s_mul_i32 s76, s76, 20480
v_mfma_f32_16x16x32_bf16 v[248:251], a[28:31], v[108:111], v[248:251]
s_mul_i32 s77, s96, 160
s_add_u32 s76, s76, s77
v_and_b32 v93, 31, v1
v_lshlrev_b32 v93, 7, v93
s_lshl_b32 s64, s95, 2
s_add_u32 s64, s64, s56
v_mfma_f32_16x16x32_bf16 v[244:247], a[24:27], v[108:111], v[244:247]
s_mul_i32 s64, s64, 171
s_lshr_b32 s64, s64, 10
s_lshl_b32 s64, s64, 12
s_add_u32 s79, s64, 17248256
s_mov_b32 s28, s4
s_mov_b32 s29, s5
v_mfma_f32_16x16x32_bf16 v[240:243], a[20:23], v[108:111], v[240:243]
s_mov_b32 s30, 2621440
s_mov_b32 s31, 0x20000
s_mov_b32 s44, s20
s_mov_b32 s45, s21
s_mov_b32 s46, 2621440
s_mov_b32 s47, 0x20000
v_mfma_f32_16x16x32_bf16 v[236:239], a[16:19], v[108:111], v[236:239]
buffer_load_dwordx4 v[108:111], v0, s[40:43], s94 offen offset:2048 sc1
s_waitcnt vmcnt(37)
v_mfma_f32_16x16x32_bf16 v[176:179], a[36:39], v[112:115], v[176:179]
v_mfma_f32_16x16x32_bf16 v[180:183], a[40:43], v[112:115], v[180:183]
buffer_load_dwordx4 v[56:59], v53, s[28:31], s76 offen
v_mfma_f32_16x16x32_bf16 v[184:187], a[44:47], v[112:115], v[184:187]
v_mfma_f32_16x16x32_bf16 v[188:191], a[48:51], v[112:115], v[188:191]
v_mfma_f32_16x16x32_bf16 v[192:195], a[52:55], v[112:115], v[192:195]
buffer_load_dwordx4 v[60:63], v54, s[28:31], s76 offen
v_mfma_f32_16x16x32_bf16 v[212:215], a[52:55], v[116:119], v[212:215]
buffer_load_dwordx4 v[112:115], v0, s[40:43], s91 offen offset:3072 sc1
v_mfma_f32_16x16x32_bf16 v[208:211], a[48:51], v[116:119], v[208:211]
v_mfma_f32_16x16x32_bf16 v[204:207], a[44:47], v[116:119], v[204:207]
v_mfma_f32_16x16x32_bf16 v[200:203], a[40:43], v[116:119], v[200:203]
buffer_load_dwordx4 v[64:67], v55, s[28:31], s76 offen
v_mfma_f32_16x16x32_bf16 v[196:199], a[36:39], v[116:119], v[196:199]
buffer_load_dwordx4 v[116:119], v0, s[40:43], s92 offen offset:3072 sc1
v_mfma_f32_16x16x32_bf16 v[216:219], a[36:39], v[120:123], v[216:219]
v_mfma_f32_16x16x32_bf16 v[220:223], a[40:43], v[120:123], v[220:223]
v_mfma_f32_16x16x32_bf16 v[224:227], a[44:47], v[120:123], v[224:227]
v_mfma_f32_16x16x32_bf16 v[228:231], a[48:51], v[120:123], v[228:231]
v_mfma_f32_16x16x32_bf16 v[232:235], a[52:55], v[120:123], v[232:235]
buffer_load_dwordx4 v[120:123], v0, s[40:43], s93 offen offset:3072 sc1
v_mfma_f32_16x16x32_bf16 v[252:255], a[52:55], v[124:127], v[252:255]
v_mfma_f32_16x16x32_bf16 v[248:251], a[48:51], v[124:127], v[248:251]
v_mfma_f32_16x16x32_bf16 v[244:247], a[44:47], v[124:127], v[244:247]
v_mfma_f32_16x16x32_bf16 v[240:243], a[40:43], v[124:127], v[240:243]
v_mfma_f32_16x16x32_bf16 v[236:239], a[36:39], v[124:127], v[236:239]
buffer_load_dwordx4 v[124:127], v0, s[40:43], s94 offen offset:3072 sc1
s_waitcnt vmcnt(12)
buffer_store_dword v21, v7, s[40:43], s75 offen sc1
s_waitcnt vmcnt(40)
v_mfma_f32_16x16x32_bf16 v[176:179], a[56:59], v[128:131], v[176:179]
v_mfma_f32_16x16x32_bf16 v[180:183], a[60:63], v[128:131], v[180:183]
v_mfma_f32_16x16x32_bf16 v[184:187], a[64:67], v[128:131], v[184:187]
v_mfma_f32_16x16x32_bf16 v[188:191], a[68:71], v[128:131], v[188:191]
v_mfma_f32_16x16x32_bf16 v[192:195], a[72:75], v[128:131], v[192:195]
v_mfma_f32_16x16x32_bf16 v[212:215], a[72:75], v[132:135], v[212:215]
v_mfma_f32_16x16x32_bf16 v[208:211], a[68:71], v[132:135], v[208:211]
v_mfma_f32_16x16x32_bf16 v[204:207], a[64:67], v[132:135], v[204:207]
v_mfma_f32_16x16x32_bf16 v[200:203], a[60:63], v[132:135], v[200:203]
v_mfma_f32_16x16x32_bf16 v[196:199], a[56:59], v[132:135], v[196:199]
v_mfma_f32_16x16x32_bf16 v[216:219], a[56:59], v[136:139], v[216:219]
v_mfma_f32_16x16x32_bf16 v[220:223], a[60:63], v[136:139], v[220:223]
v_mfma_f32_16x16x32_bf16 v[224:227], a[64:67], v[136:139], v[224:227]
v_mfma_f32_16x16x32_bf16 v[228:231], a[68:71], v[136:139], v[228:231]
v_mfma_f32_16x16x32_bf16 v[232:235], a[72:75], v[136:139], v[232:235]
v_mfma_f32_16x16x32_bf16 v[252:255], a[72:75], v[140:143], v[252:255]
v_mfma_f32_16x16x32_bf16 v[248:251], a[68:71], v[140:143], v[248:251]
v_mfma_f32_16x16x32_bf16 v[244:247], a[64:67], v[140:143], v[244:247]
v_mfma_f32_16x16x32_bf16 v[240:243], a[60:63], v[140:143], v[240:243]
v_mfma_f32_16x16x32_bf16 v[236:239], a[56:59], v[140:143], v[236:239]
s_waitcnt vmcnt(36)
v_mfma_f32_16x16x32_bf16 v[176:179], a[76:79], v[144:147], v[176:179]
v_mfma_f32_16x16x32_bf16 v[180:183], a[80:83], v[144:147], v[180:183]
v_mfma_f32_16x16x32_bf16 v[184:187], a[84:87], v[144:147], v[184:187]
v_mfma_f32_16x16x32_bf16 v[188:191], a[88:91], v[144:147], v[188:191]
v_mfma_f32_16x16x32_bf16 v[192:195], a[92:95], v[144:147], v[192:195]
v_mfma_f32_16x16x32_bf16 v[212:215], a[92:95], v[148:151], v[212:215]
v_mfma_f32_16x16x32_bf16 v[208:211], a[88:91], v[148:151], v[208:211]
v_mfma_f32_16x16x32_bf16 v[204:207], a[84:87], v[148:151], v[204:207]
v_mfma_f32_16x16x32_bf16 v[200:203], a[80:83], v[148:151], v[200:203]
v_mfma_f32_16x16x32_bf16 v[196:199], a[76:79], v[148:151], v[196:199]
v_mfma_f32_16x16x32_bf16 v[216:219], a[76:79], v[152:155], v[216:219]
v_mfma_f32_16x16x32_bf16 v[220:223], a[80:83], v[152:155], v[220:223]
v_mfma_f32_16x16x32_bf16 v[224:227], a[84:87], v[152:155], v[224:227]
v_mfma_f32_16x16x32_bf16 v[228:231], a[88:91], v[152:155], v[228:231]
v_mfma_f32_16x16x32_bf16 v[232:235], a[92:95], v[152:155], v[232:235]
v_mfma_f32_16x16x32_bf16 v[252:255], a[92:95], v[156:159], v[252:255]
v_mfma_f32_16x16x32_bf16 v[248:251], a[88:91], v[156:159], v[248:251]
v_mfma_f32_16x16x32_bf16 v[244:247], a[84:87], v[156:159], v[244:247]
v_mfma_f32_16x16x32_bf16 v[240:243], a[80:83], v[156:159], v[240:243]
v_mfma_f32_16x16x32_bf16 v[236:239], a[76:79], v[156:159], v[236:239]
s_waitcnt vmcnt(24)
v_mfma_f32_16x16x32_bf16 v[176:179], a[96:99], v[160:163], v[176:179]
v_mfma_f32_16x16x32_bf16 v[180:183], a[100:103], v[160:163], v[180:183]
v_mfma_f32_16x16x32_bf16 v[184:187], a[104:107], v[160:163], v[184:187]
v_mfma_f32_16x16x32_bf16 v[188:191], a[108:111], v[160:163], v[188:191]
v_mfma_f32_16x16x32_bf16 v[192:195], a[196:199], v[160:163], v[192:195]
v_mfma_f32_16x16x32_bf16 v[212:215], a[196:199], v[164:167], v[212:215]
v_mfma_f32_16x16x32_bf16 v[208:211], a[108:111], v[164:167], v[208:211]
v_mfma_f32_16x16x32_bf16 v[204:207], a[104:107], v[164:167], v[204:207]
v_mfma_f32_16x16x32_bf16 v[200:203], a[100:103], v[164:167], v[200:203]
v_mfma_f32_16x16x32_bf16 v[196:199], a[96:99], v[164:167], v[196:199]
v_mfma_f32_16x16x32_bf16 v[216:219], a[96:99], v[168:171], v[216:219]
v_mfma_f32_16x16x32_bf16 v[220:223], a[100:103], v[168:171], v[220:223]
v_mfma_f32_16x16x32_bf16 v[224:227], a[104:107], v[168:171], v[224:227]
v_mfma_f32_16x16x32_bf16 v[228:231], a[108:111], v[168:171], v[228:231]
v_mfma_f32_16x16x32_bf16 v[232:235], a[196:199], v[168:171], v[232:235]
v_mfma_f32_16x16x32_bf16 v[252:255], a[196:199], v[172:175], v[252:255]
v_mfma_f32_16x16x32_bf16 v[248:251], a[108:111], v[172:175], v[248:251]
v_mfma_f32_16x16x32_bf16 v[244:247], a[104:107], v[172:175], v[244:247]
v_mfma_f32_16x16x32_bf16 v[240:243], a[100:103], v[172:175], v[240:243]
v_mfma_f32_16x16x32_bf16 v[236:239], a[96:99], v[172:175], v[236:239]
s_waitcnt vmcnt(0)
s_barrier
v_mfma_f32_16x16x32_bf16 v[196:199], a[200:203], v[100:103], v[196:199]
v_mfma_f32_16x16x32_bf16 v[200:203], a[204:207], v[100:103], v[200:203]
v_mfma_f32_16x16x32_bf16 v[204:207], a[208:211], v[100:103], v[204:207]
v_mfma_f32_16x16x32_bf16 v[208:211], a[212:215], v[100:103], v[208:211]
v_mfma_f32_16x16x32_bf16 v[212:215], a[216:219], v[100:103], v[212:215]
v_mfma_f32_16x16x32_bf16 v[196:199], a[220:223], v[116:119], v[196:199]
v_mfma_f32_16x16x32_bf16 v[200:203], a[224:227], v[116:119], v[200:203]
v_mfma_f32_16x16x32_bf16 v[204:207], a[228:231], v[116:119], v[204:207]
v_mfma_f32_16x16x32_bf16 v[208:211], a[232:235], v[116:119], v[208:211]
v_mfma_f32_16x16x32_bf16 v[212:215], a[236:239], v[116:119], v[212:215]
buffer_load_dword v84, v93, s[40:43], s79 offen sc1
v_mfma_f32_16x16x32_bf16 v[216:219], a[200:203], v[104:107], v[216:219]
v_mfma_f32_16x16x32_bf16 v[220:223], a[204:207], v[104:107], v[220:223]
v_mfma_f32_16x16x32_bf16 v[224:227], a[208:211], v[104:107], v[224:227]
v_mfma_f32_16x16x32_bf16 v[228:231], a[212:215], v[104:107], v[228:231]
ds_write_b128 v48, v[196:199] offset:0
v_mfma_f32_16x16x32_bf16 v[232:235], a[216:219], v[104:107], v[232:235]
v_mfma_f32_16x16x32_bf16 v[216:219], a[220:223], v[120:123], v[216:219]
ds_write_b128 v48, v[200:203] offset:1024
v_mfma_f32_16x16x32_bf16 v[220:223], a[224:227], v[120:123], v[220:223]
v_mfma_f32_16x16x32_bf16 v[224:227], a[228:231], v[120:123], v[224:227]
ds_write_b128 v48, v[204:207] offset:2048
v_mfma_f32_16x16x32_bf16 v[228:231], a[232:235], v[120:123], v[228:231]
v_mfma_f32_16x16x32_bf16 v[232:235], a[236:239], v[120:123], v[232:235]
v_mfma_f32_16x16x32_bf16 v[236:239], a[200:203], v[108:111], v[236:239]
ds_write_b128 v48, v[208:211] offset:3072
v_mfma_f32_16x16x32_bf16 v[240:243], a[204:207], v[108:111], v[240:243]
v_mfma_f32_16x16x32_bf16 v[244:247], a[208:211], v[108:111], v[244:247]
ds_write_b128 v48, v[212:215] offset:4096
v_mfma_f32_16x16x32_bf16 v[248:251], a[212:215], v[108:111], v[248:251]
ds_write_b128 v49, v[216:219] offset:5120
v_mfma_f32_16x16x32_bf16 v[252:255], a[216:219], v[108:111], v[252:255]
v_mfma_f32_16x16x32_bf16 v[236:239], a[220:223], v[124:127], v[236:239]
ds_write_b128 v49, v[220:223] offset:6144
v_mfma_f32_16x16x32_bf16 v[240:243], a[224:227], v[124:127], v[240:243]
v_mfma_f32_16x16x32_bf16 v[244:247], a[228:231], v[124:127], v[244:247]
ds_write_b128 v49, v[224:227] offset:7168
v_mfma_f32_16x16x32_bf16 v[248:251], a[232:235], v[124:127], v[248:251]
v_mfma_f32_16x16x32_bf16 v[252:255], a[236:239], v[124:127], v[252:255]
v_mfma_f32_16x16x32_bf16 v[176:179], a[200:203], v[96:99], v[176:179]
ds_write_b128 v49, v[228:231] offset:8192
v_mfma_f32_16x16x32_bf16 v[180:183], a[204:207], v[96:99], v[180:183]
v_mfma_f32_16x16x32_bf16 v[184:187], a[208:211], v[96:99], v[184:187]
ds_write_b128 v49, v[232:235] offset:9216
ds_write_b128 v50, v[236:239] offset:10240
v_mfma_f32_16x16x32_bf16 v[188:191], a[212:215], v[96:99], v[188:191]
v_mfma_f32_16x16x32_bf16 v[192:195], a[216:219], v[96:99], v[192:195]
ds_write_b128 v50, v[240:243] offset:11264
v_mfma_f32_16x16x32_bf16 v[176:179], a[220:223], v[112:115], v[176:179]
ds_write_b128 v50, v[244:247] offset:12288
v_mfma_f32_16x16x32_bf16 v[180:183], a[224:227], v[112:115], v[180:183]
v_mfma_f32_16x16x32_bf16 v[184:187], a[228:231], v[112:115], v[184:187]
ds_write_b128 v50, v[248:251] offset:13312
v_mfma_f32_16x16x32_bf16 v[188:191], a[232:235], v[112:115], v[188:191]
v_mfma_f32_16x16x32_bf16 v[192:195], a[236:239], v[112:115], v[192:195]
ds_write_b128 v50, v[252:255] offset:14336
Ltail:
s_mul_i32 s64, s56, -12288
s_add_u32 s64, s64, 49152
s_add_u32 s91, s91, s64
s_mov_b32 s78, 0
s_waitcnt vmcnt(0)
v_cmp_eq_u32 vcc, 0, v84
s_cbranch_vccnz Lo_late
s_add_u32 s64, s91, 0
buffer_load_dwordx4 v[96:99], v6, s[40:43], s64 offen offset:0 sc1
buffer_load_dwordx4 v[100:103], v6, s[40:43], s64 offen offset:1024 sc1
buffer_load_dwordx4 v[104:107], v6, s[40:43], s64 offen offset:2048 sc1
buffer_load_dwordx4 v[108:111], v6, s[40:43], s64 offen offset:3072 sc1
s_add_u32 s64, s91, 4096
buffer_load_dwordx4 v[112:115], v6, s[40:43], s64 offen offset:0 sc1
buffer_load_dwordx4 v[116:119], v6, s[40:43], s64 offen offset:1024 sc1
buffer_load_dwordx4 v[120:123], v6, s[40:43], s64 offen offset:2048 sc1
buffer_load_dwordx4 v[124:127], v6, s[40:43], s64 offen offset:3072 sc1
s_mov_b32 s78, 1
Lo_late:
s_waitcnt lgkmcnt(0)
s_barrier
ds_read_b128 v[196:199], v51 offset:0
ds_read_b128 v[200:203], v51 offset:1024
ds_read_b128 v[204:207], v51 offset:2048
ds_read_b128 v[208:211], v51 offset:3072
ds_read_b128 v[212:215], v51 offset:4096
ds_read_b128 v[216:219], v51 offset:5120
ds_read_b128 v[220:223], v51 offset:6144
ds_read_b128 v[224:227], v51 offset:7168
ds_read_b128 v[228:231], v51 offset:8192
ds_read_b128 v[232:235], v51 offset:9216
ds_read_b128 v[236:239], v51 offset:10240
ds_read_b128 v[240:243], v51 offset:11264
ds_read_b128 v[244:247], v51 offset:12288
ds_read_b128 v[248:251], v51 offset:13312
ds_read_b128 v[252:255], v51 offset:14336
s_waitcnt lgkmcnt(10)
v_pk_add_f32 v[176:177], v[176:177], v[196:197]
ds_read_b128 a[0:3], v20 offset:0
v_pk_add_f32 v[178:179], v[178:179], v[198:199]
v_pk_add_f32 v[180:181], v[180:181], v[200:201]
ds_read_b128 a[4:7], v20 offset:4096
v_pk_add_f32 v[182:183], v[182:183], v[202:203]
v_pk_add_f32 v[184:185], v[184:185], v[204:205]
ds_read_b128 a[8:11], v20 offset:8192
v_pk_add_f32 v[186:187], v[186:187], v[206:207]
v_pk_add_f32 v[188:189], v[188:189], v[208:209]
ds_read_b128 a[12:15], v20 offset:12288
v_pk_add_f32 v[190:191], v[190:191], v[210:211]
v_pk_add_f32 v[192:193], v[192:193], v[212:213]
ds_read_b128 a[16:19], v20 offset:16384
v_pk_add_f32 v[194:195], v[194:195], v[214:215]
s_waitcnt lgkmcnt(10)
v_pk_add_f32 v[176:177], v[176:177], v[216:217]
ds_read_b128 a[20:23], v20 offset:20480
v_pk_add_f32 v[178:179], v[178:179], v[218:219]
v_pk_add_f32 v[180:181], v[180:181], v[220:221]
ds_read_b128 a[24:27], v20 offset:24576
v_pk_add_f32 v[182:183], v[182:183], v[222:223]
v_pk_add_f32 v[184:185], v[184:185], v[224:225]
ds_read_b128 a[28:31], v20 offset:28672
v_pk_add_f32 v[186:187], v[186:187], v[226:227]
v_pk_add_f32 v[188:189], v[188:189], v[228:229]
ds_read_b128 a[32:35], v20 offset:32768
v_pk_add_f32 v[190:191], v[190:191], v[230:231]
v_pk_add_f32 v[192:193], v[192:193], v[232:233]
ds_read_b128 a[36:39], v20 offset:36864
v_pk_add_f32 v[194:195], v[194:195], v[234:235]
s_waitcnt lgkmcnt(10)
v_pk_add_f32 v[176:177], v[176:177], v[236:237]
ds_read_b128 a[40:43], v20 offset:40960
v_pk_add_f32 v[178:179], v[178:179], v[238:239]
v_pk_add_f32 v[180:181], v[180:181], v[240:241]
ds_read_b128 a[44:47], v20 offset:45056
v_pk_add_f32 v[182:183], v[182:183], v[242:243]
v_pk_add_f32 v[184:185], v[184:185], v[244:245]
ds_read_b128 a[48:51], v20 offset:49152
v_pk_add_f32 v[186:187], v[186:187], v[246:247]
v_pk_add_f32 v[188:189], v[188:189], v[248:249]
ds_read_b128 a[52:55], v20 offset:53248
v_pk_add_f32 v[190:191], v[190:191], v[250:251]
v_pk_add_f32 v[192:193], v[192:193], v[252:253]
ds_read_b128 a[56:59], v20 offset:57344
v_pk_add_f32 v[194:195], v[194:195], v[254:255]
s_cmp_eq_u32 s78, 1
s_cbranch_scc1 Lo_have
buffer_load_dword v84, v93, s[40:43], s79 offen sc1
s_waitcnt vmcnt(0)
v_cmp_eq_u32 vcc, 0, v84
s_cbranch_vccz Lok16
s_mov_b32 s85, 40000
Lsp16:
buffer_load_dword v84, v93, s[40:43], s79 offen sc1
s_waitcnt vmcnt(0)
v_cmp_eq_u32 vcc, 0, v84
s_cbranch_vccz Lok16
s_sub_u32 s85, s85, 1
s_cmp_lg_u32 s85, 0
s_cbranch_scc1 Lsp16
Lok16:
s_add_u32 s64, s91, 0
buffer_load_dwordx4 v[96:99], v6, s[40:43], s64 offen offset:0 sc1
buffer_load_dwordx4 v[100:103], v6, s[40:43], s64 offen offset:1024 sc1
buffer_load_dwordx4 v[104:107], v6, s[40:43], s64 offen offset:2048 sc1
buffer_load_dwordx4 v[108:111], v6, s[40:43], s64 offen offset:3072 sc1
s_add_u32 s64, s91, 4096
buffer_load_dwordx4 v[112:115], v6, s[40:43], s64 offen offset:0 sc1
buffer_load_dwordx4 v[116:119], v6, s[40:43], s64 offen offset:1024 sc1
buffer_load_dwordx4 v[120:123], v6, s[40:43], s64 offen offset:2048 sc1
buffer_load_dwordx4 v[124:127], v6, s[40:43], s64 offen offset:3072 sc1
Lo_have:
s_waitcnt vmcnt(7)
s_waitcnt lgkmcnt(10)
v_mfma_f32_16x16x32_bf16 v[176:179], a[0:3], v[96:99], v[176:179]
ds_read_b128 a[60:63], v20 offset:61440
v_mfma_f32_16x16x32_bf16 v[180:183], a[4:7], v[96:99], v[180:183]
ds_read_b128 a[64:67], v94 offset:0
s_add_u32 s64, s91, 8192
v_mfma_f32_16x16x32_bf16 v[184:187], a[8:11], v[96:99], v[184:187]
buffer_load_dwordx4 v[128:131], v6, s[40:43], s64 offen offset:0 sc1
ds_read_b128 a[68:71], v94 offset:4096
v_mfma_f32_16x16x32_bf16 v[188:191], a[12:15], v[96:99], v[188:191]
ds_read_b128 a[72:75], v94 offset:8192
buffer_load_dwordx4 v[132:135], v6, s[40:43], s64 offen offset:1024 sc1
v_mfma_f32_16x16x32_bf16 v[192:195], a[16:19], v[96:99], v[192:195]
ds_read_b128 a[76:79], v94 offset:12288
s_waitcnt vmcnt(8)
s_waitcnt lgkmcnt(10)
v_mfma_f32_16x16x32_bf16 v[176:179], a[20:23], v[100:103], v[176:179]
ds_read_b128 a[80:83], v94 offset:16384
v_mfma_f32_16x16x32_bf16 v[180:183], a[24:27], v[100:103], v[180:183]
ds_read_b128 a[84:87], v94 offset:20480
buffer_load_dwordx4 v[136:139], v6, s[40:43], s64 offen offset:2048 sc1
v_mfma_f32_16x16x32_bf16 v[184:187], a[28:31], v[100:103], v[184:187]
ds_read_b128 a[88:91], v94 offset:24576
v_mfma_f32_16x16x32_bf16 v[188:191], a[32:35], v[100:103], v[188:191]
ds_read_b128 a[92:95], v94 offset:28672
buffer_load_dwordx4 v[140:143], v6, s[40:43], s64 offen offset:3072 sc1
v_mfma_f32_16x16x32_bf16 v[192:195], a[36:39], v[100:103], v[192:195]
ds_read_b128 a[96:99], v94 offset:32768
s_waitcnt vmcnt(9)
s_waitcnt lgkmcnt(10)
v_mfma_f32_16x16x32_bf16 v[176:179], a[40:43], v[104:107], v[176:179]
ds_read_b128 a[100:103], v20 offset:1024
v_mfma_f32_16x16x32_bf16 v[180:183], a[44:47], v[104:107], v[180:183]
ds_read_b128 a[104:107], v20 offset:5120
s_add_u32 s64, s91, 12288
v_mfma_f32_16x16x32_bf16 v[184:187], a[48:51], v[104:107], v[184:187]
buffer_load_dwordx4 v[144:147], v6, s[40:43], s64 offen offset:0 sc1
ds_read_b128 a[108:111], v20 offset:9216
v_mfma_f32_16x16x32_bf16 v[188:191], a[52:55], v[104:107], v[188:191]
ds_read_b128 a[112:115], v20 offset:13312
buffer_load_dwordx4 v[148:151], v6, s[40:43], s64 offen offset:1024 sc1
v_mfma_f32_16x16x32_bf16 v[192:195], a[56:59], v[104:107], v[192:195]
ds_read_b128 a[116:119], v20 offset:17408
s_waitcnt vmcnt(10)
s_waitcnt lgkmcnt(10)
v_mfma_f32_16x16x32_bf16 v[176:179], a[60:63], v[108:111], v[176:179]
ds_read_b128 a[120:123], v20 offset:21504
v_mfma_f32_16x16x32_bf16 v[180:183], a[64:67], v[108:111], v[180:183]
ds_read_b128 a[124:127], v20 offset:25600
buffer_load_dwordx4 v[152:155], v6, s[40:43], s64 offen offset:2048 sc1
v_mfma_f32_16x16x32_bf16 v[184:187], a[68:71], v[108:111], v[184:187]
ds_read_b128 a[128:131], v20 offset:29696
v_mfma_f32_16x16x32_bf16 v[188:191], a[72:75], v[108:111], v[188:191]
ds_read_b128 a[132:135], v20 offset:33792
buffer_load_dwordx4 v[156:159], v6, s[40:43], s64 offen offset:3072 sc1
v_mfma_f32_16x16x32_bf16 v[192:195], a[76:79], v[108:111], v[192:195]
ds_read_b128 a[136:139], v20 offset:37888
s_waitcnt vmcnt(11)
s_waitcnt lgkmcnt(10)
v_mfma_f32_16x16x32_bf16 v[176:179], a[80:83], v[112:115], v[176:179]
ds_read_b128 a[140:143], v20 offset:41984
v_mfma_f32_16x16x32_bf16 v[180:183], a[84:87], v[112:115], v[180:183]
ds_read_b128 a[144:147], v20 offset:46080
s_add_u32 s64, s91, 16384
v_mfma_f32_16x16x32_bf16 v[184:187], a[88:91], v[112:115], v[184:187]
buffer_load_dwordx4 v[160:163], v6, s[40:43], s64 offen offset:0 sc1
ds_read_b128 a[148:151], v20 offset:50176
v_mfma_f32_16x16x32_bf16 v[188:191], a[92:95], v[112:115], v[188:191]
ds_read_b128 a[152:155], v20 offset:54272
buffer_load_dwordx4 v[164:167], v6, s[40:43], s64 offen offset:1024 sc1
v_mfma_f32_16x16x32_bf16 v[192:195], a[96:99], v[112:115], v[192:195]
ds_read_b128 a[156:159], v20 offset:58368
s_waitcnt vmcnt(12)
s_waitcnt lgkmcnt(10)
v_mfma_f32_16x16x32_bf16 v[176:179], a[100:103], v[116:119], v[176:179]
ds_read_b128 a[160:163], v20 offset:62464
v_mfma_f32_16x16x32_bf16 v[180:183], a[104:107], v[116:119], v[180:183]
ds_read_b128 a[164:167], v94 offset:1024
buffer_load_dwordx4 v[168:171], v6, s[40:43], s64 offen offset:2048 sc1
v_mfma_f32_16x16x32_bf16 v[184:187], a[108:111], v[116:119], v[184:187]
ds_read_b128 a[168:171], v94 offset:5120
v_mfma_f32_16x16x32_bf16 v[188:191], a[112:115], v[116:119], v[188:191]
ds_read_b128 a[172:175], v94 offset:9216
buffer_load_dwordx4 v[172:175], v6, s[40:43], s64 offen offset:3072 sc1
v_mfma_f32_16x16x32_bf16 v[192:195], a[116:119], v[116:119], v[192:195]
ds_read_b128 a[176:179], v94 offset:13312
s_waitcnt vmcnt(13)
s_waitcnt lgkmcnt(10)
v_mfma_f32_16x16x32_bf16 v[176:179], a[120:123], v[120:123], v[176:179]
ds_read_b128 a[180:183], v94 offset:17408
v_mfma_f32_16x16x32_bf16 v[180:183], a[124:127], v[120:123], v[180:183]
ds_read_b128 a[184:187], v94 offset:21504
v_mfma_f32_16x16x32_bf16 v[184:187], a[128:131], v[120:123], v[184:187]
ds_read_b128 a[188:191], v94 offset:25600
v_mfma_f32_16x16x32_bf16 v[188:191], a[132:135], v[120:123], v[188:191]
ds_read_b128 a[192:195], v94 offset:29696
v_mfma_f32_16x16x32_bf16 v[192:195], a[136:139], v[120:123], v[192:195]
ds_read_b128 a[196:199], v94 offset:33792
s_waitcnt vmcnt(12)
s_waitcnt lgkmcnt(10)
v_mfma_f32_16x16x32_bf16 v[176:179], a[140:143], v[124:127], v[176:179]
ds_read_b128 a[200:203], v20 offset:2048
v_mfma_f32_16x16x32_bf16 v[180:183], a[144:147], v[124:127], v[180:183]
ds_read_b128 a[204:207], v20 offset:6144
v_mfma_f32_16x16x32_bf16 v[184:187], a[148:151], v[124:127], v[184:187]
ds_read_b128 a[208:211], v20 offset:10240
v_mfma_f32_16x16x32_bf16 v[188:191], a[152:155], v[124:127], v[188:191]
ds_read_b128 a[212:215], v20 offset:14336
v_mfma_f32_16x16x32_bf16 v[192:195], a[156:159], v[124:127], v[192:195]
ds_read_b128 a[216:219], v20 offset:18432
s_waitcnt vmcnt(11)
s_waitcnt lgkmcnt(10)
v_mfma_f32_16x16x32_bf16 v[176:179], a[160:163], v[128:131], v[176:179]
ds_read_b128 a[220:223], v20 offset:22528
v_mfma_f32_16x16x32_bf16 v[180:183], a[164:167], v[128:131], v[180:183]
ds_read_b128 a[224:227], v20 offset:26624
v_mfma_f32_16x16x32_bf16 v[184:187], a[168:171], v[128:131], v[184:187]
ds_read_b128 a[228:231], v20 offset:30720
v_mfma_f32_16x16x32_bf16 v[188:191], a[172:175], v[128:131], v[188:191]
ds_read_b128 a[232:235], v20 offset:34816
v_mfma_f32_16x16x32_bf16 v[192:195], a[176:179], v[128:131], v[192:195]
ds_read_b128 a[236:239], v20 offset:38912
s_waitcnt vmcnt(10)
s_waitcnt lgkmcnt(10)
v_mfma_f32_16x16x32_bf16 v[176:179], a[180:183], v[132:135], v[176:179]
ds_read_b128 a[0:3], v20 offset:43008
v_mfma_f32_16x16x32_bf16 v[180:183], a[184:187], v[132:135], v[180:183]
ds_read_b128 a[4:7], v20 offset:47104
v_mfma_f32_16x16x32_bf16 v[184:187], a[188:191], v[132:135], v[184:187]
ds_read_b128 a[8:11], v20 offset:51200
v_mfma_f32_16x16x32_bf16 v[188:191], a[192:195], v[132:135], v[188:191]
ds_read_b128 a[12:15], v20 offset:55296
v_mfma_f32_16x16x32_bf16 v[192:195], a[196:199], v[132:135], v[192:195]
ds_read_b128 a[16:19], v20 offset:59392
s_waitcnt vmcnt(9)
s_waitcnt lgkmcnt(10)
v_mfma_f32_16x16x32_bf16 v[176:179], a[200:203], v[136:139], v[176:179]
ds_read_b128 a[20:23], v20 offset:63488
v_mfma_f32_16x16x32_bf16 v[180:183], a[204:207], v[136:139], v[180:183]
ds_read_b128 a[24:27], v94 offset:2048
v_mfma_f32_16x16x32_bf16 v[184:187], a[208:211], v[136:139], v[184:187]
ds_read_b128 a[28:31], v94 offset:6144
v_mfma_f32_16x16x32_bf16 v[188:191], a[212:215], v[136:139], v[188:191]
ds_read_b128 a[32:35], v94 offset:10240
v_mfma_f32_16x16x32_bf16 v[192:195], a[216:219], v[136:139], v[192:195]
ds_read_b128 a[36:39], v94 offset:14336
s_waitcnt vmcnt(8)
s_waitcnt lgkmcnt(10)
v_mfma_f32_16x16x32_bf16 v[176:179], a[220:223], v[140:143], v[176:179]
ds_read_b128 a[40:43], v94 offset:18432
v_mfma_f32_16x16x32_bf16 v[180:183], a[224:227], v[140:143], v[180:183]
ds_read_b128 a[44:47], v94 offset:22528
v_mfma_f32_16x16x32_bf16 v[184:187], a[228:231], v[140:143], v[184:187]
ds_read_b128 a[48:51], v94 offset:26624
v_mfma_f32_16x16x32_bf16 v[188:191], a[232:235], v[140:143], v[188:191]
ds_read_b128 a[52:55], v94 offset:30720
v_mfma_f32_16x16x32_bf16 v[192:195], a[236:239], v[140:143], v[192:195]
ds_read_b128 a[56:59], v94 offset:34816
s_waitcnt vmcnt(7)
s_waitcnt lgkmcnt(10)
v_mfma_f32_16x16x32_bf16 v[176:179], a[0:3], v[144:147], v[176:179]
ds_read_b128 a[60:63], v20 offset:3072
v_mfma_f32_16x16x32_bf16 v[180:183], a[4:7], v[144:147], v[180:183]
ds_read_b128 a[64:67], v20 offset:7168
v_mfma_f32_16x16x32_bf16 v[184:187], a[8:11], v[144:147], v[184:187]
ds_read_b128 a[68:71], v20 offset:11264
v_mfma_f32_16x16x32_bf16 v[188:191], a[12:15], v[144:147], v[188:191]
ds_read_b128 a[72:75], v20 offset:15360
v_mfma_f32_16x16x32_bf16 v[192:195], a[16:19], v[144:147], v[192:195]
ds_read_b128 a[76:79], v20 offset:19456
s_waitcnt vmcnt(6)
s_waitcnt lgkmcnt(10)
v_mfma_f32_16x16x32_bf16 v[176:179], a[20:23], v[148:151], v[176:179]
ds_read_b128 a[80:83], v20 offset:23552
v_mfma_f32_16x16x32_bf16 v[180:183], a[24:27], v[148:151], v[180:183]
ds_read_b128 a[84:87], v20 offset:27648
v_mfma_f32_16x16x32_bf16 v[184:187], a[28:31], v[148:151], v[184:187]
ds_read_b128 a[88:91], v20 offset:31744
v_mfma_f32_16x16x32_bf16 v[188:191], a[32:35], v[148:151], v[188:191]
ds_read_b128 a[92:95], v20 offset:35840
v_mfma_f32_16x16x32_bf16 v[192:195], a[36:39], v[148:151], v[192:195]
ds_read_b128 a[96:99], v20 offset:39936
s_waitcnt vmcnt(5)
s_waitcnt lgkmcnt(10)
v_mfma_f32_16x16x32_bf16 v[176:179], a[40:43], v[152:155], v[176:179]
ds_read_b128 a[100:103], v20 offset:44032
v_mfma_f32_16x16x32_bf16 v[180:183], a[44:47], v[152:155], v[180:183]
ds_read_b128 a[104:107], v20 offset:48128
v_mfma_f32_16x16x32_bf16 v[184:187], a[48:51], v[152:155], v[184:187]
ds_read_b128 a[108:111], v20 offset:52224
v_mfma_f32_16x16x32_bf16 v[188:191], a[52:55], v[152:155], v[188:191]
ds_read_b128 a[112:115], v20 offset:56320
v_mfma_f32_16x16x32_bf16 v[192:195], a[56:59], v[152:155], v[192:195]
ds_read_b128 a[116:119], v20 offset:60416
s_waitcnt vmcnt(4)
s_waitcnt lgkmcnt(10)
v_mfma_f32_16x16x32_bf16 v[176:179], a[60:63], v[156:159], v[176:179]
ds_read_b128 a[120:123], v20 offset:64512
v_mfma_f32_16x16x32_bf16 v[180:183], a[64:67], v[156:159], v[180:183]
ds_read_b128 a[124:127], v94 offset:3072
v_mfma_f32_16x16x32_bf16 v[184:187], a[68:71], v[156:159], v[184:187]
ds_read_b128 a[128:131], v94 offset:7168
v_mfma_f32_16x16x32_bf16 v[188:191], a[72:75], v[156:159], v[188:191]
ds_read_b128 a[132:135], v94 offset:11264
v_mfma_f32_16x16x32_bf16 v[192:195], a[76:79], v[156:159], v[192:195]
ds_read_b128 a[136:139], v94 offset:15360
s_waitcnt vmcnt(3)
s_waitcnt lgkmcnt(10)
v_mfma_f32_16x16x32_bf16 v[176:179], a[80:83], v[160:163], v[176:179]
ds_read_b128 a[140:143], v94 offset:19456
v_mfma_f32_16x16x32_bf16 v[180:183], a[84:87], v[160:163], v[180:183]
ds_read_b128 a[144:147], v94 offset:23552
v_mfma_f32_16x16x32_bf16 v[184:187], a[88:91], v[160:163], v[184:187]
ds_read_b128 a[148:151], v94 offset:27648
v_mfma_f32_16x16x32_bf16 v[188:191], a[92:95], v[160:163], v[188:191]
ds_read_b128 a[152:155], v94 offset:31744
v_mfma_f32_16x16x32_bf16 v[192:195], a[96:99], v[160:163], v[192:195]
ds_read_b128 a[156:159], v94 offset:35840
s_waitcnt vmcnt(2)
s_waitcnt lgkmcnt(10)
v_mfma_f32_16x16x32_bf16 v[176:179], a[100:103], v[164:167], v[176:179]
v_mfma_f32_16x16x32_bf16 v[180:183], a[104:107], v[164:167], v[180:183]
v_mfma_f32_16x16x32_bf16 v[184:187], a[108:111], v[164:167], v[184:187]
v_mfma_f32_16x16x32_bf16 v[188:191], a[112:115], v[164:167], v[188:191]
v_mfma_f32_16x16x32_bf16 v[192:195], a[116:119], v[164:167], v[192:195]
s_waitcnt vmcnt(1)
s_waitcnt lgkmcnt(5)
v_mfma_f32_16x16x32_bf16 v[176:179], a[120:123], v[168:171], v[176:179]
v_mfma_f32_16x16x32_bf16 v[180:183], a[124:127], v[168:171], v[180:183]
v_mfma_f32_16x16x32_bf16 v[184:187], a[128:131], v[168:171], v[184:187]
v_mfma_f32_16x16x32_bf16 v[188:191], a[132:135], v[168:171], v[188:191]
v_mfma_f32_16x16x32_bf16 v[192:195], a[136:139], v[168:171], v[192:195]
s_waitcnt vmcnt(0)
s_waitcnt lgkmcnt(0)
v_mfma_f32_16x16x32_bf16 v[176:179], a[140:143], v[172:175], v[176:179]
v_mfma_f32_16x16x32_bf16 v[180:183], a[144:147], v[172:175], v[180:183]
v_mfma_f32_16x16x32_bf16 v[184:187], a[148:151], v[172:175], v[184:187]
v_mfma_f32_16x16x32_bf16 v[188:191], a[152:155], v[172:175], v[188:191]
v_mfma_f32_16x16x32_bf16 v[192:195], a[156:159], v[172:175], v[192:195]
s_nop 3
ds_write_b128 v52, v[176:179] offset:0
ds_write_b128 v52, v[180:183] offset:64
ds_write_b128 v52, v[184:187] offset:128
ds_write_b128 v52, v[188:191] offset:192
ds_write_b128 v52, v[192:195] offset:256
s_waitcnt lgkmcnt(0)
ds_read_b64 v[96:97], v68 offset:0
ds_read_b64 v[98:99], v68 offset:16
ds_read_b64 v[100:101], v68 offset:32
ds_read_b64 v[102:103], v68 offset:48
ds_read_b64 v[104:105], v69 offset:0
ds_read_b64 v[106:107], v69 offset:16
ds_read_b64 v[108:109], v69 offset:32
ds_read_b64 v[110:111], v69 offset:48
ds_read_b64 v[112:113], v70 offset:0
ds_read_b64 v[114:115], v70 offset:16
ds_read_b64 v[116:117], v70 offset:32
ds_read_b64 v[118:119], v70 offset:48
v_lshlrev_b32_e64 v120, 16, v56
v_and_b32 v121, 0xffff0000, v56
v_lshlrev_b32_e64 v122, 16, v57
v_and_b32 v123, 0xffff0000, v57
v_lshlrev_b32_e64 v124, 16, v58
v_and_b32 v125, 0xffff0000, v58
v_lshlrev_b32_e64 v126, 16, v59
v_and_b32 v127, 0xffff0000, v59
s_waitcnt lgkmcnt(8)
v_add_f32 v120, v120, v96
v_add_f32 v121, v121, v98
v_add_f32 v122, v122, v100
v_add_f32 v123, v123, v102
v_add_f32 v124, v124, v97
v_add_f32 v125, v125, v99
v_add_f32 v126, v126, v101
v_add_f32_e64 v127, v127, v103
v_cvt_pk_bf16_f32 v56, v120, v121
v_cvt_pk_bf16_f32 v57, v122, v123
v_cvt_pk_bf16_f32 v58, v124, v125
v_cvt_pk_bf16_f32 v59, v126, v127
buffer_store_dwordx4 v[56:59], v53, s[44:47], s76 offen
v_lshlrev_b32_e64 v120, 16, v60
v_and_b32 v121, 0xffff0000, v60
v_lshlrev_b32_e64 v122, 16, v61
v_and_b32 v123, 0xffff0000, v61
v_lshlrev_b32_e64 v124, 16, v62
v_and_b32 v125, 0xffff0000, v62
v_lshlrev_b32_e64 v126, 16, v63
v_and_b32 v127, 0xffff0000, v63
s_waitcnt lgkmcnt(4)
v_add_f32 v120, v120, v104
v_add_f32 v121, v121, v106
v_add_f32 v122, v122, v108
v_add_f32 v123, v123, v110
v_add_f32 v124, v124, v105
v_add_f32 v125, v125, v107
v_add_f32 v126, v126, v109
v_add_f32_e64 v127, v127, v111
v_cvt_pk_bf16_f32 v60, v120, v121
v_cvt_pk_bf16_f32 v61, v122, v123
v_cvt_pk_bf16_f32 v62, v124, v125
v_cvt_pk_bf16_f32 v63, v126, v127
buffer_store_dwordx4 v[60:63], v54, s[44:47], s76 offen
v_lshlrev_b32_e64 v120, 16, v64
v_and_b32 v121, 0xffff0000, v64
v_lshlrev_b32_e64 v122, 16, v65
v_and_b32 v123, 0xffff0000, v65
v_lshlrev_b32_e64 v124, 16, v66
v_and_b32 v125, 0xffff0000, v66
v_lshlrev_b32_e64 v126, 16, v67
v_and_b32 v127, 0xffff0000, v67
s_waitcnt lgkmcnt(0)
v_add_f32 v120, v120, v112
v_add_f32 v121, v121, v114
v_add_f32 v122, v122, v116
v_add_f32 v123, v123, v118
v_add_f32 v124, v124, v113
v_add_f32 v125, v125, v115
v_add_f32 v126, v126, v117
v_add_f32_e64 v127, v127, v119
v_cvt_pk_bf16_f32 v64, v120, v121
v_cvt_pk_bf16_f32 v65, v122, v123
v_cvt_pk_bf16_f32 v66, v124, v125
v_cvt_pk_bf16_f32 v67, v126, v127
buffer_store_dwordx4 v[64:67], v55, s[44:47], s76 offen
Lfin:
Lend:
s_endpgm
.fill 64, 4, 0xBF800000
.section .rodata,"a"
.p2align 6
.amdhsa_kernel parallel_sum__linear_kernel_hedgehog__glu_gated_swiglu__prompt_kernel
  .amdhsa_next_free_vgpr 512
  .amdhsa_next_free_sgpr 102
  .amdhsa_accum_offset 256
  .amdhsa_group_segment_fixed_size 0
  .amdhsa_kernarg_size 88
  .amdhsa_user_sgpr_count 2
  .amdhsa_user_sgpr_kernarg_segment_ptr 1
  .amdhsa_system_sgpr_workgroup_id_x 1
.end_amdhsa_kernel
```
